```python
import torch

def _softmax(x, axis=-1):
    return torch.softmax(x, dim=axis)
def _gelu(x):
    return torch.nn.functional.gelu(x, approximate="tanh")
def _silu(x):
    return torch.nn.functional.silu(x)
def _sigmoid(x):
    return torch.sigmoid(x)
def _layernorm(x, axis=-1, eps=1e-5):
    m = x.mean(dim=axis, keepdim=True)
    v = x.var(dim=axis, keepdim=True, unbiased=False)
    return (x - m) / torch.sqrt(v + eps)
def _scatter_add(tgt, idx, src, axis=0):
    return tgt.clone().index_add_(axis, idx, src)
def _segment_sum(src, seg, n):
    out = torch.zeros((n,) + src.shape[1:], dtype=src.dtype)
    return out.index_add_(0, seg, src)
def _pad(x, pw):
    flat = tuple(v for pair in reversed(pw) for v in pair)
    return torch.nn.functional.pad(x, flat)

kernel_name = 'sequential_preLN__spectral_gfnet__geglu_ffn__prompt'

def setup_inputs():

    _w = (lambda a: (lambda t: t.to(torch.bfloat16) if t.is_floating_point() else t)(torch.as_tensor(a)))
    def _A_setup():
        B, S, D = 1, 2048, 576
        Df = D // 2 + 1
        return {
            "x": _w((lambda *s: torch.randn(*s, dtype=torch.bfloat16) * 0.05)(B, S, D)),
            "w_r": _w((lambda *s: torch.randn(*s, dtype=torch.bfloat16) * 0.4)(S, Df) * 0.02),
            "w_i": _w((lambda *s: torch.randn(*s, dtype=torch.bfloat16) * 0.4)(S, Df) * 0.02),
        }
    _A_in = _A_setup()

    def _B_setup():
        B, S, D, F = 1, 2048, 576, 4608
        return {
            "x": _w((lambda *s: torch.randn(*s, dtype=torch.bfloat16) * 0.05)(B, S, D)),
            "w_gate": _w((lambda *s: torch.randn(*s, dtype=torch.bfloat16) * 0.05)(D, F)),
            "w_up": _w((lambda *s: torch.randn(*s, dtype=torch.bfloat16) * 0.05)(D, F)),
            "w_down": _w((lambda *s: torch.randn(*s, dtype=torch.bfloat16) * 0.05)(F, D)),
        }
    _B_in = _B_setup()

    return {
        "A_x": _A_in["x"],
        "A_w_r": _A_in["w_r"],
        "A_w_i": _A_in["w_i"],
        "B_x": _B_in["x"],
        "B_w_gate": _B_in["w_gate"],
        "B_w_up": _B_in["w_up"],
        "B_w_down": _B_in["w_down"],
    }

def reference(A_x, A_w_r, A_w_i, B_x, B_w_gate, B_w_up, B_w_down):
    def _A_ref(x, w_r, w_i):
        B, S, D = x.shape
        X = (lambda x, axes=(-2,-1): torch.fft.rfft2(x.float(), dim=axes))(x, axes=(-2, -1))
        W = w_r + 1j * w_i
        X = X * W
        y = (lambda x, s, axes=(-2,-1): torch.fft.irfft2(x, s=s, dim=axes).to(torch.bfloat16))(X, (S, D), axes=(-2, -1))
        return y

    def _B_ref(x, w_gate, w_up, w_down):
        return (_gelu(x @ w_gate) * (x @ w_up)) @ w_down

    x = A_x
    h = x + _A_ref(_layernorm(x, axis=-1), A_w_r, A_w_i)
    h2 = h + _B_ref(_layernorm(h, axis=-1), B_w_gate, B_w_up, B_w_down)
    return h2
```

```asm
; @launch grid=(256,1,1) block=(256,1,1) lds=161344
.amdgcn_target "amdgcn-amd-amdhsa--gfx950"
.text
.globl sequential_preLN__spectral_gfnet__geglu_ffn__prompt_kernel
.p2align 8
.type sequential_preLN__spectral_gfnet__geglu_ffn__prompt_kernel,@function
sequential_preLN__spectral_gfnet__geglu_ffn__prompt_kernel:

  s_cmp_ge_u32 s2, 256
  s_cbranch_scc1 L_end
  s_getpc_b64 s[44:45]
L_pc:
  s_load_dwordx2 s[4:5], s[0:1], 0
  s_load_dwordx4 s[48:51], s[0:1], 8
  s_load_dwordx4 s[36:39], s[0:1], 64
  v_lshrrev_b32 v8, 6, v0
  v_and_b32 v9, 63, v0
  v_readfirstlane_b32 s16, v8
  v_lshlrev_b32 v250, 6, v9
  s_cmp_ge_u32 s2, 64
  s_cbranch_scc1 L_fftwg
  s_mov_b32 s46, L_codeend - L_pc
  s_mov_b32 s47, 0x20000
  s_lshl_b32 s23, s16, 13
  v_lshl_add_u32 v11, v9, 7, s23
  buffer_load_dword v254, v11, s[44:47], 0 offen
  s_branch L_pure
L_fftwg:
  v_mov_b32 v10, 161280
  v_mov_b32 v12, 0
  v_mov_b32 v13, 0
  v_mov_b32 v14, 0
  v_mov_b32 v15, 0
  ds_write_b128 v10, v[12:15]
  s_and_b32 s33, s2, 7
  s_lshr_b32 s34, s2, 3
  s_sub_u32 s34, s34, 8
  s_cmp_eq_u32 s16, 3
  s_cbranch_scc1 L_he
  s_mul_i32 s17, s34, 43
  s_lshr_b32 s17, s17, 7
  s_mul_i32 s18, s17, 3
  s_sub_u32 s18, s34, s18
  s_lshl_b32 s23, s33, 3
  s_add_u32 s17, s17, s23
  v_and_b32 v1, 31, v9
  v_lshrrev_b32 v2, 5, v9
  v_lshrrev_b32 v3, 2, v1
  s_mov_b32 s23, 73728
  v_mul_lo_u32 v4, v3, s23
  v_and_b32 v5, 3, v9
  v_lshl_add_u32 v4, v5, 4, v4
  v_lshl_add_u32 v4, v2, 6, v4
  s_mul_i32 s20, s17, 1152
  s_mul_i32 s23, s16, 384
  s_add_u32 s25, s20, s23
  s_mov_b32 s10, 2359296
  s_mov_b32 s11, 0x20000
  s_mul_i32 s24, s16, 12288
  s_waitcnt lgkmcnt(0)
  s_mov_b32 s8, s4
  s_mov_b32 s9, s5
  s_add_u32 m0, s24, 0
  s_add_u32 s23, s25, 0
  buffer_load_dwordx4 v4, s[8:11], s23 offen nt lds
  s_add_u32 m0, s24, 4096
  s_add_u32 s23, s25, 128
  buffer_load_dwordx4 v4, s[8:11], s23 offen nt lds
  s_add_u32 m0, s24, 8192
  s_add_u32 s23, s25, 256
  buffer_load_dwordx4 v4, s[8:11], s23 offen nt lds
  s_add_u32 m0, s24, 1024
  s_add_u32 s23, s25, 589824
  buffer_load_dwordx4 v4, s[8:11], s23 offen nt lds
  s_add_u32 m0, s24, 5120
  s_add_u32 s23, s25, 589952
  buffer_load_dwordx4 v4, s[8:11], s23 offen nt lds
  s_add_u32 m0, s24, 9216
  s_add_u32 s23, s25, 590080
  buffer_load_dwordx4 v4, s[8:11], s23 offen nt lds
  s_add_u32 m0, s24, 2048
  s_add_u32 s23, s25, 1179648
  buffer_load_dwordx4 v4, s[8:11], s23 offen nt lds
  s_add_u32 m0, s24, 6144
  s_add_u32 s23, s25, 1179776
  buffer_load_dwordx4 v4, s[8:11], s23 offen nt lds
  s_add_u32 m0, s24, 10240
  s_add_u32 s23, s25, 1179904
  buffer_load_dwordx4 v4, s[8:11], s23 offen nt lds
  s_add_u32 m0, s24, 3072
  s_add_u32 s23, s25, 1769472
  buffer_load_dwordx4 v4, s[8:11], s23 offen nt lds
  s_add_u32 m0, s24, 7168
  s_add_u32 s23, s25, 1769600
  buffer_load_dwordx4 v4, s[8:11], s23 offen nt lds
  s_add_u32 m0, s24, 11264
  s_add_u32 s23, s25, 1769728
  buffer_load_dwordx4 v4, s[8:11], s23 offen nt lds
  s_branch L_p1
L_he:
  s_waitcnt lgkmcnt(0)
  s_branch L_help
L_pure:
  s_add_u32 s23, s2, s16
  s_cmp_lg_u32 s23, 0
  s_cbranch_scc1 L_notok
  s_memrealtime s[40:41]
  v_lshlrev_b32 v2, 7, v9
  v_add_u32 v2, 49807360, v2
  v_mov_b32 v3, 0
  s_waitcnt lgkmcnt(0)
  s_or_b32 s40, s40, 1
  v_mov_b32 v4, s40
  v_mov_b32 v5, s41
  s_mov_b64 exec, 1
  global_store_dwordx2 v3, v[4:5], s[36:37] sc1
  s_mov_b64 exec, 0xffff
  global_store_dword v2, v3, s[38:39] sc1
  s_mov_b64 exec, -1
L_notok:
  s_mov_b32 s58, 0
  v_bfrev_b32 v255, 1
  s_waitcnt lgkmcnt(0)
  s_mov_b32 s12, s38
  s_mov_b32 s13, s39
  s_mov_b32 s14, 268435456
  s_mov_b32 s15, 0x20000
  s_mov_b32 s38, 256
  s_mov_b32 s39, 0x20000
  v_min_u32 v251, 1, v9
  v_lshlrev_b32 v251, 31, v251
  s_lshl_b32 s17, s2, 2
  s_add_u32 s17, s17, s16
  v_lshlrev_b32 v1, 4, v9
  v_mov_b32 v12, -1
  v_mov_b32 v13, -1
  v_mov_b32 v14, -1
  v_mov_b32 v15, -1
  s_lshl_b32 s27, s2, 6
  s_add_u32 s27, s27, 48373760
  s_cmp_eq_u32 s16, 0
  s_cselect_b32 s23, 0, 0x80000000
  v_or_b32 v5, s23, v251
  s_mul_i32 s26, s17, 9216
  s_add_u32 s25, s26, 2359296
  buffer_load_dwordx2 v[252:253], off, s[36:39], 0 offset:0 sc1
  s_waitcnt vmcnt(0)
  v_readfirstlane_b32 s56, v252
  v_readfirstlane_b32 s57, v253
  s_nop 1
  s_cmp_lg_u32 s56, 0
  s_cbranch_scc1 L_ok27
  s_mov_b32 s59, 50000
L_lp28:
  s_sleep 4
  buffer_load_dwordx2 v[252:253], off, s[36:39], 0 offset:0 sc1
  s_waitcnt vmcnt(0)
  s_sub_u32 s59, s59, 1
  s_cbranch_scc1 L_ok27
  v_readfirstlane_b32 s56, v252
  v_readfirstlane_b32 s57, v253
  s_nop 1
  s_cmp_lg_u32 s56, 0
  s_cbranch_scc0 L_lp28
L_ok27:
  buffer_store_dwordx4 v[12:15], v1, s[12:15], s25 offen offset:0 sc1
  buffer_store_dwordx4 v[12:15], v1, s[12:15], s25 offen offset:1024 sc1
  buffer_store_dwordx4 v[12:15], v1, s[12:15], s25 offen offset:2048 sc1
  buffer_store_dwordx4 v[12:15], v1, s[12:15], s25 offen offset:3072 sc1
  s_add_u32 s25, s25, 4096
  buffer_store_dwordx4 v[12:15], v1, s[12:15], s25 offen offset:0 sc1
  buffer_store_dwordx4 v[12:15], v1, s[12:15], s25 offen offset:1024 sc1
  buffer_store_dwordx4 v[12:15], v1, s[12:15], s25 offen offset:2048 sc1
  buffer_store_dwordx4 v[12:15], v1, s[12:15], s25 offen offset:3072 sc1
  s_add_u32 s25, s25, 4096
  buffer_store_dwordx4 v[12:15], v1, s[12:15], s25 offen offset:0 sc1
  s_add_u32 s25, s26, 4718592
  buffer_store_dwordx4 v[12:15], v1, s[12:15], s25 offen offset:0 sc1
  buffer_store_dwordx4 v[12:15], v1, s[12:15], s25 offen offset:1024 sc1
  buffer_store_dwordx4 v[12:15], v1, s[12:15], s25 offen offset:2048 sc1
  buffer_store_dwordx4 v[12:15], v1, s[12:15], s25 offen offset:3072 sc1
  s_add_u32 s25, s25, 4096
  buffer_store_dwordx4 v[12:15], v1, s[12:15], s25 offen offset:0 sc1
  buffer_store_dwordx4 v[12:15], v1, s[12:15], s25 offen offset:1024 sc1
  buffer_store_dwordx4 v[12:15], v1, s[12:15], s25 offen offset:2048 sc1
  buffer_store_dwordx4 v[12:15], v1, s[12:15], s25 offen offset:3072 sc1
  s_add_u32 s25, s25, 4096
  buffer_store_dwordx4 v[12:15], v1, s[12:15], s25 offen offset:0 sc1
  s_waitcnt vmcnt(0)
  s_barrier
  s_add_u32 s23, s27, 0
  buffer_store_dwordx2 v[252:253], v5, s[12:15], s23 offen sc1
  v_add_u32 v11, 32768, v11
  buffer_load_dword v254, v11, s[44:47], 0 offen
  v_add_u32 v11, 32768, v11
  buffer_load_dword v254, v11, s[44:47], 0 offen
  s_load_dwordx4 s[4:7], s[0:1], 32
  s_load_dwordx2 s[8:9], s[0:1], 48
  s_mul_i32 s23, s17, 20736
  v_mul_u32_u24 v2, 128, v9
  v_add_u32 v2, s23, v2
  s_waitcnt lgkmcnt(0)
  s_mov_b32 s40, s4
  s_mov_b32 s41, s5
  s_mov_b32 s42, 5308416
  s_mov_b32 s43, 0x20000
  s_mov_b32 s44, s6
  s_mov_b32 s45, s7
  s_mov_b32 s46, 5308416
  s_mov_b32 s47, 0x20000
  s_mov_b32 s48, s8
  s_mov_b32 s49, s9
  s_mov_b32 s50, 5308416
  s_mov_b32 s51, 0x20000
  v_add_u32 v3, 0, v2
  buffer_load_dword v254, v3, s[40:43], 0 offen
  v_add_u32 v3, 8192, v2
  buffer_load_dword v254, v3, s[40:43], 0 offen
  s_cmp_lg_u32 s16, 3
  s_cbranch_scc1 L_ntk
  s_mov_b32 s23, 48373760
  s_mov_b64 s[20:21], 1
  s_mov_b64 exec, s[20:21]
  buffer_load_dwordx2 v[248:249], v250, s[12:15], s23 offen sc1
  s_mov_b64 exec, -1
  s_waitcnt vmcnt(0)
  v_cmp_eq_u64 vcc, s[56:57], v[248:249]
  s_nop 1
  s_orn2_b64 vcc, vcc, s[20:21]
  s_cmp_eq_u64 vcc, -1
  s_cbranch_scc0 L_lp30s
L_ok29:
  s_getreg_b32 s30, hwreg(HW_REG_XCC_ID)
  s_mov_b32 s28, 7
L_tk31:
  s_and_b32 s30, s30, 7
  s_lshl_b32 s31, s30, 7
  s_add_u32 s31, s31, 49808384
  s_mov_b32 s35, 1
  s_atomic_add s35, s[12:13], s31 glc
  s_waitcnt lgkmcnt(0)
  s_add_u32 s30, s30, 1
  s_cmp_lt_u32 s35, 8
  s_cbranch_scc1 L_tk31x
  s_sub_u32 s28, s28, 1
  s_cbranch_scc0 L_tk31
  s_lshr_b32 s35, s2, 3
  s_and_b32 s30, s2, 7
  s_add_u32 s30, s30, 1
L_tk31x:
  s_sub_u32 s30, s30, 1
  s_add_u32 s35, s35, 0
  s_lshl_b32 s35, s35, 3
  s_add_u32 s35, s35, s30
  v_mov_b32 v10, 161296
  v_mov_b32 v11, s35
  ds_write_b32 v10, v11
  s_waitcnt lgkmcnt(0)
L_ntk:
  v_add_u32 v3, 16384, v2
  s_bfm_b64 exec, 34, 0
  buffer_load_dword v254, v3, s[40:43], 0 offen
  s_mov_b64 exec, -1
  v_add_u32 v3, 0, v2
  buffer_load_dword v254, v3, s[44:47], 0 offen
  v_add_u32 v3, 8192, v2
  buffer_load_dword v254, v3, s[44:47], 0 offen
  v_add_u32 v3, 16384, v2
  s_bfm_b64 exec, 34, 0
  buffer_load_dword v254, v3, s[44:47], 0 offen
  s_mov_b64 exec, -1
  s_barrier
  v_mov_b32 v2, 161296
  ds_read_b32 v2, v2
  s_waitcnt lgkmcnt(0)
  v_readfirstlane_b32 s35, v2
  s_nop 1
  s_branch L_ffn
.p2align 12
L_p1:
  s_mul_i32 s19, s18, 3
  s_add_u32 s19, s19, s16
  s_add_u32 s23, s16, 0
  s_cmp_ge_u32 s23, 3
  s_cselect_b32 s24, 3, 0
  s_sub_u32 s28, s23, s24
  s_add_u32 s23, s16, 1
  s_cmp_ge_u32 s23, 3
  s_cselect_b32 s24, 3, 0
  s_sub_u32 s29, s23, s24
  s_add_u32 s23, s16, 2
  s_cmp_ge_u32 s23, 3
  s_cselect_b32 s24, 3, 0
  s_sub_u32 s30, s23, s24
  s_waitcnt lgkmcnt(0)
  s_mov_b32 s12, s38
  s_mov_b32 s13, s39
  s_mov_b32 s14, 268435456
  s_mov_b32 s15, 0x20000
  s_mov_b32 s38, 256
  s_mov_b32 s39, 0x20000
  v_min_u32 v251, 1, v9
  v_lshlrev_b32 v251, 31, v251
  v_lshlrev_b32 v247, 4, v9
  s_lshl_b32 s23, s19, 5
  s_add_u32 s23, s23, 1
  v_add_u32 v6, s23, v1
  v_cvt_f32_u32 v6, v6
  v_mul_f32 v7, 0x3ae38e39, v6
  v_mul_f32 v10, 0x3d638e39, v6
  v_cvt_f32_u32 v11, v2
  v_mul_f32 v12, 0x3f000000, v7
  v_cos_f32 v136, v12
  v_sin_f32 v137, v12
  v_mul_f32 v12, 0x3fc00000, v7
  v_cos_f32 v138, v12
  v_sin_f32 v139, v12
  v_mul_f32 v12, 0x40200000, v7
  v_cos_f32 v140, v12
  v_sin_f32 v141, v12
  v_mul_f32 v12, 0x40600000, v7
  v_cos_f32 v142, v12
  v_sin_f32 v143, v12
  v_mul_f32 v7, 0x40600000, v7
  v_mul_f32 v136, 0x24000000, v136
  v_mul_f32 v137, 0x24000000, v137
  v_mul_f32 v138, 0x24000000, v138
  v_mul_f32 v139, 0x24000000, v139
  v_mul_f32 v140, 0x24000000, v140
  v_mul_f32 v141, 0x24000000, v141
  v_mul_f32 v142, 0x24000000, v142
  v_mul_f32 v143, 0x24000000, v143
  v_add_f32 v12, 0x00000000, v11
  v_mul_f32 v12, v12, v10
  v_fract_f32 v12, v12
  v_add_f32 v12, v12, v7
  v_cos_f32 v14, v12
  v_sin_f32 v15, v12
  s_nop 0
  v_pk_mul_f32 v[160:161], v[136:137], v[14:15] op_sel:[0,0] op_sel_hi:[0,1]
  v_pk_mul_f32 v[162:163], v[138:139], v[14:15] op_sel:[0,0] op_sel_hi:[0,1]
  v_pk_mul_f32 v[164:165], v[140:141], v[14:15] op_sel:[0,0] op_sel_hi:[0,1]
  v_pk_mul_f32 v[166:167], v[142:143], v[14:15] op_sel:[0,0] op_sel_hi:[0,1]
  v_pk_fma_f32 v[158:159], v[136:137], v[14:15], v[160:161] op_sel:[1,1,0] op_sel_hi:[1,0,1] neg_hi:[1,0,0]
  v_pk_fma_f32 v[156:157], v[138:139], v[14:15], v[162:163] op_sel:[1,1,0] op_sel_hi:[1,0,1] neg_hi:[1,0,0]
  v_pk_fma_f32 v[154:155], v[140:141], v[14:15], v[164:165] op_sel:[1,1,0] op_sel_hi:[1,0,1] neg_hi:[1,0,0]
  v_pk_fma_f32 v[152:153], v[142:143], v[14:15], v[166:167] op_sel:[1,1,0] op_sel_hi:[1,0,1] neg_hi:[1,0,0]
  v_pk_fma_f32 v[160:161], v[136:137], v[14:15], v[160:161] op_sel:[1,1,0] op_sel_hi:[1,0,1] neg_lo:[1,0,0]
  v_pk_fma_f32 v[162:163], v[138:139], v[14:15], v[162:163] op_sel:[1,1,0] op_sel_hi:[1,0,1] neg_lo:[1,0,0]
  v_pk_fma_f32 v[164:165], v[140:141], v[14:15], v[164:165] op_sel:[1,1,0] op_sel_hi:[1,0,1] neg_lo:[1,0,0]
  v_pk_fma_f32 v[166:167], v[142:143], v[14:15], v[166:167] op_sel:[1,1,0] op_sel_hi:[1,0,1] neg_lo:[1,0,0]
  v_cvt_pk_bf16_f32 v64, v152, v154
  v_cvt_pk_bf16_f32 v68, -v153, -v155
  v_cvt_pk_bf16_f32 v65, v156, v158
  v_cvt_pk_bf16_f32 v69, -v157, -v159
  v_cvt_pk_bf16_f32 v66, v160, v162
  v_cvt_pk_bf16_f32 v70, -v161, -v163
  v_cvt_pk_bf16_f32 v67, v164, v166
  v_cvt_pk_bf16_f32 v71, -v165, -v167
  v_add_f32 v12, 0x40000000, v11
  v_mul_f32 v12, v12, v10
  v_fract_f32 v12, v12
  v_add_f32 v12, v12, v7
  v_cos_f32 v14, v12
  v_sin_f32 v15, v12
  s_nop 0
  v_pk_mul_f32 v[160:161], v[136:137], v[14:15] op_sel:[0,0] op_sel_hi:[0,1]
  v_pk_mul_f32 v[162:163], v[138:139], v[14:15] op_sel:[0,0] op_sel_hi:[0,1]
  v_pk_mul_f32 v[164:165], v[140:141], v[14:15] op_sel:[0,0] op_sel_hi:[0,1]
  v_pk_mul_f32 v[166:167], v[142:143], v[14:15] op_sel:[0,0] op_sel_hi:[0,1]
  v_pk_fma_f32 v[158:159], v[136:137], v[14:15], v[160:161] op_sel:[1,1,0] op_sel_hi:[1,0,1] neg_hi:[1,0,0]
  v_pk_fma_f32 v[156:157], v[138:139], v[14:15], v[162:163] op_sel:[1,1,0] op_sel_hi:[1,0,1] neg_hi:[1,0,0]
  v_pk_fma_f32 v[154:155], v[140:141], v[14:15], v[164:165] op_sel:[1,1,0] op_sel_hi:[1,0,1] neg_hi:[1,0,0]
  v_pk_fma_f32 v[152:153], v[142:143], v[14:15], v[166:167] op_sel:[1,1,0] op_sel_hi:[1,0,1] neg_hi:[1,0,0]
  v_pk_fma_f32 v[160:161], v[136:137], v[14:15], v[160:161] op_sel:[1,1,0] op_sel_hi:[1,0,1] neg_lo:[1,0,0]
  v_pk_fma_f32 v[162:163], v[138:139], v[14:15], v[162:163] op_sel:[1,1,0] op_sel_hi:[1,0,1] neg_lo:[1,0,0]
  v_pk_fma_f32 v[164:165], v[140:141], v[14:15], v[164:165] op_sel:[1,1,0] op_sel_hi:[1,0,1] neg_lo:[1,0,0]
  v_pk_fma_f32 v[166:167], v[142:143], v[14:15], v[166:167] op_sel:[1,1,0] op_sel_hi:[1,0,1] neg_lo:[1,0,0]
  v_cvt_pk_bf16_f32 v72, v152, v154
  v_cvt_pk_bf16_f32 v76, -v153, -v155
  v_cvt_pk_bf16_f32 v73, v156, v158
  v_cvt_pk_bf16_f32 v77, -v157, -v159
  v_cvt_pk_bf16_f32 v74, v160, v162
  v_cvt_pk_bf16_f32 v78, -v161, -v163
  v_cvt_pk_bf16_f32 v75, v164, v166
  v_cvt_pk_bf16_f32 v79, -v165, -v167
  v_add_f32 v12, 0x40800000, v11
  v_mul_f32 v12, v12, v10
  v_fract_f32 v12, v12
  v_add_f32 v12, v12, v7
  v_cos_f32 v14, v12
  v_sin_f32 v15, v12
  s_nop 0
  v_pk_mul_f32 v[160:161], v[136:137], v[14:15] op_sel:[0,0] op_sel_hi:[0,1]
  v_pk_mul_f32 v[162:163], v[138:139], v[14:15] op_sel:[0,0] op_sel_hi:[0,1]
  v_pk_mul_f32 v[164:165], v[140:141], v[14:15] op_sel:[0,0] op_sel_hi:[0,1]
  v_pk_mul_f32 v[166:167], v[142:143], v[14:15] op_sel:[0,0] op_sel_hi:[0,1]
  v_pk_fma_f32 v[158:159], v[136:137], v[14:15], v[160:161] op_sel:[1,1,0] op_sel_hi:[1,0,1] neg_hi:[1,0,0]
  v_pk_fma_f32 v[156:157], v[138:139], v[14:15], v[162:163] op_sel:[1,1,0] op_sel_hi:[1,0,1] neg_hi:[1,0,0]
  v_pk_fma_f32 v[154:155], v[140:141], v[14:15], v[164:165] op_sel:[1,1,0] op_sel_hi:[1,0,1] neg_hi:[1,0,0]
  v_pk_fma_f32 v[152:153], v[142:143], v[14:15], v[166:167] op_sel:[1,1,0] op_sel_hi:[1,0,1] neg_hi:[1,0,0]
  v_pk_fma_f32 v[160:161], v[136:137], v[14:15], v[160:161] op_sel:[1,1,0] op_sel_hi:[1,0,1] neg_lo:[1,0,0]
  v_pk_fma_f32 v[162:163], v[138:139], v[14:15], v[162:163] op_sel:[1,1,0] op_sel_hi:[1,0,1] neg_lo:[1,0,0]
  v_pk_fma_f32 v[164:165], v[140:141], v[14:15], v[164:165] op_sel:[1,1,0] op_sel_hi:[1,0,1] neg_lo:[1,0,0]
  v_pk_fma_f32 v[166:167], v[142:143], v[14:15], v[166:167] op_sel:[1,1,0] op_sel_hi:[1,0,1] neg_lo:[1,0,0]
  v_cvt_pk_bf16_f32 v80, v152, v154
  v_cvt_pk_bf16_f32 v84, -v153, -v155
  v_cvt_pk_bf16_f32 v81, v156, v158
  v_cvt_pk_bf16_f32 v85, -v157, -v159
  v_cvt_pk_bf16_f32 v82, v160, v162
  v_cvt_pk_bf16_f32 v86, -v161, -v163
  v_cvt_pk_bf16_f32 v83, v164, v166
  v_cvt_pk_bf16_f32 v87, -v165, -v167
  v_add_f32 v12, 0x40c00000, v11
  v_mul_f32 v12, v12, v10
  v_fract_f32 v12, v12
  v_add_f32 v12, v12, v7
  v_cos_f32 v14, v12
  v_sin_f32 v15, v12
  s_nop 0
  v_pk_mul_f32 v[160:161], v[136:137], v[14:15] op_sel:[0,0] op_sel_hi:[0,1]
  v_pk_mul_f32 v[162:163], v[138:139], v[14:15] op_sel:[0,0] op_sel_hi:[0,1]
  v_pk_mul_f32 v[164:165], v[140:141], v[14:15] op_sel:[0,0] op_sel_hi:[0,1]
  v_pk_mul_f32 v[166:167], v[142:143], v[14:15] op_sel:[0,0] op_sel_hi:[0,1]
  v_pk_fma_f32 v[158:159], v[136:137], v[14:15], v[160:161] op_sel:[1,1,0] op_sel_hi:[1,0,1] neg_hi:[1,0,0]
  v_pk_fma_f32 v[156:157], v[138:139], v[14:15], v[162:163] op_sel:[1,1,0] op_sel_hi:[1,0,1] neg_hi:[1,0,0]
  v_pk_fma_f32 v[154:155], v[140:141], v[14:15], v[164:165] op_sel:[1,1,0] op_sel_hi:[1,0,1] neg_hi:[1,0,0]
  v_pk_fma_f32 v[152:153], v[142:143], v[14:15], v[166:167] op_sel:[1,1,0] op_sel_hi:[1,0,1] neg_hi:[1,0,0]
  v_pk_fma_f32 v[160:161], v[136:137], v[14:15], v[160:161] op_sel:[1,1,0] op_sel_hi:[1,0,1] neg_lo:[1,0,0]
  v_pk_fma_f32 v[162:163], v[138:139], v[14:15], v[162:163] op_sel:[1,1,0] op_sel_hi:[1,0,1] neg_lo:[1,0,0]
  v_pk_fma_f32 v[164:165], v[140:141], v[14:15], v[164:165] op_sel:[1,1,0] op_sel_hi:[1,0,1] neg_lo:[1,0,0]
  v_pk_fma_f32 v[166:167], v[142:143], v[14:15], v[166:167] op_sel:[1,1,0] op_sel_hi:[1,0,1] neg_lo:[1,0,0]
  v_cvt_pk_bf16_f32 v88, v152, v154
  v_cvt_pk_bf16_f32 v92, -v153, -v155
  v_cvt_pk_bf16_f32 v89, v156, v158
  v_cvt_pk_bf16_f32 v93, -v157, -v159
  v_cvt_pk_bf16_f32 v90, v160, v162
  v_cvt_pk_bf16_f32 v94, -v161, -v163
  v_cvt_pk_bf16_f32 v91, v164, v166
  v_cvt_pk_bf16_f32 v95, -v165, -v167
  v_add_f32 v12, 0x41000000, v11
  v_mul_f32 v12, v12, v10
  v_fract_f32 v12, v12
  v_add_f32 v12, v12, v7
  v_cos_f32 v14, v12
  v_sin_f32 v15, v12
  s_nop 0
  v_pk_mul_f32 v[160:161], v[136:137], v[14:15] op_sel:[0,0] op_sel_hi:[0,1]
  v_pk_mul_f32 v[162:163], v[138:139], v[14:15] op_sel:[0,0] op_sel_hi:[0,1]
  v_pk_mul_f32 v[164:165], v[140:141], v[14:15] op_sel:[0,0] op_sel_hi:[0,1]
  v_pk_mul_f32 v[166:167], v[142:143], v[14:15] op_sel:[0,0] op_sel_hi:[0,1]
  v_pk_fma_f32 v[158:159], v[136:137], v[14:15], v[160:161] op_sel:[1,1,0] op_sel_hi:[1,0,1] neg_hi:[1,0,0]
  v_pk_fma_f32 v[156:157], v[138:139], v[14:15], v[162:163] op_sel:[1,1,0] op_sel_hi:[1,0,1] neg_hi:[1,0,0]
  v_pk_fma_f32 v[154:155], v[140:141], v[14:15], v[164:165] op_sel:[1,1,0] op_sel_hi:[1,0,1] neg_hi:[1,0,0]
  v_pk_fma_f32 v[152:153], v[142:143], v[14:15], v[166:167] op_sel:[1,1,0] op_sel_hi:[1,0,1] neg_hi:[1,0,0]
  v_pk_fma_f32 v[160:161], v[136:137], v[14:15], v[160:161] op_sel:[1,1,0] op_sel_hi:[1,0,1] neg_lo:[1,0,0]
  v_pk_fma_f32 v[162:163], v[138:139], v[14:15], v[162:163] op_sel:[1,1,0] op_sel_hi:[1,0,1] neg_lo:[1,0,0]
  v_pk_fma_f32 v[164:165], v[140:141], v[14:15], v[164:165] op_sel:[1,1,0] op_sel_hi:[1,0,1] neg_lo:[1,0,0]
  v_pk_fma_f32 v[166:167], v[142:143], v[14:15], v[166:167] op_sel:[1,1,0] op_sel_hi:[1,0,1] neg_lo:[1,0,0]
  v_cvt_pk_bf16_f32 v96, v152, v154
  v_cvt_pk_bf16_f32 v100, -v153, -v155
  v_cvt_pk_bf16_f32 v97, v156, v158
  v_cvt_pk_bf16_f32 v101, -v157, -v159
  v_cvt_pk_bf16_f32 v98, v160, v162
  v_cvt_pk_bf16_f32 v102, -v161, -v163
  v_cvt_pk_bf16_f32 v99, v164, v166
  v_cvt_pk_bf16_f32 v103, -v165, -v167
  v_add_f32 v12, 0x41200000, v11
  v_mul_f32 v12, v12, v10
  v_fract_f32 v12, v12
  v_add_f32 v12, v12, v7
  v_cos_f32 v14, v12
  v_sin_f32 v15, v12
  s_nop 0
  v_pk_mul_f32 v[160:161], v[136:137], v[14:15] op_sel:[0,0] op_sel_hi:[0,1]
  v_pk_mul_f32 v[162:163], v[138:139], v[14:15] op_sel:[0,0] op_sel_hi:[0,1]
  v_pk_mul_f32 v[164:165], v[140:141], v[14:15] op_sel:[0,0] op_sel_hi:[0,1]
  v_pk_mul_f32 v[166:167], v[142:143], v[14:15] op_sel:[0,0] op_sel_hi:[0,1]
  v_pk_fma_f32 v[158:159], v[136:137], v[14:15], v[160:161] op_sel:[1,1,0] op_sel_hi:[1,0,1] neg_hi:[1,0,0]
  v_pk_fma_f32 v[156:157], v[138:139], v[14:15], v[162:163] op_sel:[1,1,0] op_sel_hi:[1,0,1] neg_hi:[1,0,0]
  v_pk_fma_f32 v[154:155], v[140:141], v[14:15], v[164:165] op_sel:[1,1,0] op_sel_hi:[1,0,1] neg_hi:[1,0,0]
  v_pk_fma_f32 v[152:153], v[142:143], v[14:15], v[166:167] op_sel:[1,1,0] op_sel_hi:[1,0,1] neg_hi:[1,0,0]
  v_pk_fma_f32 v[160:161], v[136:137], v[14:15], v[160:161] op_sel:[1,1,0] op_sel_hi:[1,0,1] neg_lo:[1,0,0]
  v_pk_fma_f32 v[162:163], v[138:139], v[14:15], v[162:163] op_sel:[1,1,0] op_sel_hi:[1,0,1] neg_lo:[1,0,0]
  v_pk_fma_f32 v[164:165], v[140:141], v[14:15], v[164:165] op_sel:[1,1,0] op_sel_hi:[1,0,1] neg_lo:[1,0,0]
  v_pk_fma_f32 v[166:167], v[142:143], v[14:15], v[166:167] op_sel:[1,1,0] op_sel_hi:[1,0,1] neg_lo:[1,0,0]
  v_cvt_pk_bf16_f32 v104, v152, v154
  v_cvt_pk_bf16_f32 v108, -v153, -v155
  v_cvt_pk_bf16_f32 v105, v156, v158
  v_cvt_pk_bf16_f32 v109, -v157, -v159
  v_cvt_pk_bf16_f32 v106, v160, v162
  v_cvt_pk_bf16_f32 v110, -v161, -v163
  v_cvt_pk_bf16_f32 v107, v164, v166
  v_cvt_pk_bf16_f32 v111, -v165, -v167
  v_add_f32 v12, 0x41400000, v11
  v_mul_f32 v12, v12, v10
  v_fract_f32 v12, v12
  v_add_f32 v12, v12, v7
  v_cos_f32 v14, v12
  v_sin_f32 v15, v12
  s_nop 0
  v_pk_mul_f32 v[160:161], v[136:137], v[14:15] op_sel:[0,0] op_sel_hi:[0,1]
  v_pk_mul_f32 v[162:163], v[138:139], v[14:15] op_sel:[0,0] op_sel_hi:[0,1]
  v_pk_mul_f32 v[164:165], v[140:141], v[14:15] op_sel:[0,0] op_sel_hi:[0,1]
  v_pk_mul_f32 v[166:167], v[142:143], v[14:15] op_sel:[0,0] op_sel_hi:[0,1]
  v_pk_fma_f32 v[158:159], v[136:137], v[14:15], v[160:161] op_sel:[1,1,0] op_sel_hi:[1,0,1] neg_hi:[1,0,0]
  v_pk_fma_f32 v[156:157], v[138:139], v[14:15], v[162:163] op_sel:[1,1,0] op_sel_hi:[1,0,1] neg_hi:[1,0,0]
  v_pk_fma_f32 v[154:155], v[140:141], v[14:15], v[164:165] op_sel:[1,1,0] op_sel_hi:[1,0,1] neg_hi:[1,0,0]
  v_pk_fma_f32 v[152:153], v[142:143], v[14:15], v[166:167] op_sel:[1,1,0] op_sel_hi:[1,0,1] neg_hi:[1,0,0]
  v_pk_fma_f32 v[160:161], v[136:137], v[14:15], v[160:161] op_sel:[1,1,0] op_sel_hi:[1,0,1] neg_lo:[1,0,0]
  v_pk_fma_f32 v[162:163], v[138:139], v[14:15], v[162:163] op_sel:[1,1,0] op_sel_hi:[1,0,1] neg_lo:[1,0,0]
  v_pk_fma_f32 v[164:165], v[140:141], v[14:15], v[164:165] op_sel:[1,1,0] op_sel_hi:[1,0,1] neg_lo:[1,0,0]
  v_pk_fma_f32 v[166:167], v[142:143], v[14:15], v[166:167] op_sel:[1,1,0] op_sel_hi:[1,0,1] neg_lo:[1,0,0]
  v_cvt_pk_bf16_f32 v112, v152, v154
  v_cvt_pk_bf16_f32 v116, -v153, -v155
  v_cvt_pk_bf16_f32 v113, v156, v158
  v_cvt_pk_bf16_f32 v117, -v157, -v159
  v_cvt_pk_bf16_f32 v114, v160, v162
  v_cvt_pk_bf16_f32 v118, -v161, -v163
  v_cvt_pk_bf16_f32 v115, v164, v166
  v_cvt_pk_bf16_f32 v119, -v165, -v167
  v_add_f32 v12, 0x41600000, v11
  v_mul_f32 v12, v12, v10
  v_fract_f32 v12, v12
  v_add_f32 v12, v12, v7
  v_cos_f32 v14, v12
  v_sin_f32 v15, v12
  s_nop 0
  v_pk_mul_f32 v[160:161], v[136:137], v[14:15] op_sel:[0,0] op_sel_hi:[0,1]
  v_pk_mul_f32 v[162:163], v[138:139], v[14:15] op_sel:[0,0] op_sel_hi:[0,1]
  v_pk_mul_f32 v[164:165], v[140:141], v[14:15] op_sel:[0,0] op_sel_hi:[0,1]
  v_pk_mul_f32 v[166:167], v[142:143], v[14:15] op_sel:[0,0] op_sel_hi:[0,1]
  v_pk_fma_f32 v[158:159], v[136:137], v[14:15], v[160:161] op_sel:[1,1,0] op_sel_hi:[1,0,1] neg_hi:[1,0,0]
  v_pk_fma_f32 v[156:157], v[138:139], v[14:15], v[162:163] op_sel:[1,1,0] op_sel_hi:[1,0,1] neg_hi:[1,0,0]
  v_pk_fma_f32 v[154:155], v[140:141], v[14:15], v[164:165] op_sel:[1,1,0] op_sel_hi:[1,0,1] neg_hi:[1,0,0]
  v_pk_fma_f32 v[152:153], v[142:143], v[14:15], v[166:167] op_sel:[1,1,0] op_sel_hi:[1,0,1] neg_hi:[1,0,0]
  v_pk_fma_f32 v[160:161], v[136:137], v[14:15], v[160:161] op_sel:[1,1,0] op_sel_hi:[1,0,1] neg_lo:[1,0,0]
  v_pk_fma_f32 v[162:163], v[138:139], v[14:15], v[162:163] op_sel:[1,1,0] op_sel_hi:[1,0,1] neg_lo:[1,0,0]
  v_pk_fma_f32 v[164:165], v[140:141], v[14:15], v[164:165] op_sel:[1,1,0] op_sel_hi:[1,0,1] neg_lo:[1,0,0]
  v_pk_fma_f32 v[166:167], v[142:143], v[14:15], v[166:167] op_sel:[1,1,0] op_sel_hi:[1,0,1] neg_lo:[1,0,0]
  v_cvt_pk_bf16_f32 v120, v152, v154
  v_cvt_pk_bf16_f32 v124, -v153, -v155
  v_cvt_pk_bf16_f32 v121, v156, v158
  v_cvt_pk_bf16_f32 v125, -v157, -v159
  v_cvt_pk_bf16_f32 v122, v160, v162
  v_cvt_pk_bf16_f32 v126, -v161, -v163
  v_cvt_pk_bf16_f32 v123, v164, v166
  v_cvt_pk_bf16_f32 v127, -v165, -v167
  v_add_f32 v12, 0x41800000, v11
  v_mul_f32 v12, v12, v10
  v_fract_f32 v12, v12
  v_add_f32 v12, v12, v7
  v_cos_f32 v14, v12
  v_sin_f32 v15, v12
  s_nop 0
  v_pk_mul_f32 v[160:161], v[136:137], v[14:15] op_sel:[0,0] op_sel_hi:[0,1]
  v_pk_mul_f32 v[162:163], v[138:139], v[14:15] op_sel:[0,0] op_sel_hi:[0,1]
  v_pk_mul_f32 v[164:165], v[140:141], v[14:15] op_sel:[0,0] op_sel_hi:[0,1]
  v_pk_mul_f32 v[166:167], v[142:143], v[14:15] op_sel:[0,0] op_sel_hi:[0,1]
  v_pk_fma_f32 v[158:159], v[136:137], v[14:15], v[160:161] op_sel:[1,1,0] op_sel_hi:[1,0,1] neg_hi:[1,0,0]
  v_pk_fma_f32 v[156:157], v[138:139], v[14:15], v[162:163] op_sel:[1,1,0] op_sel_hi:[1,0,1] neg_hi:[1,0,0]
  v_pk_fma_f32 v[154:155], v[140:141], v[14:15], v[164:165] op_sel:[1,1,0] op_sel_hi:[1,0,1] neg_hi:[1,0,0]
  v_pk_fma_f32 v[152:153], v[142:143], v[14:15], v[166:167] op_sel:[1,1,0] op_sel_hi:[1,0,1] neg_hi:[1,0,0]
  v_pk_fma_f32 v[160:161], v[136:137], v[14:15], v[160:161] op_sel:[1,1,0] op_sel_hi:[1,0,1] neg_lo:[1,0,0]
  v_pk_fma_f32 v[162:163], v[138:139], v[14:15], v[162:163] op_sel:[1,1,0] op_sel_hi:[1,0,1] neg_lo:[1,0,0]
  v_pk_fma_f32 v[164:165], v[140:141], v[14:15], v[164:165] op_sel:[1,1,0] op_sel_hi:[1,0,1] neg_lo:[1,0,0]
  v_pk_fma_f32 v[166:167], v[142:143], v[14:15], v[166:167] op_sel:[1,1,0] op_sel_hi:[1,0,1] neg_lo:[1,0,0]
  v_cvt_pk_bf16_f32 v128, v152, v154
  v_cvt_pk_bf16_f32 v132, -v153, -v155
  v_cvt_pk_bf16_f32 v129, v156, v158
  v_cvt_pk_bf16_f32 v133, -v157, -v159
  v_cvt_pk_bf16_f32 v130, v160, v162
  v_cvt_pk_bf16_f32 v134, -v161, -v163
  v_cvt_pk_bf16_f32 v131, v164, v166
  v_cvt_pk_bf16_f32 v135, -v165, -v167
  v_mul_f32 v12, 0x3c638e39, v6
  v_add_f32 v13, v12, v12
  v_add_f32 v14, v13, v12
  v_cos_f32 v216, v12
  v_sin_f32 v217, -v12
  v_cos_f32 v218, v13
  v_sin_f32 v219, -v13
  v_cos_f32 v220, v14
  v_sin_f32 v221, -v14
  v_lshl_add_u32 v12, v2, 6, s17
  v_mul_u32_u24 v12, v12, v1
  v_cvt_f32_u32 v12, v12
  v_mul_f32 v12, 0x3a000000, v12
  v_cvt_f32_u32 v13, v1
  v_mul_f32 v13, 0x3d800000, v13
  v_cos_f32 v16, v12
  v_sin_f32 v17, v12
  v_add_f32 v12, v12, v13
  v_cos_f32 v18, v12
  v_sin_f32 v19, v12
  v_add_f32 v12, v12, v13
  v_cos_f32 v20, v12
  v_sin_f32 v21, v12
  v_add_f32 v12, v12, v13
  v_cos_f32 v22, v12
  v_sin_f32 v23, v12
  v_add_f32 v12, v12, v13
  v_cos_f32 v24, v12
  v_sin_f32 v25, v12
  v_add_f32 v12, v12, v13
  v_cos_f32 v26, v12
  v_sin_f32 v27, v12
  v_add_f32 v12, v12, v13
  v_cos_f32 v28, v12
  v_sin_f32 v29, v12
  v_add_f32 v12, v12, v13
  v_cos_f32 v30, v12
  v_sin_f32 v31, v12
  v_add_f32 v12, v12, v13
  v_cos_f32 v32, v12
  v_sin_f32 v33, v12
  v_add_f32 v12, v12, v13
  v_cos_f32 v34, v12
  v_sin_f32 v35, v12
  v_add_f32 v12, v12, v13
  v_cos_f32 v36, v12
  v_sin_f32 v37, v12
  v_add_f32 v12, v12, v13
  v_cos_f32 v38, v12
  v_sin_f32 v39, v12
  v_add_f32 v12, v12, v13
  v_cos_f32 v40, v12
  v_sin_f32 v41, v12
  v_add_f32 v12, v12, v13
  v_cos_f32 v42, v12
  v_sin_f32 v43, v12
  v_add_f32 v12, v12, v13
  v_cos_f32 v44, v12
  v_sin_f32 v45, v12
  v_add_f32 v12, v12, v13
  v_cos_f32 v46, v12
  v_sin_f32 v47, v12
  v_add_f32 v12, v12, v13
  s_waitcnt vmcnt(0)
  s_barrier
  ds_read_b128 a[0:3], v247 offset:0
  ds_read_b128 a[4:7], v247 offset:4096
  ds_read_b128 a[8:11], v247 offset:8192
  ds_read_b128 a[12:15], v247 offset:12288
  ds_read_b128 a[16:19], v247 offset:16384
  ds_read_b128 a[20:23], v247 offset:20480
  ds_read_b128 a[24:27], v247 offset:24576
  ds_read_b128 a[28:31], v247 offset:28672
  ds_read_b128 a[32:35], v247 offset:32768
  s_waitcnt lgkmcnt(8)
  v_mfma_f32_32x32x16_bf16 v[136:151], a[0:3], v[64:67], 0
  ds_read_b128 a[36:39], v247 offset:1024
  ds_read_b128 a[40:43], v247 offset:5120
  ds_read_b128 a[44:47], v247 offset:9216
  ds_read_b128 a[48:51], v247 offset:13312
  ds_read_b128 a[52:55], v247 offset:17408
  v_mfma_f32_32x32x16_bf16 v[152:167], a[0:3], v[68:71], 0
  ds_read_b128 a[56:59], v247 offset:21504
  ds_read_b128 a[60:63], v247 offset:25600
  ds_read_b128 a[64:67], v247 offset:29696
  ds_read_b128 a[68:71], v247 offset:33792
  v_lshl_add_u32 v10, v1, 6, s17
  s_waitcnt lgkmcnt(15)
  v_mfma_f32_32x32x16_bf16 v[136:151], a[4:7], v[72:75], v[136:151]
  v_cvt_f32_u32 v10, v10
  v_mul_f32 v10, 0x3a000000, v10
  v_cvt_f32_u32 v11, v2
  v_mul_f32 v11, 4.0, v11
  v_mul_f32 v11, v11, v10
  v_mfma_f32_32x32x16_bf16 v[152:167], a[4:7], v[76:79], v[152:167]
  v_mul_f32 v12, 0x40a00000, v10
  v_cos_f32 v222, v11
  v_sin_f32 v223, v11
  v_add_f32 v11, v11, v10
  v_cvt_pk_bf16_f32 v224, v222, -v223
  v_mfma_f32_32x32x16_bf16 v[136:151], a[8:11], v[80:83], v[136:151]
  v_cvt_pk_bf16_f32 v225, v223, v222
  v_accvgpr_write_b32 a176, v224
  v_accvgpr_write_b32 a192, v225
  v_cos_f32 v226, v11
  v_sin_f32 v227, v11
  v_mfma_f32_32x32x16_bf16 v[152:167], a[8:11], v[84:87], v[152:167]
  v_add_f32 v11, v11, v10
  v_cvt_pk_bf16_f32 v228, v226, -v227
  v_cvt_pk_bf16_f32 v229, v227, v226
  v_accvgpr_write_b32 a177, v228
  v_accvgpr_write_b32 a193, v229
  s_waitcnt lgkmcnt(14)
  v_mfma_f32_32x32x16_bf16 v[136:151], a[12:15], v[88:91], v[136:151]
  v_cos_f32 v222, v11
  v_sin_f32 v223, v11
  v_add_f32 v11, v11, v10
  v_cvt_pk_bf16_f32 v224, v222, -v223
  v_cvt_pk_bf16_f32 v225, v223, v222
  v_mfma_f32_32x32x16_bf16 v[152:167], a[12:15], v[92:95], v[152:167]
  v_accvgpr_write_b32 a178, v224
  v_accvgpr_write_b32 a194, v225
  v_cos_f32 v226, v11
  v_sin_f32 v227, v11
  v_add_f32 v11, v11, v12
  s_waitcnt lgkmcnt(13)
  v_mfma_f32_32x32x16_bf16 v[136:151], a[16:19], v[96:99], v[136:151]
  v_cvt_pk_bf16_f32 v228, v226, -v227
  v_cvt_pk_bf16_f32 v229, v227, v226
  v_accvgpr_write_b32 a179, v228
  v_accvgpr_write_b32 a195, v229
  v_mfma_f32_32x32x16_bf16 v[152:167], a[16:19], v[100:103], v[152:167]
  v_cos_f32 v222, v11
  v_sin_f32 v223, v11
  v_add_f32 v11, v11, v10
  v_cvt_pk_bf16_f32 v224, v222, -v223
  v_cvt_pk_bf16_f32 v225, v223, v222
  s_waitcnt lgkmcnt(12)
  v_mfma_f32_32x32x16_bf16 v[136:151], a[20:23], v[104:107], v[136:151]
  v_accvgpr_write_b32 a180, v224
  v_accvgpr_write_b32 a196, v225
  v_cos_f32 v226, v11
  v_sin_f32 v227, v11
  v_add_f32 v11, v11, v10
  v_mfma_f32_32x32x16_bf16 v[152:167], a[20:23], v[108:111], v[152:167]
  v_cvt_pk_bf16_f32 v228, v226, -v227
  v_cvt_pk_bf16_f32 v229, v227, v226
  v_accvgpr_write_b32 a181, v228
  v_accvgpr_write_b32 a197, v229
  v_cos_f32 v222, v11
  s_waitcnt lgkmcnt(11)
  v_mfma_f32_32x32x16_bf16 v[136:151], a[24:27], v[112:115], v[136:151]
  v_sin_f32 v223, v11
  v_add_f32 v11, v11, v10
  v_cvt_pk_bf16_f32 v224, v222, -v223
  v_cvt_pk_bf16_f32 v225, v223, v222
  v_accvgpr_write_b32 a182, v224
  v_mfma_f32_32x32x16_bf16 v[152:167], a[24:27], v[116:119], v[152:167]
  v_accvgpr_write_b32 a198, v225
  v_cos_f32 v226, v11
  v_sin_f32 v227, v11
  v_add_f32 v11, v11, v12
  v_cvt_pk_bf16_f32 v228, v226, -v227
  s_waitcnt lgkmcnt(10)
  v_mfma_f32_32x32x16_bf16 v[136:151], a[28:31], v[120:123], v[136:151]
  v_cvt_pk_bf16_f32 v229, v227, v226
  v_accvgpr_write_b32 a183, v228
  v_accvgpr_write_b32 a199, v229
  v_cos_f32 v222, v11
  v_sin_f32 v223, v11
  v_mfma_f32_32x32x16_bf16 v[152:167], a[28:31], v[124:127], v[152:167]
  v_add_f32 v11, v11, v10
  v_cvt_pk_bf16_f32 v224, v222, -v223
  v_cvt_pk_bf16_f32 v225, v223, v222
  v_accvgpr_write_b32 a184, v224
  v_accvgpr_write_b32 a200, v225
  s_waitcnt lgkmcnt(9)
  v_mfma_f32_32x32x16_bf16 v[136:151], a[32:35], v[128:131], v[136:151]
  ds_read_b128 a[72:75], v247 offset:2048
  ds_read_b128 a[76:79], v247 offset:6144
  ds_read_b128 a[80:83], v247 offset:10240
  ds_read_b128 a[84:87], v247 offset:14336
  ds_read_b128 a[88:91], v247 offset:18432
  v_mfma_f32_32x32x16_bf16 v[152:167], a[32:35], v[132:135], v[152:167]
  ds_read_b128 a[92:95], v247 offset:22528
  ds_read_b128 a[96:99], v247 offset:26624
  ds_read_b128 a[100:103], v247 offset:30720
  ds_read_b128 a[104:107], v247 offset:34816
  s_waitcnt lgkmcnt(15)
  v_mfma_f32_32x32x16_bf16 v[168:183], a[36:39], v[64:67], 0
  ds_read_b128 a[108:111], v247 offset:3072
  ds_read_b128 a[112:115], v247 offset:7168
  ds_read_b128 a[116:119], v247 offset:11264
  ds_read_b128 a[120:123], v247 offset:15360
  ds_read_b128 a[124:127], v247 offset:19456
  v_mfma_f32_32x32x16_bf16 v[184:199], a[36:39], v[68:71], 0
  ds_read_b128 a[128:131], v247 offset:23552
  ds_read_b128 a[132:135], v247 offset:27648
  ds_read_b128 a[136:139], v247 offset:31744
  ds_read_b128 a[140:143], v247 offset:35840
  v_lshrrev_b32 v5, 3, v1
  v_mfma_f32_32x32x16_bf16 v[168:183], a[40:43], v[72:75], v[168:183]
  v_lshlrev_b32 v5, 10, v5
  v_and_b32 v4, 7, v1
  v_lshl_add_u32 v5, v4, 6, v5
  v_lshl_add_u32 v5, v2, 5, v5
  v_mfma_f32_32x32x16_bf16 v[184:199], a[40:43], v[76:79], v[184:199]
  s_lshr_b32 s23, s19, 1
  s_lshl_b32 s23, s23, 12
  s_and_b32 s24, s19, 1
  s_lshl_b32 s24, s24, 9
  s_add_u32 s23, s23, s24
  v_mfma_f32_32x32x16_bf16 v[168:183], a[44:47], v[80:83], v[168:183]
  v_add_u32 v4, s23, v5
  s_add_u32 s24, s19, 9
  s_lshr_b32 s23, s24, 1
  s_lshl_b32 s23, s23, 12
  s_and_b32 s24, s24, 1
  v_mfma_f32_32x32x16_bf16 v[184:199], a[44:47], v[84:87], v[184:199]
  s_lshl_b32 s24, s24, 9
  s_add_u32 s23, s23, s24
  v_add_u32 v5, s23, v5
  ds_read_b128 a[240:243], v4 offset:0
  s_waitcnt lgkmcnt(15)
  v_mfma_f32_32x32x16_bf16 v[168:183], a[48:51], v[88:91], v[168:183]
  ds_read_b128 a[244:247], v4 offset:16
  ds_read_b128 a[248:251], v5 offset:0
  ds_read_b128 a[252:255], v5 offset:16
  v_fmac_f32 v136, v216, v137
  v_fmac_f32 v152, v216, v153
  v_mfma_f32_32x32x16_bf16 v[184:199], a[48:51], v[92:95], v[184:199]
  v_fmac_f32 v140, v216, v141
  v_fmac_f32 v156, v216, v157
  v_fmac_f32 v144, v216, v145
  v_fmac_f32 v160, v216, v161
  v_mfma_f32_32x32x16_bf16 v[168:183], a[52:55], v[96:99], v[168:183]
  v_fmac_f32 v148, v216, v149
  v_fmac_f32 v164, v216, v165
  v_fma_f32 v136, -v217, v153, v136
  v_fmac_f32 v152, v217, v137
  v_fma_f32 v140, -v217, v157, v140
  v_mfma_f32_32x32x16_bf16 v[184:199], a[52:55], v[100:103], v[184:199]
  v_fmac_f32 v156, v217, v141
  v_fma_f32 v144, -v217, v161, v144
  v_fmac_f32 v160, v217, v145
  v_fma_f32 v148, -v217, v165, v148
  v_fmac_f32 v164, v217, v149
  v_mfma_f32_32x32x16_bf16 v[168:183], a[56:59], v[104:107], v[168:183]
  v_fmac_f32 v136, v218, v138
  v_fmac_f32 v152, v218, v154
  v_fmac_f32 v140, v218, v142
  v_fmac_f32 v156, v218, v158
  v_mfma_f32_32x32x16_bf16 v[184:199], a[56:59], v[108:111], v[184:199]
  v_fmac_f32 v144, v218, v146
  v_fmac_f32 v160, v218, v162
  v_fmac_f32 v148, v218, v150
  v_fmac_f32 v164, v218, v166
  v_fma_f32 v136, -v219, v154, v136
  v_mfma_f32_32x32x16_bf16 v[168:183], a[60:63], v[112:115], v[168:183]
  v_fmac_f32 v152, v219, v138
  v_fma_f32 v140, -v219, v158, v140
  v_fmac_f32 v156, v219, v142
  v_fma_f32 v144, -v219, v162, v144
  v_mfma_f32_32x32x16_bf16 v[184:199], a[60:63], v[116:119], v[184:199]
  v_fmac_f32 v160, v219, v146
  v_fma_f32 v148, -v219, v166, v148
  v_fmac_f32 v164, v219, v150
  v_fmac_f32 v136, v220, v139
  v_fmac_f32 v152, v220, v155
  v_mfma_f32_32x32x16_bf16 v[168:183], a[64:67], v[120:123], v[168:183]
  v_fmac_f32 v140, v220, v143
  v_fmac_f32 v156, v220, v159
  v_fmac_f32 v144, v220, v147
  v_fmac_f32 v160, v220, v163
  v_fmac_f32 v148, v220, v151
  v_mfma_f32_32x32x16_bf16 v[184:199], a[64:67], v[124:127], v[184:199]
  v_fmac_f32 v164, v220, v167
  v_fma_f32 v136, -v221, v155, v136
  v_fmac_f32 v152, v221, v139
  v_fma_f32 v140, -v221, v159, v140
  v_mfma_f32_32x32x16_bf16 v[168:183], a[68:71], v[128:131], v[168:183]
  v_fmac_f32 v156, v221, v143
  v_fma_f32 v144, -v221, v163, v144
  v_fmac_f32 v160, v221, v147
  v_fma_f32 v148, -v221, v167, v148
  v_fmac_f32 v164, v221, v151
  v_mfma_f32_32x32x16_bf16 v[184:199], a[68:71], v[132:135], v[184:199]
  v_cvt_pk_bf16_f32 v200, v136, v152
  v_cvt_pk_bf16_f32 v201, v140, v156
  v_cvt_pk_bf16_f32 v202, v144, v160
  v_cvt_pk_bf16_f32 v203, v148, v164
  v_mfma_f32_32x32x16_bf16 v[136:151], a[72:75], v[64:67], 0
  v_cos_f32 v226, v11
  v_sin_f32 v227, v11
  v_add_f32 v11, v11, v10
  v_cvt_pk_bf16_f32 v228, v226, -v227
  v_cvt_pk_bf16_f32 v229, v227, v226
  v_accvgpr_write_b32 a185, v228
  v_mfma_f32_32x32x16_bf16 v[152:167], a[72:75], v[68:71], 0
  v_accvgpr_write_b32 a201, v229
  v_cos_f32 v222, v11
  v_sin_f32 v223, v11
  v_add_f32 v11, v11, v10
  v_cvt_pk_bf16_f32 v224, v222, -v223
  v_cvt_pk_bf16_f32 v225, v223, v222
  v_mfma_f32_32x32x16_bf16 v[136:151], a[76:79], v[72:75], v[136:151]
  v_accvgpr_write_b32 a186, v224
  v_accvgpr_write_b32 a202, v225
  v_cos_f32 v226, v11
  v_sin_f32 v227, v11
  v_add_f32 v11, v11, v12
  v_mfma_f32_32x32x16_bf16 v[152:167], a[76:79], v[76:79], v[152:167]
  v_cvt_pk_bf16_f32 v228, v226, -v227
  v_cvt_pk_bf16_f32 v229, v227, v226
  v_accvgpr_write_b32 a187, v228
  v_accvgpr_write_b32 a203, v229
  v_cos_f32 v222, v11
  v_sin_f32 v223, v11
  v_mfma_f32_32x32x16_bf16 v[136:151], a[80:83], v[80:83], v[136:151]
  v_add_f32 v11, v11, v10
  v_cvt_pk_bf16_f32 v224, v222, -v223
  v_cvt_pk_bf16_f32 v225, v223, v222
  v_accvgpr_write_b32 a188, v224
  v_accvgpr_write_b32 a204, v225
  v_cos_f32 v226, v11
  v_mfma_f32_32x32x16_bf16 v[152:167], a[80:83], v[84:87], v[152:167]
  v_sin_f32 v227, v11
  v_add_f32 v11, v11, v10
  v_cvt_pk_bf16_f32 v228, v226, -v227
  v_cvt_pk_bf16_f32 v229, v227, v226
  v_accvgpr_write_b32 a189, v228
  v_mfma_f32_32x32x16_bf16 v[136:151], a[84:87], v[88:91], v[136:151]
  v_accvgpr_write_b32 a205, v229
  v_cos_f32 v222, v11
  v_sin_f32 v223, v11
  v_add_f32 v11, v11, v10
  v_cvt_pk_bf16_f32 v224, v222, -v223
  v_cvt_pk_bf16_f32 v225, v223, v222
  v_mfma_f32_32x32x16_bf16 v[152:167], a[84:87], v[92:95], v[152:167]
  v_accvgpr_write_b32 a190, v224
  v_accvgpr_write_b32 a206, v225
  v_cos_f32 v226, v11
  v_sin_f32 v227, v11
  v_add_f32 v11, v11, v12
  s_waitcnt lgkmcnt(15)
  v_mfma_f32_32x32x16_bf16 v[136:151], a[88:91], v[96:99], v[136:151]
  v_cvt_pk_bf16_f32 v228, v226, -v227
  v_cvt_pk_bf16_f32 v229, v227, v226
  v_accvgpr_write_b32 a191, v228
L_qad0:
  s_cbranch_execz L_qad1
  v_accvgpr_write_b32 a207, v229
  v_fmac_f32 v168, v216, v169
  v_fmac_f32 v184, v216, v185
  v_mfma_f32_32x32x16_bf16 v[152:167], a[88:91], v[100:103], v[152:167]
  v_fmac_f32 v172, v216, v173
  v_fmac_f32 v188, v216, v189
  v_fmac_f32 v176, v216, v177
  v_fmac_f32 v192, v216, v193
  v_fmac_f32 v180, v216, v181
  v_fmac_f32 v196, v216, v197
  v_mfma_f32_32x32x16_bf16 v[136:151], a[92:95], v[104:107], v[136:151]
  v_fma_f32 v168, -v217, v185, v168
  v_fmac_f32 v184, v217, v169
  v_fma_f32 v172, -v217, v189, v172
  v_fmac_f32 v188, v217, v173
  v_fma_f32 v176, -v217, v193, v176
  v_mfma_f32_32x32x16_bf16 v[152:167], a[92:95], v[108:111], v[152:167]
  v_fmac_f32 v192, v217, v177
  v_fma_f32 v180, -v217, v197, v180
  v_fmac_f32 v196, v217, v181
  v_fmac_f32 v168, v218, v170
  v_fmac_f32 v184, v218, v186
  v_fmac_f32 v172, v218, v174
  v_mfma_f32_32x32x16_bf16 v[136:151], a[96:99], v[112:115], v[136:151]
  v_fmac_f32 v188, v218, v190
  v_fmac_f32 v176, v218, v178
  v_fmac_f32 v192, v218, v194
  v_fmac_f32 v180, v218, v182
  v_fmac_f32 v196, v218, v198
  v_mfma_f32_32x32x16_bf16 v[152:167], a[96:99], v[116:119], v[152:167]
  v_fma_f32 v168, -v219, v186, v168
  v_fmac_f32 v184, v219, v170
  v_fma_f32 v172, -v219, v190, v172
  v_fmac_f32 v188, v219, v174
  v_fma_f32 v176, -v219, v194, v176
  v_fmac_f32 v192, v219, v178
  s_waitcnt lgkmcnt(14)
  v_mfma_f32_32x32x16_bf16 v[136:151], a[100:103], v[120:123], v[136:151]
  v_fma_f32 v180, -v219, v198, v180
  v_fmac_f32 v196, v219, v182
  v_fmac_f32 v168, v220, v171
  v_fmac_f32 v184, v220, v187
  v_fmac_f32 v172, v220, v175
  v_fmac_f32 v188, v220, v191
  v_mfma_f32_32x32x16_bf16 v[152:167], a[100:103], v[124:127], v[152:167]
  v_fmac_f32 v176, v220, v179
  v_fmac_f32 v192, v220, v195
  v_fmac_f32 v180, v220, v183
  v_fmac_f32 v196, v220, v199
  v_fma_f32 v168, -v221, v187, v168
  s_waitcnt lgkmcnt(13)
  v_mfma_f32_32x32x16_bf16 v[136:151], a[104:107], v[128:131], v[136:151]
  v_fmac_f32 v184, v221, v171
  v_fma_f32 v172, -v221, v191, v172
  v_fmac_f32 v188, v221, v175
  v_fma_f32 v176, -v221, v195, v176
  v_fmac_f32 v192, v221, v179
  v_fma_f32 v180, -v221, v199, v180
  v_mfma_f32_32x32x16_bf16 v[152:167], a[104:107], v[132:135], v[152:167]
  v_fmac_f32 v196, v221, v183
  v_cvt_pk_bf16_f32 v204, v168, v184
  v_cvt_pk_bf16_f32 v205, v172, v188
  v_cvt_pk_bf16_f32 v206, v176, v192
  v_cvt_pk_bf16_f32 v207, v180, v196
  s_waitcnt lgkmcnt(12)
  v_mfma_f32_32x32x16_bf16 v[168:183], a[108:111], v[64:67], 0
  v_mov_b32 v12, 161292
L_ls1:
  ds_read_b32 v13, v12
  s_waitcnt lgkmcnt(0)
  v_readfirstlane_b32 s59, v13
  s_nop 1
  s_cmp_ge_u32 s59, 64
  s_cbranch_scc0 L_ls1
  v_lshlrev_b32 v12, 6, v2
  v_add_u32 v12, 159744, v12
  v_lshlrev_b32 v13, 2, v1
  v_add_u32 v13, 159872, v13
  ds_read_b128 v[48:51], v12 offset:0
  v_mfma_f32_32x32x16_bf16 v[184:199], a[108:111], v[68:71], 0
  ds_read_b128 v[52:55], v12 offset:16
  ds_read_b128 v[56:59], v12 offset:32
  ds_read_b128 v[60:63], v12 offset:48
  ds_read_b32 v254, v13
  v_fmac_f32 v136, v216, v137
  v_mfma_f32_32x32x16_bf16 v[168:183], a[112:115], v[72:75], v[168:183]
  v_fmac_f32 v152, v216, v153
  v_fmac_f32 v140, v216, v141
  v_fmac_f32 v156, v216, v157
  v_fmac_f32 v144, v216, v145
  v_fmac_f32 v160, v216, v161
  v_mfma_f32_32x32x16_bf16 v[184:199], a[112:115], v[76:79], v[184:199]
  v_fmac_f32 v148, v216, v149
  v_fmac_f32 v164, v216, v165
  v_fma_f32 v136, -v217, v153, v136
  v_fmac_f32 v152, v217, v137
  v_fma_f32 v140, -v217, v157, v140
  v_fmac_f32 v156, v217, v141
  v_mfma_f32_32x32x16_bf16 v[168:183], a[116:119], v[80:83], v[168:183]
  v_fma_f32 v144, -v217, v161, v144
  v_fmac_f32 v160, v217, v145
  v_fma_f32 v148, -v217, v165, v148
  v_fmac_f32 v164, v217, v149
  v_fmac_f32 v136, v218, v138
  v_mfma_f32_32x32x16_bf16 v[184:199], a[116:119], v[84:87], v[184:199]
  v_fmac_f32 v152, v218, v154
  v_fmac_f32 v140, v218, v142
  v_fmac_f32 v156, v218, v158
  v_fmac_f32 v144, v218, v146
  v_fmac_f32 v160, v218, v162
  v_mfma_f32_32x32x16_bf16 v[168:183], a[120:123], v[88:91], v[168:183]
  v_fmac_f32 v148, v218, v150
  v_fmac_f32 v164, v218, v166
  v_fma_f32 v136, -v219, v154, v136
  v_fmac_f32 v152, v219, v138
  v_fma_f32 v140, -v219, v158, v140
  v_mfma_f32_32x32x16_bf16 v[184:199], a[120:123], v[92:95], v[184:199]
  v_fmac_f32 v156, v219, v142
  v_fma_f32 v144, -v219, v162, v144
  v_fmac_f32 v160, v219, v146
  v_fma_f32 v148, -v219, v166, v148
  v_fmac_f32 v164, v219, v150
  v_fmac_f32 v136, v220, v139
  v_mfma_f32_32x32x16_bf16 v[168:183], a[124:127], v[96:99], v[168:183]
  v_fmac_f32 v152, v220, v155
  v_fmac_f32 v140, v220, v143
  v_fmac_f32 v156, v220, v159
  v_fmac_f32 v144, v220, v147
  v_fmac_f32 v160, v220, v163
  v_mfma_f32_32x32x16_bf16 v[184:199], a[124:127], v[100:103], v[184:199]
  v_fmac_f32 v148, v220, v151
  v_fmac_f32 v164, v220, v167
  v_fma_f32 v136, -v221, v155, v136
  v_fmac_f32 v152, v221, v139
  v_fma_f32 v140, -v221, v159, v140
  v_mfma_f32_32x32x16_bf16 v[168:183], a[128:131], v[104:107], v[168:183]
  v_fmac_f32 v156, v221, v143
  v_fma_f32 v144, -v221, v163, v144
  v_fmac_f32 v160, v221, v147
  v_fma_f32 v148, -v221, v167, v148
  v_fmac_f32 v164, v221, v151
  v_cvt_pk_bf16_f32 v208, v136, v152
  v_mfma_f32_32x32x16_bf16 v[184:199], a[128:131], v[108:111], v[184:199]
  v_cvt_pk_bf16_f32 v209, v140, v156
  v_cvt_pk_bf16_f32 v210, v144, v160
  v_cvt_pk_bf16_f32 v211, v148, v164
  s_waitcnt lgkmcnt(0)
  v_mul_f32 v16, v16, v48
  v_mfma_f32_32x32x16_bf16 v[168:183], a[132:135], v[112:115], v[168:183]
  v_mul_f32 v17, v17, v48
  v_mul_f32 v18, v18, v49
  v_mul_f32 v19, v19, v49
  v_mul_f32 v20, v20, v50
  v_mul_f32 v21, v21, v50
  v_mfma_f32_32x32x16_bf16 v[184:199], a[132:135], v[116:119], v[184:199]
  v_mul_f32 v22, v22, v51
  v_mul_f32 v23, v23, v51
  v_mul_f32 v24, v24, v52
  v_mul_f32 v25, v25, v52
  v_mul_f32 v26, v26, v53
  v_mfma_f32_32x32x16_bf16 v[168:183], a[136:139], v[120:123], v[168:183]
  v_mul_f32 v27, v27, v53
  v_mul_f32 v28, v28, v54
  v_mul_f32 v29, v29, v54
  v_mul_f32 v30, v30, v55
  v_mul_f32 v31, v31, v55
  v_cvt_pk_bf16_f32 v230, v16, v17
  v_mfma_f32_32x32x16_bf16 v[184:199], a[136:139], v[124:127], v[184:199]
  v_cvt_pk_bf16_f32 v48, -v17, v16
  v_cvt_pk_bf16_f32 v231, v18, v19
  v_cvt_pk_bf16_f32 v49, -v19, v18
  v_cvt_pk_bf16_f32 v232, v20, v21
  v_cvt_pk_bf16_f32 v50, -v21, v20
  v_mfma_f32_32x32x16_bf16 v[168:183], a[140:143], v[128:131], v[168:183]
  v_cvt_pk_bf16_f32 v233, v22, v23
  v_cvt_pk_bf16_f32 v51, -v23, v22
  v_cvt_pk_bf16_f32 v234, v24, v25
  v_cvt_pk_bf16_f32 v52, -v25, v24
  v_cvt_pk_bf16_f32 v235, v26, v27
  v_mfma_f32_32x32x16_bf16 v[184:199], a[140:143], v[132:135], v[184:199]
  v_cvt_pk_bf16_f32 v53, -v27, v26
  v_cvt_pk_bf16_f32 v236, v28, v29
  v_cvt_pk_bf16_f32 v54, -v29, v28
  v_cvt_pk_bf16_f32 v237, v30, v31
  v_cvt_pk_bf16_f32 v55, -v31, v30
  s_nop 1
  v_mfma_f32_32x32x16_bf16 v[136:151], v[230:233], v[200:203], 0
  v_mul_f32 v32, v32, v56
  v_mul_f32 v33, v33, v56
  v_mul_f32 v34, v34, v57
  v_mul_f32 v35, v35, v57
  v_mul_f32 v36, v36, v58
  v_mul_f32 v37, v37, v58
  v_mul_f32 v38, v38, v59
  v_mul_f32 v39, v39, v59
  v_mfma_f32_32x32x16_bf16 v[152:167], v[48:51], v[200:203], 0
  v_mul_f32 v40, v40, v60
  v_mul_f32 v41, v41, v60
  v_mul_f32 v42, v42, v61
  v_mul_f32 v43, v43, v61
  v_mul_f32 v44, v44, v62
  v_mul_f32 v45, v45, v62
  v_mul_f32 v46, v46, v63
  v_mul_f32 v47, v47, v63
  v_mfma_f32_32x32x16_bf16 v[136:151], v[234:237], v[204:207], v[136:151]
  v_cvt_pk_bf16_f32 v238, v32, v33
  v_cvt_pk_bf16_f32 v56, -v33, v32
  v_cvt_pk_bf16_f32 v239, v34, v35
  v_cvt_pk_bf16_f32 v57, -v35, v34
  v_cvt_pk_bf16_f32 v240, v36, v37
  v_cvt_pk_bf16_f32 v58, -v37, v36
  v_cvt_pk_bf16_f32 v241, v38, v39
  v_cvt_pk_bf16_f32 v59, -v39, v38
  v_mfma_f32_32x32x16_bf16 v[152:167], v[52:55], v[204:207], v[152:167]
  v_cvt_pk_bf16_f32 v242, v40, v41
  v_cvt_pk_bf16_f32 v60, -v41, v40
  v_cvt_pk_bf16_f32 v243, v42, v43
  v_cvt_pk_bf16_f32 v61, -v43, v42
  v_cvt_pk_bf16_f32 v244, v44, v45
  v_cvt_pk_bf16_f32 v62, -v45, v44
  v_cvt_pk_bf16_f32 v245, v46, v47
  v_cvt_pk_bf16_f32 v63, -v47, v46
  v_mov_b32 v12, 161292
L_ls2:
  ds_read_b32 v13, v12
  s_waitcnt lgkmcnt(0)
  v_readfirstlane_b32 s59, v13
  s_nop 1
  s_cmp_ge_u32 s59, 128
  s_cbranch_scc0 L_ls2
  v_mov_b32 v12, 161296
  ds_read_b64 v[252:253], v12 offset:8
  v_fmac_f32 v168, v216, v169
  v_fmac_f32 v184, v216, v185
  v_fmac_f32 v172, v216, v173
  v_fmac_f32 v188, v216, v189
  v_fmac_f32 v176, v216, v177
  v_fmac_f32 v192, v216, v193
  v_fmac_f32 v180, v216, v181
  v_fmac_f32 v196, v216, v197
  v_fma_f32 v168, -v217, v185, v168
  v_fmac_f32 v184, v217, v169
  v_fma_f32 v172, -v217, v189, v172
  v_fmac_f32 v188, v217, v173
  v_fma_f32 v176, -v217, v193, v176
  v_fmac_f32 v192, v217, v177
  v_fma_f32 v180, -v217, v197, v180
  v_fmac_f32 v196, v217, v181
  v_fmac_f32 v168, v218, v170
  v_fmac_f32 v184, v218, v186
  v_fmac_f32 v172, v218, v174
  v_fmac_f32 v188, v218, v190
  v_mfma_f32_32x32x16_bf16 v[136:151], v[238:241], v[208:211], v[136:151]
  v_fmac_f32 v176, v218, v178
  v_fmac_f32 v192, v218, v194
  v_fmac_f32 v180, v218, v182
  v_fmac_f32 v196, v218, v198
  v_fma_f32 v168, -v219, v186, v168
  v_fmac_f32 v184, v219, v170
  v_fma_f32 v172, -v219, v190, v172
  v_fmac_f32 v188, v219, v174
  v_fma_f32 v176, -v219, v194, v176
  v_fmac_f32 v192, v219, v178
  v_fma_f32 v180, -v219, v198, v180
  v_fmac_f32 v196, v219, v182
  v_fmac_f32 v168, v220, v171
  v_fmac_f32 v184, v220, v187
  v_fmac_f32 v172, v220, v175
  v_fmac_f32 v188, v220, v191
  v_mfma_f32_32x32x16_bf16 v[152:167], v[56:59], v[208:211], v[152:167]
  v_fmac_f32 v176, v220, v179
  v_fmac_f32 v192, v220, v195
  v_fmac_f32 v180, v220, v183
  v_fmac_f32 v196, v220, v199
  v_fma_f32 v168, -v221, v187, v168
  v_fmac_f32 v184, v221, v171
  v_fma_f32 v172, -v221, v191, v172
  v_fmac_f32 v188, v221, v175
  v_fma_f32 v176, -v221, v195, v176
  v_fmac_f32 v192, v221, v179
  v_fma_f32 v180, -v221, v199, v180
  v_fmac_f32 v196, v221, v183
  v_cvt_pk_bf16_f32 v212, v168, v184
  v_cvt_pk_bf16_f32 v213, v172, v188
  v_cvt_pk_bf16_f32 v214, v176, v192
  v_cvt_pk_bf16_f32 v215, v180, v196
  s_nop 1
  v_mfma_f32_32x32x16_bf16 v[136:151], v[242:245], v[212:215], v[136:151]
  v_mfma_f32_32x32x16_bf16 v[152:167], v[60:63], v[212:215], v[152:167]
  s_waitcnt lgkmcnt(0)
  s_mov_b32 s31, 0x9e3779b1
  v_mov_b32 v14, 0x5bd1e9
  v_and_b32 v15, 3, v9
  v_lshlrev_b32 v15, 2, v15
  v_mad_u32_u24 v222, v15, v14, v252
  v_mul_lo_u32 v222, v222, s31
  v_alignbit_b32 v13, v222, v222, 13
  v_xor_b32 v222, v222, v13
  v_and_b32 v222, 1879076864, v222
  v_add_u32 v15, 1, v15
  v_mad_u32_u24 v223, v15, v14, v252
  v_mul_lo_u32 v223, v223, s31
  v_alignbit_b32 v13, v223, v223, 13
  v_xor_b32 v223, v223, v13
  v_and_b32 v223, 1879076864, v223
  v_add_u32 v15, 1, v15
  v_mad_u32_u24 v224, v15, v14, v252
  v_mul_lo_u32 v224, v224, s31
  v_alignbit_b32 v13, v224, v224, 13
  v_xor_b32 v224, v224, v13
  v_and_b32 v224, 1879076864, v224
  v_add_u32 v15, 1, v15
  v_mad_u32_u24 v225, v15, v14, v252
  v_mul_lo_u32 v225, v225, s31
  v_alignbit_b32 v13, v225, v225, 13
  v_xor_b32 v225, v225, v13
  v_and_b32 v225, 1879076864, v225
  v_add_u32 v15, 1, v15
  s_mov_b32 s23, 294912
  v_mul_lo_u32 v12, v2, s23
  v_lshl_add_u32 v12, v1, 4, v12
  s_lshl_b32 s22, s19, 6
  s_add_u32 s22, s22, s17
  s_lshl_b32 s23, s22, 9
  s_add_u32 s23, s23, 0
  v_cvt_pk_bf16_f32 v200, v136, v152
  v_cvt_pk_bf16_f32 v201, v137, v153
  v_cvt_pk_bf16_f32 v202, v138, v154
  v_cvt_pk_bf16_f32 v203, v139, v155
  v_xor_b32 v200, v200, v222
  v_xor_b32 v201, v201, v223
  v_xor_b32 v202, v202, v224
  v_xor_b32 v203, v203, v225
  buffer_store_dwordx4 v[200:203], v12, s[12:15], s23 offen sc1
  s_add_u32 s23, s23, 589824
  v_cvt_pk_bf16_f32 v204, v140, v156
  v_cvt_pk_bf16_f32 v205, v141, v157
  v_cvt_pk_bf16_f32 v206, v142, v158
  v_cvt_pk_bf16_f32 v207, v143, v159
  v_xor_b32 v204, v204, v222
  v_xor_b32 v205, v205, v223
  v_xor_b32 v206, v206, v224
  v_xor_b32 v207, v207, v225
  buffer_store_dwordx4 v[204:207], v12, s[12:15], s23 offen sc1
  s_add_u32 s23, s23, 589824
  v_cvt_pk_bf16_f32 v208, v144, v160
  v_cvt_pk_bf16_f32 v209, v145, v161
  v_cvt_pk_bf16_f32 v210, v146, v162
  v_cvt_pk_bf16_f32 v211, v147, v163
  v_xor_b32 v208, v208, v222
  v_xor_b32 v209, v209, v223
  v_xor_b32 v210, v210, v224
  v_xor_b32 v211, v211, v225
  buffer_store_dwordx4 v[208:211], v12, s[12:15], s23 offen sc1
  s_add_u32 s23, s23, 589824
  v_cvt_pk_bf16_f32 v212, v148, v164
  v_cvt_pk_bf16_f32 v213, v149, v165
  v_cvt_pk_bf16_f32 v214, v150, v166
  v_cvt_pk_bf16_f32 v215, v151, v167
  v_xor_b32 v212, v212, v222
  v_xor_b32 v213, v213, v223
  v_xor_b32 v214, v214, v224
  v_xor_b32 v215, v215, v225
  buffer_store_dwordx4 v[212:215], v12, s[12:15], s23 offen sc1
  v_and_b32 v15, 15, v9
  v_mad_u32_u24 v246, v15, v14, v252
  v_mul_lo_u32 v246, v246, s31
  v_alignbit_b32 v13, v246, v246, 13
  v_xor_b32 v246, v246, v13
  v_and_b32 v246, 1879076864, v246
  s_mul_i32 s24, s34, 3
  s_add_u32 s24, s24, s16
  s_lshr_b32 s20, s24, 3
  s_and_b32 s21, s24, 7
  v_and_b32 v3, 15, v9
  v_lshrrev_b32 v4, 4, v9
  v_mov_b32 v14, v247
  v_lshlrev_b32 v8, 9, v4
  v_and_b32 v6, 3, v9
  v_lshl_add_u32 v8, v6, 5, v8
  v_and_b32 v6, 1, v9
  v_lshlrev_b32 v6, 1, v6
  v_sub_u32 v8, v8, v6
  v_bfe_u32 v6, v9, 2, 2
  v_lshl_add_u32 v8, v6, 1, v8
  s_lshl_b32 s23, s16, 3
  s_add_u32 s23, s23, 110594
  v_add_u32 v8, s23, v8
  v_mov_b32 v32, 0
  v_mov_b32 v33, 0
  v_mov_b32 v34, 0
  v_mov_b32 v35, 0
  v_mov_b32 v36, 0
  v_mov_b32 v37, 0
  v_mov_b32 v38, 0
  v_mov_b32 v39, 0
  v_mov_b32 v40, 0
  v_mov_b32 v41, 0
  v_mov_b32 v42, 0
  v_mov_b32 v43, 0
  v_mov_b32 v44, 0
  v_mov_b32 v45, 0
  v_mov_b32 v46, 0
  v_mov_b32 v47, 0
  v_mov_b32 v48, 0
  v_mov_b32 v49, 0
  v_mov_b32 v50, 0
  v_mov_b32 v51, 0
  v_mov_b32 v52, 0
  v_mov_b32 v53, 0
  v_mov_b32 v54, 0
  v_mov_b32 v55, 0
  v_mov_b32 v56, 0
  v_mov_b32 v57, 0
  v_mov_b32 v58, 0
  v_mov_b32 v59, 0
  v_mov_b32 v60, 0
  v_mov_b32 v61, 0
  v_mov_b32 v62, 0
  v_mov_b32 v63, 0
  v_mov_b32 v10, 161288
  s_branch L_ls3b
L_ls3:
  s_sleep 1
L_ls3b:
  ds_read_b32 v11, v10
  s_waitcnt lgkmcnt(0)
  v_readfirstlane_b32 s59, v11
  s_nop 1
  s_cmp_ge_u32 s59, 64
  s_cbranch_scc0 L_ls3
  v_lshlrev_b32 v240, 11, v4
  v_lshl_add_u32 v240, v3, 2, v240
  s_mul_i32 s22, s33, 9
  s_add_u32 s22, s22, s20
  s_lshl_b32 s22, s22, 15
  s_lshl_b32 s23, s21, 6
  s_add_u32 s22, s22, s23
  s_add_u32 s22, s22, 0
  s_add_u32 s24, s22, 8192
  s_add_u32 s25, s22, 16384
  s_add_u32 s26, s22, 24576
  s_mov_b32 s27, s22
  v_cvt_f32_u32 v5, v3
  v_mul_f32 v5, 0x3c800000, v5
  v_cvt_f32_u32 v6, v4
  v_mul_f32 v6, 4.0, v6
  v_mul_f32 v6, v6, v5
  v_mul_f32 v7, 0x41500000, v5
  ds_read_u16_d16_hi v32, v8 offset:0
  ds_read_u16_d16_hi v48, v8 offset:8192
  ds_read_u16_d16_hi v33, v8 offset:128
  ds_read_u16_d16_hi v49, v8 offset:8320
  v_cos_f32 v10, v6
  v_sin_f32 v11, v6
  v_add_f32 v6, v6, v5
  v_cvt_pk_bf16_f32 v112, v10, v11
  v_cvt_pk_bf16_f32 v128, -v11, v10
  v_cvt_pk_bf16_f32 v144, v10, v11
  v_cvt_pk_bf16_f32 v160, -v11, v10
  v_cvt_pk_bf16_f32 v176, v10, v11
  v_cvt_pk_bf16_f32 v192, -v11, v10
  v_cvt_pk_bf16_f32 v208, v10, v11
  v_cvt_pk_bf16_f32 v224, -v11, v10
  ds_read_u16_d16_hi v34, v8 offset:256
  ds_read_u16_d16_hi v50, v8 offset:8448
  ds_read_u16_d16_hi v35, v8 offset:384
  ds_read_u16_d16_hi v51, v8 offset:8576
  v_cos_f32 v12, v6
  v_sin_f32 v13, v6
  v_add_f32 v6, v6, v5
  v_cvt_pk_bf16_f32 v113, v12, v13
  v_cvt_pk_bf16_f32 v129, -v13, v12
  v_cvt_pk_bf16_f32 v145, -v13, v12
  v_cvt_pk_bf16_f32 v161, -v12, -v13
  v_cvt_pk_bf16_f32 v177, -v12, -v13
  v_cvt_pk_bf16_f32 v193, v13, -v12
  v_cvt_pk_bf16_f32 v209, v13, -v12
  v_cvt_pk_bf16_f32 v225, v12, v13
  ds_read_u16_d16_hi v36, v8 offset:2048
  ds_read_u16_d16_hi v52, v8 offset:10240
  ds_read_u16_d16_hi v37, v8 offset:2176
  ds_read_u16_d16_hi v53, v8 offset:10368
  v_cos_f32 v10, v6
  v_sin_f32 v11, v6
  v_add_f32 v6, v6, v5
  v_cvt_pk_bf16_f32 v114, v10, v11
  v_cvt_pk_bf16_f32 v130, -v11, v10
  v_cvt_pk_bf16_f32 v146, -v10, -v11
  v_cvt_pk_bf16_f32 v162, v11, -v10
  v_cvt_pk_bf16_f32 v178, v10, v11
  v_cvt_pk_bf16_f32 v194, -v11, v10
  v_cvt_pk_bf16_f32 v210, -v10, -v11
  v_cvt_pk_bf16_f32 v226, v11, -v10
  ds_read_u16_d16_hi v38, v8 offset:2304
  ds_read_u16_d16_hi v54, v8 offset:10496
  ds_read_u16_d16_hi v39, v8 offset:2432
  ds_read_u16_d16_hi v55, v8 offset:10624
  v_cos_f32 v12, v6
  v_sin_f32 v13, v6
  v_add_f32 v6, v6, v7
  v_cvt_pk_bf16_f32 v115, v12, v13
  v_cvt_pk_bf16_f32 v131, -v13, v12
  v_cvt_pk_bf16_f32 v147, v13, -v12
  v_cvt_pk_bf16_f32 v163, v12, v13
  v_cvt_pk_bf16_f32 v179, -v12, -v13
  v_cvt_pk_bf16_f32 v195, v13, -v12
  v_cvt_pk_bf16_f32 v211, -v13, v12
  v_cvt_pk_bf16_f32 v227, -v12, -v13
  ds_read_u16_d16_hi v40, v8 offset:4096
  ds_read_u16_d16_hi v56, v8 offset:12288
  ds_read_u16_d16_hi v41, v8 offset:4224
  ds_read_u16_d16_hi v57, v8 offset:12416
  v_cos_f32 v10, v6
  v_sin_f32 v11, v6
  v_add_f32 v6, v6, v5
  v_cvt_pk_bf16_f32 v116, v10, v11
  v_cvt_pk_bf16_f32 v132, -v11, v10
  v_cvt_pk_bf16_f32 v148, v10, v11
  v_cvt_pk_bf16_f32 v164, -v11, v10
  v_cvt_pk_bf16_f32 v180, v10, v11
  v_cvt_pk_bf16_f32 v196, -v11, v10
  v_cvt_pk_bf16_f32 v212, v10, v11
  v_cvt_pk_bf16_f32 v228, -v11, v10
  ds_read_u16_d16_hi v42, v8 offset:4352
  ds_read_u16_d16_hi v58, v8 offset:12544
  ds_read_u16_d16_hi v43, v8 offset:4480
  ds_read_u16_d16_hi v59, v8 offset:12672
  v_cos_f32 v12, v6
  v_sin_f32 v13, v6
  v_add_f32 v6, v6, v5
  v_cvt_pk_bf16_f32 v117, v12, v13
  v_cvt_pk_bf16_f32 v133, -v13, v12
  v_cvt_pk_bf16_f32 v149, -v13, v12
  v_cvt_pk_bf16_f32 v165, -v12, -v13
  v_cvt_pk_bf16_f32 v181, -v12, -v13
  v_cvt_pk_bf16_f32 v197, v13, -v12
  v_cvt_pk_bf16_f32 v213, v13, -v12
  v_cvt_pk_bf16_f32 v229, v12, v13
  ds_read_u16_d16_hi v44, v8 offset:6144
  ds_read_u16_d16_hi v60, v8 offset:14336
  ds_read_u16_d16_hi v45, v8 offset:6272
  ds_read_u16_d16_hi v61, v8 offset:14464
  v_cos_f32 v10, v6
  v_sin_f32 v11, v6
  v_add_f32 v6, v6, v5
  v_cvt_pk_bf16_f32 v118, v10, v11
  v_cvt_pk_bf16_f32 v134, -v11, v10
  v_cvt_pk_bf16_f32 v150, -v10, -v11
  v_cvt_pk_bf16_f32 v166, v11, -v10
  v_cvt_pk_bf16_f32 v182, v10, v11
  v_cvt_pk_bf16_f32 v198, -v11, v10
  v_cvt_pk_bf16_f32 v214, -v10, -v11
  v_cvt_pk_bf16_f32 v230, v11, -v10
  ds_read_u16_d16_hi v46, v8 offset:6400
  ds_read_u16_d16_hi v62, v8 offset:14592
  ds_read_u16_d16_hi v47, v8 offset:6528
  ds_read_u16_d16_hi v63, v8 offset:14720
  v_cos_f32 v12, v6
  v_sin_f32 v13, v6
  v_add_f32 v6, v6, v7
  v_cvt_pk_bf16_f32 v119, v12, v13
  v_cvt_pk_bf16_f32 v135, -v13, v12
  v_cvt_pk_bf16_f32 v151, v13, -v12
  v_cvt_pk_bf16_f32 v167, v12, v13
  v_cvt_pk_bf16_f32 v183, -v12, -v13
  v_cvt_pk_bf16_f32 v199, v13, -v12
  v_cvt_pk_bf16_f32 v215, -v13, v12
  v_cvt_pk_bf16_f32 v231, -v12, -v13
  v_cos_f32 v10, v6
  v_sin_f32 v11, v6
  v_add_f32 v6, v6, v5
  v_cvt_pk_bf16_f32 v120, v10, v11
  v_cvt_pk_bf16_f32 v136, -v11, v10
  v_cvt_pk_bf16_f32 v152, v10, v11
  v_cvt_pk_bf16_f32 v168, -v11, v10
  v_cvt_pk_bf16_f32 v184, v10, v11
  v_cvt_pk_bf16_f32 v200, -v11, v10
  v_cvt_pk_bf16_f32 v216, v10, v11
  v_cvt_pk_bf16_f32 v232, -v11, v10
  v_cos_f32 v12, v6
  v_sin_f32 v13, v6
  v_add_f32 v6, v6, v5
  v_cvt_pk_bf16_f32 v121, v12, v13
  v_cvt_pk_bf16_f32 v137, -v13, v12
  v_cvt_pk_bf16_f32 v153, -v13, v12
  v_cvt_pk_bf16_f32 v169, -v12, -v13
  v_cvt_pk_bf16_f32 v185, -v12, -v13
  v_cvt_pk_bf16_f32 v201, v13, -v12
  v_cvt_pk_bf16_f32 v217, v13, -v12
  v_cvt_pk_bf16_f32 v233, v12, v13
  v_cos_f32 v10, v6
  v_sin_f32 v11, v6
  v_add_f32 v6, v6, v5
  v_cvt_pk_bf16_f32 v122, v10, v11
  v_cvt_pk_bf16_f32 v138, -v11, v10
  v_cvt_pk_bf16_f32 v154, -v10, -v11
  v_cvt_pk_bf16_f32 v170, v11, -v10
  v_cvt_pk_bf16_f32 v186, v10, v11
  v_cvt_pk_bf16_f32 v202, -v11, v10
  v_cvt_pk_bf16_f32 v218, -v10, -v11
  v_cvt_pk_bf16_f32 v234, v11, -v10
  v_cos_f32 v12, v6
  v_sin_f32 v13, v6
  v_add_f32 v6, v6, v7
  v_cvt_pk_bf16_f32 v123, v12, v13
  v_cvt_pk_bf16_f32 v139, -v13, v12
  v_cvt_pk_bf16_f32 v155, v13, -v12
  v_cvt_pk_bf16_f32 v171, v12, v13
  v_cvt_pk_bf16_f32 v187, -v12, -v13
  v_cvt_pk_bf16_f32 v203, v13, -v12
  v_cvt_pk_bf16_f32 v219, -v13, v12
  v_cvt_pk_bf16_f32 v235, -v12, -v13
  v_cos_f32 v10, v6
  v_sin_f32 v11, v6
  v_add_f32 v6, v6, v5
  v_cvt_pk_bf16_f32 v124, v10, v11
  v_cvt_pk_bf16_f32 v140, -v11, v10
  v_cvt_pk_bf16_f32 v156, v10, v11
  v_cvt_pk_bf16_f32 v172, -v11, v10
  v_cvt_pk_bf16_f32 v188, v10, v11
  v_cvt_pk_bf16_f32 v204, -v11, v10
  v_cvt_pk_bf16_f32 v220, v10, v11
  v_cvt_pk_bf16_f32 v236, -v11, v10
  v_cos_f32 v12, v6
  v_sin_f32 v13, v6
  v_add_f32 v6, v6, v5
  v_cvt_pk_bf16_f32 v125, v12, v13
  v_cvt_pk_bf16_f32 v141, -v13, v12
  v_cvt_pk_bf16_f32 v157, -v13, v12
  v_cvt_pk_bf16_f32 v173, -v12, -v13
  v_cvt_pk_bf16_f32 v189, -v12, -v13
  v_cvt_pk_bf16_f32 v205, v13, -v12
  v_cvt_pk_bf16_f32 v221, v13, -v12
  v_cvt_pk_bf16_f32 v237, v12, v13
  v_cos_f32 v10, v6
  v_sin_f32 v11, v6
  v_add_f32 v6, v6, v5
  v_cvt_pk_bf16_f32 v126, v10, v11
  v_cvt_pk_bf16_f32 v142, -v11, v10
  v_cvt_pk_bf16_f32 v158, -v10, -v11
  v_cvt_pk_bf16_f32 v174, v11, -v10
  v_cvt_pk_bf16_f32 v190, v10, v11
  v_cvt_pk_bf16_f32 v206, -v11, v10
  v_cvt_pk_bf16_f32 v222, -v10, -v11
  v_cvt_pk_bf16_f32 v238, v11, -v10
  v_cos_f32 v12, v6
  v_sin_f32 v13, v6
  v_add_f32 v6, v6, v7
  v_cvt_pk_bf16_f32 v127, v12, v13
  v_cvt_pk_bf16_f32 v143, -v13, v12
  v_cvt_pk_bf16_f32 v159, v13, -v12
  v_cvt_pk_bf16_f32 v175, v12, v13
  v_cvt_pk_bf16_f32 v191, -v12, -v13
  v_cvt_pk_bf16_f32 v207, v13, -v12
  v_cvt_pk_bf16_f32 v223, -v13, v12
  v_cvt_pk_bf16_f32 v239, -v12, -v13
  buffer_load_dword v16, v240, s[12:15], s27 offen offset:0 sc1
  buffer_load_dword v17, v240, s[12:15], s27 offen offset:512 sc1
  buffer_load_dword v18, v240, s[12:15], s27 offen offset:1024 sc1
  buffer_load_dword v19, v240, s[12:15], s27 offen offset:1536 sc1
  buffer_load_dword v20, v240, s[12:15], s24 offen offset:0 sc1
  buffer_load_dword v21, v240, s[12:15], s24 offen offset:512 sc1
  buffer_load_dword v22, v240, s[12:15], s24 offen offset:1024 sc1
  buffer_load_dword v23, v240, s[12:15], s24 offen offset:1536 sc1
  buffer_load_dword v24, v240, s[12:15], s25 offen offset:0 sc1
  buffer_load_dword v25, v240, s[12:15], s25 offen offset:512 sc1
L_qad1:
  s_cbranch_execz L_qad2
  buffer_load_dword v26, v240, s[12:15], s25 offen offset:1024 sc1
  buffer_load_dword v27, v240, s[12:15], s25 offen offset:1536 sc1
  buffer_load_dword v28, v240, s[12:15], s26 offen offset:0 sc1
  buffer_load_dword v29, v240, s[12:15], s26 offen offset:512 sc1
  buffer_load_dword v30, v240, s[12:15], s26 offen offset:1024 sc1
  buffer_load_dword v31, v240, s[12:15], s26 offen offset:1536 sc1
  s_mov_b32 s23, 36864
  v_lshrrev_b32 v6, 2, v9
  v_mul_lo_u32 v6, v6, s23
  v_and_b32 v7, 3, v9
  v_lshl_add_u32 v6, v7, 4, v6
  s_lshl_b32 s23, s16, 12
  s_add_u32 s23, s23, 147456
  v_lshlrev_b32 v7, 6, v3
  v_lshl_add_u32 v7, v4, 4, v7
  v_add_u32 v7, s23, v7
  v_add_u32 v15, s23, v14
  s_lshl_b32 s22, s20, 12
  s_lshl_b32 s23, s33, 9
  s_add_u32 s22, s22, s23
  s_lshl_b32 s23, s21, 6
  s_add_u32 s22, s22, s23
  s_add_u32 s22, s22, 2359296
  s_waitcnt lgkmcnt(0)
  v_mul_f32 v32, 0x6ce38e39, v32
  v_mul_f32 v33, 0x6ce38e39, v33
  v_mul_f32 v34, 0x6ce38e39, v34
  v_mul_f32 v35, 0x6ce38e39, v35
  v_mul_f32 v36, 0x6ce38e39, v36
  v_mul_f32 v37, 0x6ce38e39, v37
  v_mul_f32 v38, 0x6ce38e39, v38
  v_mul_f32 v39, 0x6ce38e39, v39
  v_mul_f32 v40, 0x6ce38e39, v40
  v_mul_f32 v41, 0x6ce38e39, v41
  v_mul_f32 v42, 0x6ce38e39, v42
  v_mul_f32 v43, 0x6ce38e39, v43
  v_mul_f32 v44, 0x6ce38e39, v44
  v_mul_f32 v45, 0x6ce38e39, v45
  v_mul_f32 v46, 0x6ce38e39, v46
  v_mul_f32 v47, 0x6ce38e39, v47
  v_mul_f32 v48, 0x6ce38e39, v48
  v_mul_f32 v49, 0x6ce38e39, v49
  v_mul_f32 v50, 0x6ce38e39, v50
  v_mul_f32 v51, 0x6ce38e39, v51
  v_mul_f32 v52, 0x6ce38e39, v52
  v_mul_f32 v53, 0x6ce38e39, v53
  v_mul_f32 v54, 0x6ce38e39, v54
  v_mul_f32 v55, 0x6ce38e39, v55
  v_mul_f32 v56, 0x6ce38e39, v56
  v_mul_f32 v57, 0x6ce38e39, v57
  v_mul_f32 v58, 0x6ce38e39, v58
  v_mul_f32 v59, 0x6ce38e39, v59
  v_mul_f32 v60, 0x6ce38e39, v60
  v_mul_f32 v61, 0x6ce38e39, v61
  v_mul_f32 v62, 0x6ce38e39, v62
  v_mul_f32 v63, 0x6ce38e39, v63
  v_mov_b32 v10, 161288
  s_branch L_ls4b
L_ls4:
  s_sleep 1
L_ls4b:
  ds_read_b32 v11, v10
  s_waitcnt lgkmcnt(0)
  v_readfirstlane_b32 s59, v11
  s_nop 1
  s_cmp_ge_u32 s59, 128
  s_cbranch_scc0 L_ls4
  s_waitcnt vmcnt(0)
  v_xor_b32 v16, v16, v246
  v_xor_b32 v17, v17, v246
  v_xor_b32 v18, v18, v246
  v_xor_b32 v19, v19, v246
  v_xor_b32 v20, v20, v246
  v_xor_b32 v21, v21, v246
  v_xor_b32 v22, v22, v246
  v_xor_b32 v23, v23, v246
  v_xor_b32 v24, v24, v246
  v_xor_b32 v25, v25, v246
  v_xor_b32 v26, v26, v246
  v_xor_b32 v27, v27, v246
  v_xor_b32 v28, v28, v246
  v_xor_b32 v29, v29, v246
  v_xor_b32 v30, v30, v246
  v_xor_b32 v31, v31, v246
  v_or3_b32 v10, v16, v17, v18
  v_or3_b32 v11, v19, v20, v21
  v_or3_b32 v10, v10, v22, v23
  v_or3_b32 v11, v11, v24, v25
  v_or3_b32 v10, v10, v26, v27
  v_or3_b32 v11, v11, v28, v29
  v_or3_b32 v10, v10, v30, v31
  v_or_b32 v10, v10, v11
  v_and_b32 v10, 1879076864, v10
  v_cmp_ne_u32 vcc, 0, v10
  s_nop 1
  s_cmp_eq_u64 vcc, 0
  s_cbranch_scc1 L_ok5
  s_mov_b32 s59, 50000
L_lp6:
  buffer_load_dword v16, v240, s[12:15], s27 offen offset:0 sc1
  buffer_load_dword v17, v240, s[12:15], s27 offen offset:512 sc1
  buffer_load_dword v18, v240, s[12:15], s27 offen offset:1024 sc1
  buffer_load_dword v19, v240, s[12:15], s27 offen offset:1536 sc1
  buffer_load_dword v20, v240, s[12:15], s24 offen offset:0 sc1
  buffer_load_dword v21, v240, s[12:15], s24 offen offset:512 sc1
  buffer_load_dword v22, v240, s[12:15], s24 offen offset:1024 sc1
  buffer_load_dword v23, v240, s[12:15], s24 offen offset:1536 sc1
  buffer_load_dword v24, v240, s[12:15], s25 offen offset:0 sc1
  buffer_load_dword v25, v240, s[12:15], s25 offen offset:512 sc1
  buffer_load_dword v26, v240, s[12:15], s25 offen offset:1024 sc1
  buffer_load_dword v27, v240, s[12:15], s25 offen offset:1536 sc1
  buffer_load_dword v28, v240, s[12:15], s26 offen offset:0 sc1
  buffer_load_dword v29, v240, s[12:15], s26 offen offset:512 sc1
  buffer_load_dword v30, v240, s[12:15], s26 offen offset:1024 sc1
  buffer_load_dword v31, v240, s[12:15], s26 offen offset:1536 sc1
  s_waitcnt vmcnt(0)
  v_xor_b32 v16, v16, v246
  v_xor_b32 v17, v17, v246
  v_xor_b32 v18, v18, v246
  v_xor_b32 v19, v19, v246
  v_xor_b32 v20, v20, v246
  v_xor_b32 v21, v21, v246
  v_xor_b32 v22, v22, v246
  v_xor_b32 v23, v23, v246
  v_xor_b32 v24, v24, v246
  v_xor_b32 v25, v25, v246
  v_xor_b32 v26, v26, v246
  v_xor_b32 v27, v27, v246
  v_xor_b32 v28, v28, v246
  v_xor_b32 v29, v29, v246
  v_xor_b32 v30, v30, v246
  v_xor_b32 v31, v31, v246
  v_or3_b32 v10, v16, v17, v18
  v_or3_b32 v11, v19, v20, v21
  v_or3_b32 v10, v10, v22, v23
  v_or3_b32 v11, v11, v24, v25
  v_or3_b32 v10, v10, v26, v27
  v_or3_b32 v11, v11, v28, v29
  v_or3_b32 v10, v10, v30, v31
  v_or_b32 v10, v10, v11
  v_and_b32 v10, 1879076864, v10
  v_cmp_ne_u32 vcc, 0, v10
  s_nop 1
  s_cmp_eq_u64 vcc, 0
  s_cbranch_scc1 L_ok5
  s_sub_u32 s59, s59, 1
  s_cbranch_scc0 L_lp6
L_ok5:
  v_mfma_f32_16x16x32_bf16 v[64:67], v[112:115], v[16:19], 0
  v_mfma_f32_16x16x32_bf16 v[64:67], v[116:119], v[20:23], v[64:67]
  v_mfma_f32_16x16x32_bf16 v[64:67], v[120:123], v[24:27], v[64:67]
  v_mfma_f32_16x16x32_bf16 v[64:67], v[124:127], v[28:31], v[64:67]
  v_mfma_f32_16x16x32_bf16 v[80:83], v[128:131], v[16:19], 0
  v_mfma_f32_16x16x32_bf16 v[80:83], v[132:135], v[20:23], v[80:83]
  v_mfma_f32_16x16x32_bf16 v[80:83], v[136:139], v[24:27], v[80:83]
  v_mfma_f32_16x16x32_bf16 v[80:83], v[140:143], v[28:31], v[80:83]
  v_mfma_f32_16x16x32_bf16 v[68:71], v[144:147], v[16:19], 0
  v_mfma_f32_16x16x32_bf16 v[68:71], v[148:151], v[20:23], v[68:71]
  v_mfma_f32_16x16x32_bf16 v[68:71], v[152:155], v[24:27], v[68:71]
  v_mfma_f32_16x16x32_bf16 v[68:71], v[156:159], v[28:31], v[68:71]
  v_mfma_f32_16x16x32_bf16 v[84:87], v[160:163], v[16:19], 0
  v_mfma_f32_16x16x32_bf16 v[84:87], v[164:167], v[20:23], v[84:87]
  v_mfma_f32_16x16x32_bf16 v[84:87], v[168:171], v[24:27], v[84:87]
  v_mfma_f32_16x16x32_bf16 v[84:87], v[172:175], v[28:31], v[84:87]
  v_mfma_f32_16x16x32_bf16 v[72:75], v[176:179], v[16:19], 0
  v_mul_f32 v10, v64, v32
  v_mul_f32 v11, v65, v33
  v_mul_f32 v12, v66, v34
  v_mfma_f32_16x16x32_bf16 v[72:75], v[180:183], v[20:23], v[72:75]
  v_mul_f32 v13, v67, v35
  v_mul_f32 v64, v64, v48
  v_mfma_f32_16x16x32_bf16 v[72:75], v[184:187], v[24:27], v[72:75]
  v_mul_f32 v65, v65, v49
  v_mul_f32 v66, v66, v50
  v_mul_f32 v67, v67, v51
  v_mfma_f32_16x16x32_bf16 v[72:75], v[188:191], v[28:31], v[72:75]
  v_fma_f32 v10, -v80, v48, v10
  v_fma_f32 v11, -v81, v49, v11
  v_mfma_f32_16x16x32_bf16 v[88:91], v[192:195], v[16:19], 0
  v_fma_f32 v12, -v82, v50, v12
  v_fma_f32 v13, -v83, v51, v13
  v_fmac_f32 v64, v80, v32
  v_mfma_f32_16x16x32_bf16 v[88:91], v[196:199], v[20:23], v[88:91]
  v_fmac_f32 v65, v81, v33
  v_fmac_f32 v66, v82, v34
  v_mfma_f32_16x16x32_bf16 v[88:91], v[200:203], v[24:27], v[88:91]
  v_fmac_f32 v67, v83, v35
  v_cvt_pk_bf16_f32 v96, v10, -v64
  v_cvt_pk_bf16_f32 v97, v11, -v65
  v_mfma_f32_16x16x32_bf16 v[88:91], v[204:207], v[28:31], v[88:91]
  v_cvt_pk_bf16_f32 v98, v12, -v66
  v_cvt_pk_bf16_f32 v99, v13, -v67
  v_mfma_f32_16x16x32_bf16 v[76:79], v[208:211], v[16:19], 0
  v_mul_f32 v10, v68, v36
  v_mul_f32 v11, v69, v37
  v_mul_f32 v12, v70, v38
  v_mfma_f32_16x16x32_bf16 v[76:79], v[212:215], v[20:23], v[76:79]
  v_mul_f32 v13, v71, v39
  v_mul_f32 v68, v68, v52
  v_mfma_f32_16x16x32_bf16 v[76:79], v[216:219], v[24:27], v[76:79]
  v_mul_f32 v69, v69, v53
  v_mul_f32 v70, v70, v54
  v_mul_f32 v71, v71, v55
  v_mfma_f32_16x16x32_bf16 v[76:79], v[220:223], v[28:31], v[76:79]
  v_fma_f32 v10, -v84, v52, v10
  v_fma_f32 v11, -v85, v53, v11
  v_mfma_f32_16x16x32_bf16 v[92:95], v[224:227], v[16:19], 0
  v_fma_f32 v12, -v86, v54, v12
  v_fma_f32 v13, -v87, v55, v13
  v_fmac_f32 v68, v84, v36
  v_mfma_f32_16x16x32_bf16 v[92:95], v[228:231], v[20:23], v[92:95]
  v_fmac_f32 v69, v85, v37
  v_fmac_f32 v70, v86, v38
  v_mfma_f32_16x16x32_bf16 v[92:95], v[232:235], v[24:27], v[92:95]
  v_fmac_f32 v71, v87, v39
  v_cvt_pk_bf16_f32 v100, v10, -v68
  v_cvt_pk_bf16_f32 v101, v11, -v69
  v_mfma_f32_16x16x32_bf16 v[92:95], v[236:239], v[28:31], v[92:95]
  v_cvt_pk_bf16_f32 v102, v12, -v70
  v_cvt_pk_bf16_f32 v103, v13, -v71
  v_mfma_f32_16x16x32_bf16 v[16:19], v[96:99], v[112:115], 0
  v_mul_f32 v10, v72, v40
  v_mul_f32 v11, v73, v41
  v_mul_f32 v12, v74, v42
  v_mfma_f32_16x16x32_bf16 v[64:67], v[96:99], v[128:131], 0
  v_mul_f32 v13, v75, v43
  v_mul_f32 v72, v72, v56
  v_mfma_f32_16x16x32_bf16 v[20:23], v[96:99], v[144:147], 0
  v_mul_f32 v73, v73, v57
  v_mul_f32 v74, v74, v58
  v_mul_f32 v75, v75, v59
  v_mfma_f32_16x16x32_bf16 v[68:71], v[96:99], v[160:163], 0
  v_fma_f32 v10, -v88, v56, v10
  v_fma_f32 v11, -v89, v57, v11
  v_mfma_f32_16x16x32_bf16 v[24:27], v[96:99], v[176:179], 0
  v_fma_f32 v12, -v90, v58, v12
  v_fma_f32 v13, -v91, v59, v13
  v_fmac_f32 v72, v88, v40
  v_mfma_f32_16x16x32_bf16 v[80:83], v[96:99], v[192:195], 0
  v_fmac_f32 v73, v89, v41
  v_fmac_f32 v74, v90, v42
  v_mfma_f32_16x16x32_bf16 v[28:31], v[96:99], v[208:211], 0
  v_fmac_f32 v75, v91, v43
  v_cvt_pk_bf16_f32 v104, v10, -v72
  v_cvt_pk_bf16_f32 v105, v11, -v73
  v_mfma_f32_16x16x32_bf16 v[84:87], v[96:99], v[224:227], 0
  v_cvt_pk_bf16_f32 v106, v12, -v74
  v_cvt_pk_bf16_f32 v107, v13, -v75
  v_mfma_f32_16x16x32_bf16 v[16:19], v[100:103], v[116:119], v[16:19]
  v_mul_f32 v10, v76, v44
  v_mul_f32 v11, v77, v45
  v_mul_f32 v12, v78, v46
  v_mfma_f32_16x16x32_bf16 v[64:67], v[100:103], v[132:135], v[64:67]
  v_mul_f32 v13, v79, v47
  v_mul_f32 v76, v76, v60
  v_mfma_f32_16x16x32_bf16 v[20:23], v[100:103], v[148:151], v[20:23]
  v_mul_f32 v77, v77, v61
  v_mul_f32 v78, v78, v62
  v_mul_f32 v79, v79, v63
  v_mfma_f32_16x16x32_bf16 v[68:71], v[100:103], v[164:167], v[68:71]
  v_fma_f32 v10, -v92, v60, v10
  v_fma_f32 v11, -v93, v61, v11
  v_mfma_f32_16x16x32_bf16 v[24:27], v[100:103], v[180:183], v[24:27]
  v_fma_f32 v12, -v94, v62, v12
  v_fma_f32 v13, -v95, v63, v13
  v_fmac_f32 v76, v92, v44
  v_mfma_f32_16x16x32_bf16 v[80:83], v[100:103], v[196:199], v[80:83]
  v_fmac_f32 v77, v93, v45
  v_fmac_f32 v78, v94, v46
  v_mfma_f32_16x16x32_bf16 v[28:31], v[100:103], v[212:215], v[28:31]
  v_fmac_f32 v79, v95, v47
  v_cvt_pk_bf16_f32 v108, v10, -v76
  v_cvt_pk_bf16_f32 v109, v11, -v77
  v_mfma_f32_16x16x32_bf16 v[84:87], v[100:103], v[228:231], v[84:87]
  v_cvt_pk_bf16_f32 v110, v12, -v78
  v_cvt_pk_bf16_f32 v111, v13, -v79
  s_nop 1
  v_mfma_f32_16x16x32_bf16 v[16:19], v[104:107], v[120:123], v[16:19]
  v_mfma_f32_16x16x32_bf16 v[64:67], v[104:107], v[136:139], v[64:67]
  v_mfma_f32_16x16x32_bf16 v[20:23], v[104:107], v[152:155], v[20:23]
  v_mfma_f32_16x16x32_bf16 v[68:71], v[104:107], v[168:171], v[68:71]
  v_mfma_f32_16x16x32_bf16 v[24:27], v[104:107], v[184:187], v[24:27]
  v_mfma_f32_16x16x32_bf16 v[80:83], v[104:107], v[200:203], v[80:83]
  v_mfma_f32_16x16x32_bf16 v[28:31], v[104:107], v[216:219], v[28:31]
  v_mfma_f32_16x16x32_bf16 v[84:87], v[104:107], v[232:235], v[84:87]
  v_mfma_f32_16x16x32_bf16 v[16:19], v[108:111], v[124:127], v[16:19]
  v_mfma_f32_16x16x32_bf16 v[64:67], v[108:111], v[140:143], v[64:67]
  v_mfma_f32_16x16x32_bf16 v[20:23], v[108:111], v[156:159], v[20:23]
  v_mfma_f32_16x16x32_bf16 v[68:71], v[108:111], v[172:175], v[68:71]
  v_mfma_f32_16x16x32_bf16 v[24:27], v[108:111], v[188:191], v[24:27]
  v_mfma_f32_16x16x32_bf16 v[80:83], v[108:111], v[204:207], v[80:83]
  v_mfma_f32_16x16x32_bf16 v[28:31], v[108:111], v[220:223], v[28:31]
  v_mfma_f32_16x16x32_bf16 v[84:87], v[108:111], v[236:239], v[84:87]
  s_nop 1
  v_cvt_pk_bf16_f32 v32, v16, -v64
  v_cvt_pk_bf16_f32 v33, v17, -v65
  v_cvt_pk_bf16_f32 v34, v18, -v66
  v_cvt_pk_bf16_f32 v35, v19, -v67
  ds_write_b128 v7, v[32:35] offset:0
  ds_read_b128 v[48:51], v15 offset:0
  v_cvt_pk_bf16_f32 v36, v20, -v68
  v_cvt_pk_bf16_f32 v37, v21, -v69
  v_cvt_pk_bf16_f32 v38, v22, -v70
  v_cvt_pk_bf16_f32 v39, v23, -v71
  ds_write_b128 v7, v[36:39] offset:1024
  ds_read_b128 v[52:55], v15 offset:1024
  v_cvt_pk_bf16_f32 v40, v24, -v80
  v_cvt_pk_bf16_f32 v41, v25, -v81
  v_cvt_pk_bf16_f32 v42, v26, -v82
  v_cvt_pk_bf16_f32 v43, v27, -v83
  ds_write_b128 v7, v[40:43] offset:2048
  ds_read_b128 v[56:59], v15 offset:2048
  s_nop 0
  v_cvt_pk_bf16_f32 v44, v28, -v84
  v_cvt_pk_bf16_f32 v45, v29, -v85
  v_cvt_pk_bf16_f32 v46, v30, -v86
  v_cvt_pk_bf16_f32 v47, v31, -v87
  ds_write_b128 v7, v[44:47] offset:3072
  ds_read_b128 v[60:63], v15 offset:3072
  s_waitcnt lgkmcnt(6)
  buffer_store_dwordx4 v[48:51], v6, s[12:15], s22 offen sc1
  s_add_u32 s22, s22, 589824
  s_waitcnt lgkmcnt(4)
  buffer_store_dwordx4 v[52:55], v6, s[12:15], s22 offen sc1
  s_add_u32 s22, s22, 589824
  s_waitcnt lgkmcnt(2)
  buffer_store_dwordx4 v[56:59], v6, s[12:15], s22 offen sc1
  s_add_u32 s22, s22, 589824
  s_waitcnt lgkmcnt(0)
  buffer_store_dwordx4 v[60:63], v6, s[12:15], s22 offen sc1
  s_waitcnt lgkmcnt(0)
  v_mov_b32 v10, 161292
  v_mov_b32 v11, 1
  ds_add_u32 v10, v11
  v_and_b32 v4, 7, v1
  v_lshlrev_b32 v4, 1, v4
  v_bfe_u32 v5, v1, 3, 1
  v_add_u32 v4, v4, v5
  v_and_b32 v5, 16, v1
  v_add_u32 v4, v4, v5
  v_lshlrev_b32 v4, 4, v4
  v_lshl_add_u32 v4, v2, 9, v4
  s_mul_i32 s20, s17, 9
  s_mul_i32 s23, s16, 3
  s_add_u32 s20, s20, s23
  s_lshl_b32 s20, s20, 12
  s_add_u32 s20, s20, 2359296
  s_add_u32 s21, s20, 4096
  s_add_u32 s22, s20, 8192
  s_mul_i32 s23, s16, 12288
  v_add_u32 v7, s23, v14
  v_and_b32 v10, 3, v9
  v_bfe_u32 v11, v9, 2, 1
  v_lshl_add_u32 v10, v11, 4, v10
  v_bfe_u32 v11, v9, 3, 2
  v_lshl_add_u32 v10, v11, 2, v10
  s_lshl_b32 s23, s19, 5
  v_add_u32 v10, s23, v10
  v_cvt_f32_u32 v10, v10
  v_mul_f32 v10, 0x3ae38e39, v10
  s_mul_i32 s23, s30, 96
  v_lshl_add_u32 v11, v2, 3, s23
  v_cvt_f32_u32 v11, v11
  v_add_f32 v11, 0x41480000, v11
  v_cvt_f32_u32 v13, v2
  s_cmp_eq_u32 s30, 2
  s_cselect_b32 s23, -0.5, 0
  v_fma_f32 v13, v13, s23, 1.0
  v_mul_f32 v12, 0x40900000, v10
  v_cos_f32 v136, v12
  v_sin_f32 v137, v12
  v_mul_f32 v12, 0x40d00000, v10
  v_cos_f32 v138, v12
  v_sin_f32 v139, v12
  v_mul_f32 v12, 0x41080000, v10
  v_cos_f32 v140, v12
  v_sin_f32 v141, v12
  v_mul_f32 v12, 0x41280000, v10
  v_cos_f32 v142, v12
  v_sin_f32 v143, v12
  v_mul_f32 v12, 0x40b00000, v10
  v_cos_f32 v144, v12
  v_sin_f32 v145, v12
  v_mul_f32 v12, 0x40f00000, v10
  v_cos_f32 v146, v12
  v_sin_f32 v147, v12
  v_mul_f32 v12, 0x41180000, v10
  v_cos_f32 v148, v12
  v_sin_f32 v149, v12
  v_mul_f32 v12, 0x41380000, v10
  v_cos_f32 v150, v12
  v_sin_f32 v151, v12
  v_mul_f32 v12, v11, v10
  v_cos_f32 v14, v12
  v_sin_f32 v15, v12
  v_add_f32 v11, 0x42000000, v11
  v_pk_mul_f32 v[168:169], v[136:137], v[14:15] op_sel:[0,0] op_sel_hi:[0,1]
  v_pk_mul_f32 v[170:171], v[138:139], v[14:15] op_sel:[0,0] op_sel_hi:[0,1]
  v_pk_mul_f32 v[172:173], v[140:141], v[14:15] op_sel:[0,0] op_sel_hi:[0,1]
  v_pk_mul_f32 v[174:175], v[142:143], v[14:15] op_sel:[0,0] op_sel_hi:[0,1]
  v_pk_fma_f32 v[166:167], v[136:137], v[14:15], v[168:169] op_sel:[1,1,0] op_sel_hi:[1,0,1] neg_hi:[1,0,0]
  v_pk_fma_f32 v[164:165], v[138:139], v[14:15], v[170:171] op_sel:[1,1,0] op_sel_hi:[1,0,1] neg_hi:[1,0,0]
  v_pk_fma_f32 v[162:163], v[140:141], v[14:15], v[172:173] op_sel:[1,1,0] op_sel_hi:[1,0,1] neg_hi:[1,0,0]
  v_pk_fma_f32 v[160:161], v[142:143], v[14:15], v[174:175] op_sel:[1,1,0] op_sel_hi:[1,0,1] neg_hi:[1,0,0]
  v_pk_fma_f32 v[168:169], v[136:137], v[14:15], v[168:169] op_sel:[1,1,0] op_sel_hi:[1,0,1] neg_lo:[1,0,0]
  v_pk_fma_f32 v[170:171], v[138:139], v[14:15], v[170:171] op_sel:[1,1,0] op_sel_hi:[1,0,1] neg_lo:[1,0,0]
  v_pk_fma_f32 v[172:173], v[140:141], v[14:15], v[172:173] op_sel:[1,1,0] op_sel_hi:[1,0,1] neg_lo:[1,0,0]
  v_pk_fma_f32 v[174:175], v[142:143], v[14:15], v[174:175] op_sel:[1,1,0] op_sel_hi:[1,0,1] neg_lo:[1,0,0]
  v_cvt_pk_bf16_f32 v188, v160, -v161
  v_cvt_pk_bf16_f32 v189, v162, -v163
  v_cvt_pk_bf16_f32 v190, v164, -v165
  v_cvt_pk_bf16_f32 v191, v166, -v167
  v_accvgpr_write_b32 a100, v188
  v_accvgpr_write_b32 a101, v189
  v_accvgpr_write_b32 a102, v190
  v_accvgpr_write_b32 a103, v191
  v_cvt_pk_bf16_f32 v192, v168, -v169
  v_cvt_pk_bf16_f32 v193, v170, -v171
  v_cvt_pk_bf16_f32 v194, v172, -v173
  v_cvt_pk_bf16_f32 v195, v174, -v175
  v_accvgpr_write_b32 a104, v192
  v_accvgpr_write_b32 a105, v193
  v_accvgpr_write_b32 a106, v194
  v_accvgpr_write_b32 a107, v195
  v_pk_mul_f32 v[176:177], v[144:145], v[14:15] op_sel:[0,0] op_sel_hi:[0,1]
  v_pk_mul_f32 v[178:179], v[146:147], v[14:15] op_sel:[0,0] op_sel_hi:[0,1]
  v_pk_mul_f32 v[180:181], v[148:149], v[14:15] op_sel:[0,0] op_sel_hi:[0,1]
  v_pk_mul_f32 v[182:183], v[150:151], v[14:15] op_sel:[0,0] op_sel_hi:[0,1]
  v_pk_fma_f32 v[158:159], v[144:145], v[14:15], v[176:177] op_sel:[1,1,0] op_sel_hi:[1,0,1] neg_hi:[1,0,0]
  v_pk_fma_f32 v[156:157], v[146:147], v[14:15], v[178:179] op_sel:[1,1,0] op_sel_hi:[1,0,1] neg_hi:[1,0,0]
  v_pk_fma_f32 v[154:155], v[148:149], v[14:15], v[180:181] op_sel:[1,1,0] op_sel_hi:[1,0,1] neg_hi:[1,0,0]
  v_pk_fma_f32 v[152:153], v[150:151], v[14:15], v[182:183] op_sel:[1,1,0] op_sel_hi:[1,0,1] neg_hi:[1,0,0]
  v_pk_fma_f32 v[176:177], v[144:145], v[14:15], v[176:177] op_sel:[1,1,0] op_sel_hi:[1,0,1] neg_lo:[1,0,0]
  v_pk_fma_f32 v[178:179], v[146:147], v[14:15], v[178:179] op_sel:[1,1,0] op_sel_hi:[1,0,1] neg_lo:[1,0,0]
  v_pk_fma_f32 v[180:181], v[148:149], v[14:15], v[180:181] op_sel:[1,1,0] op_sel_hi:[1,0,1] neg_lo:[1,0,0]
  v_pk_fma_f32 v[182:183], v[150:151], v[14:15], v[182:183] op_sel:[1,1,0] op_sel_hi:[1,0,1] neg_lo:[1,0,0]
  v_cvt_pk_bf16_f32 v184, v152, -v153
  v_cvt_pk_bf16_f32 v185, v154, -v155
  v_cvt_pk_bf16_f32 v186, v156, -v157
  v_cvt_pk_bf16_f32 v187, v158, -v159
  v_accvgpr_write_b32 a96, v184
  v_accvgpr_write_b32 a97, v185
  v_accvgpr_write_b32 a98, v186
  v_accvgpr_write_b32 a99, v187
  v_cvt_pk_bf16_f32 v196, v176, -v177
  v_cvt_pk_bf16_f32 v197, v178, -v179
  v_cvt_pk_bf16_f32 v198, v180, -v181
  v_cvt_pk_bf16_f32 v199, v182, -v183
  v_accvgpr_write_b32 a108, v196
  v_accvgpr_write_b32 a109, v197
  v_accvgpr_write_b32 a110, v198
  v_accvgpr_write_b32 a111, v199
  v_mul_f32 v12, v11, v10
  v_cos_f32 v14, v12
  v_sin_f32 v15, v12
  v_add_f32 v11, 0x42000000, v11
  v_pk_mul_f32 v[168:169], v[136:137], v[14:15] op_sel:[0,0] op_sel_hi:[0,1]
  v_pk_mul_f32 v[170:171], v[138:139], v[14:15] op_sel:[0,0] op_sel_hi:[0,1]
  v_pk_mul_f32 v[172:173], v[140:141], v[14:15] op_sel:[0,0] op_sel_hi:[0,1]
  v_pk_mul_f32 v[174:175], v[142:143], v[14:15] op_sel:[0,0] op_sel_hi:[0,1]
  v_pk_fma_f32 v[166:167], v[136:137], v[14:15], v[168:169] op_sel:[1,1,0] op_sel_hi:[1,0,1] neg_hi:[1,0,0]
  v_pk_fma_f32 v[164:165], v[138:139], v[14:15], v[170:171] op_sel:[1,1,0] op_sel_hi:[1,0,1] neg_hi:[1,0,0]
  v_pk_fma_f32 v[162:163], v[140:141], v[14:15], v[172:173] op_sel:[1,1,0] op_sel_hi:[1,0,1] neg_hi:[1,0,0]
  v_pk_fma_f32 v[160:161], v[142:143], v[14:15], v[174:175] op_sel:[1,1,0] op_sel_hi:[1,0,1] neg_hi:[1,0,0]
  v_pk_fma_f32 v[168:169], v[136:137], v[14:15], v[168:169] op_sel:[1,1,0] op_sel_hi:[1,0,1] neg_lo:[1,0,0]
  v_pk_fma_f32 v[170:171], v[138:139], v[14:15], v[170:171] op_sel:[1,1,0] op_sel_hi:[1,0,1] neg_lo:[1,0,0]
  v_pk_fma_f32 v[172:173], v[140:141], v[14:15], v[172:173] op_sel:[1,1,0] op_sel_hi:[1,0,1] neg_lo:[1,0,0]
  v_pk_fma_f32 v[174:175], v[142:143], v[14:15], v[174:175] op_sel:[1,1,0] op_sel_hi:[1,0,1] neg_lo:[1,0,0]
  v_cvt_pk_bf16_f32 v188, v160, -v161
  v_cvt_pk_bf16_f32 v189, v162, -v163
  v_cvt_pk_bf16_f32 v190, v164, -v165
  v_cvt_pk_bf16_f32 v191, v166, -v167
  v_accvgpr_write_b32 a116, v188
  v_accvgpr_write_b32 a117, v189
  v_accvgpr_write_b32 a118, v190
  v_accvgpr_write_b32 a119, v191
  v_cvt_pk_bf16_f32 v192, v168, -v169
  v_cvt_pk_bf16_f32 v193, v170, -v171
  v_cvt_pk_bf16_f32 v194, v172, -v173
  v_cvt_pk_bf16_f32 v195, v174, -v175
  v_accvgpr_write_b32 a120, v192
  v_accvgpr_write_b32 a121, v193
  v_accvgpr_write_b32 a122, v194
  v_accvgpr_write_b32 a123, v195
  v_pk_mul_f32 v[176:177], v[144:145], v[14:15] op_sel:[0,0] op_sel_hi:[0,1]
  v_pk_mul_f32 v[178:179], v[146:147], v[14:15] op_sel:[0,0] op_sel_hi:[0,1]
  v_pk_mul_f32 v[180:181], v[148:149], v[14:15] op_sel:[0,0] op_sel_hi:[0,1]
  v_pk_mul_f32 v[182:183], v[150:151], v[14:15] op_sel:[0,0] op_sel_hi:[0,1]
  v_pk_fma_f32 v[158:159], v[144:145], v[14:15], v[176:177] op_sel:[1,1,0] op_sel_hi:[1,0,1] neg_hi:[1,0,0]
  v_pk_fma_f32 v[156:157], v[146:147], v[14:15], v[178:179] op_sel:[1,1,0] op_sel_hi:[1,0,1] neg_hi:[1,0,0]
  v_pk_fma_f32 v[154:155], v[148:149], v[14:15], v[180:181] op_sel:[1,1,0] op_sel_hi:[1,0,1] neg_hi:[1,0,0]
  v_pk_fma_f32 v[152:153], v[150:151], v[14:15], v[182:183] op_sel:[1,1,0] op_sel_hi:[1,0,1] neg_hi:[1,0,0]
  v_pk_fma_f32 v[176:177], v[144:145], v[14:15], v[176:177] op_sel:[1,1,0] op_sel_hi:[1,0,1] neg_lo:[1,0,0]
  v_pk_fma_f32 v[178:179], v[146:147], v[14:15], v[178:179] op_sel:[1,1,0] op_sel_hi:[1,0,1] neg_lo:[1,0,0]
  v_pk_fma_f32 v[180:181], v[148:149], v[14:15], v[180:181] op_sel:[1,1,0] op_sel_hi:[1,0,1] neg_lo:[1,0,0]
  v_pk_fma_f32 v[182:183], v[150:151], v[14:15], v[182:183] op_sel:[1,1,0] op_sel_hi:[1,0,1] neg_lo:[1,0,0]
  v_cvt_pk_bf16_f32 v184, v152, -v153
  v_cvt_pk_bf16_f32 v185, v154, -v155
  v_cvt_pk_bf16_f32 v186, v156, -v157
  v_cvt_pk_bf16_f32 v187, v158, -v159
  v_accvgpr_write_b32 a112, v184
  v_accvgpr_write_b32 a113, v185
  v_accvgpr_write_b32 a114, v186
  v_accvgpr_write_b32 a115, v187
  v_cvt_pk_bf16_f32 v196, v176, -v177
  v_cvt_pk_bf16_f32 v197, v178, -v179
  v_cvt_pk_bf16_f32 v198, v180, -v181
  v_cvt_pk_bf16_f32 v199, v182, -v183
  v_accvgpr_write_b32 a124, v196
  v_accvgpr_write_b32 a125, v197
  v_accvgpr_write_b32 a126, v198
  v_accvgpr_write_b32 a127, v199
  v_mul_f32 v12, v11, v10
  v_cos_f32 v14, v12
  v_sin_f32 v15, v12
  v_add_f32 v11, 0x42000000, v11
  v_pk_mul_f32 v[168:169], v[136:137], v[14:15] op_sel:[0,0] op_sel_hi:[0,1]
  v_pk_mul_f32 v[170:171], v[138:139], v[14:15] op_sel:[0,0] op_sel_hi:[0,1]
  v_pk_mul_f32 v[172:173], v[140:141], v[14:15] op_sel:[0,0] op_sel_hi:[0,1]
  v_pk_mul_f32 v[174:175], v[142:143], v[14:15] op_sel:[0,0] op_sel_hi:[0,1]
  v_pk_fma_f32 v[166:167], v[136:137], v[14:15], v[168:169] op_sel:[1,1,0] op_sel_hi:[1,0,1] neg_hi:[1,0,0]
  v_pk_fma_f32 v[164:165], v[138:139], v[14:15], v[170:171] op_sel:[1,1,0] op_sel_hi:[1,0,1] neg_hi:[1,0,0]
  v_pk_fma_f32 v[162:163], v[140:141], v[14:15], v[172:173] op_sel:[1,1,0] op_sel_hi:[1,0,1] neg_hi:[1,0,0]
  v_pk_fma_f32 v[160:161], v[142:143], v[14:15], v[174:175] op_sel:[1,1,0] op_sel_hi:[1,0,1] neg_hi:[1,0,0]
  v_pk_fma_f32 v[168:169], v[136:137], v[14:15], v[168:169] op_sel:[1,1,0] op_sel_hi:[1,0,1] neg_lo:[1,0,0]
  v_pk_fma_f32 v[170:171], v[138:139], v[14:15], v[170:171] op_sel:[1,1,0] op_sel_hi:[1,0,1] neg_lo:[1,0,0]
  v_pk_fma_f32 v[172:173], v[140:141], v[14:15], v[172:173] op_sel:[1,1,0] op_sel_hi:[1,0,1] neg_lo:[1,0,0]
  v_pk_fma_f32 v[174:175], v[142:143], v[14:15], v[174:175] op_sel:[1,1,0] op_sel_hi:[1,0,1] neg_lo:[1,0,0]
  v_cvt_pk_bf16_f32 v188, v160, -v161
  v_cvt_pk_bf16_f32 v189, v162, -v163
  v_cvt_pk_bf16_f32 v190, v164, -v165
  v_cvt_pk_bf16_f32 v191, v166, -v167
  v_accvgpr_write_b32 a132, v188
  v_accvgpr_write_b32 a133, v189
  v_accvgpr_write_b32 a134, v190
  v_accvgpr_write_b32 a135, v191
  v_cvt_pk_bf16_f32 v192, v168, -v169
  v_cvt_pk_bf16_f32 v193, v170, -v171
  v_cvt_pk_bf16_f32 v194, v172, -v173
  v_cvt_pk_bf16_f32 v195, v174, -v175
  v_accvgpr_write_b32 a136, v192
  v_accvgpr_write_b32 a137, v193
  v_accvgpr_write_b32 a138, v194
  v_accvgpr_write_b32 a139, v195
  v_pk_mul_f32 v[176:177], v[144:145], v[14:15] op_sel:[0,0] op_sel_hi:[0,1]
  v_pk_mul_f32 v[178:179], v[146:147], v[14:15] op_sel:[0,0] op_sel_hi:[0,1]
  v_pk_mul_f32 v[180:181], v[148:149], v[14:15] op_sel:[0,0] op_sel_hi:[0,1]
  v_pk_mul_f32 v[182:183], v[150:151], v[14:15] op_sel:[0,0] op_sel_hi:[0,1]
  v_pk_fma_f32 v[158:159], v[144:145], v[14:15], v[176:177] op_sel:[1,1,0] op_sel_hi:[1,0,1] neg_hi:[1,0,0]
  v_pk_fma_f32 v[156:157], v[146:147], v[14:15], v[178:179] op_sel:[1,1,0] op_sel_hi:[1,0,1] neg_hi:[1,0,0]
  v_pk_fma_f32 v[154:155], v[148:149], v[14:15], v[180:181] op_sel:[1,1,0] op_sel_hi:[1,0,1] neg_hi:[1,0,0]
  v_pk_fma_f32 v[152:153], v[150:151], v[14:15], v[182:183] op_sel:[1,1,0] op_sel_hi:[1,0,1] neg_hi:[1,0,0]
  v_pk_fma_f32 v[176:177], v[144:145], v[14:15], v[176:177] op_sel:[1,1,0] op_sel_hi:[1,0,1] neg_lo:[1,0,0]
  v_pk_fma_f32 v[178:179], v[146:147], v[14:15], v[178:179] op_sel:[1,1,0] op_sel_hi:[1,0,1] neg_lo:[1,0,0]
  v_pk_fma_f32 v[180:181], v[148:149], v[14:15], v[180:181] op_sel:[1,1,0] op_sel_hi:[1,0,1] neg_lo:[1,0,0]
  v_pk_fma_f32 v[182:183], v[150:151], v[14:15], v[182:183] op_sel:[1,1,0] op_sel_hi:[1,0,1] neg_lo:[1,0,0]
  v_mul_f32 v182, v182, v13
  v_mul_f32 v183, v183, v13
  v_cvt_pk_bf16_f32 v184, v152, -v153
  v_cvt_pk_bf16_f32 v185, v154, -v155
  v_cvt_pk_bf16_f32 v186, v156, -v157
  v_cvt_pk_bf16_f32 v187, v158, -v159
  v_accvgpr_write_b32 a128, v184
  v_accvgpr_write_b32 a129, v185
  v_accvgpr_write_b32 a130, v186
  v_accvgpr_write_b32 a131, v187
  v_cvt_pk_bf16_f32 v196, v176, -v177
  v_cvt_pk_bf16_f32 v197, v178, -v179
  v_cvt_pk_bf16_f32 v198, v180, -v181
  v_cvt_pk_bf16_f32 v199, v182, -v183
  v_accvgpr_write_b32 a140, v196
  v_accvgpr_write_b32 a141, v197
  v_accvgpr_write_b32 a142, v198
  v_accvgpr_write_b32 a143, v199
  v_mov_b32 v14, v247
  v_accvgpr_read_b32 v16, a240
  v_accvgpr_read_b32 v17, a241
  v_accvgpr_read_b32 v18, a242
  v_accvgpr_read_b32 v19, a243
  v_accvgpr_read_b32 v20, a244
  v_accvgpr_read_b32 v21, a245
  v_accvgpr_read_b32 v22, a246
  v_accvgpr_read_b32 v23, a247
  v_accvgpr_read_b32 v24, a248
  v_accvgpr_read_b32 v25, a249
  v_accvgpr_read_b32 v26, a250
  v_accvgpr_read_b32 v27, a251
  v_accvgpr_read_b32 v28, a252
  v_accvgpr_read_b32 v29, a253
  v_accvgpr_read_b32 v30, a254
  v_accvgpr_read_b32 v31, a255
  v_lshlrev_b32 v12, 16, v16
  v_lshlrev_b32 v13, 16, v24
  v_sub_f32 v192, v12, v13
  v_mul_f32 v192, 0.5, v192
  v_sub_f32 v12, v12, v254
  v_sub_f32 v208, v12, v192
  v_and_b32 v12, 0xffff0000, v16
  v_and_b32 v13, 0xffff0000, v24
  v_sub_f32 v193, v12, v13
  v_mul_f32 v193, 0.5, v193
  v_sub_f32 v12, v12, v254
  v_sub_f32 v209, v12, v193
  v_lshlrev_b32 v12, 16, v17
  v_lshlrev_b32 v13, 16, v25
  v_sub_f32 v194, v12, v13
L_qad2:
  s_cbranch_execz L_qad3
  v_mul_f32 v194, 0.5, v194
  v_sub_f32 v12, v12, v254
  v_sub_f32 v210, v12, v194
  v_and_b32 v12, 0xffff0000, v17
  v_and_b32 v13, 0xffff0000, v25
  v_sub_f32 v195, v12, v13
  v_mul_f32 v195, 0.5, v195
  v_sub_f32 v12, v12, v254
  v_sub_f32 v211, v12, v195
  v_lshlrev_b32 v12, 16, v18
  v_lshlrev_b32 v13, 16, v26
  v_sub_f32 v196, v12, v13
  v_mul_f32 v196, 0.5, v196
  v_sub_f32 v12, v12, v254
  v_sub_f32 v212, v12, v196
  v_and_b32 v12, 0xffff0000, v18
  v_and_b32 v13, 0xffff0000, v26
  v_sub_f32 v197, v12, v13
  v_mul_f32 v197, 0.5, v197
  v_sub_f32 v12, v12, v254
  v_sub_f32 v213, v12, v197
  v_lshlrev_b32 v12, 16, v19
  v_lshlrev_b32 v13, 16, v27
  v_sub_f32 v198, v12, v13
  v_mul_f32 v198, 0.5, v198
  v_sub_f32 v12, v12, v254
  v_sub_f32 v214, v12, v198
  v_and_b32 v12, 0xffff0000, v19
  v_and_b32 v13, 0xffff0000, v27
  v_sub_f32 v199, v12, v13
  v_mul_f32 v199, 0.5, v199
  v_sub_f32 v12, v12, v254
  v_sub_f32 v215, v12, v199
  v_lshlrev_b32 v12, 16, v20
  v_lshlrev_b32 v13, 16, v28
  v_sub_f32 v200, v12, v13
  v_mul_f32 v200, 0.5, v200
  v_sub_f32 v12, v12, v254
  v_sub_f32 v216, v12, v200
  v_and_b32 v12, 0xffff0000, v20
  v_and_b32 v13, 0xffff0000, v28
  v_sub_f32 v201, v12, v13
  v_mul_f32 v201, 0.5, v201
  v_sub_f32 v12, v12, v254
  v_sub_f32 v217, v12, v201
  v_lshlrev_b32 v12, 16, v21
  v_lshlrev_b32 v13, 16, v29
  v_sub_f32 v202, v12, v13
  v_mul_f32 v202, 0.5, v202
  v_sub_f32 v12, v12, v254
  v_sub_f32 v218, v12, v202
  v_and_b32 v12, 0xffff0000, v21
  v_and_b32 v13, 0xffff0000, v29
  v_sub_f32 v203, v12, v13
  v_mul_f32 v203, 0.5, v203
  v_sub_f32 v12, v12, v254
  v_sub_f32 v219, v12, v203
  v_lshlrev_b32 v12, 16, v22
  v_lshlrev_b32 v13, 16, v30
  v_sub_f32 v204, v12, v13
  v_mul_f32 v204, 0.5, v204
  v_sub_f32 v12, v12, v254
  v_sub_f32 v220, v12, v204
  v_and_b32 v12, 0xffff0000, v22
  v_and_b32 v13, 0xffff0000, v30
  v_sub_f32 v205, v12, v13
  v_mul_f32 v205, 0.5, v205
  v_sub_f32 v12, v12, v254
  v_sub_f32 v221, v12, v205
  v_lshlrev_b32 v12, 16, v23
  v_lshlrev_b32 v13, 16, v31
  v_sub_f32 v206, v12, v13
  v_mul_f32 v206, 0.5, v206
  v_sub_f32 v12, v12, v254
  v_sub_f32 v222, v12, v206
  v_and_b32 v12, 0xffff0000, v23
  v_and_b32 v13, 0xffff0000, v31
  v_sub_f32 v207, v12, v13
  v_mul_f32 v207, 0.5, v207
  v_sub_f32 v12, v12, v254
  v_sub_f32 v223, v12, v207
  buffer_load_dwordx4 v[48:51], v4, s[12:15], s20 offen offset:0 sc1
  buffer_load_dwordx4 v[52:55], v4, s[12:15], s20 offen offset:1024 sc1
  buffer_load_dwordx4 v[56:59], v4, s[12:15], s20 offen offset:2048 sc1
  buffer_load_dwordx4 v[60:63], v4, s[12:15], s20 offen offset:3072 sc1
  buffer_load_dwordx4 v[64:67], v4, s[12:15], s21 offen offset:0 sc1
  buffer_load_dwordx4 v[68:71], v4, s[12:15], s21 offen offset:1024 sc1
  buffer_load_dwordx4 v[72:75], v4, s[12:15], s21 offen offset:2048 sc1
  buffer_load_dwordx4 v[76:79], v4, s[12:15], s21 offen offset:3072 sc1
  buffer_load_dwordx4 v[80:83], v4, s[12:15], s22 offen offset:0 sc1
  buffer_load_dwordx4 v[84:87], v4, s[12:15], s22 offen offset:1024 sc1
  buffer_load_dwordx4 v[88:91], v4, s[12:15], s22 offen offset:2048 sc1
  buffer_load_dwordx4 v[92:95], v4, s[12:15], s22 offen offset:3072 sc1
  v_mov_b32 v10, 161288
  s_branch L_ls7b
L_ls7:
  s_sleep 1
L_ls7b:
  ds_read_b32 v11, v10
  s_waitcnt lgkmcnt(0)
  v_readfirstlane_b32 s59, v11
  s_nop 1
  s_cmp_ge_u32 s59, 192
  s_cbranch_scc0 L_ls7
  s_mul_i32 s24, s16, 24576
  s_add_u32 s24, s24, 36864
  v_add_u32 v5, s24, v14
  ds_read_b128 a[0:3], v5 offset:0
  ds_read_b128 a[4:7], v5 offset:1024
  ds_read_b128 a[8:11], v5 offset:2048
  ds_read_b128 a[12:15], v5 offset:3072
  ds_read_b128 a[16:19], v5 offset:4096
  ds_read_b128 a[20:23], v5 offset:5120
  ds_read_b128 a[24:27], v5 offset:6144
  ds_read_b128 a[28:31], v5 offset:7168
  ds_read_b128 a[32:35], v5 offset:8192
  ds_read_b128 a[36:39], v5 offset:9216
  ds_read_b128 a[40:43], v5 offset:10240
  ds_read_b128 a[44:47], v5 offset:11264
  ds_read_b128 a[48:51], v5 offset:12288
  ds_read_b128 a[52:55], v5 offset:13312
  ds_read_b128 a[56:59], v5 offset:14336
  ds_read_b128 a[60:63], v5 offset:15360
  ds_read_b128 a[64:67], v5 offset:16384
  ds_read_b128 a[68:71], v5 offset:17408
  ds_read_b128 a[72:75], v5 offset:18432
  ds_read_b128 a[76:79], v5 offset:19456
  ds_read_b128 a[80:83], v5 offset:20480
  ds_read_b128 a[84:87], v5 offset:21504
  ds_read_b128 a[88:91], v5 offset:22528
  ds_read_b128 a[92:95], v5 offset:23552
  s_mul_i32 s23, s29, 12288
  v_add_u32 v225, s23, v14
  s_mul_i32 s23, s30, 12288
  v_add_u32 v226, s23, v14
  v_lshlrev_b32 v8, 11, v2
  v_lshl_add_u32 v8, v1, 4, v8
  s_lshr_b32 s23, s17, 1
  s_mul_i32 s24, s23, 73728
  s_and_b32 s26, s17, 1
  s_lshl_b32 s27, s26, 9
  s_add_u32 s24, s24, s27
  s_lshl_b32 s27, s19, 12
  s_add_u32 s24, s24, s27
  s_add_u32 s24, s24, 4718592
  s_add_u32 s27, s24, 36864
  s_mul_i32 s25, s26, 9
  s_add_u32 s25, s25, s19
  s_lshl_b32 s25, s25, 6
  s_lshl_b32 s31, s23, 11
  s_add_u32 s25, s25, s31
  s_add_u32 s58, s25, 48308224
  s_mul_i32 s23, s23, 9
  s_add_u32 s23, s23, s19
  s_lshl_b32 s23, s23, 8
  s_lshl_b32 s26, s26, 7
  s_add_u32 s23, s23, s26
  s_add_u32 s23, s23, 9502720
  v_lshlrev_b32 v6, 2, v1
  v_mov_b32 v255, v251
  v_mov_b32 v10, 161292
L_ls8:
  ds_read_b32 v11, v10
  s_waitcnt lgkmcnt(0)
  v_readfirstlane_b32 s59, v11
  s_nop 1
  s_cmp_ge_u32 s59, 320
  s_cbranch_scc0 L_ls8
  v_mov_b32 v10, 161296
  ds_read_b64 v[252:253], v10 offset:8
  ds_read_b32 v10, v10
  s_waitcnt lgkmcnt(0)
  v_readfirstlane_b32 s35, v10
  v_readfirstlane_b32 s56, v252
  v_readfirstlane_b32 s57, v253
  s_nop 1
  s_waitcnt vmcnt(8)
  v_max3_u32 v10, v48, v49, v50
  v_max3_u32 v11, v51, v52, v53
  v_max3_u32 v10, v10, v54, v55
  v_max3_u32 v11, v11, v56, v57
  v_max3_u32 v10, v10, v58, v59
  v_max3_u32 v11, v11, v60, v61
  v_max3_u32 v10, v10, v62, v63
  v_max_u32 v10, v10, v11
  v_cmp_eq_u32 vcc, -1, v10
  s_nop 1
  s_cmp_eq_u64 vcc, 0
  s_cbranch_scc1 L_ok9
L_lp10s:
  s_mov_b32 s59, 50000
L_lp10:
  buffer_load_dwordx4 v[48:51], v4, s[12:15], s20 offen offset:0 sc1
  buffer_load_dwordx4 v[52:55], v4, s[12:15], s20 offen offset:1024 sc1
  buffer_load_dwordx4 v[56:59], v4, s[12:15], s20 offen offset:2048 sc1
  buffer_load_dwordx4 v[60:63], v4, s[12:15], s20 offen offset:3072 sc1
  buffer_load_dwordx4 v[64:67], v4, s[12:15], s21 offen offset:0 sc1
  buffer_load_dwordx4 v[68:71], v4, s[12:15], s21 offen offset:1024 sc1
  buffer_load_dwordx4 v[72:75], v4, s[12:15], s21 offen offset:2048 sc1
  buffer_load_dwordx4 v[76:79], v4, s[12:15], s21 offen offset:3072 sc1
  buffer_load_dwordx4 v[80:83], v4, s[12:15], s22 offen offset:0 sc1
  buffer_load_dwordx4 v[84:87], v4, s[12:15], s22 offen offset:1024 sc1
  buffer_load_dwordx4 v[88:91], v4, s[12:15], s22 offen offset:2048 sc1
  buffer_load_dwordx4 v[92:95], v4, s[12:15], s22 offen offset:3072 sc1
  s_waitcnt vmcnt(0)
  s_sub_u32 s59, s59, 1
  s_cbranch_scc1 L_ok9
  v_max3_u32 v10, v48, v49, v50
  v_max3_u32 v11, v51, v52, v53
  v_max3_u32 v10, v10, v54, v55
  v_max3_u32 v11, v11, v56, v57
  v_max3_u32 v10, v10, v58, v59
  v_max3_u32 v11, v11, v60, v61
  v_max3_u32 v10, v10, v62, v63
  v_max_u32 v10, v10, v11
  v_cmp_eq_u32 vcc, -1, v10
  s_nop 1
  s_cmp_eq_u64 vcc, 0
  s_cbranch_scc0 L_lp10
L_ok9:
  v_mfma_f32_32x32x16_bf16 v[128:143], v[48:51], a[176:179], 0
  v_mfma_f32_32x32x16_bf16 v[144:159], v[48:51], a[192:195], 0
  v_mfma_f32_32x32x16_bf16 v[128:143], v[52:55], a[180:183], v[128:143]
  s_waitcnt vmcnt(4)
  v_max3_u32 v10, v64, v65, v66
  v_max3_u32 v11, v67, v68, v69
  v_max3_u32 v10, v10, v70, v71
  v_max3_u32 v11, v11, v72, v73
  v_max3_u32 v10, v10, v74, v75
  v_max3_u32 v11, v11, v76, v77
  v_max3_u32 v10, v10, v78, v79
  v_max_u32 v10, v10, v11
  v_cmp_eq_u32 vcc, -1, v10
  s_nop 1
  s_cmp_eq_u64 vcc, 0
  s_cbranch_scc0 L_lp12s
L_ok11:
  v_mfma_f32_32x32x16_bf16 v[144:159], v[52:55], a[196:199], v[144:159]
  v_mfma_f32_32x32x16_bf16 v[128:143], v[56:59], a[184:187], v[128:143]
  v_mfma_f32_32x32x16_bf16 v[144:159], v[56:59], a[200:203], v[144:159]
  v_mfma_f32_32x32x16_bf16 v[128:143], v[60:63], a[188:191], v[128:143]
  v_mfma_f32_32x32x16_bf16 v[144:159], v[60:63], a[204:207], v[144:159]
  v_mfma_f32_32x32x16_bf16 v[160:175], v[64:67], a[176:179], 0
  s_waitcnt vmcnt(0)
  v_max3_u32 v10, v80, v81, v82
  v_max3_u32 v11, v83, v84, v85
  v_max3_u32 v10, v10, v86, v87
  v_max3_u32 v11, v11, v88, v89
  v_max3_u32 v10, v10, v90, v91
  v_max3_u32 v11, v11, v92, v93
  v_max3_u32 v10, v10, v94, v95
  v_max_u32 v10, v10, v11
  v_cmp_eq_u32 vcc, -1, v10
  s_nop 1
  s_cmp_eq_u64 vcc, 0
  s_cbranch_scc0 L_lp14s
L_ok13:
  v_mfma_f32_32x32x16_bf16 v[176:191], v[64:67], a[192:195], 0
  v_cvt_pk_bf16_f32 v48, v128, v144
  v_cvt_pk_bf16_f32 v49, v129, v145
  v_cvt_pk_bf16_f32 v50, v130, v146
  v_cvt_pk_bf16_f32 v51, v131, v147
  v_mfma_f32_32x32x16_bf16 v[160:175], v[68:71], a[180:183], v[160:175]
  ds_write_b128 v7, v[48:51] offset:0
  v_cvt_pk_bf16_f32 v52, v132, v148
  v_cvt_pk_bf16_f32 v53, v133, v149
  v_mfma_f32_32x32x16_bf16 v[176:191], v[68:71], a[196:199], v[176:191]
  v_cvt_pk_bf16_f32 v54, v134, v150
  v_cvt_pk_bf16_f32 v55, v135, v151
  ds_write_b128 v7, v[52:55] offset:1024
  v_mfma_f32_32x32x16_bf16 v[160:175], v[72:75], a[184:187], v[160:175]
  v_cvt_pk_bf16_f32 v56, v136, v152
  v_cvt_pk_bf16_f32 v57, v137, v153
  v_cvt_pk_bf16_f32 v58, v138, v154
  v_cvt_pk_bf16_f32 v59, v139, v155
  v_mfma_f32_32x32x16_bf16 v[176:191], v[72:75], a[200:203], v[176:191]
  ds_write_b128 v7, v[56:59] offset:2048
  v_cvt_pk_bf16_f32 v60, v140, v156
  v_cvt_pk_bf16_f32 v61, v141, v157
  v_mfma_f32_32x32x16_bf16 v[160:175], v[76:79], a[188:191], v[160:175]
  v_cvt_pk_bf16_f32 v62, v142, v158
  v_cvt_pk_bf16_f32 v63, v143, v159
  ds_write_b128 v7, v[60:63] offset:3072
  v_mfma_f32_32x32x16_bf16 v[176:191], v[76:79], a[204:207], v[176:191]
  v_mfma_f32_32x32x16_bf16 v[128:143], v[80:83], a[176:179], 0
  v_mfma_f32_32x32x16_bf16 v[144:159], v[80:83], a[192:195], 0
  v_mfma_f32_32x32x16_bf16 v[128:143], v[84:87], a[180:183], v[128:143]
  s_nop 7
  v_mfma_f32_32x32x16_bf16 v[144:159], v[84:87], a[196:199], v[144:159]
  v_cvt_pk_bf16_f32 v64, v160, v176
  v_cvt_pk_bf16_f32 v65, v161, v177
  v_cvt_pk_bf16_f32 v66, v162, v178
  v_cvt_pk_bf16_f32 v67, v163, v179
  v_mfma_f32_32x32x16_bf16 v[128:143], v[88:91], a[184:187], v[128:143]
  ds_write_b128 v7, v[64:67] offset:4096
  v_cvt_pk_bf16_f32 v68, v164, v180
  v_cvt_pk_bf16_f32 v69, v165, v181
  v_cvt_pk_bf16_f32 v70, v166, v182
  v_mfma_f32_32x32x16_bf16 v[144:159], v[88:91], a[200:203], v[144:159]
  v_cvt_pk_bf16_f32 v71, v167, v183
  ds_write_b128 v7, v[68:71] offset:5120
  v_cvt_pk_bf16_f32 v72, v168, v184
  v_cvt_pk_bf16_f32 v73, v169, v185
  v_mfma_f32_32x32x16_bf16 v[128:143], v[92:95], a[188:191], v[128:143]
  v_cvt_pk_bf16_f32 v74, v170, v186
  v_cvt_pk_bf16_f32 v75, v171, v187
  ds_write_b128 v7, v[72:75] offset:6144
  v_cvt_pk_bf16_f32 v76, v172, v188
  v_mfma_f32_32x32x16_bf16 v[144:159], v[92:95], a[204:207], v[144:159]
  v_cvt_pk_bf16_f32 v77, v173, v189
  v_cvt_pk_bf16_f32 v78, v174, v190
  v_cvt_pk_bf16_f32 v79, v175, v191
  ds_write_b128 v7, v[76:79] offset:7168
  v_mfma_f32_32x32x16_bf16 v[192:207], a[0:3], v[48:51], v[192:207]
  v_mfma_f32_32x32x16_bf16 v[208:223], a[4:7], v[52:55], v[208:223]
  v_mfma_f32_32x32x16_bf16 v[192:207], a[8:11], v[56:59], v[192:207]
  s_nop 7
  v_mfma_f32_32x32x16_bf16 v[208:223], a[12:15], v[60:63], v[208:223]
  v_cvt_pk_bf16_f32 v80, v128, v144
  v_cvt_pk_bf16_f32 v81, v129, v145
  v_cvt_pk_bf16_f32 v82, v130, v146
  v_cvt_pk_bf16_f32 v83, v131, v147
  v_mfma_f32_32x32x16_bf16 v[192:207], a[16:19], v[64:67], v[192:207]
  ds_write_b128 v7, v[80:83] offset:8192
  v_cvt_pk_bf16_f32 v84, v132, v148
  v_cvt_pk_bf16_f32 v85, v133, v149
  v_cvt_pk_bf16_f32 v86, v134, v150
  v_mfma_f32_32x32x16_bf16 v[208:223], a[20:23], v[68:71], v[208:223]
  v_cvt_pk_bf16_f32 v87, v135, v151
  ds_write_b128 v7, v[84:87] offset:9216
  v_cvt_pk_bf16_f32 v88, v136, v152
  v_cvt_pk_bf16_f32 v89, v137, v153
  v_mfma_f32_32x32x16_bf16 v[192:207], a[24:27], v[72:75], v[192:207]
  v_cvt_pk_bf16_f32 v90, v138, v154
  v_cvt_pk_bf16_f32 v91, v139, v155
  ds_write_b128 v7, v[88:91] offset:10240
  v_cvt_pk_bf16_f32 v92, v140, v156
  v_mfma_f32_32x32x16_bf16 v[208:223], a[28:31], v[76:79], v[208:223]
  v_cvt_pk_bf16_f32 v93, v141, v157
  v_cvt_pk_bf16_f32 v94, v142, v158
  v_cvt_pk_bf16_f32 v95, v143, v159
  ds_write_b128 v7, v[92:95] offset:11264
  s_waitcnt lgkmcnt(0)
  v_mov_b32 v10, 161284
  v_mov_b32 v11, 1
  ds_add_u32 v10, v11
  v_mfma_f32_32x32x16_bf16 v[192:207], a[32:35], v[80:83], v[192:207]
  v_mfma_f32_32x32x16_bf16 v[208:223], a[36:39], v[84:87], v[208:223]
  v_mfma_f32_32x32x16_bf16 v[192:207], a[40:43], v[88:91], v[192:207]
  v_mov_b32 v10, 161284
L_ls15:
  ds_read_b32 v11, v10
  s_waitcnt lgkmcnt(0)
  v_readfirstlane_b32 s59, v11
  s_nop 1
  s_cmp_ge_u32 s59, 192
  s_cbranch_scc0 L_ls15
  ds_read_b128 v[32:35], v225 offset:0
  ds_read_b128 v[36:39], v225 offset:1024
  ds_read_b128 v[40:43], v225 offset:2048
  ds_read_b128 v[44:47], v225 offset:3072
  ds_read_b128 v[16:19], v225 offset:4096
  ds_read_b128 v[20:23], v225 offset:5120
  ds_read_b128 v[24:27], v225 offset:6144
  v_mfma_f32_32x32x16_bf16 v[208:223], a[44:47], v[92:95], v[208:223]
  s_waitcnt lgkmcnt(6)
  v_mfma_f32_32x32x16_bf16 v[192:207], a[48:51], v[32:35], v[192:207]
  ds_read_b128 v[28:31], v225 offset:7168
  s_waitcnt lgkmcnt(6)
  v_mfma_f32_32x32x16_bf16 v[208:223], a[52:55], v[36:39], v[208:223]
  ds_read_b128 v[32:35], v225 offset:8192
  s_waitcnt lgkmcnt(6)
  v_mfma_f32_32x32x16_bf16 v[192:207], a[56:59], v[40:43], v[192:207]
  ds_read_b128 v[36:39], v225 offset:9216
  s_waitcnt lgkmcnt(6)
  v_mfma_f32_32x32x16_bf16 v[208:223], a[60:63], v[44:47], v[208:223]
  ds_read_b128 v[40:43], v225 offset:10240
  s_waitcnt lgkmcnt(6)
  v_mfma_f32_32x32x16_bf16 v[192:207], a[64:67], v[16:19], v[192:207]
  ds_read_b128 v[44:47], v225 offset:11264
  s_waitcnt lgkmcnt(6)
  v_mfma_f32_32x32x16_bf16 v[208:223], a[68:71], v[20:23], v[208:223]
  ds_read_b128 v[16:19], v226 offset:0
  s_waitcnt lgkmcnt(6)
  v_mfma_f32_32x32x16_bf16 v[192:207], a[72:75], v[24:27], v[192:207]
  ds_read_b128 v[20:23], v226 offset:1024
  s_waitcnt lgkmcnt(6)
  v_mfma_f32_32x32x16_bf16 v[208:223], a[76:79], v[28:31], v[208:223]
  ds_read_b128 v[24:27], v226 offset:2048
  s_waitcnt lgkmcnt(6)
  v_mfma_f32_32x32x16_bf16 v[192:207], a[80:83], v[32:35], v[192:207]
  ds_read_b128 v[28:31], v226 offset:3072
  s_waitcnt lgkmcnt(6)
  v_mfma_f32_32x32x16_bf16 v[208:223], a[84:87], v[36:39], v[208:223]
  ds_read_b128 v[32:35], v226 offset:4096
  s_waitcnt lgkmcnt(6)
  v_mfma_f32_32x32x16_bf16 v[192:207], a[88:91], v[40:43], v[192:207]
  ds_read_b128 v[36:39], v226 offset:5120
  s_waitcnt lgkmcnt(6)
  v_mfma_f32_32x32x16_bf16 v[208:223], a[92:95], v[44:47], v[208:223]
  ds_read_b128 v[40:43], v226 offset:6144
  s_waitcnt lgkmcnt(6)
  v_mfma_f32_32x32x16_bf16 v[192:207], a[96:99], v[16:19], v[192:207]
  ds_read_b128 v[44:47], v226 offset:7168
  s_waitcnt lgkmcnt(6)
  v_mfma_f32_32x32x16_bf16 v[208:223], a[100:103], v[20:23], v[208:223]
  ds_read_b128 v[16:19], v226 offset:8192
  s_waitcnt lgkmcnt(6)
  v_mfma_f32_32x32x16_bf16 v[192:207], a[104:107], v[24:27], v[192:207]
  ds_read_b128 v[20:23], v226 offset:9216
  s_waitcnt lgkmcnt(6)
  v_mfma_f32_32x32x16_bf16 v[208:223], a[108:111], v[28:31], v[208:223]
  ds_read_b128 v[24:27], v226 offset:10240
  s_waitcnt lgkmcnt(6)
  v_mfma_f32_32x32x16_bf16 v[192:207], a[112:115], v[32:35], v[192:207]
  ds_read_b128 v[28:31], v226 offset:11264
  s_waitcnt lgkmcnt(6)
  v_mfma_f32_32x32x16_bf16 v[208:223], a[116:119], v[36:39], v[208:223]
  s_waitcnt lgkmcnt(5)
  v_mfma_f32_32x32x16_bf16 v[192:207], a[120:123], v[40:43], v[192:207]
  s_waitcnt lgkmcnt(4)
  v_mfma_f32_32x32x16_bf16 v[208:223], a[124:127], v[44:47], v[208:223]
  s_waitcnt lgkmcnt(3)
  v_mfma_f32_32x32x16_bf16 v[192:207], a[128:131], v[16:19], v[192:207]
  s_waitcnt lgkmcnt(2)
  v_mfma_f32_32x32x16_bf16 v[208:223], a[132:135], v[20:23], v[208:223]
  s_waitcnt lgkmcnt(1)
  v_mfma_f32_32x32x16_bf16 v[192:207], a[136:139], v[24:27], v[192:207]
  s_waitcnt lgkmcnt(0)
  v_mfma_f32_32x32x16_bf16 v[208:223], a[140:143], v[28:31], v[208:223]
  s_nop 7
  s_nop 3
  v_add_f32 v128, v208, v192
  v_add_f32 v129, v209, v193
  v_add_f32 v130, v210, v194
  v_add_f32 v131, v211, v195
  v_add_f32 v132, v212, v196
  v_add_f32 v133, v213, v197
  v_add_f32 v134, v214, v198
  v_add_f32 v135, v215, v199
  v_cvt_pk_bf16_f32 v48, v128, v129
  v_cvt_pk_bf16_f32 v49, v130, v131
  v_cvt_pk_bf16_f32 v50, v132, v133
  v_cvt_pk_bf16_f32 v51, v134, v135
  buffer_store_dwordx4 v[48:51], v8, s[12:15], s24 offen offset:0 sc1
  v_add_f32 v136, v216, v200
  v_add_f32 v137, v217, v201
  v_add_f32 v138, v218, v202
  v_add_f32 v139, v219, v203
  v_add_f32 v140, v220, v204
  v_add_f32 v141, v221, v205
  v_add_f32 v142, v222, v206
  v_add_f32 v143, v223, v207
  v_cvt_pk_bf16_f32 v52, v136, v137
  v_cvt_pk_bf16_f32 v53, v138, v139
  v_cvt_pk_bf16_f32 v54, v140, v141
  v_cvt_pk_bf16_f32 v55, v142, v143
  buffer_store_dwordx4 v[52:55], v8, s[12:15], s24 offen offset:1024 sc1
  v_sub_f32 v144, v208, v192
  v_sub_f32 v145, v209, v193
  v_sub_f32 v146, v210, v194
  v_sub_f32 v147, v211, v195
  v_sub_f32 v148, v212, v196
  v_sub_f32 v149, v213, v197
  v_sub_f32 v150, v214, v198
  v_sub_f32 v151, v215, v199
  v_cvt_pk_bf16_f32 v56, v144, v145
  v_cvt_pk_bf16_f32 v57, v146, v147
  v_cvt_pk_bf16_f32 v58, v148, v149
  v_cvt_pk_bf16_f32 v59, v150, v151
  buffer_store_dwordx4 v[56:59], v8, s[12:15], s27 offen offset:0 sc1
  v_sub_f32 v152, v216, v200
  v_sub_f32 v153, v217, v201
  v_sub_f32 v154, v218, v202
  v_sub_f32 v155, v219, v203
  v_sub_f32 v156, v220, v204
  v_sub_f32 v157, v221, v205
  v_sub_f32 v158, v222, v206
  v_sub_f32 v159, v223, v207
  v_cvt_pk_bf16_f32 v60, v152, v153
  v_cvt_pk_bf16_f32 v61, v154, v155
  v_cvt_pk_bf16_f32 v62, v156, v157
  v_cvt_pk_bf16_f32 v63, v158, v159
  buffer_store_dwordx4 v[60:63], v8, s[12:15], s27 offen offset:1024 sc1
  v_mul_f32 v11, v128, v128
  v_mul_f32 v12, v144, v144
  v_fmac_f32 v11, v129, v129
  v_fmac_f32 v12, v145, v145
  v_fmac_f32 v11, v130, v130
  v_fmac_f32 v12, v146, v146
  v_fmac_f32 v11, v131, v131
  v_fmac_f32 v12, v147, v147
  v_fmac_f32 v11, v132, v132
  v_fmac_f32 v12, v148, v148
  v_fmac_f32 v11, v133, v133
  v_fmac_f32 v12, v149, v149
  v_fmac_f32 v11, v134, v134
  v_fmac_f32 v12, v150, v150
  v_fmac_f32 v11, v135, v135
  v_fmac_f32 v12, v151, v151
  v_fmac_f32 v11, v136, v136
  v_fmac_f32 v12, v152, v152
  v_fmac_f32 v11, v137, v137
  v_fmac_f32 v12, v153, v153
  v_fmac_f32 v11, v138, v138
  v_fmac_f32 v12, v154, v154
  v_fmac_f32 v11, v139, v139
  v_fmac_f32 v12, v155, v155
  v_fmac_f32 v11, v140, v140
  v_fmac_f32 v12, v156, v156
  v_fmac_f32 v11, v141, v141
  v_fmac_f32 v12, v157, v157
  v_fmac_f32 v11, v142, v142
  v_fmac_f32 v12, v158, v158
  v_fmac_f32 v11, v143, v143
  v_fmac_f32 v12, v159, v159
  v_add_f32 v11, v11, v12
  v_mov_b32 v12, v11
  s_nop 1
  v_permlane32_swap_b32 v11, v12
  s_nop 1
  v_add_f32 v11, v11, v12
  buffer_store_dword v11, v6, s[12:15], s23 offen sc1
  s_lshl_b32 s23, s17, 7
  s_add_u32 s23, s23, 9437184
  s_cmp_eq_u32 s19, 0
  s_cselect_b32 s24, 0, 0x80000000
  v_or_b32 v6, s24, v6
  buffer_store_dword v254, v6, s[12:15], s23 offen sc1
  s_branch L_ffn
L_lp12s:
  s_mov_b32 s59, 50000
L_lp12:
  buffer_load_dwordx4 v[64:67], v4, s[12:15], s21 offen offset:0 sc1
  buffer_load_dwordx4 v[68:71], v4, s[12:15], s21 offen offset:1024 sc1
  buffer_load_dwordx4 v[72:75], v4, s[12:15], s21 offen offset:2048 sc1
  buffer_load_dwordx4 v[76:79], v4, s[12:15], s21 offen offset:3072 sc1
  buffer_load_dwordx4 v[80:83], v4, s[12:15], s22 offen offset:0 sc1
  buffer_load_dwordx4 v[84:87], v4, s[12:15], s22 offen offset:1024 sc1
  buffer_load_dwordx4 v[88:91], v4, s[12:15], s22 offen offset:2048 sc1
  buffer_load_dwordx4 v[92:95], v4, s[12:15], s22 offen offset:3072 sc1
  s_waitcnt vmcnt(0)
  s_sub_u32 s59, s59, 1
  s_cbranch_scc1 L_ok11
  v_max3_u32 v10, v64, v65, v66
  v_max3_u32 v11, v67, v68, v69
  v_max3_u32 v10, v10, v70, v71
  v_max3_u32 v11, v11, v72, v73
  v_max3_u32 v10, v10, v74, v75
  v_max3_u32 v11, v11, v76, v77
  v_max3_u32 v10, v10, v78, v79
  v_max_u32 v10, v10, v11
  v_cmp_eq_u32 vcc, -1, v10
  s_nop 1
  s_cmp_eq_u64 vcc, 0
  s_cbranch_scc0 L_lp12
  s_branch L_ok11
L_lp14s:
  s_mov_b32 s59, 50000
L_lp14:
  buffer_load_dwordx4 v[80:83], v4, s[12:15], s22 offen offset:0 sc1
  buffer_load_dwordx4 v[84:87], v4, s[12:15], s22 offen offset:1024 sc1
  buffer_load_dwordx4 v[88:91], v4, s[12:15], s22 offen offset:2048 sc1
  buffer_load_dwordx4 v[92:95], v4, s[12:15], s22 offen offset:3072 sc1
  s_waitcnt vmcnt(0)
  s_sub_u32 s59, s59, 1
  s_cbranch_scc1 L_ok13
  v_max3_u32 v10, v80, v81, v82
  v_max3_u32 v11, v83, v84, v85
  v_max3_u32 v10, v10, v86, v87
  v_max3_u32 v11, v11, v88, v89
  v_max3_u32 v10, v10, v90, v91
  v_max3_u32 v11, v11, v92, v93
  v_max3_u32 v10, v10, v94, v95
  v_max_u32 v10, v10, v11
  v_cmp_eq_u32 vcc, -1, v10
  s_nop 1
  s_cmp_eq_u64 vcc, 0
  s_cbranch_scc0 L_lp14
  s_branch L_ok13
L_qad3:
  s_branch L_qad_end
L_help:
  s_mov_b32 s58, 0
  v_bfrev_b32 v255, 1
  s_mov_b32 s40, s48
  s_mov_b32 s41, s49
  s_mov_b32 s42, 1183744
  s_mov_b32 s43, 0x20000
  s_mov_b32 s44, s50
  s_mov_b32 s45, s51
  s_mov_b32 s46, 1183744
  s_mov_b32 s47, 0x20000
  v_lshrrev_b32 v4, 3, v9
  v_lshlrev_b32 v4, 5, v4
  v_bfe_u32 v5, v9, 1, 2
  v_add_u32 v4, v4, v5
  v_mul_u32_u24 v4, 578, v4
  v_and_b32 v5, 2, v9
  v_add_u32 v4, v4, v5
  v_and_b32 v5, 1, v9
  v_lshl_add_u32 v4, v5, 4, v4
  s_mul_i32 s22, s33, 2312
  s_mul_i32 s23, s34, 24
  s_add_u32 s22, s22, s23
  v_mul_u32_u24 v5, 13, v9
  v_lshrrev_b32 v5, 8, v5
  v_mul_u32_u24 v6, 20, v5
  v_sub_u32 v6, v9, v6
  s_mul_i32 s23, s34, 3
  v_add_u32 v5, s23, v5
  v_mul_u32_u24 v5, 18496, v5
  s_mul_i32 s23, s33, 2312
  v_add_u32 v5, s23, v5
  v_and_b32 v5, 0xffffff80, v5
  v_lshl_add_u32 v5, v6, 7, v5
  s_waitcnt lgkmcnt(0)
  s_mov_b32 s12, s38
  s_mov_b32 s13, s39
  s_mov_b32 s14, 268435456
  s_mov_b32 s15, 0x20000
  s_mov_b32 s38, 256
  s_mov_b32 s39, 0x20000
  v_min_u32 v251, 1, v9
  v_lshlrev_b32 v251, 31, v251
  v_and_b32 v18, 3, v9
  v_bfe_u32 v19, v9, 2, 1
  v_lshl_add_u32 v18, v19, 4, v18
  v_bfe_u32 v19, v9, 3, 2
  v_lshl_add_u32 v18, v19, 2, v18
  s_mul_i32 s24, s34, 43
  s_lshr_b32 s24, s24, 7
  s_mul_i32 s24, s24, 3
  s_sub_u32 s23, s34, s24
  s_mul_i32 s23, s23, 96
  v_add_u32 v18, s23, v18
  v_lshrrev_b32 v19, 5, v9
  v_cvt_f32_u32 v17, v19
  v_fma_f32 v17, v17, -0.5, 1.0
  v_lshl_add_u32 v19, v19, 3, 1
  v_cvt_f32_u32 v19, v19
  v_lshlrev_b32 v20, 4, v9
  v_add_u32 v20, 36864, v20
  s_mov_b32 s27, 48373760
  v_add_u32 v21, 0, v18
  v_cvt_f32_u32 v21, v21
  v_mul_f32 v21, 0x3ae38e39, v21
  v_mul_f32 v23, 0x40900000, v21
  v_cos_f32 v196, v23
  v_sin_f32 v197, v23
  v_mul_f32 v23, 0x40d00000, v21
  v_cos_f32 v198, v23
  v_sin_f32 v199, v23
  v_mul_f32 v23, 0x41080000, v21
  v_cos_f32 v200, v23
  v_sin_f32 v201, v23
  v_mul_f32 v23, 0x41280000, v21
  v_cos_f32 v202, v23
  v_sin_f32 v203, v23
  v_mul_f32 v23, 0x40b00000, v21
  v_cos_f32 v204, v23
  v_sin_f32 v205, v23
  v_mul_f32 v23, 0x40f00000, v21
  v_cos_f32 v206, v23
  v_sin_f32 v207, v23
  v_mul_f32 v23, 0x41180000, v21
  v_cos_f32 v208, v23
  v_sin_f32 v209, v23
  v_mul_f32 v23, 0x41380000, v21
  v_cos_f32 v210, v23
  v_sin_f32 v211, v23
  v_add_f32 v22, 0x41380000, v19
  s_mov_b32 s31, 0
L_gg16:
  v_mul_f32 v23, v22, v21
  v_cos_f32 v24, v23
  v_sin_f32 v25, v23
  v_add_f32 v22, 0x42000000, v22
  s_cmp_eq_u32 s31, 8
  s_cselect_b64 vcc, -1, 0
  v_cndmask_b32 v26, 1.0, v17, vcc
  v_pk_mul_f32 v[152:153], v[196:197], v[24:25] op_sel:[0,0] op_sel_hi:[0,1]
  v_pk_mul_f32 v[154:155], v[198:199], v[24:25] op_sel:[0,0] op_sel_hi:[0,1]
  v_pk_mul_f32 v[156:157], v[200:201], v[24:25] op_sel:[0,0] op_sel_hi:[0,1]
  v_pk_mul_f32 v[158:159], v[202:203], v[24:25] op_sel:[0,0] op_sel_hi:[0,1]
  v_pk_fma_f32 v[150:151], v[196:197], v[24:25], v[152:153] op_sel:[1,1,0] op_sel_hi:[1,0,1] neg_hi:[1,0,0]
  v_pk_fma_f32 v[148:149], v[198:199], v[24:25], v[154:155] op_sel:[1,1,0] op_sel_hi:[1,0,1] neg_hi:[1,0,0]
  v_pk_fma_f32 v[146:147], v[200:201], v[24:25], v[156:157] op_sel:[1,1,0] op_sel_hi:[1,0,1] neg_hi:[1,0,0]
  v_pk_fma_f32 v[144:145], v[202:203], v[24:25], v[158:159] op_sel:[1,1,0] op_sel_hi:[1,0,1] neg_hi:[1,0,0]
  v_pk_fma_f32 v[152:153], v[196:197], v[24:25], v[152:153] op_sel:[1,1,0] op_sel_hi:[1,0,1] neg_lo:[1,0,0]
  v_pk_fma_f32 v[154:155], v[198:199], v[24:25], v[154:155] op_sel:[1,1,0] op_sel_hi:[1,0,1] neg_lo:[1,0,0]
  v_pk_fma_f32 v[156:157], v[200:201], v[24:25], v[156:157] op_sel:[1,1,0] op_sel_hi:[1,0,1] neg_lo:[1,0,0]
  v_pk_fma_f32 v[158:159], v[202:203], v[24:25], v[158:159] op_sel:[1,1,0] op_sel_hi:[1,0,1] neg_lo:[1,0,0]
  v_cvt_pk_bf16_f32 v216, v144, -v145
  v_cvt_pk_bf16_f32 v217, v146, -v147
  v_cvt_pk_bf16_f32 v218, v148, -v149
  v_cvt_pk_bf16_f32 v219, v150, -v151
  ds_write_b128 v20, v[216:219] offset:1024
  v_cvt_pk_bf16_f32 v220, v152, -v153
  v_cvt_pk_bf16_f32 v221, v154, -v155
  v_cvt_pk_bf16_f32 v222, v156, -v157
  v_cvt_pk_bf16_f32 v223, v158, -v159
  ds_write_b128 v20, v[220:223] offset:2048
  v_pk_mul_f32 v[160:161], v[204:205], v[24:25] op_sel:[0,0] op_sel_hi:[0,1]
  v_pk_mul_f32 v[162:163], v[206:207], v[24:25] op_sel:[0,0] op_sel_hi:[0,1]
  v_pk_mul_f32 v[164:165], v[208:209], v[24:25] op_sel:[0,0] op_sel_hi:[0,1]
  v_pk_mul_f32 v[166:167], v[210:211], v[24:25] op_sel:[0,0] op_sel_hi:[0,1]
  v_pk_fma_f32 v[142:143], v[204:205], v[24:25], v[160:161] op_sel:[1,1,0] op_sel_hi:[1,0,1] neg_hi:[1,0,0]
  v_pk_fma_f32 v[140:141], v[206:207], v[24:25], v[162:163] op_sel:[1,1,0] op_sel_hi:[1,0,1] neg_hi:[1,0,0]
  v_pk_fma_f32 v[138:139], v[208:209], v[24:25], v[164:165] op_sel:[1,1,0] op_sel_hi:[1,0,1] neg_hi:[1,0,0]
  v_pk_fma_f32 v[136:137], v[210:211], v[24:25], v[166:167] op_sel:[1,1,0] op_sel_hi:[1,0,1] neg_hi:[1,0,0]
  v_pk_fma_f32 v[160:161], v[204:205], v[24:25], v[160:161] op_sel:[1,1,0] op_sel_hi:[1,0,1] neg_lo:[1,0,0]
  v_pk_fma_f32 v[162:163], v[206:207], v[24:25], v[162:163] op_sel:[1,1,0] op_sel_hi:[1,0,1] neg_lo:[1,0,0]
  v_pk_fma_f32 v[164:165], v[208:209], v[24:25], v[164:165] op_sel:[1,1,0] op_sel_hi:[1,0,1] neg_lo:[1,0,0]
  v_pk_fma_f32 v[166:167], v[210:211], v[24:25], v[166:167] op_sel:[1,1,0] op_sel_hi:[1,0,1] neg_lo:[1,0,0]
  v_mul_f32 v166, v166, v26
  v_mul_f32 v167, v167, v26
  v_cvt_pk_bf16_f32 v212, v136, -v137
  v_cvt_pk_bf16_f32 v213, v138, -v139
  v_cvt_pk_bf16_f32 v214, v140, -v141
  v_cvt_pk_bf16_f32 v215, v142, -v143
  ds_write_b128 v20, v[212:215] offset:0
  v_cvt_pk_bf16_f32 v224, v160, -v161
  v_cvt_pk_bf16_f32 v225, v162, -v163
  v_cvt_pk_bf16_f32 v226, v164, -v165
  v_cvt_pk_bf16_f32 v227, v166, -v167
  ds_write_b128 v20, v[224:227] offset:3072
  v_add_u32 v20, 4096, v20
  s_add_u32 s31, s31, 1
  s_cmp_lt_u32 s31, 4
  s_cbranch_scc1 L_gg16
  buffer_load_dwordx2 v[252:253], off, s[36:39], 0 offset:0 sc1
  s_bfm_b64 exec, 60, 0
  buffer_load_dword v254, v5, s[40:43], 0 offen nt
  buffer_load_dword v254, v5, s[44:47], 0 offen nt
  s_mov_b64 exec, -1
  v_lshlrev_b32 v28, 4, v9
  v_mov_b32 v29, 0x3f803f80
  v_mov_b32 v228, 0
  v_mov_b32 v229, 0
  v_mov_b32 v230, 0
  v_mov_b32 v231, 0
  v_mov_b32 v232, 0
  v_mov_b32 v233, 0
  v_mov_b32 v234, 0
  v_mov_b32 v235, 0
  s_barrier
  ds_read_b128 v[32:35], v28 offset:0
  ds_read_b128 v[36:39], v28 offset:1024
  ds_read_b128 v[40:43], v28 offset:2048
  ds_read_b128 v[44:47], v28 offset:3072
  ds_read_b128 v[48:51], v28 offset:4096
  ds_read_b128 v[52:55], v28 offset:5120
  ds_read_b128 v[56:59], v28 offset:6144
  ds_read_b128 v[60:63], v28 offset:7168
  ds_read_b128 v[64:67], v28 offset:8192
  ds_read_b128 v[68:71], v28 offset:9216
  ds_read_b128 v[72:75], v28 offset:10240
  ds_read_b128 v[76:79], v28 offset:11264
  ds_read_b128 v[80:83], v28 offset:12288
  ds_read_b128 v[84:87], v28 offset:13312
  ds_read_b128 v[88:91], v28 offset:14336
  ds_read_b128 v[92:95], v28 offset:15360
  s_waitcnt lgkmcnt(12)
  ds_read_b128 v[96:99], v28 offset:16384
  v_dot2c_f32_bf16 v228, v32, v29
  v_dot2c_f32_bf16 v229, v32, v32
  v_dot2c_f32_bf16 v230, v36, v29
  v_dot2c_f32_bf16 v231, v36, v36
  v_dot2c_f32_bf16 v232, v40, v29
  v_dot2c_f32_bf16 v233, v40, v40
  v_dot2c_f32_bf16 v234, v44, v29
  v_dot2c_f32_bf16 v235, v44, v44
  ds_read_b128 v[100:103], v28 offset:17408
  v_dot2c_f32_bf16 v228, v33, v29
  v_dot2c_f32_bf16 v229, v33, v33
  v_dot2c_f32_bf16 v230, v37, v29
  v_dot2c_f32_bf16 v231, v37, v37
  v_dot2c_f32_bf16 v232, v41, v29
  v_dot2c_f32_bf16 v233, v41, v41
  v_dot2c_f32_bf16 v234, v45, v29
  v_dot2c_f32_bf16 v235, v45, v45
  ds_read_b128 v[104:107], v28 offset:18432
  v_dot2c_f32_bf16 v228, v34, v29
  v_dot2c_f32_bf16 v229, v34, v34
  v_dot2c_f32_bf16 v230, v38, v29
  v_dot2c_f32_bf16 v231, v38, v38
  v_dot2c_f32_bf16 v232, v42, v29
  v_dot2c_f32_bf16 v233, v42, v42
  v_dot2c_f32_bf16 v234, v46, v29
  v_dot2c_f32_bf16 v235, v46, v46
  ds_read_b128 v[108:111], v28 offset:19456
  v_dot2c_f32_bf16 v228, v35, v29
  v_dot2c_f32_bf16 v229, v35, v35
  v_dot2c_f32_bf16 v230, v39, v29
  v_dot2c_f32_bf16 v231, v39, v39
  v_dot2c_f32_bf16 v232, v43, v29
  v_dot2c_f32_bf16 v233, v43, v43
  v_dot2c_f32_bf16 v234, v47, v29
  v_dot2c_f32_bf16 v235, v47, v47
  s_waitcnt lgkmcnt(12)
  ds_read_b128 v[112:115], v28 offset:20480
  v_dot2c_f32_bf16 v228, v48, v29
  v_dot2c_f32_bf16 v229, v48, v48
  v_dot2c_f32_bf16 v230, v52, v29
  v_dot2c_f32_bf16 v231, v52, v52
  v_dot2c_f32_bf16 v232, v56, v29
  v_dot2c_f32_bf16 v233, v56, v56
  v_dot2c_f32_bf16 v234, v60, v29
  v_dot2c_f32_bf16 v235, v60, v60
  ds_read_b128 v[116:119], v28 offset:21504
  v_dot2c_f32_bf16 v228, v49, v29
  v_dot2c_f32_bf16 v229, v49, v49
  v_dot2c_f32_bf16 v230, v53, v29
  v_dot2c_f32_bf16 v231, v53, v53
  v_dot2c_f32_bf16 v232, v57, v29
  v_dot2c_f32_bf16 v233, v57, v57
  v_dot2c_f32_bf16 v234, v61, v29
  v_dot2c_f32_bf16 v235, v61, v61
  ds_read_b128 v[120:123], v28 offset:22528
  v_dot2c_f32_bf16 v228, v50, v29
  v_dot2c_f32_bf16 v229, v50, v50
  v_dot2c_f32_bf16 v230, v54, v29
  v_dot2c_f32_bf16 v231, v54, v54
  v_dot2c_f32_bf16 v232, v58, v29
  v_dot2c_f32_bf16 v233, v58, v58
  v_dot2c_f32_bf16 v234, v62, v29
  v_dot2c_f32_bf16 v235, v62, v62
  ds_read_b128 v[124:127], v28 offset:23552
  v_dot2c_f32_bf16 v228, v51, v29
  v_dot2c_f32_bf16 v229, v51, v51
  v_dot2c_f32_bf16 v230, v55, v29
  v_dot2c_f32_bf16 v231, v55, v55
  v_dot2c_f32_bf16 v232, v59, v29
  v_dot2c_f32_bf16 v233, v59, v59
  v_dot2c_f32_bf16 v234, v63, v29
  v_dot2c_f32_bf16 v235, v63, v63
  s_waitcnt lgkmcnt(12)
  ds_read_b128 v[128:131], v28 offset:24576
  v_dot2c_f32_bf16 v228, v64, v29
  v_dot2c_f32_bf16 v229, v64, v64
  v_dot2c_f32_bf16 v230, v68, v29
  v_dot2c_f32_bf16 v231, v68, v68
  v_dot2c_f32_bf16 v232, v72, v29
  v_dot2c_f32_bf16 v233, v72, v72
  v_dot2c_f32_bf16 v234, v76, v29
  v_dot2c_f32_bf16 v235, v76, v76
  ds_read_b128 v[132:135], v28 offset:25600
  v_dot2c_f32_bf16 v228, v65, v29
  v_dot2c_f32_bf16 v229, v65, v65
  v_dot2c_f32_bf16 v230, v69, v29
  v_dot2c_f32_bf16 v231, v69, v69
  v_dot2c_f32_bf16 v232, v73, v29
  v_dot2c_f32_bf16 v233, v73, v73
  v_dot2c_f32_bf16 v234, v77, v29
  v_dot2c_f32_bf16 v235, v77, v77
  ds_read_b128 v[136:139], v28 offset:26624
  v_dot2c_f32_bf16 v228, v66, v29
  v_dot2c_f32_bf16 v229, v66, v66
  v_dot2c_f32_bf16 v230, v70, v29
  v_dot2c_f32_bf16 v231, v70, v70
  v_dot2c_f32_bf16 v232, v74, v29
  v_dot2c_f32_bf16 v233, v74, v74
  v_dot2c_f32_bf16 v234, v78, v29
  v_dot2c_f32_bf16 v235, v78, v78
  ds_read_b128 v[140:143], v28 offset:27648
  v_dot2c_f32_bf16 v228, v67, v29
  v_dot2c_f32_bf16 v229, v67, v67
  v_dot2c_f32_bf16 v230, v71, v29
  v_dot2c_f32_bf16 v231, v71, v71
  v_dot2c_f32_bf16 v232, v75, v29
  v_dot2c_f32_bf16 v233, v75, v75
  v_dot2c_f32_bf16 v234, v79, v29
  v_dot2c_f32_bf16 v235, v79, v79
  s_waitcnt lgkmcnt(12)
  ds_read_b128 v[144:147], v28 offset:28672
  v_dot2c_f32_bf16 v228, v80, v29
  v_dot2c_f32_bf16 v229, v80, v80
  v_dot2c_f32_bf16 v230, v84, v29
  v_dot2c_f32_bf16 v231, v84, v84
  v_dot2c_f32_bf16 v232, v88, v29
  v_dot2c_f32_bf16 v233, v88, v88
  v_dot2c_f32_bf16 v234, v92, v29
  v_dot2c_f32_bf16 v235, v92, v92
  ds_read_b128 v[148:151], v28 offset:29696
  v_dot2c_f32_bf16 v228, v81, v29
  v_dot2c_f32_bf16 v229, v81, v81
  v_dot2c_f32_bf16 v230, v85, v29
  v_dot2c_f32_bf16 v231, v85, v85
  v_dot2c_f32_bf16 v232, v89, v29
  v_dot2c_f32_bf16 v233, v89, v89
  v_dot2c_f32_bf16 v234, v93, v29
  v_dot2c_f32_bf16 v235, v93, v93
  ds_read_b128 v[152:155], v28 offset:30720
  v_dot2c_f32_bf16 v228, v82, v29
  v_dot2c_f32_bf16 v229, v82, v82
  v_dot2c_f32_bf16 v230, v86, v29
  v_dot2c_f32_bf16 v231, v86, v86
  v_dot2c_f32_bf16 v232, v90, v29
  v_dot2c_f32_bf16 v233, v90, v90
  v_dot2c_f32_bf16 v234, v94, v29
  v_dot2c_f32_bf16 v235, v94, v94
  ds_read_b128 v[156:159], v28 offset:31744
  v_dot2c_f32_bf16 v228, v83, v29
  v_dot2c_f32_bf16 v229, v83, v83
  v_dot2c_f32_bf16 v230, v87, v29
  v_dot2c_f32_bf16 v231, v87, v87
  v_dot2c_f32_bf16 v232, v91, v29
  v_dot2c_f32_bf16 v233, v91, v91
  v_dot2c_f32_bf16 v234, v95, v29
  v_dot2c_f32_bf16 v235, v95, v95
  s_waitcnt lgkmcnt(12)
  ds_read_b128 v[160:163], v28 offset:32768
  v_dot2c_f32_bf16 v228, v96, v29
  v_dot2c_f32_bf16 v229, v96, v96
  v_dot2c_f32_bf16 v230, v100, v29
  v_dot2c_f32_bf16 v231, v100, v100
  v_dot2c_f32_bf16 v232, v104, v29
  v_dot2c_f32_bf16 v233, v104, v104
  v_dot2c_f32_bf16 v234, v108, v29
  v_dot2c_f32_bf16 v235, v108, v108
  ds_read_b128 v[164:167], v28 offset:33792
  v_dot2c_f32_bf16 v228, v97, v29
  v_dot2c_f32_bf16 v229, v97, v97
  v_dot2c_f32_bf16 v230, v101, v29
  v_dot2c_f32_bf16 v231, v101, v101
  v_dot2c_f32_bf16 v232, v105, v29
  v_dot2c_f32_bf16 v233, v105, v105
  v_dot2c_f32_bf16 v234, v109, v29
  v_dot2c_f32_bf16 v235, v109, v109
  ds_read_b128 v[168:171], v28 offset:34816
  v_dot2c_f32_bf16 v228, v98, v29
  v_dot2c_f32_bf16 v229, v98, v98
  v_dot2c_f32_bf16 v230, v102, v29
  v_dot2c_f32_bf16 v231, v102, v102
  v_dot2c_f32_bf16 v232, v106, v29
  v_dot2c_f32_bf16 v233, v106, v106
  v_dot2c_f32_bf16 v234, v110, v29
  v_dot2c_f32_bf16 v235, v110, v110
  ds_read_b128 v[172:175], v28 offset:35840
  v_dot2c_f32_bf16 v228, v99, v29
  v_dot2c_f32_bf16 v229, v99, v99
  v_dot2c_f32_bf16 v230, v103, v29
  v_dot2c_f32_bf16 v231, v103, v103
  v_dot2c_f32_bf16 v232, v107, v29
  v_dot2c_f32_bf16 v233, v107, v107
  v_dot2c_f32_bf16 v234, v111, v29
  v_dot2c_f32_bf16 v235, v111, v111
  s_waitcnt lgkmcnt(12)
  v_dot2c_f32_bf16 v228, v112, v29
  v_dot2c_f32_bf16 v229, v112, v112
  v_dot2c_f32_bf16 v230, v116, v29
  v_dot2c_f32_bf16 v231, v116, v116
  v_dot2c_f32_bf16 v232, v120, v29
  v_dot2c_f32_bf16 v233, v120, v120
  v_dot2c_f32_bf16 v234, v124, v29
  v_dot2c_f32_bf16 v235, v124, v124
  v_dot2c_f32_bf16 v228, v113, v29
  v_dot2c_f32_bf16 v229, v113, v113
  v_dot2c_f32_bf16 v230, v117, v29
  v_dot2c_f32_bf16 v231, v117, v117
  v_dot2c_f32_bf16 v232, v121, v29
  v_dot2c_f32_bf16 v233, v121, v121
  v_dot2c_f32_bf16 v234, v125, v29
  v_dot2c_f32_bf16 v235, v125, v125
  v_dot2c_f32_bf16 v228, v114, v29
  v_dot2c_f32_bf16 v229, v114, v114
  v_dot2c_f32_bf16 v230, v118, v29
  v_dot2c_f32_bf16 v231, v118, v118
  v_dot2c_f32_bf16 v232, v122, v29
  v_dot2c_f32_bf16 v233, v122, v122
  v_dot2c_f32_bf16 v234, v126, v29
  v_dot2c_f32_bf16 v235, v126, v126
  v_dot2c_f32_bf16 v228, v115, v29
  v_dot2c_f32_bf16 v229, v115, v115
  v_dot2c_f32_bf16 v230, v119, v29
  v_dot2c_f32_bf16 v231, v119, v119
  v_dot2c_f32_bf16 v232, v123, v29
  v_dot2c_f32_bf16 v233, v123, v123
  v_dot2c_f32_bf16 v234, v127, v29
  v_dot2c_f32_bf16 v235, v127, v127
  s_waitcnt lgkmcnt(8)
  v_dot2c_f32_bf16 v228, v128, v29
  v_dot2c_f32_bf16 v229, v128, v128
  v_dot2c_f32_bf16 v230, v132, v29
  v_dot2c_f32_bf16 v231, v132, v132
  v_dot2c_f32_bf16 v232, v136, v29
  v_dot2c_f32_bf16 v233, v136, v136
  v_dot2c_f32_bf16 v234, v140, v29
  v_dot2c_f32_bf16 v235, v140, v140
  v_dot2c_f32_bf16 v228, v129, v29
  v_dot2c_f32_bf16 v229, v129, v129
  v_dot2c_f32_bf16 v230, v133, v29
  v_dot2c_f32_bf16 v231, v133, v133
  v_dot2c_f32_bf16 v232, v137, v29
  v_dot2c_f32_bf16 v233, v137, v137
  v_dot2c_f32_bf16 v234, v141, v29
  v_dot2c_f32_bf16 v235, v141, v141
  v_dot2c_f32_bf16 v228, v130, v29
  v_dot2c_f32_bf16 v229, v130, v130
  v_dot2c_f32_bf16 v230, v134, v29
  v_dot2c_f32_bf16 v231, v134, v134
  v_dot2c_f32_bf16 v232, v138, v29
  v_dot2c_f32_bf16 v233, v138, v138
  v_dot2c_f32_bf16 v234, v142, v29
  v_dot2c_f32_bf16 v235, v142, v142
  v_dot2c_f32_bf16 v228, v131, v29
  v_dot2c_f32_bf16 v229, v131, v131
  v_dot2c_f32_bf16 v230, v135, v29
  v_dot2c_f32_bf16 v231, v135, v135
  v_dot2c_f32_bf16 v232, v139, v29
  v_dot2c_f32_bf16 v233, v139, v139
  v_dot2c_f32_bf16 v234, v143, v29
  v_dot2c_f32_bf16 v235, v143, v143
  s_waitcnt lgkmcnt(4)
  v_dot2c_f32_bf16 v228, v144, v29
  v_dot2c_f32_bf16 v229, v144, v144
  v_dot2c_f32_bf16 v230, v148, v29
  v_dot2c_f32_bf16 v231, v148, v148
  v_dot2c_f32_bf16 v232, v152, v29
  v_dot2c_f32_bf16 v233, v152, v152
  v_dot2c_f32_bf16 v234, v156, v29
  v_dot2c_f32_bf16 v235, v156, v156
  v_dot2c_f32_bf16 v228, v145, v29
  v_dot2c_f32_bf16 v229, v145, v145
  v_dot2c_f32_bf16 v230, v149, v29
  v_dot2c_f32_bf16 v231, v149, v149
  v_dot2c_f32_bf16 v232, v153, v29
  v_dot2c_f32_bf16 v233, v153, v153
  v_dot2c_f32_bf16 v234, v157, v29
  v_dot2c_f32_bf16 v235, v157, v157
  v_dot2c_f32_bf16 v228, v146, v29
  v_dot2c_f32_bf16 v229, v146, v146
  v_dot2c_f32_bf16 v230, v150, v29
  v_dot2c_f32_bf16 v231, v150, v150
  v_dot2c_f32_bf16 v232, v154, v29
  v_dot2c_f32_bf16 v233, v154, v154
  v_dot2c_f32_bf16 v234, v158, v29
  v_dot2c_f32_bf16 v235, v158, v158
  v_dot2c_f32_bf16 v228, v147, v29
  v_dot2c_f32_bf16 v229, v147, v147
  v_dot2c_f32_bf16 v230, v151, v29
  v_dot2c_f32_bf16 v231, v151, v151
  v_dot2c_f32_bf16 v232, v155, v29
  v_dot2c_f32_bf16 v233, v155, v155
  v_dot2c_f32_bf16 v234, v159, v29
  v_dot2c_f32_bf16 v235, v159, v159
  s_waitcnt lgkmcnt(0)
  v_dot2c_f32_bf16 v228, v160, v29
  v_dot2c_f32_bf16 v229, v160, v160
  v_dot2c_f32_bf16 v230, v164, v29
  v_dot2c_f32_bf16 v231, v164, v164
  v_dot2c_f32_bf16 v232, v168, v29
  v_dot2c_f32_bf16 v233, v168, v168
  v_dot2c_f32_bf16 v234, v172, v29
  v_dot2c_f32_bf16 v235, v172, v172
  v_dot2c_f32_bf16 v228, v161, v29
  v_dot2c_f32_bf16 v229, v161, v161
  v_dot2c_f32_bf16 v230, v165, v29
  v_dot2c_f32_bf16 v231, v165, v165
  v_dot2c_f32_bf16 v232, v169, v29
  v_dot2c_f32_bf16 v233, v169, v169
  v_dot2c_f32_bf16 v234, v173, v29
  v_dot2c_f32_bf16 v235, v173, v173
  v_dot2c_f32_bf16 v228, v162, v29
  v_dot2c_f32_bf16 v229, v162, v162
  v_dot2c_f32_bf16 v230, v166, v29
  v_dot2c_f32_bf16 v231, v166, v166
  v_dot2c_f32_bf16 v232, v170, v29
  v_dot2c_f32_bf16 v233, v170, v170
  v_dot2c_f32_bf16 v234, v174, v29
  v_dot2c_f32_bf16 v235, v174, v174
  v_dot2c_f32_bf16 v228, v163, v29
  v_dot2c_f32_bf16 v229, v163, v163
  v_dot2c_f32_bf16 v230, v167, v29
  v_dot2c_f32_bf16 v231, v167, v167
  v_dot2c_f32_bf16 v232, v171, v29
  v_dot2c_f32_bf16 v233, v171, v171
  v_dot2c_f32_bf16 v234, v175, v29
  v_dot2c_f32_bf16 v235, v175, v175
  s_nop 2
  v_add_f32_dpp v228, v228, v228 quad_perm:[1,0,3,2] row_mask:0xf bank_mask:0xf
  v_add_f32_dpp v229, v229, v229 quad_perm:[1,0,3,2] row_mask:0xf bank_mask:0xf
  v_add_f32_dpp v230, v230, v230 quad_perm:[1,0,3,2] row_mask:0xf bank_mask:0xf
  v_add_f32_dpp v231, v231, v231 quad_perm:[1,0,3,2] row_mask:0xf bank_mask:0xf
  v_add_f32_dpp v232, v232, v232 quad_perm:[1,0,3,2] row_mask:0xf bank_mask:0xf
  v_add_f32_dpp v233, v233, v233 quad_perm:[1,0,3,2] row_mask:0xf bank_mask:0xf
  v_add_f32_dpp v234, v234, v234 quad_perm:[1,0,3,2] row_mask:0xf bank_mask:0xf
  v_add_f32_dpp v235, v235, v235 quad_perm:[1,0,3,2] row_mask:0xf bank_mask:0xf
  v_add_f32_dpp v228, v228, v228 quad_perm:[2,3,0,1] row_mask:0xf bank_mask:0xf
  v_add_f32_dpp v229, v229, v229 quad_perm:[2,3,0,1] row_mask:0xf bank_mask:0xf
  v_add_f32_dpp v230, v230, v230 quad_perm:[2,3,0,1] row_mask:0xf bank_mask:0xf
  v_add_f32_dpp v231, v231, v231 quad_perm:[2,3,0,1] row_mask:0xf bank_mask:0xf
  v_add_f32_dpp v232, v232, v232 quad_perm:[2,3,0,1] row_mask:0xf bank_mask:0xf
  v_add_f32_dpp v233, v233, v233 quad_perm:[2,3,0,1] row_mask:0xf bank_mask:0xf
  v_add_f32_dpp v234, v234, v234 quad_perm:[2,3,0,1] row_mask:0xf bank_mask:0xf
  v_add_f32_dpp v235, v235, v235 quad_perm:[2,3,0,1] row_mask:0xf bank_mask:0xf
  s_nop 0
  v_permlane32_swap_b32 v228, v232
  v_permlane32_swap_b32 v229, v233
  v_permlane32_swap_b32 v230, v234
  v_permlane32_swap_b32 v231, v235
  s_nop 0
  v_add_f32 v228, v228, v232
  v_add_f32 v229, v229, v233
  v_add_f32 v230, v230, v234
  v_add_f32 v231, v231, v235
  v_mul_f32 v228, 0x3ae38e39, v228
  v_mov_b32 v232, 0x3727c5ac
  v_fmac_f32 v232, 0x3ae38e39, v229
  v_fma_f32 v232, -v228, v228, v232
  v_max_f32 v232, 0x3727c5ac, v232
  v_rsq_f32 v232, v232
  v_mul_f32 v230, 0x3ae38e39, v230
  v_mov_b32 v233, 0x3727c5ac
  v_fmac_f32 v233, 0x3ae38e39, v231
  v_fma_f32 v233, -v230, v230, v233
  v_max_f32 v233, 0x3727c5ac, v233
  v_rsq_f32 v233, v233
  v_lshrrev_b32 v28, 5, v9
  v_bfe_u32 v29, v9, 2, 3
  v_lshl_add_u32 v30, v28, 4, v29
  v_lshlrev_b32 v30, 2, v30
  v_add_u32 v30, 159872, v30
  v_bfe_u32 v29, v9, 3, 2
  v_lshl_add_u32 v28, v28, 3, v29
  v_bfe_u32 v29, v9, 2, 1
  v_lshl_add_u32 v28, v29, 4, v28
  v_lshlrev_b32 v28, 2, v28
  v_add_u32 v28, 159744, v28
  v_mul_f32 v232, 0x24000000, v232
  v_mul_f32 v233, 0x24000000, v233
  ds_write_b32 v28, v232 offset:0
  ds_write_b32 v30, v228 offset:0
  ds_write_b32 v28, v233 offset:16
  ds_write_b32 v30, v230 offset:32
  s_waitcnt lgkmcnt(0)
  v_mov_b32 v10, 161292
  v_mov_b32 v11, 1
  ds_add_u32 v10, v11
  s_waitcnt vmcnt(0)
  v_readfirstlane_b32 s56, v252
  v_readfirstlane_b32 s57, v253
  s_nop 1
  s_cmp_lg_u32 s56, 0
  s_cbranch_scc1 L_ok17
  s_mov_b32 s59, 50000
L_lp18:
  s_sleep 4
  buffer_load_dwordx2 v[252:253], off, s[36:39], 0 offset:0 sc1
  s_waitcnt vmcnt(0)
  s_sub_u32 s59, s59, 1
  s_cbranch_scc1 L_ok17
  v_readfirstlane_b32 s56, v252
  v_readfirstlane_b32 s57, v253
  s_nop 1
  s_cmp_lg_u32 s56, 0
  s_cbranch_scc0 L_lp18
L_ok17:
  v_mov_b32 v10, 161296
  ds_write_b64 v10, v[252:253] offset:8
  s_waitcnt lgkmcnt(0)
  v_mov_b32 v10, 161292
  v_mov_b32 v11, 1
  ds_add_u32 v10, v11
  s_mov_b32 m0, 110592
  s_add_u32 s23, s22, 0
  buffer_load_dwordx4 v4, s[40:43], s23 offen  lds
  s_mov_b32 m0, 118784
  s_add_u32 s23, s22, 0
  buffer_load_dwordx4 v4, s[44:47], s23 offen  lds
  s_mov_b32 m0, 111616
  s_add_u32 s23, s22, 147968
  buffer_load_dwordx4 v4, s[40:43], s23 offen  lds
  s_mov_b32 m0, 119808
  s_add_u32 s23, s22, 147968
  buffer_load_dwordx4 v4, s[44:47], s23 offen  lds
  s_mov_b32 m0, 112640
  s_add_u32 s23, s22, 295936
  buffer_load_dwordx4 v4, s[40:43], s23 offen  lds
  s_mov_b32 m0, 120832
  s_add_u32 s23, s22, 295936
  buffer_load_dwordx4 v4, s[44:47], s23 offen  lds
  s_mov_b32 m0, 113664
  s_add_u32 s23, s22, 443904
  buffer_load_dwordx4 v4, s[40:43], s23 offen  lds
  s_mov_b32 m0, 121856
  s_add_u32 s23, s22, 443904
  buffer_load_dwordx4 v4, s[44:47], s23 offen  lds
  s_mov_b32 m0, 114688
  s_add_u32 s23, s22, 591872
  buffer_load_dwordx4 v4, s[40:43], s23 offen  lds
  s_mov_b32 m0, 122880
  s_add_u32 s23, s22, 591872
  buffer_load_dwordx4 v4, s[44:47], s23 offen  lds
  s_mov_b32 m0, 115712
  s_add_u32 s23, s22, 739840
  buffer_load_dwordx4 v4, s[40:43], s23 offen  lds
  s_mov_b32 m0, 123904
  s_add_u32 s23, s22, 739840
  buffer_load_dwordx4 v4, s[44:47], s23 offen  lds
  s_mov_b32 m0, 116736
  s_add_u32 s23, s22, 887808
  buffer_load_dwordx4 v4, s[40:43], s23 offen  lds
  s_mov_b32 m0, 124928
  s_add_u32 s23, s22, 887808
  buffer_load_dwordx4 v4, s[44:47], s23 offen  lds
  s_mov_b32 m0, 117760
  s_add_u32 s23, s22, 1035776
  buffer_load_dwordx4 v4, s[40:43], s23 offen  lds
  s_mov_b32 m0, 125952
  s_add_u32 s23, s22, 1035776
  buffer_load_dwordx4 v4, s[44:47], s23 offen  lds
  s_mov_b64 exec, 0
  s_branch L_qad0
L_qad_end:
  s_mov_b64 exec, -1
  v_add_f32 v22, 0x430b8000, v19
  s_mov_b32 s31, 4
L_gg19:
  v_mul_f32 v23, v22, v21
  v_cos_f32 v24, v23
  v_sin_f32 v25, v23
  v_add_f32 v22, 0x42000000, v22
  s_cmp_eq_u32 s31, 8
  s_cselect_b64 vcc, -1, 0
  v_cndmask_b32 v26, 1.0, v17, vcc
  v_pk_mul_f32 v[152:153], v[196:197], v[24:25] op_sel:[0,0] op_sel_hi:[0,1]
  v_pk_mul_f32 v[154:155], v[198:199], v[24:25] op_sel:[0,0] op_sel_hi:[0,1]
  v_pk_mul_f32 v[156:157], v[200:201], v[24:25] op_sel:[0,0] op_sel_hi:[0,1]
  v_pk_mul_f32 v[158:159], v[202:203], v[24:25] op_sel:[0,0] op_sel_hi:[0,1]
  v_pk_fma_f32 v[150:151], v[196:197], v[24:25], v[152:153] op_sel:[1,1,0] op_sel_hi:[1,0,1] neg_hi:[1,0,0]
  v_pk_fma_f32 v[148:149], v[198:199], v[24:25], v[154:155] op_sel:[1,1,0] op_sel_hi:[1,0,1] neg_hi:[1,0,0]
  v_pk_fma_f32 v[146:147], v[200:201], v[24:25], v[156:157] op_sel:[1,1,0] op_sel_hi:[1,0,1] neg_hi:[1,0,0]
  v_pk_fma_f32 v[144:145], v[202:203], v[24:25], v[158:159] op_sel:[1,1,0] op_sel_hi:[1,0,1] neg_hi:[1,0,0]
  v_pk_fma_f32 v[152:153], v[196:197], v[24:25], v[152:153] op_sel:[1,1,0] op_sel_hi:[1,0,1] neg_lo:[1,0,0]
  v_pk_fma_f32 v[154:155], v[198:199], v[24:25], v[154:155] op_sel:[1,1,0] op_sel_hi:[1,0,1] neg_lo:[1,0,0]
  v_pk_fma_f32 v[156:157], v[200:201], v[24:25], v[156:157] op_sel:[1,1,0] op_sel_hi:[1,0,1] neg_lo:[1,0,0]
  v_pk_fma_f32 v[158:159], v[202:203], v[24:25], v[158:159] op_sel:[1,1,0] op_sel_hi:[1,0,1] neg_lo:[1,0,0]
  v_cvt_pk_bf16_f32 v216, v144, -v145
  v_cvt_pk_bf16_f32 v217, v146, -v147
  v_cvt_pk_bf16_f32 v218, v148, -v149
  v_cvt_pk_bf16_f32 v219, v150, -v151
  ds_write_b128 v20, v[216:219] offset:1024
  v_cvt_pk_bf16_f32 v220, v152, -v153
  v_cvt_pk_bf16_f32 v221, v154, -v155
  v_cvt_pk_bf16_f32 v222, v156, -v157
  v_cvt_pk_bf16_f32 v223, v158, -v159
  ds_write_b128 v20, v[220:223] offset:2048
  v_pk_mul_f32 v[160:161], v[204:205], v[24:25] op_sel:[0,0] op_sel_hi:[0,1]
  v_pk_mul_f32 v[162:163], v[206:207], v[24:25] op_sel:[0,0] op_sel_hi:[0,1]
  v_pk_mul_f32 v[164:165], v[208:209], v[24:25] op_sel:[0,0] op_sel_hi:[0,1]
  v_pk_mul_f32 v[166:167], v[210:211], v[24:25] op_sel:[0,0] op_sel_hi:[0,1]
  v_pk_fma_f32 v[142:143], v[204:205], v[24:25], v[160:161] op_sel:[1,1,0] op_sel_hi:[1,0,1] neg_hi:[1,0,0]
  v_pk_fma_f32 v[140:141], v[206:207], v[24:25], v[162:163] op_sel:[1,1,0] op_sel_hi:[1,0,1] neg_hi:[1,0,0]
  v_pk_fma_f32 v[138:139], v[208:209], v[24:25], v[164:165] op_sel:[1,1,0] op_sel_hi:[1,0,1] neg_hi:[1,0,0]
  v_pk_fma_f32 v[136:137], v[210:211], v[24:25], v[166:167] op_sel:[1,1,0] op_sel_hi:[1,0,1] neg_hi:[1,0,0]
  v_pk_fma_f32 v[160:161], v[204:205], v[24:25], v[160:161] op_sel:[1,1,0] op_sel_hi:[1,0,1] neg_lo:[1,0,0]
  v_pk_fma_f32 v[162:163], v[206:207], v[24:25], v[162:163] op_sel:[1,1,0] op_sel_hi:[1,0,1] neg_lo:[1,0,0]
  v_pk_fma_f32 v[164:165], v[208:209], v[24:25], v[164:165] op_sel:[1,1,0] op_sel_hi:[1,0,1] neg_lo:[1,0,0]
  v_pk_fma_f32 v[166:167], v[210:211], v[24:25], v[166:167] op_sel:[1,1,0] op_sel_hi:[1,0,1] neg_lo:[1,0,0]
  v_mul_f32 v166, v166, v26
  v_mul_f32 v167, v167, v26
  v_cvt_pk_bf16_f32 v212, v136, -v137
  v_cvt_pk_bf16_f32 v213, v138, -v139
  v_cvt_pk_bf16_f32 v214, v140, -v141
  v_cvt_pk_bf16_f32 v215, v142, -v143
  ds_write_b128 v20, v[212:215] offset:0
  v_cvt_pk_bf16_f32 v224, v160, -v161
  v_cvt_pk_bf16_f32 v225, v162, -v163
  v_cvt_pk_bf16_f32 v226, v164, -v165
  v_cvt_pk_bf16_f32 v227, v166, -v167
  ds_write_b128 v20, v[224:227] offset:3072
  v_add_u32 v20, 4096, v20
  s_add_u32 s31, s31, 1
  s_cmp_lt_u32 s31, 6
  s_cbranch_scc1 L_gg19
  s_waitcnt vmcnt(0)
  s_waitcnt lgkmcnt(0)
  v_mov_b32 v10, 161288
  v_mov_b32 v11, 1
  ds_add_u32 v10, v11
  buffer_load_dwordx2 v[240:241], v250, s[12:15], s27 offen sc1
  v_add_u32 v21, 32, v18
  v_cvt_f32_u32 v21, v21
  v_mul_f32 v21, 0x3ae38e39, v21
  v_mul_f32 v23, 0x40900000, v21
  v_cos_f32 v196, v23
  v_sin_f32 v197, v23
  v_mul_f32 v23, 0x40d00000, v21
  v_cos_f32 v198, v23
  v_sin_f32 v199, v23
  v_mul_f32 v23, 0x41080000, v21
  v_cos_f32 v200, v23
  v_sin_f32 v201, v23
  v_mul_f32 v23, 0x41280000, v21
  v_cos_f32 v202, v23
  v_sin_f32 v203, v23
  v_mul_f32 v23, 0x40b00000, v21
  v_cos_f32 v204, v23
  v_sin_f32 v205, v23
  v_mul_f32 v23, 0x40f00000, v21
  v_cos_f32 v206, v23
  v_sin_f32 v207, v23
  v_mul_f32 v23, 0x41180000, v21
  v_cos_f32 v208, v23
  v_sin_f32 v209, v23
  v_mul_f32 v23, 0x41380000, v21
  v_cos_f32 v210, v23
  v_sin_f32 v211, v23
  v_add_f32 v22, 0x42d70000, v19
  s_mov_b32 s31, 3
L_gg20:
  v_mul_f32 v23, v22, v21
  v_cos_f32 v24, v23
  v_sin_f32 v25, v23
  v_add_f32 v22, 0x42000000, v22
  s_cmp_eq_u32 s31, 8
  s_cselect_b64 vcc, -1, 0
  v_cndmask_b32 v26, 1.0, v17, vcc
  v_pk_mul_f32 v[152:153], v[196:197], v[24:25] op_sel:[0,0] op_sel_hi:[0,1]
  v_pk_mul_f32 v[154:155], v[198:199], v[24:25] op_sel:[0,0] op_sel_hi:[0,1]
  v_pk_mul_f32 v[156:157], v[200:201], v[24:25] op_sel:[0,0] op_sel_hi:[0,1]
  v_pk_mul_f32 v[158:159], v[202:203], v[24:25] op_sel:[0,0] op_sel_hi:[0,1]
  v_pk_fma_f32 v[150:151], v[196:197], v[24:25], v[152:153] op_sel:[1,1,0] op_sel_hi:[1,0,1] neg_hi:[1,0,0]
  v_pk_fma_f32 v[148:149], v[198:199], v[24:25], v[154:155] op_sel:[1,1,0] op_sel_hi:[1,0,1] neg_hi:[1,0,0]
  v_pk_fma_f32 v[146:147], v[200:201], v[24:25], v[156:157] op_sel:[1,1,0] op_sel_hi:[1,0,1] neg_hi:[1,0,0]
  v_pk_fma_f32 v[144:145], v[202:203], v[24:25], v[158:159] op_sel:[1,1,0] op_sel_hi:[1,0,1] neg_hi:[1,0,0]
  v_pk_fma_f32 v[152:153], v[196:197], v[24:25], v[152:153] op_sel:[1,1,0] op_sel_hi:[1,0,1] neg_lo:[1,0,0]
  v_pk_fma_f32 v[154:155], v[198:199], v[24:25], v[154:155] op_sel:[1,1,0] op_sel_hi:[1,0,1] neg_lo:[1,0,0]
  v_pk_fma_f32 v[156:157], v[200:201], v[24:25], v[156:157] op_sel:[1,1,0] op_sel_hi:[1,0,1] neg_lo:[1,0,0]
  v_pk_fma_f32 v[158:159], v[202:203], v[24:25], v[158:159] op_sel:[1,1,0] op_sel_hi:[1,0,1] neg_lo:[1,0,0]
  v_cvt_pk_bf16_f32 v216, v144, -v145
  v_cvt_pk_bf16_f32 v217, v146, -v147
  v_cvt_pk_bf16_f32 v218, v148, -v149
  v_cvt_pk_bf16_f32 v219, v150, -v151
  ds_write_b128 v20, v[216:219] offset:1024
  v_cvt_pk_bf16_f32 v220, v152, -v153
  v_cvt_pk_bf16_f32 v221, v154, -v155
  v_cvt_pk_bf16_f32 v222, v156, -v157
  v_cvt_pk_bf16_f32 v223, v158, -v159
  ds_write_b128 v20, v[220:223] offset:2048
  v_pk_mul_f32 v[160:161], v[204:205], v[24:25] op_sel:[0,0] op_sel_hi:[0,1]
  v_pk_mul_f32 v[162:163], v[206:207], v[24:25] op_sel:[0,0] op_sel_hi:[0,1]
  v_pk_mul_f32 v[164:165], v[208:209], v[24:25] op_sel:[0,0] op_sel_hi:[0,1]
  v_pk_mul_f32 v[166:167], v[210:211], v[24:25] op_sel:[0,0] op_sel_hi:[0,1]
  v_pk_fma_f32 v[142:143], v[204:205], v[24:25], v[160:161] op_sel:[1,1,0] op_sel_hi:[1,0,1] neg_hi:[1,0,0]
  v_pk_fma_f32 v[140:141], v[206:207], v[24:25], v[162:163] op_sel:[1,1,0] op_sel_hi:[1,0,1] neg_hi:[1,0,0]
  v_pk_fma_f32 v[138:139], v[208:209], v[24:25], v[164:165] op_sel:[1,1,0] op_sel_hi:[1,0,1] neg_hi:[1,0,0]
  v_pk_fma_f32 v[136:137], v[210:211], v[24:25], v[166:167] op_sel:[1,1,0] op_sel_hi:[1,0,1] neg_hi:[1,0,0]
  v_pk_fma_f32 v[160:161], v[204:205], v[24:25], v[160:161] op_sel:[1,1,0] op_sel_hi:[1,0,1] neg_lo:[1,0,0]
  v_pk_fma_f32 v[162:163], v[206:207], v[24:25], v[162:163] op_sel:[1,1,0] op_sel_hi:[1,0,1] neg_lo:[1,0,0]
  v_pk_fma_f32 v[164:165], v[208:209], v[24:25], v[164:165] op_sel:[1,1,0] op_sel_hi:[1,0,1] neg_lo:[1,0,0]
  v_pk_fma_f32 v[166:167], v[210:211], v[24:25], v[166:167] op_sel:[1,1,0] op_sel_hi:[1,0,1] neg_lo:[1,0,0]
  v_mul_f32 v166, v166, v26
  v_mul_f32 v167, v167, v26
  v_cvt_pk_bf16_f32 v212, v136, -v137
  v_cvt_pk_bf16_f32 v213, v138, -v139
  v_cvt_pk_bf16_f32 v214, v140, -v141
  v_cvt_pk_bf16_f32 v215, v142, -v143
  ds_write_b128 v20, v[212:215] offset:0
  v_cvt_pk_bf16_f32 v224, v160, -v161
  v_cvt_pk_bf16_f32 v225, v162, -v163
  v_cvt_pk_bf16_f32 v226, v164, -v165
  v_cvt_pk_bf16_f32 v227, v166, -v167
  ds_write_b128 v20, v[224:227] offset:3072
  v_add_u32 v20, 4096, v20
  s_add_u32 s31, s31, 1
  s_cmp_lt_u32 s31, 5
  s_cbranch_scc1 L_gg20
  s_waitcnt vmcnt(0)
  v_cmp_eq_u64 vcc, s[56:57], v[240:241]
  s_nop 1
  s_cmp_eq_u64 vcc, -1
  s_cbranch_scc0 L_lp22s
L_ok21:
  s_waitcnt lgkmcnt(0)
  v_mov_b32 v10, 161288
  v_mov_b32 v11, 1
  ds_add_u32 v10, v11
  s_waitcnt lgkmcnt(0)
  s_getreg_b32 s30, hwreg(HW_REG_XCC_ID)
  s_and_b32 s30, s30, 7
  s_lshl_b32 s29, s30, 7
  s_add_u32 s29, s29, 49807360
  s_mov_b32 s35, 1
  s_atomic_add s35, s[12:13], s29 glc
  v_add_f32 v22, 0x432b8000, v19
  s_mov_b32 s31, 5
L_gg23:
  v_mul_f32 v23, v22, v21
  v_cos_f32 v24, v23
  v_sin_f32 v25, v23
  v_add_f32 v22, 0x42000000, v22
  s_cmp_eq_u32 s31, 8
  s_cselect_b64 vcc, -1, 0
  v_cndmask_b32 v26, 1.0, v17, vcc
  v_pk_mul_f32 v[152:153], v[196:197], v[24:25] op_sel:[0,0] op_sel_hi:[0,1]
  v_pk_mul_f32 v[154:155], v[198:199], v[24:25] op_sel:[0,0] op_sel_hi:[0,1]
  v_pk_mul_f32 v[156:157], v[200:201], v[24:25] op_sel:[0,0] op_sel_hi:[0,1]
  v_pk_mul_f32 v[158:159], v[202:203], v[24:25] op_sel:[0,0] op_sel_hi:[0,1]
  v_pk_fma_f32 v[150:151], v[196:197], v[24:25], v[152:153] op_sel:[1,1,0] op_sel_hi:[1,0,1] neg_hi:[1,0,0]
  v_pk_fma_f32 v[148:149], v[198:199], v[24:25], v[154:155] op_sel:[1,1,0] op_sel_hi:[1,0,1] neg_hi:[1,0,0]
  v_pk_fma_f32 v[146:147], v[200:201], v[24:25], v[156:157] op_sel:[1,1,0] op_sel_hi:[1,0,1] neg_hi:[1,0,0]
  v_pk_fma_f32 v[144:145], v[202:203], v[24:25], v[158:159] op_sel:[1,1,0] op_sel_hi:[1,0,1] neg_hi:[1,0,0]
  v_pk_fma_f32 v[152:153], v[196:197], v[24:25], v[152:153] op_sel:[1,1,0] op_sel_hi:[1,0,1] neg_lo:[1,0,0]
  v_pk_fma_f32 v[154:155], v[198:199], v[24:25], v[154:155] op_sel:[1,1,0] op_sel_hi:[1,0,1] neg_lo:[1,0,0]
  v_pk_fma_f32 v[156:157], v[200:201], v[24:25], v[156:157] op_sel:[1,1,0] op_sel_hi:[1,0,1] neg_lo:[1,0,0]
  v_pk_fma_f32 v[158:159], v[202:203], v[24:25], v[158:159] op_sel:[1,1,0] op_sel_hi:[1,0,1] neg_lo:[1,0,0]
  v_cvt_pk_bf16_f32 v216, v144, -v145
  v_cvt_pk_bf16_f32 v217, v146, -v147
  v_cvt_pk_bf16_f32 v218, v148, -v149
  v_cvt_pk_bf16_f32 v219, v150, -v151
  ds_write_b128 v20, v[216:219] offset:1024
  v_cvt_pk_bf16_f32 v220, v152, -v153
  v_cvt_pk_bf16_f32 v221, v154, -v155
  v_cvt_pk_bf16_f32 v222, v156, -v157
  v_cvt_pk_bf16_f32 v223, v158, -v159
  ds_write_b128 v20, v[220:223] offset:2048
  v_pk_mul_f32 v[160:161], v[204:205], v[24:25] op_sel:[0,0] op_sel_hi:[0,1]
  v_pk_mul_f32 v[162:163], v[206:207], v[24:25] op_sel:[0,0] op_sel_hi:[0,1]
  v_pk_mul_f32 v[164:165], v[208:209], v[24:25] op_sel:[0,0] op_sel_hi:[0,1]
  v_pk_mul_f32 v[166:167], v[210:211], v[24:25] op_sel:[0,0] op_sel_hi:[0,1]
  v_pk_fma_f32 v[142:143], v[204:205], v[24:25], v[160:161] op_sel:[1,1,0] op_sel_hi:[1,0,1] neg_hi:[1,0,0]
  v_pk_fma_f32 v[140:141], v[206:207], v[24:25], v[162:163] op_sel:[1,1,0] op_sel_hi:[1,0,1] neg_hi:[1,0,0]
  v_pk_fma_f32 v[138:139], v[208:209], v[24:25], v[164:165] op_sel:[1,1,0] op_sel_hi:[1,0,1] neg_hi:[1,0,0]
  v_pk_fma_f32 v[136:137], v[210:211], v[24:25], v[166:167] op_sel:[1,1,0] op_sel_hi:[1,0,1] neg_hi:[1,0,0]
  v_pk_fma_f32 v[160:161], v[204:205], v[24:25], v[160:161] op_sel:[1,1,0] op_sel_hi:[1,0,1] neg_lo:[1,0,0]
  v_pk_fma_f32 v[162:163], v[206:207], v[24:25], v[162:163] op_sel:[1,1,0] op_sel_hi:[1,0,1] neg_lo:[1,0,0]
  v_pk_fma_f32 v[164:165], v[208:209], v[24:25], v[164:165] op_sel:[1,1,0] op_sel_hi:[1,0,1] neg_lo:[1,0,0]
  v_pk_fma_f32 v[166:167], v[210:211], v[24:25], v[166:167] op_sel:[1,1,0] op_sel_hi:[1,0,1] neg_lo:[1,0,0]
  v_mul_f32 v166, v166, v26
  v_mul_f32 v167, v167, v26
  v_cvt_pk_bf16_f32 v212, v136, -v137
  v_cvt_pk_bf16_f32 v213, v138, -v139
  v_cvt_pk_bf16_f32 v214, v140, -v141
  v_cvt_pk_bf16_f32 v215, v142, -v143
  ds_write_b128 v20, v[212:215] offset:0
  v_cvt_pk_bf16_f32 v224, v160, -v161
  v_cvt_pk_bf16_f32 v225, v162, -v163
  v_cvt_pk_bf16_f32 v226, v164, -v165
  v_cvt_pk_bf16_f32 v227, v166, -v167
  ds_write_b128 v20, v[224:227] offset:3072
  v_add_u32 v20, 4096, v20
  s_add_u32 s31, s31, 1
  s_cmp_lt_u32 s31, 7
  s_cbranch_scc1 L_gg23
  s_waitcnt lgkmcnt(0)
  s_mov_b32 s28, 7
  s_branch L_tkc
L_tkl:
  s_add_u32 s30, s30, 1
  s_and_b32 s30, s30, 7
  s_lshl_b32 s29, s30, 7
  s_add_u32 s29, s29, 49807360
  s_mov_b32 s35, 1
  s_atomic_add s35, s[12:13], s29 glc
  s_waitcnt lgkmcnt(0)
L_tkc:
  s_cmp_lt_u32 s35, 24
  s_cbranch_scc1 L_tkx
  s_sub_u32 s28, s28, 1
  s_cbranch_scc0 L_tkl
  s_mov_b32 s35, s34
  s_mov_b32 s30, s33
L_tkx:
  s_add_u32 s35, s35, 8
  s_lshl_b32 s35, s35, 3
  s_add_u32 s35, s35, s30
  v_mov_b32 v10, 161296
  v_mov_b32 v11, s35
  ds_write_b32 v10, v11
  v_add_f32 v22, 0x436b8000, v19
  s_mov_b32 s31, 7
L_gg24:
  v_mul_f32 v23, v22, v21
  v_cos_f32 v24, v23
  v_sin_f32 v25, v23
  v_add_f32 v22, 0x42000000, v22
  s_cmp_eq_u32 s31, 8
  s_cselect_b64 vcc, -1, 0
  v_cndmask_b32 v26, 1.0, v17, vcc
  v_pk_mul_f32 v[152:153], v[196:197], v[24:25] op_sel:[0,0] op_sel_hi:[0,1]
  v_pk_mul_f32 v[154:155], v[198:199], v[24:25] op_sel:[0,0] op_sel_hi:[0,1]
  v_pk_mul_f32 v[156:157], v[200:201], v[24:25] op_sel:[0,0] op_sel_hi:[0,1]
  v_pk_mul_f32 v[158:159], v[202:203], v[24:25] op_sel:[0,0] op_sel_hi:[0,1]
  v_pk_fma_f32 v[150:151], v[196:197], v[24:25], v[152:153] op_sel:[1,1,0] op_sel_hi:[1,0,1] neg_hi:[1,0,0]
  v_pk_fma_f32 v[148:149], v[198:199], v[24:25], v[154:155] op_sel:[1,1,0] op_sel_hi:[1,0,1] neg_hi:[1,0,0]
  v_pk_fma_f32 v[146:147], v[200:201], v[24:25], v[156:157] op_sel:[1,1,0] op_sel_hi:[1,0,1] neg_hi:[1,0,0]
  v_pk_fma_f32 v[144:145], v[202:203], v[24:25], v[158:159] op_sel:[1,1,0] op_sel_hi:[1,0,1] neg_hi:[1,0,0]
  v_pk_fma_f32 v[152:153], v[196:197], v[24:25], v[152:153] op_sel:[1,1,0] op_sel_hi:[1,0,1] neg_lo:[1,0,0]
  v_pk_fma_f32 v[154:155], v[198:199], v[24:25], v[154:155] op_sel:[1,1,0] op_sel_hi:[1,0,1] neg_lo:[1,0,0]
  v_pk_fma_f32 v[156:157], v[200:201], v[24:25], v[156:157] op_sel:[1,1,0] op_sel_hi:[1,0,1] neg_lo:[1,0,0]
  v_pk_fma_f32 v[158:159], v[202:203], v[24:25], v[158:159] op_sel:[1,1,0] op_sel_hi:[1,0,1] neg_lo:[1,0,0]
  v_cvt_pk_bf16_f32 v216, v144, -v145
  v_cvt_pk_bf16_f32 v217, v146, -v147
  v_cvt_pk_bf16_f32 v218, v148, -v149
  v_cvt_pk_bf16_f32 v219, v150, -v151
  ds_write_b128 v20, v[216:219] offset:1024
  v_cvt_pk_bf16_f32 v220, v152, -v153
  v_cvt_pk_bf16_f32 v221, v154, -v155
  v_cvt_pk_bf16_f32 v222, v156, -v157
  v_cvt_pk_bf16_f32 v223, v158, -v159
  ds_write_b128 v20, v[220:223] offset:2048
  v_pk_mul_f32 v[160:161], v[204:205], v[24:25] op_sel:[0,0] op_sel_hi:[0,1]
  v_pk_mul_f32 v[162:163], v[206:207], v[24:25] op_sel:[0,0] op_sel_hi:[0,1]
  v_pk_mul_f32 v[164:165], v[208:209], v[24:25] op_sel:[0,0] op_sel_hi:[0,1]
  v_pk_mul_f32 v[166:167], v[210:211], v[24:25] op_sel:[0,0] op_sel_hi:[0,1]
  v_pk_fma_f32 v[142:143], v[204:205], v[24:25], v[160:161] op_sel:[1,1,0] op_sel_hi:[1,0,1] neg_hi:[1,0,0]
  v_pk_fma_f32 v[140:141], v[206:207], v[24:25], v[162:163] op_sel:[1,1,0] op_sel_hi:[1,0,1] neg_hi:[1,0,0]
  v_pk_fma_f32 v[138:139], v[208:209], v[24:25], v[164:165] op_sel:[1,1,0] op_sel_hi:[1,0,1] neg_hi:[1,0,0]
  v_pk_fma_f32 v[136:137], v[210:211], v[24:25], v[166:167] op_sel:[1,1,0] op_sel_hi:[1,0,1] neg_hi:[1,0,0]
  v_pk_fma_f32 v[160:161], v[204:205], v[24:25], v[160:161] op_sel:[1,1,0] op_sel_hi:[1,0,1] neg_lo:[1,0,0]
  v_pk_fma_f32 v[162:163], v[206:207], v[24:25], v[162:163] op_sel:[1,1,0] op_sel_hi:[1,0,1] neg_lo:[1,0,0]
  v_pk_fma_f32 v[164:165], v[208:209], v[24:25], v[164:165] op_sel:[1,1,0] op_sel_hi:[1,0,1] neg_lo:[1,0,0]
  v_pk_fma_f32 v[166:167], v[210:211], v[24:25], v[166:167] op_sel:[1,1,0] op_sel_hi:[1,0,1] neg_lo:[1,0,0]
  v_mul_f32 v166, v166, v26
  v_mul_f32 v167, v167, v26
  v_cvt_pk_bf16_f32 v212, v136, -v137
  v_cvt_pk_bf16_f32 v213, v138, -v139
  v_cvt_pk_bf16_f32 v214, v140, -v141
  v_cvt_pk_bf16_f32 v215, v142, -v143
  ds_write_b128 v20, v[212:215] offset:0
  v_cvt_pk_bf16_f32 v224, v160, -v161
  v_cvt_pk_bf16_f32 v225, v162, -v163
  v_cvt_pk_bf16_f32 v226, v164, -v165
  v_cvt_pk_bf16_f32 v227, v166, -v167
  ds_write_b128 v20, v[224:227] offset:3072
  v_add_u32 v20, 4096, v20
  s_add_u32 s31, s31, 1
  s_cmp_lt_u32 s31, 9
  s_cbranch_scc1 L_gg24
  v_add_u32 v21, 64, v18
  v_cvt_f32_u32 v21, v21
  v_mul_f32 v21, 0x3ae38e39, v21
  v_mul_f32 v23, 0x40900000, v21
  v_cos_f32 v196, v23
  v_sin_f32 v197, v23
  v_mul_f32 v23, 0x40d00000, v21
  v_cos_f32 v198, v23
  v_sin_f32 v199, v23
  v_mul_f32 v23, 0x41080000, v21
  v_cos_f32 v200, v23
  v_sin_f32 v201, v23
  v_mul_f32 v23, 0x41280000, v21
  v_cos_f32 v202, v23
  v_sin_f32 v203, v23
  v_mul_f32 v23, 0x40b00000, v21
  v_cos_f32 v204, v23
  v_sin_f32 v205, v23
  v_mul_f32 v23, 0x40f00000, v21
  v_cos_f32 v206, v23
  v_sin_f32 v207, v23
  v_mul_f32 v23, 0x41180000, v21
  v_cos_f32 v208, v23
  v_sin_f32 v209, v23
  v_mul_f32 v23, 0x41380000, v21
  v_cos_f32 v210, v23
  v_sin_f32 v211, v23
  v_add_f32 v22, 0x434b8000, v19
  s_mov_b32 s31, 6
L_gg25:
  v_mul_f32 v23, v22, v21
  v_cos_f32 v24, v23
  v_sin_f32 v25, v23
  v_add_f32 v22, 0x42000000, v22
  s_cmp_eq_u32 s31, 8
  s_cselect_b64 vcc, -1, 0
  v_cndmask_b32 v26, 1.0, v17, vcc
  v_pk_mul_f32 v[152:153], v[196:197], v[24:25] op_sel:[0,0] op_sel_hi:[0,1]
  v_pk_mul_f32 v[154:155], v[198:199], v[24:25] op_sel:[0,0] op_sel_hi:[0,1]
  v_pk_mul_f32 v[156:157], v[200:201], v[24:25] op_sel:[0,0] op_sel_hi:[0,1]
  v_pk_mul_f32 v[158:159], v[202:203], v[24:25] op_sel:[0,0] op_sel_hi:[0,1]
  v_pk_fma_f32 v[150:151], v[196:197], v[24:25], v[152:153] op_sel:[1,1,0] op_sel_hi:[1,0,1] neg_hi:[1,0,0]
  v_pk_fma_f32 v[148:149], v[198:199], v[24:25], v[154:155] op_sel:[1,1,0] op_sel_hi:[1,0,1] neg_hi:[1,0,0]
  v_pk_fma_f32 v[146:147], v[200:201], v[24:25], v[156:157] op_sel:[1,1,0] op_sel_hi:[1,0,1] neg_hi:[1,0,0]
  v_pk_fma_f32 v[144:145], v[202:203], v[24:25], v[158:159] op_sel:[1,1,0] op_sel_hi:[1,0,1] neg_hi:[1,0,0]
  v_pk_fma_f32 v[152:153], v[196:197], v[24:25], v[152:153] op_sel:[1,1,0] op_sel_hi:[1,0,1] neg_lo:[1,0,0]
  v_pk_fma_f32 v[154:155], v[198:199], v[24:25], v[154:155] op_sel:[1,1,0] op_sel_hi:[1,0,1] neg_lo:[1,0,0]
  v_pk_fma_f32 v[156:157], v[200:201], v[24:25], v[156:157] op_sel:[1,1,0] op_sel_hi:[1,0,1] neg_lo:[1,0,0]
  v_pk_fma_f32 v[158:159], v[202:203], v[24:25], v[158:159] op_sel:[1,1,0] op_sel_hi:[1,0,1] neg_lo:[1,0,0]
  v_cvt_pk_bf16_f32 v216, v144, -v145
  v_cvt_pk_bf16_f32 v217, v146, -v147
  v_cvt_pk_bf16_f32 v218, v148, -v149
  v_cvt_pk_bf16_f32 v219, v150, -v151
  ds_write_b128 v20, v[216:219] offset:1024
  v_cvt_pk_bf16_f32 v220, v152, -v153
  v_cvt_pk_bf16_f32 v221, v154, -v155
  v_cvt_pk_bf16_f32 v222, v156, -v157
  v_cvt_pk_bf16_f32 v223, v158, -v159
  ds_write_b128 v20, v[220:223] offset:2048
  v_pk_mul_f32 v[160:161], v[204:205], v[24:25] op_sel:[0,0] op_sel_hi:[0,1]
  v_pk_mul_f32 v[162:163], v[206:207], v[24:25] op_sel:[0,0] op_sel_hi:[0,1]
  v_pk_mul_f32 v[164:165], v[208:209], v[24:25] op_sel:[0,0] op_sel_hi:[0,1]
  v_pk_mul_f32 v[166:167], v[210:211], v[24:25] op_sel:[0,0] op_sel_hi:[0,1]
  v_pk_fma_f32 v[142:143], v[204:205], v[24:25], v[160:161] op_sel:[1,1,0] op_sel_hi:[1,0,1] neg_hi:[1,0,0]
  v_pk_fma_f32 v[140:141], v[206:207], v[24:25], v[162:163] op_sel:[1,1,0] op_sel_hi:[1,0,1] neg_hi:[1,0,0]
  v_pk_fma_f32 v[138:139], v[208:209], v[24:25], v[164:165] op_sel:[1,1,0] op_sel_hi:[1,0,1] neg_hi:[1,0,0]
  v_pk_fma_f32 v[136:137], v[210:211], v[24:25], v[166:167] op_sel:[1,1,0] op_sel_hi:[1,0,1] neg_hi:[1,0,0]
  v_pk_fma_f32 v[160:161], v[204:205], v[24:25], v[160:161] op_sel:[1,1,0] op_sel_hi:[1,0,1] neg_lo:[1,0,0]
  v_pk_fma_f32 v[162:163], v[206:207], v[24:25], v[162:163] op_sel:[1,1,0] op_sel_hi:[1,0,1] neg_lo:[1,0,0]
  v_pk_fma_f32 v[164:165], v[208:209], v[24:25], v[164:165] op_sel:[1,1,0] op_sel_hi:[1,0,1] neg_lo:[1,0,0]
  v_pk_fma_f32 v[166:167], v[210:211], v[24:25], v[166:167] op_sel:[1,1,0] op_sel_hi:[1,0,1] neg_lo:[1,0,0]
  v_mul_f32 v166, v166, v26
  v_mul_f32 v167, v167, v26
  v_cvt_pk_bf16_f32 v212, v136, -v137
  v_cvt_pk_bf16_f32 v213, v138, -v139
  v_cvt_pk_bf16_f32 v214, v140, -v141
  v_cvt_pk_bf16_f32 v215, v142, -v143
  ds_write_b128 v20, v[212:215] offset:0
  v_cvt_pk_bf16_f32 v224, v160, -v161
  v_cvt_pk_bf16_f32 v225, v162, -v163
  v_cvt_pk_bf16_f32 v226, v164, -v165
  v_cvt_pk_bf16_f32 v227, v166, -v167
  ds_write_b128 v20, v[224:227] offset:3072
  v_add_u32 v20, 4096, v20
  s_add_u32 s31, s31, 1
  s_cmp_lt_u32 s31, 9
  s_cbranch_scc1 L_gg25
  v_add_f32 v22, 0x41380000, v19
  s_mov_b32 s31, 0
L_gg26:
  v_mul_f32 v23, v22, v21
  v_cos_f32 v24, v23
  v_sin_f32 v25, v23
  v_add_f32 v22, 0x42000000, v22
  s_cmp_eq_u32 s31, 8
  s_cselect_b64 vcc, -1, 0
  v_cndmask_b32 v26, 1.0, v17, vcc
  v_pk_mul_f32 v[152:153], v[196:197], v[24:25] op_sel:[0,0] op_sel_hi:[0,1]
  v_pk_mul_f32 v[154:155], v[198:199], v[24:25] op_sel:[0,0] op_sel_hi:[0,1]
  v_pk_mul_f32 v[156:157], v[200:201], v[24:25] op_sel:[0,0] op_sel_hi:[0,1]
  v_pk_mul_f32 v[158:159], v[202:203], v[24:25] op_sel:[0,0] op_sel_hi:[0,1]
  v_pk_fma_f32 v[150:151], v[196:197], v[24:25], v[152:153] op_sel:[1,1,0] op_sel_hi:[1,0,1] neg_hi:[1,0,0]
  v_pk_fma_f32 v[148:149], v[198:199], v[24:25], v[154:155] op_sel:[1,1,0] op_sel_hi:[1,0,1] neg_hi:[1,0,0]
  v_pk_fma_f32 v[146:147], v[200:201], v[24:25], v[156:157] op_sel:[1,1,0] op_sel_hi:[1,0,1] neg_hi:[1,0,0]
  v_pk_fma_f32 v[144:145], v[202:203], v[24:25], v[158:159] op_sel:[1,1,0] op_sel_hi:[1,0,1] neg_hi:[1,0,0]
  v_pk_fma_f32 v[152:153], v[196:197], v[24:25], v[152:153] op_sel:[1,1,0] op_sel_hi:[1,0,1] neg_lo:[1,0,0]
  v_pk_fma_f32 v[154:155], v[198:199], v[24:25], v[154:155] op_sel:[1,1,0] op_sel_hi:[1,0,1] neg_lo:[1,0,0]
  v_pk_fma_f32 v[156:157], v[200:201], v[24:25], v[156:157] op_sel:[1,1,0] op_sel_hi:[1,0,1] neg_lo:[1,0,0]
  v_pk_fma_f32 v[158:159], v[202:203], v[24:25], v[158:159] op_sel:[1,1,0] op_sel_hi:[1,0,1] neg_lo:[1,0,0]
  v_cvt_pk_bf16_f32 v216, v144, -v145
  v_cvt_pk_bf16_f32 v217, v146, -v147
  v_cvt_pk_bf16_f32 v218, v148, -v149
  v_cvt_pk_bf16_f32 v219, v150, -v151
  ds_write_b128 v20, v[216:219] offset:1024
  v_cvt_pk_bf16_f32 v220, v152, -v153
  v_cvt_pk_bf16_f32 v221, v154, -v155
  v_cvt_pk_bf16_f32 v222, v156, -v157
  v_cvt_pk_bf16_f32 v223, v158, -v159
  ds_write_b128 v20, v[220:223] offset:2048
  v_pk_mul_f32 v[160:161], v[204:205], v[24:25] op_sel:[0,0] op_sel_hi:[0,1]
  v_pk_mul_f32 v[162:163], v[206:207], v[24:25] op_sel:[0,0] op_sel_hi:[0,1]
  v_pk_mul_f32 v[164:165], v[208:209], v[24:25] op_sel:[0,0] op_sel_hi:[0,1]
  v_pk_mul_f32 v[166:167], v[210:211], v[24:25] op_sel:[0,0] op_sel_hi:[0,1]
  v_pk_fma_f32 v[142:143], v[204:205], v[24:25], v[160:161] op_sel:[1,1,0] op_sel_hi:[1,0,1] neg_hi:[1,0,0]
  v_pk_fma_f32 v[140:141], v[206:207], v[24:25], v[162:163] op_sel:[1,1,0] op_sel_hi:[1,0,1] neg_hi:[1,0,0]
  v_pk_fma_f32 v[138:139], v[208:209], v[24:25], v[164:165] op_sel:[1,1,0] op_sel_hi:[1,0,1] neg_hi:[1,0,0]
  v_pk_fma_f32 v[136:137], v[210:211], v[24:25], v[166:167] op_sel:[1,1,0] op_sel_hi:[1,0,1] neg_hi:[1,0,0]
  v_pk_fma_f32 v[160:161], v[204:205], v[24:25], v[160:161] op_sel:[1,1,0] op_sel_hi:[1,0,1] neg_lo:[1,0,0]
  v_pk_fma_f32 v[162:163], v[206:207], v[24:25], v[162:163] op_sel:[1,1,0] op_sel_hi:[1,0,1] neg_lo:[1,0,0]
  v_pk_fma_f32 v[164:165], v[208:209], v[24:25], v[164:165] op_sel:[1,1,0] op_sel_hi:[1,0,1] neg_lo:[1,0,0]
  v_pk_fma_f32 v[166:167], v[210:211], v[24:25], v[166:167] op_sel:[1,1,0] op_sel_hi:[1,0,1] neg_lo:[1,0,0]
  v_mul_f32 v166, v166, v26
  v_mul_f32 v167, v167, v26
  v_cvt_pk_bf16_f32 v212, v136, -v137
  v_cvt_pk_bf16_f32 v213, v138, -v139
  v_cvt_pk_bf16_f32 v214, v140, -v141
  v_cvt_pk_bf16_f32 v215, v142, -v143
  ds_write_b128 v20, v[212:215] offset:0
  v_cvt_pk_bf16_f32 v224, v160, -v161
  v_cvt_pk_bf16_f32 v225, v162, -v163
  v_cvt_pk_bf16_f32 v226, v164, -v165
  v_cvt_pk_bf16_f32 v227, v166, -v167
  ds_write_b128 v20, v[224:227] offset:3072
  v_add_u32 v20, 4096, v20
  s_add_u32 s31, s31, 1
  s_cmp_lt_u32 s31, 3
  s_cbranch_scc1 L_gg26
  s_waitcnt lgkmcnt(0)
  v_mov_b32 v10, 161288
  v_mov_b32 v11, 1
  ds_add_u32 v10, v11
  s_branch L_ffn
L_ffn:
  s_cmp_lg_u32 s16, 3
  s_cbranch_scc1 L_pad_end
  s_mov_b64 exec, 0
  s_branch L_pad0
L_pad_end:
  s_mov_b64 exec, -1
  s_load_dwordx2 s[32:33], s[0:1], 56
  s_load_dwordx4 s[4:7], s[0:1], 32
  s_load_dwordx2 s[48:49], s[0:1], 48
  v_lshlrev_b32 v1, 4, v9
  s_and_b32 s23, s35, 7
  s_lshr_b32 s24, s35, 3
  s_and_b32 s19, s24, 1
  s_and_b32 s17, s23, 3
  s_lshl_b32 s17, s17, 1
  s_lshr_b32 s25, s24, 1
  s_and_b32 s25, s25, 1
  s_add_u32 s17, s17, s25
  s_lshr_b32 s18, s23, 2
  s_lshl_b32 s18, s18, 3
  s_lshr_b32 s25, s24, 2
  s_add_u32 s18, s18, s25
  s_lshr_b32 s54, s16, 1
  s_and_b32 s55, s16, 1
  v_lshrrev_b32 v30, 3, v9
  v_and_b32 v31, 7, v9
  v_bfe_u32 v24, v9, 4, 1
  v_lshlrev_b32 v25, 2, v24
  v_xor_b32 v31, v25, v31
  s_mul_i32 s23, s16, 24
  v_add_u32 v26, s23, v30
  v_mul_u32_u24 v26, 9216, v26
  v_lshl_add_u32 v240, v31, 4, v26
  v_add_u32 v241, 72704, v240
  v_add_u32 v242, 145408, v240
  s_mul_i32 s22, s16, 3072
  s_mul_i32 s20, s17, 1152
  s_lshl_b32 s23, s19, 6
  s_add_u32 s21, s20, s23
  s_add_u32 s21, s21, 512
  s_mul_i32 s23, s19, 640
  s_add_u32 s20, s20, s23
  s_waitcnt lgkmcnt(0)
  s_mov_b32 s40, s4
  s_mov_b32 s41, s5
  s_mov_b32 s42, 5308416
  s_mov_b32 s43, 0x20000
  s_mov_b32 s44, s6
  s_mov_b32 s45, s7
  s_mov_b32 s46, 5308416
  s_mov_b32 s47, 0x20000
  s_mov_b32 s50, 5308416
  s_mov_b32 s51, 0x20000
  s_mov_b32 s34, 2359296
  s_mov_b32 s35, 0x20000
  s_cmp_lg_u32 s16, 3
  s_cbranch_scc1 L_nopre
  s_cmp_lt_u32 s2, 64
  s_cbranch_scc1 L_pre
  v_mov_b32 v26, 161284
  s_branch L_ls32b
L_ls32:
  s_sleep 1
L_ls32b:
  ds_read_b32 v27, v26
  s_waitcnt lgkmcnt(0)
  v_readfirstlane_b32 s59, v27
  s_nop 1
  s_cmp_ge_u32 s59, 192
  s_cbranch_scc0 L_ls32
  s_and_b32 s23, s2, 7
  s_mul_i32 s23, s23, 24
  s_lshr_b32 s24, s2, 3
  s_add_u32 s23, s23, s24
  s_sub_u32 s23, s23, 8
  s_mul_i32 s24, s23, 5462
  s_lshr_b32 s24, s24, 16
  s_lshl_b32 s24, s24, 2
  s_add_u32 s23, s23, s24
  s_lshl_b32 s23, s23, 6
  s_add_u32 s23, s23, 48234496
  s_mov_b32 s3, s23
  s_mov_b64 exec, 1
  buffer_store_dwordx2 v[252:253], off, s[12:15], s3 sc1
  s_mov_b64 exec, -1
L_pre:
  s_mov_b32 s23, 48373760
  buffer_load_dwordx2 v[248:249], v250, s[12:15], s23 offen sc1
  s_mov_b32 s25, 81920
  s_mov_b32 s24, s20
  s_mov_b32 s26, 0
  v_subrev_u32 v48, 663552, v240
  v_subrev_u32 v49, 663552, v241
  v_subrev_u32 v50, 663552, v242
L_prel:
  s_mov_b32 m0, s25
  s_add_u32 s27, s25, 12288
  buffer_load_dwordx4 v48, s[40:43], s24 offen offset:0 lds
  buffer_load_dwordx4 v49, s[40:43], s24 offen offset:1024 lds
  buffer_load_dwordx4 v50, s[40:43], s24 offen offset:2048 lds
  s_mov_b32 m0, s27
  s_add_u32 s26, s26, 1
  buffer_load_dwordx4 v48, s[44:47], s24 offen offset:0 lds
  buffer_load_dwordx4 v49, s[44:47], s24 offen offset:1024 lds
  buffer_load_dwordx4 v50, s[44:47], s24 offen offset:2048 lds
  s_add_u32 s24, s24, 221184
  s_add_u32 s25, s25, 3072
  s_and_b32 s27, s26, 3
  s_cmp_eq_u32 s27, 0
  s_cselect_b32 s27, 12288, 0
  s_add_u32 s25, s25, s27
  s_cmp_lt_u32 s26, 12
  s_cbranch_scc1 L_prel
L_nopre:
  s_cmp_ge_u32 s2, 64
  s_cbranch_scc1 L_nowd
  s_barrier
  s_lshl_b32 s24, s2, 2
  s_add_u32 s24, s24, s16
  s_mul_i32 s24, s24, 20736
  v_lshl_add_u32 v48, v9, 7, s24
  s_bfm_b64 exec, 54, 0
  buffer_load_dword v254, v48, s[48:51], 0 offen
  v_add_u32 v48, 6912, v48
  buffer_load_dword v254, v48, s[48:51], 0 offen
  v_add_u32 v48, 6912, v48
  buffer_load_dword v254, v48, s[48:51], 0 offen
  v_add_u32 v48, 6912, v48
  s_mov_b64 exec, -1
L_nowd:
  s_mul_i32 s30, s18, 147456
  s_add_u32 s30, s30, s22
  s_add_u32 s30, s30, 4718592
  s_lshl_b32 s31, s18, 1
  s_add_u32 s31, s31, s54
  s_mul_i32 s27, s31, 2304
  s_add_u32 s27, s27, 9502720
  v_lshlrev_b32 v8, 2, v9
  s_lshl_b32 s28, s16, 10
  s_mul_i32 s23, s17, 663552
  s_mul_i32 s24, s19, 368640
  s_add_u32 s4, s23, s24
  s_sub_u32 s5, s23, s24
  s_add_u32 s5, s5, 368640
  s_mul_i32 s24, s19, 36864
  s_add_u32 s6, s23, s24
  s_add_u32 s6, s6, 294912
  s_sub_u32 s7, s23, s24
  s_add_u32 s7, s7, 331776
  s_lshl_b32 s9, s19, 6
  s_add_u32 s9, s9, 512
  s_sub_u32 s23, s7, 36864
  s_cmp_eq_u32 s54, 0
  s_cselect_b32 s8, s6, s23
  s_add_u32 s8, s8, s9
  s_lshr_b32 s3, s17, 1
  s_mul_i32 s23, s19, 640
  s_add_u32 s24, s3, 1
  s_and_b32 s24, s24, 3
  s_lshl_b32 s24, s24, 7
  s_add_u32 s36, s24, s23
  s_add_u32 s24, s3, 2
  s_and_b32 s24, s24, 3
  s_lshl_b32 s24, s24, 7
  s_add_u32 s37, s24, s23
  s_add_u32 s24, s3, 3
  s_and_b32 s24, s24, 3
  s_lshl_b32 s24, s24, 7
  s_add_u32 s38, s24, s23
  s_add_u32 s24, s3, 4
  s_and_b32 s24, s24, 3
  s_lshl_b32 s24, s24, 7
  s_add_u32 s39, s24, s23
  s_mov_b32 s29, s39
  s_sub_u32 s39, s39, s38
  s_sub_u32 s38, s38, s37
  s_sub_u32 s37, s37, s36
  s_add_u32 s3, s4, s9
  s_lshl_b32 s23, s16, 3
  v_add_u32 v26, s23, v30
  v_mul_u32_u24 v26, 1152, v26
  v_lshl_add_u32 v5, v31, 4, v26
  v_lshrrev_b32 v25, 2, v9
  v_and_b32 v27, 3, v9
  s_lshl_b32 s23, s16, 4
  v_add_u32 v26, s23, v25
  v_mul_u32_u24 v26, 1152, v26
  v_lshl_add_u32 v6, v27, 4, v26
  s_mul_i32 s23, s16, 48
  v_add_u32 v26, s23, v25
  v_mul_u32_u24 v26, 9216, v26
  v_lshl_add_u32 v7, v27, 4, v26
  v_and_b32 v29, 15, v9
  v_lshrrev_b32 v25, 4, v9
  v_lshlrev_b32 v2, 10, v25
  v_lshl_add_u32 v2, v29, 4, v2
  s_lshl_b32 s23, s55, 9
  v_add_u32 v2, s23, v2
  v_lshl_add_u32 v243, v25, 10, v2
  s_mul_i32 s23, s54, 12288
  v_add_u32 v2, s23, v2
  v_xor_b32 v3, 512, v2
  s_lshl_b32 s23, s54, 10
  v_add_u32 v243, s23, v243
  s_lshl_b32 s24, s55, 13
  v_add_u32 v4, s24, v243
  s_lshl_b32 s24, s18, 3
  s_add_u32 s24, s24, s17
  s_lshl_b32 s24, s24, 1
  s_add_u32 s25, s24, s19
  s_xor_b32 s24, s25, 1
  s_mul_i32 s10, s25, 73728
  s_add_u32 s10, s10, 67108864
  s_mul_i32 s11, s24, 73728
  s_add_u32 s11, s11, 67108864
  s_lshl_b32 s52, s25, 10
  s_lshl_b32 s23, s16, 6
  s_add_u32 s52, s52, s23
  s_add_u32 s52, s52, 49283072
  s_lshl_b32 s53, s24, 10
  s_lshl_b32 s23, s54, 7
  s_add_u32 s53, s53, s23
  s_add_u32 s53, s53, 49283072
  v_bfe_u32 v24, v9, 2, 2
  v_lshl_add_u32 v25, v25, 3, v24
  v_lshlrev_b32 v27, 4, v27
  v_lshl_add_u32 v23, v25, 6, v27
  v_lshl_add_u32 v22, v25, 7, v27
  v_bfe_u32 v24, v9, 3, 1
  v_xor_b32 v24, s55, v24
  v_lshl_add_u32 v22, v24, 6, v22
  s_lshl_b32 s26, s18, 12
  s_add_u32 s26, s26, 48308224
  s_mov_b32 s96, 0x3ffff
  s_mov_b32 s97, 0x3ffff
  s_mov_b64 s[98:99], 3
  s_cmp_lg_u32 s16, 3
  s_cbranch_scc1 L_w3
  s_waitcnt vmcnt(0)
L_w3:
  s_cmp_lg_u32 s16, 3
  s_cbranch_scc1 L_c3skip
  s_cmp_ge_u32 s2, 64
  s_cbranch_scc1 L_c3skip
  s_mov_b32 s23, 48373760
  v_cmp_eq_u64 vcc, s[56:57], v[248:249]
  s_nop 1
  s_cmp_eq_u64 vcc, -1
  s_cbranch_scc0 L_lp34s
L_ok33:
  s_lshl_b32 s23, s18, 10
  s_add_u32 s23, s23, 48234496
  s_bfm_b64 s[100:101], 12, 0
  s_mov_b64 exec, s[100:101]
  buffer_load_dwordx2 v[248:249], v250, s[12:15], s23 offen sc1
  s_mov_b64 exec, -1
  s_waitcnt vmcnt(0)
  v_cmp_eq_u64 vcc, s[56:57], v[248:249]
  s_nop 1
  s_orn2_b64 vcc, vcc, s[100:101]
  s_cmp_eq_u64 vcc, -1
  s_cbranch_scc0 L_lp36s
L_ok35:
L_c3skip:
  s_barrier
  s_add_u32 m0, s22, 0
  s_add_u32 s24, s30, 0
  buffer_load_dwordx4 v1, s[12:15], s24 offen offset:0 sc1 lds
  buffer_load_dwordx4 v1, s[12:15], s24 offen offset:1024 sc1 lds
  buffer_load_dwordx4 v1, s[12:15], s24 offen offset:2048 sc1 lds
  s_add_u32 m0, s22, 12288
  s_add_u32 s24, s30, 73728
  buffer_load_dwordx4 v1, s[12:15], s24 offen offset:0 sc1 lds
  buffer_load_dwordx4 v1, s[12:15], s24 offen offset:1024 sc1 lds
  buffer_load_dwordx4 v1, s[12:15], s24 offen offset:2048 sc1 lds
  s_add_u32 m0, s22, 24576
  s_add_u32 s24, s30, 12288
  buffer_load_dwordx4 v1, s[12:15], s24 offen offset:0 sc1 lds
  buffer_load_dwordx4 v1, s[12:15], s24 offen offset:1024 sc1 lds
  buffer_load_dwordx4 v1, s[12:15], s24 offen offset:2048 sc1 lds
  s_add_u32 m0, s22, 36864
  s_add_u32 s24, s30, 86016
  buffer_load_dwordx4 v1, s[12:15], s24 offen offset:0 sc1 lds
  buffer_load_dwordx4 v1, s[12:15], s24 offen offset:1024 sc1 lds
  buffer_load_dwordx4 v1, s[12:15], s24 offen offset:2048 sc1 lds
  s_waitcnt vmcnt(12)
  buffer_store_dwordx2 v[252:253], v255, s[12:15], s58 offen sc1
  s_add_u32 s58, s5, s9
  v_add_u32 v247, s22, v1
  s_waitcnt vmcnt(7)
  ds_read_b128 v[112:115], v247 offset:0
  ds_read_b128 v[116:119], v247 offset:1024
  ds_read_b128 v[120:123], v247 offset:2048
  ds_read_b128 v[124:127], v247 offset:12288
  ds_read_b128 v[128:131], v247 offset:13312
  ds_read_b128 v[132:135], v247 offset:14336
  s_waitcnt lgkmcnt(0)
  v_max3_u32 v136, v112, v113, v114
  v_max3_u32 v137, v115, v116, v117
  v_max3_u32 v136, v136, v118, v119
  v_max3_u32 v137, v137, v120, v121
  v_max3_u32 v136, v136, v122, v123
  v_max3_u32 v137, v137, v124, v125
  v_max3_u32 v136, v136, v126, v127
  v_max3_u32 v137, v137, v128, v129
  v_max3_u32 v136, v136, v130, v131
  v_max3_u32 v137, v137, v132, v133
  v_max3_u32 v136, v136, v134, v135
  v_max_u32 v136, v136, v137
  v_cmp_eq_u32 vcc, -1, v136
  s_nop 1
  s_cmp_eq_u64 vcc, 0
  s_cbranch_scc1 L_ok37
L_lp38s:
  s_mov_b32 s59, 50000
L_lp38:
  s_add_u32 m0, s22, 0
  s_add_u32 s24, s30, 0
  buffer_load_dwordx4 v1, s[12:15], s24 offen offset:0 sc1 lds
  buffer_load_dwordx4 v1, s[12:15], s24 offen offset:1024 sc1 lds
  buffer_load_dwordx4 v1, s[12:15], s24 offen offset:2048 sc1 lds
  s_add_u32 m0, s22, 12288
  s_add_u32 s24, s30, 73728
  buffer_load_dwordx4 v1, s[12:15], s24 offen offset:0 sc1 lds
  buffer_load_dwordx4 v1, s[12:15], s24 offen offset:1024 sc1 lds
  buffer_load_dwordx4 v1, s[12:15], s24 offen offset:2048 sc1 lds
  s_add_u32 m0, s22, 24576
  s_add_u32 s24, s30, 12288
  buffer_load_dwordx4 v1, s[12:15], s24 offen offset:0 sc1 lds
  buffer_load_dwordx4 v1, s[12:15], s24 offen offset:1024 sc1 lds
  buffer_load_dwordx4 v1, s[12:15], s24 offen offset:2048 sc1 lds
  s_add_u32 m0, s22, 36864
  s_add_u32 s24, s30, 86016
  buffer_load_dwordx4 v1, s[12:15], s24 offen offset:0 sc1 lds
  buffer_load_dwordx4 v1, s[12:15], s24 offen offset:1024 sc1 lds
  buffer_load_dwordx4 v1, s[12:15], s24 offen offset:2048 sc1 lds
  s_waitcnt vmcnt(0)
  ds_read_b128 v[112:115], v247 offset:0
  ds_read_b128 v[116:119], v247 offset:1024
  ds_read_b128 v[120:123], v247 offset:2048
  ds_read_b128 v[124:127], v247 offset:12288
  ds_read_b128 v[128:131], v247 offset:13312
  ds_read_b128 v[132:135], v247 offset:14336
  s_waitcnt lgkmcnt(0)
  s_sub_u32 s59, s59, 1
  s_cbranch_scc1 L_ok37
  v_max3_u32 v136, v112, v113, v114
  v_max3_u32 v137, v115, v116, v117
  v_max3_u32 v136, v136, v118, v119
  v_max3_u32 v137, v137, v120, v121
  v_max3_u32 v136, v136, v122, v123
  v_max3_u32 v137, v137, v124, v125
  v_max3_u32 v136, v136, v126, v127
  v_max3_u32 v137, v137, v128, v129
  v_max3_u32 v136, v136, v130, v131
  v_max3_u32 v137, v137, v132, v133
  v_max3_u32 v136, v136, v134, v135
  v_max_u32 v136, v136, v137
  v_cmp_eq_u32 vcc, -1, v136
  s_nop 1
  s_cmp_eq_u64 vcc, 0
  s_cbranch_scc0 L_lp38
L_ok37:
  s_barrier
  v_add_u32 v22, 81920, v22
  ds_read_b64_tr_b16 v[176:177], v22 offset:0
  ds_read_b64_tr_b16 v[178:179], v22 offset:512
  ds_read_b64_tr_b16 v[180:181], v22 offset:4096
  ds_read_b64_tr_b16 v[182:183], v22 offset:4608
  ds_read_b64_tr_b16 v[184:185], v22 offset:8192
  ds_read_b64_tr_b16 v[186:187], v22 offset:8704
  ds_read_b128 a[0:3], v2 offset:0
  ds_read_b128 a[16:19], v2 offset:4096
  ds_read_b128 a[32:35], v2 offset:8192
  ds_read_b128 a[4:7], v2 offset:256
  ds_read_b128 a[20:23], v2 offset:4352
  s_waitcnt lgkmcnt(4)
  v_mfma_f32_16x16x32_bf16 v[48:51], v[176:179], a[0:3], 0
  ds_read_b128 a[36:39], v2 offset:8448
  s_add_u32 m0, s22, 49152
  s_waitcnt lgkmcnt(4)
  v_mfma_f32_16x16x32_bf16 v[48:51], v[180:183], a[16:19], v[48:51]
  ds_read_b128 a[8:11], v3 offset:0
  s_waitcnt lgkmcnt(4)
  v_mfma_f32_16x16x32_bf16 v[48:51], v[184:187], a[32:35], v[48:51]
  ds_read_b128 a[24:27], v3 offset:4096
  s_add_u32 s24, s30, 24576
  s_waitcnt lgkmcnt(4)
  v_mfma_f32_16x16x32_bf16 v[64:67], v[176:179], a[4:7], 0
  ds_read_b128 a[40:43], v3 offset:8192
  s_waitcnt lgkmcnt(4)
  v_mfma_f32_16x16x32_bf16 v[64:67], v[180:183], a[20:23], v[64:67]
  ds_read_b128 a[12:15], v3 offset:256
  ds_read_b64_tr_b16 v[188:189], v22 offset:8
  s_waitcnt lgkmcnt(5)
  v_mfma_f32_16x16x32_bf16 v[64:67], v[184:187], a[36:39], v[64:67]
  ds_read_b128 a[28:31], v3 offset:4352
  ds_read_b64_tr_b16 v[190:191], v22 offset:520
  s_waitcnt lgkmcnt(6)
  v_mfma_f32_16x16x32_bf16 v[80:83], v[176:179], a[8:11], 0
L_pad0:
  s_cbranch_execz L_pad1
  ds_read_b128 a[44:47], v3 offset:8448
  ds_read_b64_tr_b16 v[192:193], v22 offset:4104
  s_waitcnt lgkmcnt(7)
  v_mfma_f32_16x16x32_bf16 v[80:83], v[180:183], a[24:27], v[80:83]
  ds_read_b64_tr_b16 v[194:195], v22 offset:4616
  ds_read_b64_tr_b16 v[196:197], v22 offset:8200
  s_waitcnt lgkmcnt(8)
  v_mfma_f32_16x16x32_bf16 v[80:83], v[184:187], a[40:43], v[80:83]
  ds_read_b64_tr_b16 v[198:199], v22 offset:8712
  s_waitcnt lgkmcnt(8)
  v_mfma_f32_16x16x32_bf16 v[96:99], v[176:179], a[12:15], 0
  buffer_load_dwordx4 v1, s[12:15], s24 offen offset:0 sc1 lds
  s_waitcnt lgkmcnt(6)
  v_mfma_f32_16x16x32_bf16 v[96:99], v[180:183], a[28:31], v[96:99]
  buffer_load_dwordx4 v1, s[12:15], s24 offen offset:1024 sc1 lds
  s_waitcnt lgkmcnt(4)
  v_mfma_f32_16x16x32_bf16 v[96:99], v[184:187], a[44:47], v[96:99]
  buffer_load_dwordx4 v1, s[12:15], s24 offen offset:2048 sc1 lds
  s_add_u32 m0, s22, 61440
  s_waitcnt vmcnt(4)
  v_mfma_f32_16x16x32_bf16 v[52:55], v[188:191], a[0:3], 0
  ds_read_b128 v[112:115], v247 offset:24576
  s_waitcnt lgkmcnt(3)
  v_mfma_f32_16x16x32_bf16 v[52:55], v[192:195], a[16:19], v[52:55]
  ds_read_b64_tr_b16 v[200:201], v22 offset:12288
  s_waitcnt lgkmcnt(2)
  v_mfma_f32_16x16x32_bf16 v[52:55], v[196:199], a[32:35], v[52:55]
  ds_read_b64_tr_b16 v[202:203], v22 offset:12800
  s_add_u32 s24, s30, 98304
  ds_read_b128 v[116:119], v247 offset:25600
  v_mfma_f32_16x16x32_bf16 v[68:71], v[188:191], a[4:7], 0
  ds_read_b64_tr_b16 v[204:205], v22 offset:16384
  v_mfma_f32_16x16x32_bf16 v[68:71], v[192:195], a[20:23], v[68:71]
  ds_read_b64_tr_b16 v[206:207], v22 offset:16896
  ds_read_b128 v[120:123], v247 offset:26624
  v_mfma_f32_16x16x32_bf16 v[68:71], v[196:199], a[36:39], v[68:71]
  ds_read_b64_tr_b16 v[176:177], v22 offset:20480
  v_mfma_f32_16x16x32_bf16 v[84:87], v[188:191], a[8:11], 0
  ds_read_b64_tr_b16 v[178:179], v22 offset:20992
  v_mfma_f32_16x16x32_bf16 v[84:87], v[192:195], a[24:27], v[84:87]
  buffer_load_dwordx4 v1, s[12:15], s24 offen offset:0 sc1 lds
  v_mfma_f32_16x16x32_bf16 v[84:87], v[196:199], a[40:43], v[84:87]
  buffer_load_dwordx4 v1, s[12:15], s24 offen offset:1024 sc1 lds
  v_mfma_f32_16x16x32_bf16 v[100:103], v[188:191], a[12:15], 0
  buffer_load_dwordx4 v1, s[12:15], s24 offen offset:2048 sc1 lds
  v_mfma_f32_16x16x32_bf16 v[100:103], v[192:195], a[28:31], v[100:103]
  ds_read_b128 v[124:127], v247 offset:36864
  ds_read_b128 v[128:131], v247 offset:37888
  ds_read_b128 v[132:135], v247 offset:38912
  v_mfma_f32_16x16x32_bf16 v[100:103], v[196:199], a[44:47], v[100:103]
  s_waitcnt lgkmcnt(9)
  v_mfma_f32_16x16x32_bf16 v[56:59], v[200:203], a[0:3], 0
  s_waitcnt lgkmcnt(6)
  v_mfma_f32_16x16x32_bf16 v[56:59], v[204:207], a[16:19], v[56:59]
  ds_read_b64_tr_b16 v[180:181], v22 offset:12296
  s_waitcnt lgkmcnt(4)
  v_mfma_f32_16x16x32_bf16 v[56:59], v[176:179], a[32:35], v[56:59]
  ds_read_b64_tr_b16 v[182:183], v22 offset:12808
  s_waitcnt lgkmcnt(2)
  v_max3_u32 v136, v112, v113, v114
  v_mfma_f32_16x16x32_bf16 v[72:75], v[200:203], a[4:7], 0
  ds_read_b64_tr_b16 v[184:185], v22 offset:16392
  v_max3_u32 v137, v115, v116, v117
  v_mfma_f32_16x16x32_bf16 v[72:75], v[204:207], a[20:23], v[72:75]
  ds_read_b64_tr_b16 v[186:187], v22 offset:16904
  v_max3_u32 v136, v136, v118, v119
  v_mfma_f32_16x16x32_bf16 v[72:75], v[176:179], a[36:39], v[72:75]
  ds_read_b64_tr_b16 v[188:189], v22 offset:20488
  v_max3_u32 v137, v137, v120, v121
  v_max3_u32 v136, v136, v122, v123
  v_mfma_f32_16x16x32_bf16 v[88:91], v[200:203], a[8:11], 0
  ds_read_b64_tr_b16 v[190:191], v22 offset:21000
  v_max3_u32 v137, v137, v124, v125
  v_mfma_f32_16x16x32_bf16 v[88:91], v[204:207], a[24:27], v[88:91]
  v_max3_u32 v136, v136, v126, v127
  v_max3_u32 v137, v137, v128, v129
  v_mfma_f32_16x16x32_bf16 v[88:91], v[176:179], a[40:43], v[88:91]
  v_max3_u32 v136, v136, v130, v131
  v_max3_u32 v137, v137, v132, v133
  v_mfma_f32_16x16x32_bf16 v[104:107], v[200:203], a[12:15], 0
  v_max3_u32 v136, v136, v134, v135
  v_max_u32 v136, v136, v137
  v_cmp_eq_u32 vcc, -1, v136
  v_mfma_f32_16x16x32_bf16 v[104:107], v[204:207], a[28:31], v[104:107]
  v_mfma_f32_16x16x32_bf16 v[104:107], v[176:179], a[44:47], v[104:107]
  s_cmp_eq_u64 vcc, 0
  s_cbranch_scc0 L_lp40s
L_ok39:
  s_waitcnt lgkmcnt(0)
  s_barrier
  v_add_u32 v22, 24576, v22
  ds_read_b64_tr_b16 v[192:193], v22 offset:0
  v_mfma_f32_16x16x32_bf16 v[60:63], v[180:183], a[0:3], 0
  ds_read_b64_tr_b16 v[194:195], v22 offset:512
  s_add_u32 m0, s22, 0
  v_mfma_f32_16x16x32_bf16 v[60:63], v[184:187], a[16:19], v[60:63]
  ds_read_b64_tr_b16 v[196:197], v22 offset:4096
  s_add_u32 s24, s30, 36864
  v_mfma_f32_16x16x32_bf16 v[60:63], v[188:191], a[32:35], v[60:63]
  ds_read_b64_tr_b16 v[198:199], v22 offset:4608
  v_mfma_f32_16x16x32_bf16 v[76:79], v[180:183], a[4:7], 0
  ds_read_b64_tr_b16 v[200:201], v22 offset:8192
  buffer_load_dwordx4 v1, s[12:15], s24 offen offset:0 sc1 lds
  v_mfma_f32_16x16x32_bf16 v[76:79], v[184:187], a[20:23], v[76:79]
  ds_read_b64_tr_b16 v[202:203], v22 offset:8704
  v_mfma_f32_16x16x32_bf16 v[76:79], v[188:191], a[36:39], v[76:79]
  ds_read_b128 a[48:51], v2 offset:24576
  buffer_load_dwordx4 v1, s[12:15], s24 offen offset:1024 sc1 lds
  v_mfma_f32_16x16x32_bf16 v[92:95], v[180:183], a[8:11], 0
  ds_read_b128 a[64:67], v2 offset:28672
  v_mfma_f32_16x16x32_bf16 v[92:95], v[184:187], a[24:27], v[92:95]
  ds_read_b128 a[80:83], v2 offset:32768
  buffer_load_dwordx4 v1, s[12:15], s24 offen offset:2048 sc1 lds
  v_mfma_f32_16x16x32_bf16 v[92:95], v[188:191], a[40:43], v[92:95]
  ds_read_b128 a[52:55], v2 offset:24832
  v_mfma_f32_16x16x32_bf16 v[108:111], v[180:183], a[12:15], 0
  ds_read_b128 a[68:71], v2 offset:28928
  s_add_u32 m0, s22, 12288
  v_mfma_f32_16x16x32_bf16 v[108:111], v[184:187], a[28:31], v[108:111]
  ds_read_b128 a[84:87], v2 offset:33024
  v_mfma_f32_16x16x32_bf16 v[108:111], v[188:191], a[44:47], v[108:111]
  ds_read_b128 a[56:59], v3 offset:24576
  s_add_u32 s24, s30, 110592
  s_waitcnt lgkmcnt(6)
  v_mfma_f32_16x16x32_bf16 v[48:51], v[192:195], a[48:51], v[48:51]
  ds_read_b128 a[72:75], v3 offset:28672
  s_waitcnt lgkmcnt(6)
  v_mfma_f32_16x16x32_bf16 v[48:51], v[196:199], a[64:67], v[48:51]
  ds_read_b128 a[88:91], v3 offset:32768
  buffer_load_dwordx4 v1, s[12:15], s24 offen offset:0 sc1 lds
  s_waitcnt lgkmcnt(6)
  v_mfma_f32_16x16x32_bf16 v[48:51], v[200:203], a[80:83], v[48:51]
  ds_read_b128 a[60:63], v3 offset:24832
  s_waitcnt lgkmcnt(6)
  v_mfma_f32_16x16x32_bf16 v[64:67], v[192:195], a[52:55], v[64:67]
  ds_read_b128 a[76:79], v3 offset:28928
  buffer_load_dwordx4 v1, s[12:15], s24 offen offset:1024 sc1 lds
  s_waitcnt lgkmcnt(6)
  v_mfma_f32_16x16x32_bf16 v[64:67], v[196:199], a[68:71], v[64:67]
  ds_read_b128 a[92:95], v3 offset:33024
  ds_read_b64_tr_b16 v[204:205], v22 offset:8
  s_waitcnt lgkmcnt(7)
  v_mfma_f32_16x16x32_bf16 v[64:67], v[200:203], a[84:87], v[64:67]
  ds_read_b64_tr_b16 v[206:207], v22 offset:520
  ds_read_b64_tr_b16 v[176:177], v22 offset:4104
  s_waitcnt lgkmcnt(8)
  v_mfma_f32_16x16x32_bf16 v[80:83], v[192:195], a[56:59], v[80:83]
  ds_read_b64_tr_b16 v[178:179], v22 offset:4616
  ds_read_b64_tr_b16 v[180:181], v22 offset:8200
  s_waitcnt lgkmcnt(9)
  v_mfma_f32_16x16x32_bf16 v[80:83], v[196:199], a[72:75], v[80:83]
  ds_read_b64_tr_b16 v[182:183], v22 offset:8712
  buffer_load_dwordx4 v1, s[12:15], s24 offen offset:2048 sc1 lds
  s_add_u32 m0, s22, 81920
  s_waitcnt lgkmcnt(9)
  v_mfma_f32_16x16x32_bf16 v[80:83], v[200:203], a[88:91], v[80:83]
  ds_read_b64_tr_b16 v[184:185], v22 offset:12288
  s_waitcnt lgkmcnt(9)
  v_mfma_f32_16x16x32_bf16 v[96:99], v[192:195], a[60:63], v[96:99]
  ds_read_b64_tr_b16 v[186:187], v22 offset:12800
  s_add_u32 s24, s20, 2654208
  s_waitcnt vmcnt(6)
  s_waitcnt lgkmcnt(9)
  v_mfma_f32_16x16x32_bf16 v[96:99], v[196:199], a[76:79], v[96:99]
  ds_read_b64_tr_b16 v[188:189], v22 offset:16384
  ds_read_b128 v[112:115], v247 offset:49152
  s_waitcnt lgkmcnt(10)
  v_mfma_f32_16x16x32_bf16 v[96:99], v[200:203], a[92:95], v[96:99]
  ds_read_b64_tr_b16 v[190:191], v22 offset:16896
  s_waitcnt lgkmcnt(5)
  v_mfma_f32_16x16x32_bf16 v[52:55], v[204:207], a[48:51], v[52:55]
  buffer_load_dwordx4 v240, s[40:43], s24 offen offset:0  lds
  ds_read_b128 v[116:119], v247 offset:50176
  v_mfma_f32_16x16x32_bf16 v[52:55], v[176:179], a[64:67], v[52:55]
  ds_read_b64_tr_b16 v[192:193], v22 offset:20480
  v_mfma_f32_16x16x32_bf16 v[52:55], v[180:183], a[80:83], v[52:55]
  ds_read_b64_tr_b16 v[194:195], v22 offset:20992
  ds_read_b128 v[120:123], v247 offset:51200
  v_mfma_f32_16x16x32_bf16 v[68:71], v[204:207], a[52:55], v[68:71]
  buffer_load_dwordx4 v241, s[40:43], s24 offen offset:1024  lds
  ds_read_b128 v[124:127], v247 offset:61440
  v_mfma_f32_16x16x32_bf16 v[68:71], v[176:179], a[68:71], v[68:71]
  ds_read_b64_tr_b16 v[196:197], v22 offset:12296
  v_mfma_f32_16x16x32_bf16 v[68:71], v[180:183], a[84:87], v[68:71]
  buffer_load_dwordx4 v242, s[40:43], s24 offen offset:2048  lds
  s_add_u32 m0, s22, 94208
  ds_read_b128 v[128:131], v247 offset:62464
  v_mfma_f32_16x16x32_bf16 v[84:87], v[204:207], a[56:59], v[84:87]
  ds_read_b64_tr_b16 v[198:199], v22 offset:12808
  v_mfma_f32_16x16x32_bf16 v[84:87], v[176:179], a[72:75], v[84:87]
  buffer_load_dwordx4 v240, s[44:47], s24 offen offset:0  lds
  ds_read_b128 v[132:135], v247 offset:63488
  v_mfma_f32_16x16x32_bf16 v[84:87], v[180:183], a[88:91], v[84:87]
  ds_read_b64_tr_b16 v[200:201], v22 offset:16392
  v_mfma_f32_16x16x32_bf16 v[100:103], v[204:207], a[60:63], v[100:103]
  ds_read_b64_tr_b16 v[202:203], v22 offset:16904
  v_mfma_f32_16x16x32_bf16 v[100:103], v[176:179], a[76:79], v[100:103]
  buffer_load_dwordx4 v241, s[44:47], s24 offen offset:1024  lds
  buffer_load_dwordx4 v242, s[44:47], s24 offen offset:2048  lds
  v_mfma_f32_16x16x32_bf16 v[100:103], v[180:183], a[92:95], v[100:103]
  ds_read_b64_tr_b16 v[204:205], v22 offset:20488
  s_waitcnt lgkmcnt(9)
  v_mfma_f32_16x16x32_bf16 v[56:59], v[184:187], a[48:51], v[56:59]
  s_waitcnt lgkmcnt(3)
  v_max3_u32 v136, v112, v113, v114
  v_max3_u32 v137, v115, v116, v117
  v_mfma_f32_16x16x32_bf16 v[56:59], v[188:191], a[64:67], v[56:59]
  ds_read_b64_tr_b16 v[206:207], v22 offset:21000
  v_max3_u32 v136, v136, v118, v119
  v_mfma_f32_16x16x32_bf16 v[56:59], v[192:195], a[80:83], v[56:59]
  v_max3_u32 v137, v137, v120, v121
  v_max3_u32 v136, v136, v122, v123
  v_mfma_f32_16x16x32_bf16 v[72:75], v[184:187], a[52:55], v[72:75]
  v_max3_u32 v137, v137, v124, v125
  v_max3_u32 v136, v136, v126, v127
  v_mfma_f32_16x16x32_bf16 v[72:75], v[188:191], a[68:71], v[72:75]
  v_max3_u32 v137, v137, v128, v129
  v_max3_u32 v136, v136, v130, v131
  v_mfma_f32_16x16x32_bf16 v[72:75], v[192:195], a[84:87], v[72:75]
  v_max3_u32 v137, v137, v132, v133
  v_max3_u32 v136, v136, v134, v135
  v_mfma_f32_16x16x32_bf16 v[88:91], v[184:187], a[56:59], v[88:91]
  v_max_u32 v136, v136, v137
  v_cmp_eq_u32 vcc, -1, v136
  v_mfma_f32_16x16x32_bf16 v[88:91], v[188:191], a[72:75], v[88:91]
  v_mfma_f32_16x16x32_bf16 v[88:91], v[192:195], a[88:91], v[88:91]
  v_mfma_f32_16x16x32_bf16 v[104:107], v[184:187], a[60:63], v[104:107]
  s_cmp_eq_u64 vcc, 0
  s_cbranch_scc0 L_lp42s
L_ok41:
  s_waitcnt lgkmcnt(0)
  s_barrier
  v_add_u32 v22, 24576, v22
  ds_read_b64_tr_b16 v[176:177], v22 offset:0
  v_mfma_f32_16x16x32_bf16 v[104:107], v[188:191], a[76:79], v[104:107]
  ds_read_b64_tr_b16 v[178:179], v22 offset:512
  s_add_u32 m0, s22, 24576
  v_mfma_f32_16x16x32_bf16 v[104:107], v[192:195], a[92:95], v[104:107]
  ds_read_b128 a[96:99], v2 offset:49152
  v_mfma_f32_16x16x32_bf16 v[60:63], v[196:199], a[48:51], v[60:63]
  ds_read_b64_tr_b16 v[180:181], v22 offset:4096
  s_add_u32 s24, s30, 49152
  v_mfma_f32_16x16x32_bf16 v[60:63], v[200:203], a[64:67], v[60:63]
  ds_read_b64_tr_b16 v[182:183], v22 offset:4608
  v_mfma_f32_16x16x32_bf16 v[60:63], v[204:207], a[80:83], v[60:63]
  ds_read_b64_tr_b16 v[184:185], v22 offset:8192
  buffer_load_dwordx4 v1, s[12:15], s24 offen offset:0 sc1 lds
  v_mfma_f32_16x16x32_bf16 v[76:79], v[196:199], a[52:55], v[76:79]
  ds_read_b64_tr_b16 v[186:187], v22 offset:8704
  v_mfma_f32_16x16x32_bf16 v[76:79], v[200:203], a[68:71], v[76:79]
  ds_read_b128 a[112:115], v2 offset:53248
  buffer_load_dwordx4 v1, s[12:15], s24 offen offset:1024 sc1 lds
  v_mfma_f32_16x16x32_bf16 v[76:79], v[204:207], a[84:87], v[76:79]
  ds_read_b128 a[128:131], v2 offset:57344
  v_mfma_f32_16x16x32_bf16 v[92:95], v[196:199], a[56:59], v[92:95]
  ds_read_b128 a[100:103], v2 offset:49408
  buffer_load_dwordx4 v1, s[12:15], s24 offen offset:2048 sc1 lds
  v_mfma_f32_16x16x32_bf16 v[92:95], v[200:203], a[72:75], v[92:95]
  ds_read_b128 a[116:119], v2 offset:53504
  v_mfma_f32_16x16x32_bf16 v[92:95], v[204:207], a[88:91], v[92:95]
  ds_read_b128 a[132:135], v2 offset:57600
  s_add_u32 m0, s22, 36864
  v_mfma_f32_16x16x32_bf16 v[108:111], v[196:199], a[60:63], v[108:111]
  ds_read_b128 a[104:107], v3 offset:49152
  v_mfma_f32_16x16x32_bf16 v[108:111], v[200:203], a[76:79], v[108:111]
  ds_read_b128 a[120:123], v3 offset:53248
  s_add_u32 s24, s30, 122880
  v_mfma_f32_16x16x32_bf16 v[108:111], v[204:207], a[92:95], v[108:111]
  ds_read_b128 a[136:139], v3 offset:57344
  s_waitcnt lgkmcnt(8)
  v_mfma_f32_16x16x32_bf16 v[48:51], v[176:179], a[96:99], v[48:51]
  ds_read_b128 a[108:111], v3 offset:49408
  buffer_load_dwordx4 v1, s[12:15], s24 offen offset:0 sc1 lds
  s_waitcnt lgkmcnt(8)
  v_mfma_f32_16x16x32_bf16 v[48:51], v[180:183], a[112:115], v[48:51]
  ds_read_b128 a[124:127], v3 offset:53504
  s_waitcnt lgkmcnt(8)
  v_mfma_f32_16x16x32_bf16 v[48:51], v[184:187], a[128:131], v[48:51]
  ds_read_b128 a[140:143], v3 offset:57600
  buffer_load_dwordx4 v1, s[12:15], s24 offen offset:1024 sc1 lds
  s_waitcnt lgkmcnt(8)
  v_mfma_f32_16x16x32_bf16 v[64:67], v[176:179], a[100:103], v[64:67]
  ds_read_b64_tr_b16 v[188:189], v22 offset:8
  s_waitcnt lgkmcnt(8)
  v_mfma_f32_16x16x32_bf16 v[64:67], v[180:183], a[116:119], v[64:67]
  ds_read_b64_tr_b16 v[190:191], v22 offset:520
  ds_read_b64_tr_b16 v[192:193], v22 offset:4104
  s_waitcnt lgkmcnt(9)
  v_mfma_f32_16x16x32_bf16 v[64:67], v[184:187], a[132:135], v[64:67]
  ds_read_b64_tr_b16 v[194:195], v22 offset:4616
  ds_read_b64_tr_b16 v[196:197], v22 offset:8200
  s_waitcnt lgkmcnt(10)
  v_mfma_f32_16x16x32_bf16 v[80:83], v[176:179], a[104:107], v[80:83]
  ds_read_b64_tr_b16 v[198:199], v22 offset:8712
  buffer_load_dwordx4 v1, s[12:15], s24 offen offset:2048 sc1 lds
  s_add_u32 m0, s22, 106496
  s_waitcnt lgkmcnt(10)
  v_mfma_f32_16x16x32_bf16 v[80:83], v[180:183], a[120:123], v[80:83]
  ds_read_b64_tr_b16 v[200:201], v22 offset:12288
  s_waitcnt lgkmcnt(10)
  v_mfma_f32_16x16x32_bf16 v[80:83], v[184:187], a[136:139], v[80:83]
  ds_read_b64_tr_b16 v[202:203], v22 offset:12800
  s_add_u32 s24, s20, 3538944
  s_waitcnt lgkmcnt(10)
  v_mfma_f32_16x16x32_bf16 v[96:99], v[176:179], a[108:111], v[96:99]
  ds_read_b64_tr_b16 v[204:205], v22 offset:16384
  s_waitcnt vmcnt(12)
  s_waitcnt lgkmcnt(10)
  v_mfma_f32_16x16x32_bf16 v[96:99], v[180:183], a[124:127], v[96:99]
  buffer_load_dwordx4 v240, s[40:43], s24 offen offset:0  lds
  ds_read_b128 v[112:115], v247 offset:0
  s_waitcnt lgkmcnt(10)
  v_mfma_f32_16x16x32_bf16 v[96:99], v[184:187], a[140:143], v[96:99]
  ds_read_b64_tr_b16 v[206:207], v22 offset:16896
  s_waitcnt lgkmcnt(5)
  v_mfma_f32_16x16x32_bf16 v[52:55], v[188:191], a[96:99], v[52:55]
  buffer_load_dwordx4 v241, s[40:43], s24 offen offset:1024  lds
  v_mfma_f32_16x16x32_bf16 v[52:55], v[192:195], a[112:115], v[52:55]
  ds_read_b64_tr_b16 v[176:177], v22 offset:20480
  v_mfma_f32_16x16x32_bf16 v[52:55], v[196:199], a[128:131], v[52:55]
  ds_read_b64_tr_b16 v[178:179], v22 offset:20992
  v_mfma_f32_16x16x32_bf16 v[68:71], v[188:191], a[100:103], v[68:71]
  buffer_load_dwordx4 v242, s[40:43], s24 offen offset:2048  lds
  v_mfma_f32_16x16x32_bf16 v[68:71], v[192:195], a[116:119], v[68:71]
  ds_read_b64_tr_b16 v[180:181], v22 offset:12296
  s_add_u32 m0, s22, 118784
  v_mfma_f32_16x16x32_bf16 v[68:71], v[196:199], a[132:135], v[68:71]
  ds_read_b128 v[116:119], v247 offset:1024
  ds_read_b128 v[120:123], v247 offset:2048
  v_mfma_f32_16x16x32_bf16 v[84:87], v[188:191], a[104:107], v[84:87]
  ds_read_b64_tr_b16 v[182:183], v22 offset:12808
  ds_read_b128 v[124:127], v247 offset:12288
  v_mfma_f32_16x16x32_bf16 v[84:87], v[192:195], a[120:123], v[84:87]
  buffer_load_dwordx4 v240, s[44:47], s24 offen offset:0  lds
  ds_read_b128 v[128:131], v247 offset:13312
  v_mfma_f32_16x16x32_bf16 v[84:87], v[196:199], a[136:139], v[84:87]
  ds_read_b64_tr_b16 v[184:185], v22 offset:16392
  ds_read_b128 v[132:135], v247 offset:14336
  v_mfma_f32_16x16x32_bf16 v[100:103], v[188:191], a[108:111], v[100:103]
  ds_read_b64_tr_b16 v[186:187], v22 offset:16904
  v_mfma_f32_16x16x32_bf16 v[100:103], v[192:195], a[124:127], v[100:103]
  buffer_load_dwordx4 v241, s[44:47], s24 offen offset:1024  lds
  buffer_load_dwordx4 v242, s[44:47], s24 offen offset:2048  lds
  v_mfma_f32_16x16x32_bf16 v[100:103], v[196:199], a[140:143], v[100:103]
  ds_read_b64_tr_b16 v[188:189], v22 offset:20488
  s_mov_b64 exec, s[96:97]
  buffer_load_dwordx2 v[248:249], v250, s[12:15], s26 offen sc1
  s_mov_b64 exec, -1
  s_waitcnt lgkmcnt(10)
  v_mfma_f32_16x16x32_bf16 v[56:59], v[200:203], a[96:99], v[56:59]
  s_waitcnt lgkmcnt(2)
  v_max3_u32 v136, v112, v113, v114
  v_max3_u32 v137, v115, v116, v117
  v_mfma_f32_16x16x32_bf16 v[56:59], v[204:207], a[112:115], v[56:59]
  ds_read_b64_tr_b16 v[190:191], v22 offset:21000
  v_max3_u32 v136, v136, v118, v119
  v_mfma_f32_16x16x32_bf16 v[56:59], v[176:179], a[128:131], v[56:59]
  v_max3_u32 v137, v137, v120, v121
  v_max3_u32 v136, v136, v122, v123
  v_mfma_f32_16x16x32_bf16 v[72:75], v[200:203], a[100:103], v[72:75]
  v_max3_u32 v137, v137, v124, v125
  v_max3_u32 v136, v136, v126, v127
  v_mfma_f32_16x16x32_bf16 v[72:75], v[204:207], a[116:119], v[72:75]
  v_max3_u32 v137, v137, v128, v129
  v_max3_u32 v136, v136, v130, v131
  v_mfma_f32_16x16x32_bf16 v[72:75], v[176:179], a[132:135], v[72:75]
  v_max3_u32 v137, v137, v132, v133
  v_max3_u32 v136, v136, v134, v135
  v_mfma_f32_16x16x32_bf16 v[88:91], v[200:203], a[104:107], v[88:91]
  v_max_u32 v136, v136, v137
  v_cmp_eq_u32 vcc, -1, v136
  v_mfma_f32_16x16x32_bf16 v[88:91], v[204:207], a[120:123], v[88:91]
  v_mfma_f32_16x16x32_bf16 v[88:91], v[176:179], a[136:139], v[88:91]
  v_mfma_f32_16x16x32_bf16 v[104:107], v[200:203], a[108:111], v[104:107]
  s_cmp_eq_u64 vcc, 0
  s_cbranch_scc0 L_lp44s
L_ok43:
  s_waitcnt vmcnt(13) lgkmcnt(0)
  s_barrier
  v_add_u32 v22, 4294918144, v22
  ds_read_b64_tr_b16 v[192:193], v22 offset:0
  v_mfma_f32_16x16x32_bf16 v[104:107], v[204:207], a[124:127], v[104:107]
  ds_read_b64_tr_b16 v[194:195], v22 offset:512
  s_add_u32 m0, s22, 49152
  v_mfma_f32_16x16x32_bf16 v[104:107], v[176:179], a[140:143], v[104:107]
  ds_read_b128 a[144:147], v2 offset:0
  v_mfma_f32_16x16x32_bf16 v[60:63], v[180:183], a[96:99], v[60:63]
  ds_read_b64_tr_b16 v[196:197], v22 offset:4096
  s_add_u32 s24, s30, 61440
  v_mfma_f32_16x16x32_bf16 v[60:63], v[184:187], a[112:115], v[60:63]
  ds_read_b64_tr_b16 v[198:199], v22 offset:4608
  v_mfma_f32_16x16x32_bf16 v[60:63], v[188:191], a[128:131], v[60:63]
  ds_read_b64_tr_b16 v[200:201], v22 offset:8192
  buffer_load_dwordx4 v1, s[12:15], s24 offen offset:0 sc1 lds
  v_mfma_f32_16x16x32_bf16 v[76:79], v[180:183], a[100:103], v[76:79]
  ds_read_b64_tr_b16 v[202:203], v22 offset:8704
  v_mfma_f32_16x16x32_bf16 v[76:79], v[184:187], a[116:119], v[76:79]
  ds_read_b128 a[160:163], v2 offset:4096
  buffer_load_dwordx4 v1, s[12:15], s24 offen offset:1024 sc1 lds
  v_mfma_f32_16x16x32_bf16 v[76:79], v[188:191], a[132:135], v[76:79]
  ds_read_b128 a[176:179], v2 offset:8192
  v_mfma_f32_16x16x32_bf16 v[92:95], v[180:183], a[104:107], v[92:95]
  ds_read_b128 a[148:151], v2 offset:256
  buffer_load_dwordx4 v1, s[12:15], s24 offen offset:2048 sc1 lds
  v_mfma_f32_16x16x32_bf16 v[92:95], v[184:187], a[120:123], v[92:95]
  ds_read_b128 a[164:167], v2 offset:4352
  v_mfma_f32_16x16x32_bf16 v[92:95], v[188:191], a[136:139], v[92:95]
  ds_read_b128 a[180:183], v2 offset:8448
  s_add_u32 m0, s22, 61440
  v_mfma_f32_16x16x32_bf16 v[108:111], v[180:183], a[108:111], v[108:111]
  ds_read_b128 a[152:155], v3 offset:0
  v_mfma_f32_16x16x32_bf16 v[108:111], v[184:187], a[124:127], v[108:111]
  ds_read_b128 a[168:171], v3 offset:4096
  s_add_u32 s24, s30, 135168
  v_mfma_f32_16x16x32_bf16 v[108:111], v[188:191], a[140:143], v[108:111]
  ds_read_b128 a[184:187], v3 offset:8192
  s_waitcnt lgkmcnt(8)
  v_mfma_f32_16x16x32_bf16 v[48:51], v[192:195], a[144:147], v[48:51]
  ds_read_b128 a[156:159], v3 offset:256
  buffer_load_dwordx4 v1, s[12:15], s24 offen offset:0 sc1 lds
  s_waitcnt lgkmcnt(8)
  v_mfma_f32_16x16x32_bf16 v[48:51], v[196:199], a[160:163], v[48:51]
  ds_read_b128 a[172:175], v3 offset:4352
  s_waitcnt lgkmcnt(8)
  v_mfma_f32_16x16x32_bf16 v[48:51], v[200:203], a[176:179], v[48:51]
  ds_read_b128 a[188:191], v3 offset:8448
  buffer_load_dwordx4 v1, s[12:15], s24 offen offset:1024 sc1 lds
  s_waitcnt lgkmcnt(8)
  v_mfma_f32_16x16x32_bf16 v[64:67], v[192:195], a[148:151], v[64:67]
  ds_read_b64_tr_b16 v[204:205], v22 offset:8
  s_waitcnt lgkmcnt(8)
  v_mfma_f32_16x16x32_bf16 v[64:67], v[196:199], a[164:167], v[64:67]
  ds_read_b64_tr_b16 v[206:207], v22 offset:520
  ds_read_b64_tr_b16 v[176:177], v22 offset:4104
  s_waitcnt lgkmcnt(9)
  v_mfma_f32_16x16x32_bf16 v[64:67], v[200:203], a[180:183], v[64:67]
  ds_read_b64_tr_b16 v[178:179], v22 offset:4616
  ds_read_b64_tr_b16 v[180:181], v22 offset:8200
  s_waitcnt lgkmcnt(10)
  v_mfma_f32_16x16x32_bf16 v[80:83], v[192:195], a[152:155], v[80:83]
  ds_read_b64_tr_b16 v[182:183], v22 offset:8712
  buffer_load_dwordx4 v1, s[12:15], s24 offen offset:2048 sc1 lds
  s_add_u32 m0, s22, 131072
  s_waitcnt lgkmcnt(10)
  v_mfma_f32_16x16x32_bf16 v[80:83], v[196:199], a[168:171], v[80:83]
  ds_read_b64_tr_b16 v[184:185], v22 offset:12288
  s_waitcnt lgkmcnt(10)
  v_mfma_f32_16x16x32_bf16 v[80:83], v[200:203], a[184:187], v[80:83]
  ds_read_b64_tr_b16 v[186:187], v22 offset:12800
  s_add_u32 s24, s20, 4423680
  s_waitcnt lgkmcnt(10)
  v_mfma_f32_16x16x32_bf16 v[96:99], v[192:195], a[156:159], v[96:99]
  ds_read_b64_tr_b16 v[188:189], v22 offset:16384
  s_waitcnt vmcnt(13)
  s_waitcnt lgkmcnt(10)
  v_mfma_f32_16x16x32_bf16 v[96:99], v[196:199], a[172:175], v[96:99]
  buffer_load_dwordx4 v240, s[40:43], s24 offen offset:0  lds
  ds_read_b128 v[112:115], v247 offset:24576
  s_waitcnt lgkmcnt(10)
  v_mfma_f32_16x16x32_bf16 v[96:99], v[200:203], a[188:191], v[96:99]
  ds_read_b64_tr_b16 v[190:191], v22 offset:16896
  s_waitcnt lgkmcnt(5)
  v_mfma_f32_16x16x32_bf16 v[52:55], v[204:207], a[144:147], v[52:55]
  buffer_load_dwordx4 v241, s[40:43], s24 offen offset:1024  lds
  v_mfma_f32_16x16x32_bf16 v[52:55], v[176:179], a[160:163], v[52:55]
  ds_read_b64_tr_b16 v[192:193], v22 offset:20480
  v_mfma_f32_16x16x32_bf16 v[52:55], v[180:183], a[176:179], v[52:55]
  ds_read_b64_tr_b16 v[194:195], v22 offset:20992
  v_mfma_f32_16x16x32_bf16 v[68:71], v[204:207], a[148:151], v[68:71]
  buffer_load_dwordx4 v242, s[40:43], s24 offen offset:2048  lds
  v_mfma_f32_16x16x32_bf16 v[68:71], v[176:179], a[164:167], v[68:71]
  ds_read_b64_tr_b16 v[196:197], v22 offset:12296
  s_add_u32 m0, s22, 143360
  v_mfma_f32_16x16x32_bf16 v[68:71], v[180:183], a[180:183], v[68:71]
  ds_read_b128 v[116:119], v247 offset:25600
  ds_read_b128 v[120:123], v247 offset:26624
  v_mfma_f32_16x16x32_bf16 v[84:87], v[204:207], a[152:155], v[84:87]
  ds_read_b64_tr_b16 v[198:199], v22 offset:12808
  ds_read_b128 v[124:127], v247 offset:36864
  v_mfma_f32_16x16x32_bf16 v[84:87], v[176:179], a[168:171], v[84:87]
  buffer_load_dwordx4 v240, s[44:47], s24 offen offset:0  lds
  ds_read_b128 v[128:131], v247 offset:37888
  v_mfma_f32_16x16x32_bf16 v[84:87], v[180:183], a[184:187], v[84:87]
  ds_read_b64_tr_b16 v[200:201], v22 offset:16392
  ds_read_b128 v[132:135], v247 offset:38912
  v_mfma_f32_16x16x32_bf16 v[100:103], v[204:207], a[156:159], v[100:103]
  ds_read_b64_tr_b16 v[202:203], v22 offset:16904
  v_mfma_f32_16x16x32_bf16 v[100:103], v[176:179], a[172:175], v[100:103]
  buffer_load_dwordx4 v241, s[44:47], s24 offen offset:1024  lds
  buffer_load_dwordx4 v242, s[44:47], s24 offen offset:2048  lds
  v_mfma_f32_16x16x32_bf16 v[100:103], v[180:183], a[188:191], v[100:103]
  ds_read_b64_tr_b16 v[204:205], v22 offset:20488
  s_waitcnt lgkmcnt(10)
  v_mfma_f32_16x16x32_bf16 v[56:59], v[184:187], a[144:147], v[56:59]
  s_waitcnt lgkmcnt(2)
  v_max3_u32 v136, v112, v113, v114
  v_max3_u32 v137, v115, v116, v117
  v_mfma_f32_16x16x32_bf16 v[56:59], v[188:191], a[160:163], v[56:59]
  ds_read_b64_tr_b16 v[206:207], v22 offset:21000
  v_max3_u32 v136, v136, v118, v119
  v_mfma_f32_16x16x32_bf16 v[56:59], v[192:195], a[176:179], v[56:59]
  v_max3_u32 v137, v137, v120, v121
  v_max3_u32 v136, v136, v122, v123
  v_mfma_f32_16x16x32_bf16 v[72:75], v[184:187], a[148:151], v[72:75]
  v_max3_u32 v137, v137, v124, v125
  v_max3_u32 v136, v136, v126, v127
  v_mfma_f32_16x16x32_bf16 v[72:75], v[188:191], a[164:167], v[72:75]
  v_max3_u32 v137, v137, v128, v129
  v_max3_u32 v136, v136, v130, v131
  v_mfma_f32_16x16x32_bf16 v[72:75], v[192:195], a[180:183], v[72:75]
  v_max3_u32 v137, v137, v132, v133
  v_max3_u32 v136, v136, v134, v135
  v_mfma_f32_16x16x32_bf16 v[88:91], v[184:187], a[152:155], v[88:91]
  v_max_u32 v136, v136, v137
  v_cmp_eq_u32 vcc, -1, v136
  v_mfma_f32_16x16x32_bf16 v[88:91], v[188:191], a[168:171], v[88:91]
  v_mfma_f32_16x16x32_bf16 v[88:91], v[192:195], a[184:187], v[88:91]
  v_mfma_f32_16x16x32_bf16 v[104:107], v[184:187], a[156:159], v[104:107]
  s_cmp_eq_u64 vcc, 0
  s_cbranch_scc0 L_lp46s
L_ok45:
  s_waitcnt vmcnt(13) lgkmcnt(0)
  s_barrier
  v_add_u32 v22, 24576, v22
  ds_read_b64_tr_b16 v[176:177], v22 offset:0
  v_mfma_f32_16x16x32_bf16 v[104:107], v[188:191], a[172:175], v[104:107]
  ds_read_b64_tr_b16 v[178:179], v22 offset:512
  s_add_u32 m0, s22, 81920
  v_mfma_f32_16x16x32_bf16 v[104:107], v[192:195], a[188:191], v[104:107]
  ds_read_b128 a[192:195], v2 offset:24576
  s_add_u32 s24, s21, 0
  v_mfma_f32_16x16x32_bf16 v[60:63], v[196:199], a[144:147], v[60:63]
  ds_read_b64_tr_b16 v[180:181], v22 offset:4096
  v_mfma_f32_16x16x32_bf16 v[60:63], v[200:203], a[160:163], v[60:63]
  ds_read_b64_tr_b16 v[182:183], v22 offset:4608
  buffer_load_dwordx4 v7, s[40:43], s24 offen  lds
  v_mfma_f32_16x16x32_bf16 v[60:63], v[204:207], a[176:179], v[60:63]
  ds_read_b64_tr_b16 v[184:185], v22 offset:8192
  s_waitcnt vmcnt(13)
  v_cmp_eq_u64 vcc, s[56:57], v[248:249]
  s_nop 1
  s_orn2_b64 vcc, vcc, s[96:97]
  s_cmp_eq_u64 vcc, -1
  s_cbranch_scc0 L_lp48s
L_ok47:
  v_mfma_f32_16x16x32_bf16 v[76:79], v[196:199], a[148:151], v[76:79]
  ds_read_b64_tr_b16 v[186:187], v22 offset:8704
  s_add_u32 m0, s22, 82944
  v_mfma_f32_16x16x32_bf16 v[76:79], v[200:203], a[164:167], v[76:79]
  ds_read_b128 a[208:211], v2 offset:28672
  s_add_u32 s24, s21, 147456
  v_mfma_f32_16x16x32_bf16 v[76:79], v[204:207], a[180:183], v[76:79]
  ds_read_b128 a[224:227], v2 offset:32768
  v_mfma_f32_16x16x32_bf16 v[92:95], v[196:199], a[152:155], v[92:95]
  ds_read_b128 a[196:199], v2 offset:24832
  buffer_load_dwordx4 v7, s[40:43], s24 offen  lds
  v_mfma_f32_16x16x32_bf16 v[92:95], v[200:203], a[168:171], v[92:95]
  ds_read_b128 a[212:215], v2 offset:28928
  v_mfma_f32_16x16x32_bf16 v[92:95], v[204:207], a[184:187], v[92:95]
  ds_read_b128 a[228:231], v2 offset:33024
  s_add_u32 m0, s22, 83968
  v_mfma_f32_16x16x32_bf16 v[108:111], v[196:199], a[156:159], v[108:111]
  ds_read_b128 a[200:203], v3 offset:24576
L_pad1:
  s_cbranch_execz L_pad2
  v_mfma_f32_16x16x32_bf16 v[108:111], v[200:203], a[172:175], v[108:111]
  ds_read_b128 a[216:219], v3 offset:28672
  s_add_u32 s24, s21, 294912
  v_mfma_f32_16x16x32_bf16 v[108:111], v[204:207], a[188:191], v[108:111]
  ds_read_b128 a[232:235], v3 offset:32768
  buffer_load_dwordx4 v7, s[40:43], s24 offen  lds
  s_waitcnt lgkmcnt(8)
  v_mfma_f32_16x16x32_bf16 v[48:51], v[176:179], a[192:195], v[48:51]
  ds_read_b128 a[204:207], v3 offset:24832
  buffer_load_dword v24, v8, s[12:15], s27 offen offset:0 sc1
  s_waitcnt lgkmcnt(8)
  v_mfma_f32_16x16x32_bf16 v[48:51], v[180:183], a[208:211], v[48:51]
  ds_read_b128 a[220:223], v3 offset:28928
  s_add_u32 m0, s22, 94208
  s_waitcnt lgkmcnt(8)
  v_mfma_f32_16x16x32_bf16 v[48:51], v[184:187], a[224:227], v[48:51]
  ds_read_b128 a[236:239], v3 offset:33024
  buffer_load_dword v25, v8, s[12:15], s27 offen offset:256 sc1
  s_waitcnt lgkmcnt(8)
  v_mfma_f32_16x16x32_bf16 v[64:67], v[176:179], a[196:199], v[64:67]
  ds_read_b64_tr_b16 v[188:189], v22 offset:8
  s_add_u32 s24, s21, 0
  s_waitcnt lgkmcnt(8)
  v_mfma_f32_16x16x32_bf16 v[64:67], v[180:183], a[212:215], v[64:67]
  ds_read_b64_tr_b16 v[190:191], v22 offset:520
  ds_read_b64_tr_b16 v[192:193], v22 offset:4104
  s_waitcnt lgkmcnt(9)
  v_mfma_f32_16x16x32_bf16 v[64:67], v[184:187], a[228:231], v[64:67]
  ds_read_b64_tr_b16 v[194:195], v22 offset:4616
  ds_read_b64_tr_b16 v[196:197], v22 offset:8200
  s_waitcnt lgkmcnt(10)
  v_mfma_f32_16x16x32_bf16 v[80:83], v[176:179], a[200:203], v[80:83]
  ds_read_b64_tr_b16 v[198:199], v22 offset:8712
  buffer_load_dword v26, v8, s[12:15], s27 offen offset:512 sc1
  s_waitcnt lgkmcnt(10)
  v_mfma_f32_16x16x32_bf16 v[80:83], v[180:183], a[216:219], v[80:83]
  ds_read_b64_tr_b16 v[200:201], v22 offset:12288
  s_waitcnt lgkmcnt(10)
  v_mfma_f32_16x16x32_bf16 v[80:83], v[184:187], a[232:235], v[80:83]
  ds_read_b64_tr_b16 v[202:203], v22 offset:12800
  s_waitcnt lgkmcnt(10)
  v_mfma_f32_16x16x32_bf16 v[96:99], v[176:179], a[204:207], v[96:99]
  ds_read_b64_tr_b16 v[204:205], v22 offset:16384
  s_waitcnt vmcnt(12)
  s_waitcnt lgkmcnt(10)
  v_mfma_f32_16x16x32_bf16 v[96:99], v[180:183], a[220:223], v[96:99]
  buffer_load_dwordx4 v7, s[44:47], s24 offen  lds
  s_add_u32 m0, s22, 95232
  s_add_u32 s24, s21, 147456
  ds_read_b128 v[112:115], v247 offset:49152
  s_waitcnt lgkmcnt(10)
  v_mfma_f32_16x16x32_bf16 v[96:99], v[184:187], a[236:239], v[96:99]
  ds_read_b64_tr_b16 v[206:207], v22 offset:16896
  buffer_load_dword v27, v8, s[12:15], s27 offen offset:768 sc1
  s_waitcnt lgkmcnt(5)
  v_mfma_f32_16x16x32_bf16 v[52:55], v[188:191], a[192:195], v[52:55]
  buffer_load_dwordx4 v7, s[44:47], s24 offen  lds
  s_add_u32 m0, s22, 96256
  v_mfma_f32_16x16x32_bf16 v[52:55], v[192:195], a[208:211], v[52:55]
  ds_read_b64_tr_b16 v[176:177], v22 offset:20480
  s_add_u32 s24, s21, 294912
  buffer_load_dword v28, v8, s[12:15], s27 offen offset:1024 sc1
  v_mfma_f32_16x16x32_bf16 v[52:55], v[196:199], a[224:227], v[52:55]
  ds_read_b64_tr_b16 v[178:179], v22 offset:20992
  v_mfma_f32_16x16x32_bf16 v[68:71], v[188:191], a[196:199], v[68:71]
  buffer_load_dwordx4 v7, s[44:47], s24 offen  lds
  v_mfma_f32_16x16x32_bf16 v[68:71], v[192:195], a[212:215], v[68:71]
  ds_read_b64_tr_b16 v[180:181], v22 offset:12296
  v_mfma_f32_16x16x32_bf16 v[68:71], v[196:199], a[228:231], v[68:71]
  ds_read_b128 v[116:119], v247 offset:50176
  v_mfma_f32_16x16x32_bf16 v[84:87], v[188:191], a[200:203], v[84:87]
  ds_read_b64_tr_b16 v[182:183], v22 offset:12808
  v_mfma_f32_16x16x32_bf16 v[84:87], v[192:195], a[216:219], v[84:87]
  ds_read_b128 v[120:123], v247 offset:51200
  ds_read_b128 v[124:127], v247 offset:61440
  v_mfma_f32_16x16x32_bf16 v[84:87], v[196:199], a[232:235], v[84:87]
  ds_read_b64_tr_b16 v[184:185], v22 offset:16392
  ds_read_b128 v[128:131], v247 offset:62464
  ds_read_b128 v[132:135], v247 offset:63488
  v_mfma_f32_16x16x32_bf16 v[100:103], v[188:191], a[204:207], v[100:103]
  ds_read_b64_tr_b16 v[186:187], v22 offset:16904
  v_mfma_f32_16x16x32_bf16 v[100:103], v[192:195], a[220:223], v[100:103]
  buffer_load_dword v29, v8, s[12:15], s27 offen offset:1280 sc1
  buffer_load_dword v30, v8, s[12:15], s27 offen offset:1536 sc1
  v_mfma_f32_16x16x32_bf16 v[100:103], v[196:199], a[236:239], v[100:103]
  ds_read_b64_tr_b16 v[188:189], v22 offset:20488
  s_waitcnt lgkmcnt(10)
  v_mfma_f32_16x16x32_bf16 v[56:59], v[200:203], a[192:195], v[56:59]
  s_waitcnt lgkmcnt(2)
  v_max3_u32 v136, v112, v113, v114
  v_max3_u32 v137, v115, v116, v117
  v_mfma_f32_16x16x32_bf16 v[56:59], v[204:207], a[208:211], v[56:59]
  ds_read_b64_tr_b16 v[190:191], v22 offset:21000
  v_max3_u32 v136, v136, v118, v119
  v_mfma_f32_16x16x32_bf16 v[56:59], v[176:179], a[224:227], v[56:59]
  v_max3_u32 v137, v137, v120, v121
  v_max3_u32 v136, v136, v122, v123
  buffer_load_dword v31, v8, s[12:15], s27 offen offset:1792 sc1
  v_mfma_f32_16x16x32_bf16 v[72:75], v[200:203], a[196:199], v[72:75]
  v_max3_u32 v137, v137, v124, v125
  v_max3_u32 v136, v136, v126, v127
  v_mfma_f32_16x16x32_bf16 v[72:75], v[204:207], a[212:215], v[72:75]
  v_max3_u32 v137, v137, v128, v129
  v_max3_u32 v136, v136, v130, v131
  v_mfma_f32_16x16x32_bf16 v[72:75], v[176:179], a[228:231], v[72:75]
  v_max3_u32 v137, v137, v132, v133
  v_max3_u32 v136, v136, v134, v135
  v_mfma_f32_16x16x32_bf16 v[88:91], v[200:203], a[200:203], v[88:91]
  v_max_u32 v136, v136, v137
  v_cmp_eq_u32 vcc, -1, v136
  v_mfma_f32_16x16x32_bf16 v[88:91], v[204:207], a[216:219], v[88:91]
  buffer_load_dword v32, v8, s[12:15], s27 offen offset:2048 sc1
  v_mfma_f32_16x16x32_bf16 v[88:91], v[176:179], a[232:235], v[88:91]
  v_mfma_f32_16x16x32_bf16 v[104:107], v[200:203], a[204:207], v[104:107]
  s_cmp_eq_u64 vcc, 0
  s_cbranch_scc0 L_lp50s
L_ok49:
  s_waitcnt vmcnt(15) lgkmcnt(0)
  s_barrier
  v_add_u32 v22, 24576, v22
  ds_read_b64_tr_b16 v[192:193], v22 offset:0
  v_mfma_f32_16x16x32_bf16 v[104:107], v[204:207], a[220:223], v[104:107]
  ds_read_b64_tr_b16 v[194:195], v22 offset:512
  s_add_u32 m0, s22, 106496
  v_mfma_f32_16x16x32_bf16 v[104:107], v[176:179], a[236:239], v[104:107]
  ds_read_b128 a[240:243], v2 offset:49152
  s_add_u32 s24, s21, 1769472
  v_mfma_f32_16x16x32_bf16 v[60:63], v[180:183], a[192:195], v[60:63]
  ds_read_b64_tr_b16 v[196:197], v22 offset:4096
  v_mfma_f32_16x16x32_bf16 v[60:63], v[184:187], a[208:211], v[60:63]
  ds_read_b64_tr_b16 v[198:199], v22 offset:4608
  buffer_load_dwordx4 v7, s[40:43], s24 offen  lds
  v_mfma_f32_16x16x32_bf16 v[60:63], v[188:191], a[224:227], v[60:63]
  ds_read_b64_tr_b16 v[200:201], v22 offset:8192
  v_mfma_f32_16x16x32_bf16 v[76:79], v[180:183], a[196:199], v[76:79]
  ds_read_b64_tr_b16 v[202:203], v22 offset:8704
  s_add_u32 m0, s22, 107520
  v_mfma_f32_16x16x32_bf16 v[76:79], v[184:187], a[212:215], v[76:79]
  ds_read_b128 v[208:211], v2 offset:53248
  s_add_u32 s24, s21, 1916928
  v_mfma_f32_16x16x32_bf16 v[76:79], v[188:191], a[228:231], v[76:79]
  ds_read_b128 v[224:227], v2 offset:57344
  v_mfma_f32_16x16x32_bf16 v[92:95], v[180:183], a[200:203], v[92:95]
  ds_read_b128 a[244:247], v2 offset:49408
  buffer_load_dwordx4 v7, s[40:43], s24 offen  lds
  v_mfma_f32_16x16x32_bf16 v[92:95], v[184:187], a[216:219], v[92:95]
  ds_read_b128 v[212:215], v2 offset:53504
  v_mfma_f32_16x16x32_bf16 v[92:95], v[188:191], a[232:235], v[92:95]
  ds_read_b128 v[228:231], v2 offset:57600
  s_add_u32 m0, s22, 108544
  v_mfma_f32_16x16x32_bf16 v[108:111], v[180:183], a[204:207], v[108:111]
  ds_read_b128 a[248:251], v3 offset:49152
  v_mfma_f32_16x16x32_bf16 v[108:111], v[184:187], a[220:223], v[108:111]
  ds_read_b128 v[216:219], v3 offset:53248
  s_add_u32 s24, s21, 2064384
  v_mfma_f32_16x16x32_bf16 v[108:111], v[188:191], a[236:239], v[108:111]
  ds_read_b128 v[232:235], v3 offset:57344
  buffer_load_dwordx4 v7, s[40:43], s24 offen  lds
  s_waitcnt lgkmcnt(8)
  v_mfma_f32_16x16x32_bf16 v[48:51], v[192:195], a[240:243], v[48:51]
  ds_read_b128 a[252:255], v3 offset:49408
  s_waitcnt lgkmcnt(8)
  v_mfma_f32_16x16x32_bf16 v[48:51], v[196:199], v[208:211], v[48:51]
  ds_read_b128 v[220:223], v3 offset:53504
  s_add_u32 m0, s22, 118784
  s_waitcnt lgkmcnt(8)
  v_mfma_f32_16x16x32_bf16 v[48:51], v[200:203], v[224:227], v[48:51]
  ds_read_b128 v[236:239], v3 offset:57600
  s_waitcnt lgkmcnt(8)
  v_mfma_f32_16x16x32_bf16 v[64:67], v[192:195], a[244:247], v[64:67]
  ds_read_b64_tr_b16 v[204:205], v22 offset:8
  s_add_u32 s24, s21, 1769472
  s_waitcnt lgkmcnt(8)
  v_mfma_f32_16x16x32_bf16 v[64:67], v[196:199], v[212:215], v[64:67]
  ds_read_b64_tr_b16 v[206:207], v22 offset:520
  ds_read_b64_tr_b16 v[176:177], v22 offset:4104
  s_waitcnt lgkmcnt(9)
  v_mfma_f32_16x16x32_bf16 v[64:67], v[200:203], v[228:231], v[64:67]
  ds_read_b64_tr_b16 v[178:179], v22 offset:4616
  ds_read_b64_tr_b16 v[180:181], v22 offset:8200
  s_waitcnt lgkmcnt(10)
  v_mfma_f32_16x16x32_bf16 v[80:83], v[192:195], a[248:251], v[80:83]
  ds_read_b64_tr_b16 v[182:183], v22 offset:8712
  s_waitcnt lgkmcnt(10)
  v_mfma_f32_16x16x32_bf16 v[80:83], v[196:199], v[216:219], v[80:83]
  ds_read_b64_tr_b16 v[184:185], v22 offset:12288
  s_waitcnt lgkmcnt(10)
  v_mfma_f32_16x16x32_bf16 v[80:83], v[200:203], v[232:235], v[80:83]
  ds_read_b64_tr_b16 v[186:187], v22 offset:12800
  s_waitcnt lgkmcnt(10)
  v_mfma_f32_16x16x32_bf16 v[96:99], v[192:195], a[252:255], v[96:99]
  ds_read_b64_tr_b16 v[188:189], v22 offset:16384
  s_waitcnt lgkmcnt(10)
  v_mfma_f32_16x16x32_bf16 v[96:99], v[196:199], v[220:223], v[96:99]
  buffer_load_dwordx4 v7, s[44:47], s24 offen  lds
  s_add_u32 m0, s22, 119808
  s_add_u32 s24, s21, 1916928
  s_waitcnt lgkmcnt(9)
  v_mfma_f32_16x16x32_bf16 v[96:99], v[200:203], v[236:239], v[96:99]
  ds_read_b64_tr_b16 v[190:191], v22 offset:16896
  s_waitcnt lgkmcnt(4)
  v_mfma_f32_16x16x32_bf16 v[52:55], v[204:207], a[240:243], v[52:55]
  buffer_load_dwordx4 v7, s[44:47], s24 offen  lds
  s_add_u32 m0, s22, 120832
  v_mfma_f32_16x16x32_bf16 v[52:55], v[176:179], v[208:211], v[52:55]
  ds_read_b64_tr_b16 v[192:193], v22 offset:20480
  s_add_u32 s24, s21, 2064384
  v_mfma_f32_16x16x32_bf16 v[52:55], v[180:183], v[224:227], v[52:55]
  ds_read_b64_tr_b16 v[194:195], v22 offset:20992
  v_mfma_f32_16x16x32_bf16 v[68:71], v[204:207], a[244:247], v[68:71]
  buffer_load_dwordx4 v7, s[44:47], s24 offen  lds
  v_mfma_f32_16x16x32_bf16 v[68:71], v[176:179], v[212:215], v[68:71]
  ds_read_b64_tr_b16 v[196:197], v22 offset:12296
  v_mfma_f32_16x16x32_bf16 v[68:71], v[180:183], v[228:231], v[68:71]
  v_mfma_f32_16x16x32_bf16 v[84:87], v[204:207], a[248:251], v[84:87]
  ds_read_b64_tr_b16 v[198:199], v22 offset:12808
  v_mfma_f32_16x16x32_bf16 v[84:87], v[176:179], v[216:219], v[84:87]
  v_mfma_f32_16x16x32_bf16 v[84:87], v[180:183], v[232:235], v[84:87]
  ds_read_b64_tr_b16 v[200:201], v22 offset:16392
  s_waitcnt vmcnt(6)
  v_add_f32 v24, v24, v25
  v_mfma_f32_16x16x32_bf16 v[100:103], v[204:207], a[252:255], v[100:103]
  ds_read_b64_tr_b16 v[202:203], v22 offset:16904
  v_add_f32 v24, v24, v26
  v_add_f32 v24, v24, v27
  v_mfma_f32_16x16x32_bf16 v[100:103], v[176:179], v[220:223], v[100:103]
  v_add_f32 v24, v24, v28
  v_add_f32 v24, v24, v29
  v_mfma_f32_16x16x32_bf16 v[100:103], v[180:183], v[236:239], v[100:103]
  ds_read_b64_tr_b16 v[204:205], v22 offset:20488
  v_add_f32 v24, v24, v30
  v_add_f32 v24, v24, v31
  s_waitcnt lgkmcnt(5)
  v_mfma_f32_16x16x32_bf16 v[56:59], v[184:187], a[240:243], v[56:59]
  v_add_f32 v24, v24, v32
  v_mov_b32 v25, 0x3727c5ac
  v_mfma_f32_16x16x32_bf16 v[56:59], v[188:191], v[208:211], v[56:59]
  ds_read_b64_tr_b16 v[206:207], v22 offset:21000
  v_fmac_f32 v25, 0x3ae38e39, v24
  v_and_b32 v26, 15, v9
  v_mfma_f32_16x16x32_bf16 v[56:59], v[192:195], v[224:227], v[56:59]
  v_lshlrev_b32 v26, 2, v26
  s_lshl_b32 s23, s55, 7
  v_add_u32 v26, s23, v26
  v_mfma_f32_16x16x32_bf16 v[72:75], v[184:187], a[244:247], v[72:75]
  v_xor_b32 v27, 128, v26
  ds_bpermute_b32 v18, v26, v25 offset:0
  v_mfma_f32_16x16x32_bf16 v[72:75], v[188:191], v[212:215], v[72:75]
  ds_bpermute_b32 v19, v26, v25 offset:64
  v_mfma_f32_16x16x32_bf16 v[72:75], v[192:195], v[228:231], v[72:75]
  ds_bpermute_b32 v20, v27, v25 offset:0
  v_mfma_f32_16x16x32_bf16 v[88:91], v[184:187], a[248:251], v[88:91]
  ds_bpermute_b32 v21, v27, v25 offset:64
  v_mfma_f32_16x16x32_bf16 v[88:91], v[188:191], v[216:219], v[88:91]
  v_mfma_f32_16x16x32_bf16 v[88:91], v[192:195], v[232:235], v[88:91]
  v_mfma_f32_16x16x32_bf16 v[104:107], v[184:187], a[252:255], v[104:107]
  s_waitcnt lgkmcnt(4)
  s_barrier
  v_add_u32 v23, 81920, v23
  ds_read_b64_tr_b16 v[176:177], v23 offset:0
  v_mfma_f32_16x16x32_bf16 v[104:107], v[188:191], v[220:223], v[104:107]
  ds_read_b64_tr_b16 v[178:179], v23 offset:256
  s_add_u32 m0, s22, 131072
  s_waitcnt lgkmcnt(2)
  v_mfma_f32_16x16x32_bf16 v[104:107], v[192:195], v[236:239], v[104:107]
  ds_read_b64_tr_b16 v[180:181], v23 offset:2048
  s_add_u32 s24, s21, 3538944
  v_rsq_f32 v28, v18
  v_mfma_f32_16x16x32_bf16 v[60:63], v[196:199], a[240:243], v[60:63]
  ds_read_b64_tr_b16 v[182:183], v23 offset:2304
  v_mfma_f32_16x16x32_bf16 v[60:63], v[200:203], v[208:211], v[60:63]
  ds_read_b64_tr_b16 v[184:185], v23 offset:4096
  buffer_load_dwordx4 v7, s[40:43], s24 offen  lds
  v_mfma_f32_16x16x32_bf16 v[60:63], v[204:207], v[224:227], v[60:63]
  ds_read_b64_tr_b16 v[186:187], v23 offset:4352
  s_add_u32 m0, s22, 132096
  v_rsq_f32 v29, v19
  v_mfma_f32_16x16x32_bf16 v[76:79], v[196:199], a[244:247], v[76:79]
  ds_read_b64_tr_b16 v[188:189], v23 offset:8
  v_rsq_f32 v30, v20
  v_mfma_f32_16x16x32_bf16 v[76:79], v[200:203], v[212:215], v[76:79]
  ds_read_b64_tr_b16 v[190:191], v23 offset:264
  s_add_u32 s24, s21, 3686400
  v_mfma_f32_16x16x32_bf16 v[76:79], v[204:207], v[228:231], v[76:79]
  ds_read_b64_tr_b16 v[192:193], v23 offset:2056
  v_rsq_f32 v31, v21
  v_mfma_f32_16x16x32_bf16 v[92:95], v[196:199], a[248:251], v[92:95]
  ds_read_b64_tr_b16 v[194:195], v23 offset:2312
  v_mul_f32 v10, 0xc0135761, v28
  v_mfma_f32_16x16x32_bf16 v[92:95], v[200:203], v[216:219], v[92:95]
  buffer_load_dwordx4 v7, s[40:43], s24 offen  lds
  s_add_u32 m0, s22, 133120
  v_mfma_f32_16x16x32_bf16 v[92:95], v[204:207], v[232:235], v[92:95]
  v_mul_f32 v11, 0xc0135761, v29
  v_mul_f32 v12, 0xc0135761, v30
  v_mul_f32 v13, 0xc0135761, v31
  v_mfma_f32_16x16x32_bf16 v[108:111], v[196:199], a[252:255], v[108:111]
  ds_read_b64_tr_b16 v[196:197], v23 offset:4104
  s_add_u32 s24, s21, 3833856
  v_mul_f32 v32, v28, v28
  v_mul_f32 v33, v29, v29
  v_mfma_f32_16x16x32_bf16 v[108:111], v[200:203], v[220:223], v[108:111]
  ds_read_b64_tr_b16 v[198:199], v23 offset:4360
  buffer_load_dwordx4 v7, s[40:43], s24 offen  lds
  v_mfma_f32_16x16x32_bf16 v[108:111], v[204:207], v[236:239], v[108:111]
  ds_read_b64_tr_b16 v[200:201], v23 offset:6144
  v_mul_f32 v34, v30, v30
  v_mul_f32 v35, v31, v31
  s_waitcnt lgkmcnt(7)
  v_mfma_f32_16x16x32_bf16 v[112:115], v[184:187], a[32:35], 0
  ds_read_b64_tr_b16 v[202:203], v23 offset:6400
  s_add_u32 m0, s22, 143360
  v_mul_f32 v14, 0x3d372713, v10
  v_mfma_f32_16x16x32_bf16 v[112:115], v[180:183], a[16:19], v[112:115]
  ds_read_b64_tr_b16 v[204:205], v23 offset:8192
  v_mul_f32 v15, 0x3d372713, v11
  v_mul_f32 v16, 0x3d372713, v12
  v_mfma_f32_16x16x32_bf16 v[112:115], v[176:179], a[0:3], v[112:115]
  ds_read_b64_tr_b16 v[206:207], v23 offset:8448
  s_add_u32 s24, s21, 3538944
  v_mul_f32 v17, 0x3d372713, v13
  v_mfma_f32_16x16x32_bf16 v[128:131], v[176:179], a[4:7], 0
  ds_read_b64_tr_b16 v[176:177], v23 offset:10240
  buffer_load_dwordx4 v7, s[44:47], s24 offen  lds
  v_mfma_f32_16x16x32_bf16 v[128:131], v[180:183], a[20:23], v[128:131]
  ds_read_b64_tr_b16 v[178:179], v23 offset:10496
  v_mul_f32 v14, v14, v32
  v_mul_f32 v15, v15, v33
  v_mfma_f32_16x16x32_bf16 v[128:131], v[184:187], a[36:39], v[128:131]
  ds_read_b64_tr_b16 v[180:181], v23 offset:6152
  s_add_u32 m0, s22, 144384
  v_mul_f32 v16, v16, v34
  v_mul_f32 v17, v17, v35
  s_waitcnt lgkmcnt(7)
  v_mfma_f32_16x16x32_bf16 v[116:119], v[196:199], a[32:35], 0
  ds_read_b64_tr_b16 v[182:183], v23 offset:6408
  s_add_u32 s24, s21, 3686400
  v_mfma_f32_16x16x32_bf16 v[116:119], v[192:195], a[16:19], v[116:119]
  ds_read_b64_tr_b16 v[184:185], v23 offset:8200
  v_mfma_f32_16x16x32_bf16 v[116:119], v[188:191], a[0:3], v[116:119]
  ds_read_b64_tr_b16 v[186:187], v23 offset:8456
  buffer_load_dwordx4 v7, s[44:47], s24 offen  lds
  v_mfma_f32_16x16x32_bf16 v[132:135], v[188:191], a[4:7], 0
  ds_read_b64_tr_b16 v[188:189], v23 offset:10248
  v_mfma_f32_16x16x32_bf16 v[132:135], v[192:195], a[20:23], v[132:135]
  ds_read_b64_tr_b16 v[190:191], v23 offset:10504
  s_add_u32 m0, s22, 145408
  v_mfma_f32_16x16x32_bf16 v[132:135], v[196:199], a[36:39], v[132:135]
  ds_read_b64_tr_b16 v[192:193], v23 offset:12288
  s_add_u32 s24, s21, 3833856
  v_mul_f32 v24, v48, v48
  s_add_u32 s31, s10, 0
  s_waitcnt lgkmcnt(7)
  v_mfma_f32_16x16x32_bf16 v[112:115], v[176:179], a[80:83], v[112:115]
  ds_read_b64_tr_b16 v[194:195], v23 offset:12544
  v_mul_f32 v25, v49, v49
  v_mul_f32 v26, v50, v50
  v_mfma_f32_16x16x32_bf16 v[112:115], v[204:207], a[64:67], v[112:115]
  ds_read_b64_tr_b16 v[196:197], v23 offset:14336
  buffer_load_dwordx4 v7, s[44:47], s24 offen  lds
  v_mfma_f32_16x16x32_bf16 v[112:115], v[200:203], a[48:51], v[112:115]
  ds_read_b64_tr_b16 v[198:199], v23 offset:14592
  s_add_u32 m0, s22, 57344
  v_mul_f32 v27, v51, v51
  v_fma_f32 v24, v24, v14, v10
  v_mfma_f32_16x16x32_bf16 v[128:131], v[200:203], a[52:55], v[128:131]
  ds_read_b64_tr_b16 v[200:201], v23 offset:16384
  v_fma_f32 v25, v25, v14, v10
  v_mfma_f32_16x16x32_bf16 v[128:131], v[204:207], a[68:71], v[128:131]
  ds_read_b64_tr_b16 v[202:203], v23 offset:16640
  s_add_u32 s24, s20, 128
  v_fma_f32 v26, v26, v14, v10
  v_fma_f32 v27, v27, v14, v10
  v_mfma_f32_16x16x32_bf16 v[128:131], v[176:179], a[84:87], v[128:131]
  ds_read_b64_tr_b16 v[204:205], v23 offset:12296
  v_mul_f32 v24, v24, v48
  s_waitcnt lgkmcnt(7)
  v_mfma_f32_16x16x32_bf16 v[116:119], v[188:191], a[80:83], v[116:119]
  ds_read_b64_tr_b16 v[206:207], v23 offset:12552
  buffer_load_dwordx4 v240, s[40:43], s24 offen offset:0  lds
  v_mfma_f32_16x16x32_bf16 v[116:119], v[184:187], a[64:67], v[116:119]
  ds_read_b64_tr_b16 v[176:177], v23 offset:14344
  buffer_load_dwordx4 v241, s[40:43], s24 offen offset:1024  lds
  v_mfma_f32_16x16x32_bf16 v[116:119], v[180:183], a[48:51], v[116:119]
  ds_read_b64_tr_b16 v[178:179], v23 offset:14600
  v_mul_f32 v25, v25, v49
  v_exp_f32 v24, v24
  v_mfma_f32_16x16x32_bf16 v[132:135], v[180:183], a[52:55], v[132:135]
  ds_read_b64_tr_b16 v[180:181], v23 offset:16392
  buffer_load_dwordx4 v242, s[40:43], s24 offen offset:2048  lds
  v_mfma_f32_16x16x32_bf16 v[132:135], v[184:187], a[68:71], v[132:135]
  ds_read_b64_tr_b16 v[182:183], v23 offset:16648
  s_add_u32 m0, s22, 69632
  v_exp_f32 v25, v25
  v_mfma_f32_16x16x32_bf16 v[132:135], v[188:191], a[84:87], v[132:135]
  ds_read_b64_tr_b16 v[184:185], v23 offset:18432
  v_mul_f32 v26, v26, v50
  s_waitcnt lgkmcnt(7)
  v_mfma_f32_16x16x32_bf16 v[120:123], v[200:203], a[32:35], 0
  ds_read_b64_tr_b16 v[186:187], v23 offset:18688
  buffer_load_dwordx4 v240, s[44:47], s24 offen offset:0  lds
  v_mfma_f32_16x16x32_bf16 v[120:123], v[196:199], a[16:19], v[120:123]
  ds_read_b64_tr_b16 v[188:189], v23 offset:20480
  v_exp_f32 v26, v26
  v_mfma_f32_16x16x32_bf16 v[120:123], v[192:195], a[0:3], v[120:123]
  ds_read_b64_tr_b16 v[190:191], v23 offset:20736
  buffer_load_dwordx4 v241, s[44:47], s24 offen offset:1024  lds
  v_mfma_f32_16x16x32_bf16 v[136:139], v[192:195], a[4:7], 0
  ds_read_b64_tr_b16 v[192:193], v23 offset:22528
  buffer_load_dwordx4 v242, s[44:47], s24 offen offset:2048  lds
  v_mfma_f32_16x16x32_bf16 v[136:139], v[196:199], a[20:23], v[136:139]
  ds_read_b64_tr_b16 v[194:195], v23 offset:22784
  v_mul_f32 v27, v27, v51
  v_mul_f32 v28, v48, v56
  v_mfma_f32_16x16x32_bf16 v[136:139], v[200:203], a[36:39], v[136:139]
  ds_read_b64_tr_b16 v[196:197], v23 offset:18440
  v_exp_f32 v27, v27
  s_waitcnt lgkmcnt(7)
  v_mfma_f32_16x16x32_bf16 v[124:127], v[180:183], a[32:35], 0
  ds_read_b64_tr_b16 v[198:199], v23 offset:18696
  v_mul_f32 v29, v49, v57
  v_mul_f32 v30, v50, v58
  v_mfma_f32_16x16x32_bf16 v[124:127], v[176:179], a[16:19], v[124:127]
  ds_read_b64_tr_b16 v[200:201], v23 offset:20488
  v_mul_f32 v31, v51, v59
  v_mfma_f32_16x16x32_bf16 v[124:127], v[204:207], a[0:3], v[124:127]
  ds_read_b64_tr_b16 v[202:203], v23 offset:20744
  v_fma_f32 v24, v24, v18, v18
  v_fma_f32 v25, v25, v18, v18
  v_mfma_f32_16x16x32_bf16 v[140:143], v[204:207], a[4:7], 0
  ds_read_b64_tr_b16 v[204:205], v23 offset:22536
  v_fma_f32 v26, v26, v18, v18
  v_mfma_f32_16x16x32_bf16 v[140:143], v[176:179], a[20:23], v[140:143]
  ds_read_b64_tr_b16 v[206:207], v23 offset:22792
  v_rcp_f32 v24, v24
  v_mfma_f32_16x16x32_bf16 v[140:143], v[180:183], a[36:39], v[140:143]
  v_rcp_f32 v25, v25
  s_waitcnt lgkmcnt(6)
  v_mfma_f32_16x16x32_bf16 v[120:123], v[192:195], a[80:83], v[120:123]
  v_fma_f32 v27, v27, v18, v18
  v_rcp_f32 v26, v26
  v_mfma_f32_16x16x32_bf16 v[120:123], v[188:191], a[64:67], v[120:123]
  v_rcp_f32 v27, v27
  v_mfma_f32_16x16x32_bf16 v[120:123], v[184:187], a[48:51], v[120:123]
  v_mul_f32 v28, v28, v24
  v_mul_f32 v29, v29, v25
  v_mul_f32 v30, v30, v26
  v_mfma_f32_16x16x32_bf16 v[136:139], v[184:187], a[52:55], v[136:139]
  s_waitcnt vmcnt(12) lgkmcnt(0)
  s_barrier
  v_add_u32 v23, 24576, v23
  ds_read_b64_tr_b16 v[176:177], v23 offset:0
  v_mfma_f32_16x16x32_bf16 v[136:139], v[188:191], a[68:71], v[136:139]
  ds_read_b64_tr_b16 v[178:179], v23 offset:256
  ds_read_b64_tr_b16 v[180:181], v23 offset:2048
  s_add_u32 m0, s22, 81920
  v_mul_f32 v31, v31, v27
  v_mfma_f32_16x16x32_bf16 v[136:139], v[192:195], a[84:87], v[136:139]
  ds_read_b64_tr_b16 v[182:183], v23 offset:2304
  ds_read_b64_tr_b16 v[184:185], v23 offset:4096
  v_mfma_f32_16x16x32_bf16 v[124:127], v[204:207], a[80:83], v[124:127]
  ds_read_b64_tr_b16 v[186:187], v23 offset:4352
  v_cvt_pk_bf16_f32 v40, v28, v29
  v_cvt_pk_bf16_f32 v41, v30, v31
  v_mfma_f32_16x16x32_bf16 v[124:127], v[200:203], a[64:67], v[124:127]
  ds_read_b64_tr_b16 v[188:189], v23 offset:8
  s_add_u32 s24, s20, 884864
  v_mul_f32 v32, v52, v52
  v_mfma_f32_16x16x32_bf16 v[124:127], v[196:199], a[48:51], v[124:127]
  ds_read_b64_tr_b16 v[190:191], v23 offset:264
  v_mul_f32 v33, v53, v53
  v_mul_f32 v34, v54, v54
  v_mfma_f32_16x16x32_bf16 v[140:143], v[196:199], a[52:55], v[140:143]
  ds_read_b64_tr_b16 v[192:193], v23 offset:2056
  v_mul_f32 v35, v55, v55
  v_mfma_f32_16x16x32_bf16 v[140:143], v[200:203], a[68:71], v[140:143]
  ds_read_b64_tr_b16 v[194:195], v23 offset:2312
  ds_read_b64_tr_b16 v[196:197], v23 offset:4104
  v_fma_f32 v32, v32, v14, v10
  v_mfma_f32_16x16x32_bf16 v[140:143], v[204:207], a[84:87], v[140:143]
  ds_read_b64_tr_b16 v[198:199], v23 offset:4360
  buffer_load_dwordx4 v240, s[40:43], s24 offen offset:0  lds
  s_waitcnt lgkmcnt(6)
  v_mfma_f32_16x16x32_bf16 v[112:115], v[184:187], a[128:131], v[112:115]
  ds_read_b64_tr_b16 v[200:201], v23 offset:6144
  v_fma_f32 v33, v33, v14, v10
  v_fma_f32 v34, v34, v14, v10
  v_mfma_f32_16x16x32_bf16 v[112:115], v[180:183], a[112:115], v[112:115]
  ds_read_b64_tr_b16 v[202:203], v23 offset:6400
  v_fma_f32 v35, v35, v14, v10
  v_mfma_f32_16x16x32_bf16 v[112:115], v[176:179], a[96:99], v[112:115]
  ds_read_b64_tr_b16 v[204:205], v23 offset:8192
  buffer_load_dwordx4 v241, s[40:43], s24 offen offset:1024  lds
  v_mfma_f32_16x16x32_bf16 v[128:131], v[176:179], a[100:103], v[128:131]
  ds_read_b64_tr_b16 v[206:207], v23 offset:8448
  v_mul_f32 v32, v32, v52
  v_mul_f32 v33, v33, v53
  v_mfma_f32_16x16x32_bf16 v[128:131], v[180:183], a[116:119], v[128:131]
  ds_read_b64_tr_b16 v[176:177], v23 offset:10240
  ds_read_b64_tr_b16 v[178:179], v23 offset:10496
  v_mul_f32 v34, v34, v54
  v_mfma_f32_16x16x32_bf16 v[128:131], v[184:187], a[132:135], v[128:131]
  ds_read_b64_tr_b16 v[180:181], v23 offset:6152
  buffer_load_dwordx4 v242, s[40:43], s24 offen offset:2048  lds
  s_waitcnt lgkmcnt(7)
  v_mfma_f32_16x16x32_bf16 v[116:119], v[196:199], a[128:131], v[116:119]
  ds_read_b64_tr_b16 v[182:183], v23 offset:6408
  v_exp_f32 v32, v32
  v_mfma_f32_16x16x32_bf16 v[116:119], v[192:195], a[112:115], v[116:119]
  ds_read_b64_tr_b16 v[184:185], v23 offset:8200
  v_mul_f32 v35, v35, v55
  v_mfma_f32_16x16x32_bf16 v[116:119], v[188:191], a[96:99], v[116:119]
  ds_read_b64_tr_b16 v[186:187], v23 offset:8456
  v_exp_f32 v33, v33
  v_mfma_f32_16x16x32_bf16 v[132:135], v[188:191], a[100:103], v[132:135]
  ds_read_b64_tr_b16 v[188:189], v23 offset:10248
  s_add_u32 m0, s22, 94208
  v_mul_f32 v36, v52, v60
  v_mfma_f32_16x16x32_bf16 v[132:135], v[192:195], a[116:119], v[132:135]
  ds_read_b64_tr_b16 v[190:191], v23 offset:10504
  v_exp_f32 v34, v34
  v_mfma_f32_16x16x32_bf16 v[132:135], v[196:199], a[132:135], v[132:135]
  ds_read_b64_tr_b16 v[192:193], v23 offset:12288
  v_mul_f32 v37, v53, v61
  s_waitcnt lgkmcnt(7)
  v_mfma_f32_16x16x32_bf16 v[112:115], v[176:179], a[176:179], v[112:115]
  ds_read_b64_tr_b16 v[194:195], v23 offset:12544
  buffer_load_dwordx4 v240, s[44:47], s24 offen offset:0  lds
  v_mfma_f32_16x16x32_bf16 v[112:115], v[204:207], a[160:163], v[112:115]
  ds_read_b64_tr_b16 v[196:197], v23 offset:14336
  v_exp_f32 v35, v35
  v_mfma_f32_16x16x32_bf16 v[112:115], v[200:203], a[144:147], v[112:115]
  ds_read_b64_tr_b16 v[198:199], v23 offset:14592
  v_mul_f32 v38, v54, v62
  v_mul_f32 v39, v55, v63
  v_mfma_f32_16x16x32_bf16 v[128:131], v[200:203], a[148:151], v[128:131]
  ds_read_b64_tr_b16 v[200:201], v23 offset:16384
  v_fma_f32 v32, v32, v18, v18
  v_mfma_f32_16x16x32_bf16 v[128:131], v[204:207], a[164:167], v[128:131]
  ds_read_b64_tr_b16 v[202:203], v23 offset:16640
  buffer_load_dwordx4 v241, s[44:47], s24 offen offset:1024  lds
  v_mfma_f32_16x16x32_bf16 v[128:131], v[176:179], a[180:183], v[128:131]
  ds_read_b64_tr_b16 v[204:205], v23 offset:12296
  v_rcp_f32 v32, v32
  s_waitcnt lgkmcnt(7)
  v_mfma_f32_16x16x32_bf16 v[116:119], v[188:191], a[176:179], v[116:119]
  ds_read_b64_tr_b16 v[206:207], v23 offset:12552
  v_fma_f32 v33, v33, v18, v18
  v_fma_f32 v34, v34, v18, v18
  v_mfma_f32_16x16x32_bf16 v[116:119], v[184:187], a[160:163], v[116:119]
  ds_read_b64_tr_b16 v[176:177], v23 offset:14344
  buffer_load_dwordx4 v242, s[44:47], s24 offen offset:2048  lds
  v_mfma_f32_16x16x32_bf16 v[116:119], v[180:183], a[144:147], v[116:119]
  ds_read_b64_tr_b16 v[178:179], v23 offset:14600
  v_rcp_f32 v33, v33
  v_mfma_f32_16x16x32_bf16 v[132:135], v[180:183], a[148:151], v[132:135]
  ds_read_b64_tr_b16 v[180:181], v23 offset:16392
  v_fma_f32 v35, v35, v18, v18
  v_mfma_f32_16x16x32_bf16 v[132:135], v[184:187], a[164:167], v[132:135]
  ds_read_b64_tr_b16 v[182:183], v23 offset:16648
  v_rcp_f32 v34, v34
  v_mfma_f32_16x16x32_bf16 v[132:135], v[188:191], a[180:183], v[132:135]
  ds_read_b64_tr_b16 v[184:185], v23 offset:18432
  v_mul_f32 v36, v36, v32
  s_waitcnt lgkmcnt(7)
  v_mfma_f32_16x16x32_bf16 v[120:123], v[200:203], a[128:131], v[120:123]
  ds_read_b64_tr_b16 v[186:187], v23 offset:18688
  v_rcp_f32 v35, v35
  v_mfma_f32_16x16x32_bf16 v[120:123], v[196:199], a[112:115], v[120:123]
  ds_read_b64_tr_b16 v[188:189], v23 offset:20480
  v_mul_f32 v37, v37, v33
  v_mfma_f32_16x16x32_bf16 v[120:123], v[192:195], a[96:99], v[120:123]
  ds_read_b64_tr_b16 v[190:191], v23 offset:20736
  v_mul_f32 v38, v38, v34
  v_mul_f32 v39, v39, v35
  v_mfma_f32_16x16x32_bf16 v[136:139], v[192:195], a[100:103], v[136:139]
  ds_read_b64_tr_b16 v[192:193], v23 offset:22528
L_pad2:
  s_cbranch_execz L_pad3
  v_cvt_pk_bf16_f32 v42, v36, v37
  v_mfma_f32_16x16x32_bf16 v[136:139], v[196:199], a[116:119], v[136:139]
  ds_read_b64_tr_b16 v[194:195], v23 offset:22784
  v_cvt_pk_bf16_f32 v43, v38, v39
  v_mul_f32 v24, v64, v64
  v_mfma_f32_16x16x32_bf16 v[136:139], v[200:203], a[132:135], v[136:139]
  ds_read_b64_tr_b16 v[196:197], v23 offset:18440
  v_mul_f32 v25, v65, v65
  s_waitcnt lgkmcnt(7)
  v_mfma_f32_16x16x32_bf16 v[124:127], v[180:183], a[128:131], v[124:127]
  ds_read_b64_tr_b16 v[198:199], v23 offset:18696
  ds_write_b128 v4, v[40:43] offset:0
  v_mfma_f32_16x16x32_bf16 v[124:127], v[176:179], a[112:115], v[124:127]
  ds_read_b64_tr_b16 v[200:201], v23 offset:20488
  v_mul_f32 v26, v66, v66
  v_mfma_f32_16x16x32_bf16 v[124:127], v[204:207], a[96:99], v[124:127]
  ds_read_b64_tr_b16 v[202:203], v23 offset:20744
  buffer_store_dwordx4 v[40:43], v4, s[12:15], s31 offen offset:0 sc1
  v_mfma_f32_16x16x32_bf16 v[140:143], v[204:207], a[100:103], v[140:143]
  ds_read_b64_tr_b16 v[204:205], v23 offset:22536
  v_mul_f32 v27, v67, v67
  v_mfma_f32_16x16x32_bf16 v[140:143], v[176:179], a[116:119], v[140:143]
  ds_read_b64_tr_b16 v[206:207], v23 offset:22792
  v_fma_f32 v24, v24, v15, v11
  v_fma_f32 v25, v25, v15, v11
  v_mfma_f32_16x16x32_bf16 v[140:143], v[180:183], a[132:135], v[140:143]
  v_fma_f32 v26, v26, v15, v11
  v_fma_f32 v27, v27, v15, v11
  s_waitcnt lgkmcnt(7)
  v_mfma_f32_16x16x32_bf16 v[120:123], v[192:195], a[176:179], v[120:123]
  v_mul_f32 v24, v24, v64
  v_mul_f32 v25, v25, v65
  v_mul_f32 v26, v26, v66
  v_mfma_f32_16x16x32_bf16 v[120:123], v[188:191], a[160:163], v[120:123]
  v_exp_f32 v24, v24
  v_mfma_f32_16x16x32_bf16 v[120:123], v[184:187], a[144:147], v[120:123]
  v_mul_f32 v27, v27, v67
  v_exp_f32 v25, v25
  v_mfma_f32_16x16x32_bf16 v[136:139], v[184:187], a[148:151], v[136:139]
  s_waitcnt vmcnt(13) lgkmcnt(0)
  s_barrier
  v_add_u32 v23, 24576, v23
  ds_read_b64_tr_b16 v[176:177], v23 offset:0
  v_mfma_f32_16x16x32_bf16 v[136:139], v[188:191], a[164:167], v[136:139]
  ds_read_b64_tr_b16 v[178:179], v23 offset:256
  ds_read_b64_tr_b16 v[180:181], v23 offset:2048
  s_add_u32 m0, s22, 106496
  v_mul_f32 v28, v64, v72
  v_mfma_f32_16x16x32_bf16 v[136:139], v[192:195], a[180:183], v[136:139]
  ds_read_b64_tr_b16 v[182:183], v23 offset:2304
  ds_read_b64_tr_b16 v[184:185], v23 offset:4096
  v_mfma_f32_16x16x32_bf16 v[124:127], v[204:207], a[176:179], v[124:127]
  ds_read_b64_tr_b16 v[186:187], v23 offset:4352
  v_exp_f32 v26, v26
  v_mfma_f32_16x16x32_bf16 v[124:127], v[200:203], a[160:163], v[124:127]
  ds_read_b64_tr_b16 v[188:189], v23 offset:8
  s_add_u32 s24, s20, 1769600
  v_mul_f32 v29, v65, v73
  v_mfma_f32_16x16x32_bf16 v[124:127], v[196:199], a[144:147], v[124:127]
  ds_read_b64_tr_b16 v[190:191], v23 offset:264
  v_exp_f32 v27, v27
  v_mfma_f32_16x16x32_bf16 v[140:143], v[196:199], a[148:151], v[140:143]
  ds_read_b64_tr_b16 v[192:193], v23 offset:2056
  v_mul_f32 v30, v66, v74
  v_mfma_f32_16x16x32_bf16 v[140:143], v[200:203], a[164:167], v[140:143]
  ds_read_b64_tr_b16 v[194:195], v23 offset:2312
  ds_read_b64_tr_b16 v[196:197], v23 offset:4104
  v_mul_f32 v31, v67, v75
  v_mfma_f32_16x16x32_bf16 v[140:143], v[204:207], a[180:183], v[140:143]
  ds_read_b64_tr_b16 v[198:199], v23 offset:4360
  buffer_load_dwordx4 v240, s[40:43], s24 offen offset:0  lds
  s_waitcnt lgkmcnt(6)
  v_mfma_f32_16x16x32_bf16 v[112:115], v[184:187], a[224:227], v[112:115]
  ds_read_b64_tr_b16 v[200:201], v23 offset:6144
  v_fma_f32 v24, v24, v19, v19
  v_fma_f32 v25, v25, v19, v19
  v_mfma_f32_16x16x32_bf16 v[112:115], v[180:183], a[208:211], v[112:115]
  ds_read_b64_tr_b16 v[202:203], v23 offset:6400
  v_fma_f32 v26, v26, v19, v19
  v_mfma_f32_16x16x32_bf16 v[112:115], v[176:179], a[192:195], v[112:115]
  ds_read_b64_tr_b16 v[204:205], v23 offset:8192
  buffer_load_dwordx4 v241, s[40:43], s24 offen offset:1024  lds
  v_mfma_f32_16x16x32_bf16 v[128:131], v[176:179], a[196:199], v[128:131]
  ds_read_b64_tr_b16 v[206:207], v23 offset:8448
  v_rcp_f32 v24, v24
  v_mfma_f32_16x16x32_bf16 v[128:131], v[180:183], a[212:215], v[128:131]
  ds_read_b64_tr_b16 v[176:177], v23 offset:10240
  ds_read_b64_tr_b16 v[178:179], v23 offset:10496
  v_fma_f32 v27, v27, v19, v19
  v_mfma_f32_16x16x32_bf16 v[128:131], v[184:187], a[228:231], v[128:131]
  ds_read_b64_tr_b16 v[180:181], v23 offset:6152
  buffer_load_dwordx4 v242, s[40:43], s24 offen offset:2048  lds
  s_waitcnt lgkmcnt(7)
  v_mfma_f32_16x16x32_bf16 v[116:119], v[196:199], a[224:227], v[116:119]
  ds_read_b64_tr_b16 v[182:183], v23 offset:6408
  v_rcp_f32 v25, v25
  v_mfma_f32_16x16x32_bf16 v[116:119], v[192:195], a[208:211], v[116:119]
  ds_read_b64_tr_b16 v[184:185], v23 offset:8200
  v_mul_f32 v28, v28, v24
  v_mfma_f32_16x16x32_bf16 v[116:119], v[188:191], a[192:195], v[116:119]
  ds_read_b64_tr_b16 v[186:187], v23 offset:8456
  v_rcp_f32 v26, v26
  v_mfma_f32_16x16x32_bf16 v[132:135], v[188:191], a[196:199], v[132:135]
  ds_read_b64_tr_b16 v[188:189], v23 offset:10248
  s_add_u32 m0, s22, 118784
  v_mul_f32 v29, v29, v25
  v_mfma_f32_16x16x32_bf16 v[132:135], v[192:195], a[212:215], v[132:135]
  ds_read_b64_tr_b16 v[190:191], v23 offset:10504
  v_rcp_f32 v27, v27
  v_mfma_f32_16x16x32_bf16 v[132:135], v[196:199], a[228:231], v[132:135]
  ds_read_b64_tr_b16 v[192:193], v23 offset:12288
  v_mul_f32 v30, v30, v26
  s_waitcnt lgkmcnt(7)
  v_mfma_f32_16x16x32_bf16 v[112:115], v[176:179], v[224:227], v[112:115]
  ds_read_b64_tr_b16 v[194:195], v23 offset:12544
  buffer_load_dwordx4 v240, s[44:47], s24 offen offset:0  lds
  v_mfma_f32_16x16x32_bf16 v[112:115], v[204:207], v[208:211], v[112:115]
  ds_read_b64_tr_b16 v[196:197], v23 offset:14336
  v_mul_f32 v31, v31, v27
  v_cvt_pk_bf16_f32 v44, v28, v29
  v_mfma_f32_16x16x32_bf16 v[112:115], v[200:203], a[240:243], v[112:115]
  ds_read_b64_tr_b16 v[198:199], v23 offset:14592
  v_cvt_pk_bf16_f32 v45, v30, v31
  v_mul_f32 v32, v68, v68
  v_mfma_f32_16x16x32_bf16 v[128:131], v[200:203], a[244:247], v[128:131]
  ds_read_b64_tr_b16 v[200:201], v23 offset:16384
  v_mul_f32 v33, v69, v69
  v_mfma_f32_16x16x32_bf16 v[128:131], v[204:207], v[212:215], v[128:131]
  ds_read_b64_tr_b16 v[202:203], v23 offset:16640
  buffer_load_dwordx4 v241, s[44:47], s24 offen offset:1024  lds
  v_mfma_f32_16x16x32_bf16 v[128:131], v[176:179], v[228:231], v[128:131]
  ds_read_b64_tr_b16 v[204:205], v23 offset:12296
  v_mul_f32 v34, v70, v70
  v_mul_f32 v35, v71, v71
  s_waitcnt lgkmcnt(7)
  v_mfma_f32_16x16x32_bf16 v[116:119], v[188:191], v[224:227], v[116:119]
  ds_read_b64_tr_b16 v[206:207], v23 offset:12552
  v_fma_f32 v32, v32, v15, v11
  v_fma_f32 v33, v33, v15, v11
  v_mfma_f32_16x16x32_bf16 v[116:119], v[184:187], v[208:211], v[116:119]
  ds_read_b64_tr_b16 v[176:177], v23 offset:14344
  buffer_load_dwordx4 v242, s[44:47], s24 offen offset:2048  lds
  v_mfma_f32_16x16x32_bf16 v[116:119], v[180:183], a[240:243], v[116:119]
  ds_read_b64_tr_b16 v[178:179], v23 offset:14600
  v_fma_f32 v34, v34, v15, v11
  v_fma_f32 v35, v35, v15, v11
  v_mfma_f32_16x16x32_bf16 v[132:135], v[180:183], a[244:247], v[132:135]
  ds_read_b64_tr_b16 v[180:181], v23 offset:16392
  v_mul_f32 v32, v32, v68
  v_mfma_f32_16x16x32_bf16 v[132:135], v[184:187], v[212:215], v[132:135]
  ds_read_b64_tr_b16 v[182:183], v23 offset:16648
  v_exp_f32 v32, v32
  v_mfma_f32_16x16x32_bf16 v[132:135], v[188:191], v[228:231], v[132:135]
  ds_read_b64_tr_b16 v[184:185], v23 offset:18432
  v_mul_f32 v33, v33, v69
  s_waitcnt lgkmcnt(7)
  v_mfma_f32_16x16x32_bf16 v[120:123], v[200:203], a[224:227], v[120:123]
  ds_read_b64_tr_b16 v[186:187], v23 offset:18688
  v_exp_f32 v33, v33
  v_mfma_f32_16x16x32_bf16 v[120:123], v[196:199], a[208:211], v[120:123]
  ds_read_b64_tr_b16 v[188:189], v23 offset:20480
  v_mul_f32 v34, v34, v70
  v_mfma_f32_16x16x32_bf16 v[120:123], v[192:195], a[192:195], v[120:123]
  ds_read_b64_tr_b16 v[190:191], v23 offset:20736
  v_exp_f32 v34, v34
  v_mfma_f32_16x16x32_bf16 v[136:139], v[192:195], a[196:199], v[136:139]
  ds_read_b64_tr_b16 v[192:193], v23 offset:22528
  v_mul_f32 v35, v35, v71
  v_mfma_f32_16x16x32_bf16 v[136:139], v[196:199], a[212:215], v[136:139]
  ds_read_b64_tr_b16 v[194:195], v23 offset:22784
  v_exp_f32 v35, v35
  v_mfma_f32_16x16x32_bf16 v[136:139], v[200:203], a[228:231], v[136:139]
  ds_read_b64_tr_b16 v[196:197], v23 offset:18440
  v_mul_f32 v36, v68, v76
  s_waitcnt lgkmcnt(7)
  v_mfma_f32_16x16x32_bf16 v[124:127], v[180:183], a[224:227], v[124:127]
  ds_read_b64_tr_b16 v[198:199], v23 offset:18696
  v_mul_f32 v37, v69, v77
  v_mul_f32 v38, v70, v78
  v_mfma_f32_16x16x32_bf16 v[124:127], v[176:179], a[208:211], v[124:127]
  ds_read_b64_tr_b16 v[200:201], v23 offset:20488
  v_mul_f32 v39, v71, v79
  v_mfma_f32_16x16x32_bf16 v[124:127], v[204:207], a[192:195], v[124:127]
  ds_read_b64_tr_b16 v[202:203], v23 offset:20744
  v_fma_f32 v32, v32, v19, v19
  v_fma_f32 v33, v33, v19, v19
  v_mfma_f32_16x16x32_bf16 v[140:143], v[204:207], a[196:199], v[140:143]
  ds_read_b64_tr_b16 v[204:205], v23 offset:22536
  v_fma_f32 v34, v34, v19, v19
  v_mfma_f32_16x16x32_bf16 v[140:143], v[176:179], a[212:215], v[140:143]
  ds_read_b64_tr_b16 v[206:207], v23 offset:22792
  v_rcp_f32 v32, v32
  v_mfma_f32_16x16x32_bf16 v[140:143], v[180:183], a[228:231], v[140:143]
  v_rcp_f32 v33, v33
  s_waitcnt lgkmcnt(6)
  v_mfma_f32_16x16x32_bf16 v[120:123], v[192:195], v[224:227], v[120:123]
  v_fma_f32 v35, v35, v19, v19
  v_rcp_f32 v34, v34
  v_mfma_f32_16x16x32_bf16 v[120:123], v[188:191], v[208:211], v[120:123]
  v_rcp_f32 v35, v35
  v_mfma_f32_16x16x32_bf16 v[120:123], v[184:187], a[240:243], v[120:123]
  v_mul_f32 v36, v36, v32
  v_mul_f32 v37, v37, v33
  v_mul_f32 v38, v38, v34
  v_mfma_f32_16x16x32_bf16 v[136:139], v[184:187], a[244:247], v[136:139]
  s_waitcnt vmcnt(13) lgkmcnt(0)
  s_barrier
  v_add_u32 v22, 4294893568, v22
  ds_read_b64_tr_b16 v[176:177], v22 offset:0
  v_mfma_f32_16x16x32_bf16 v[136:139], v[188:191], v[212:215], v[136:139]
  ds_read_b64_tr_b16 v[178:179], v22 offset:512
  ds_read_b64_tr_b16 v[180:181], v22 offset:4096
  s_add_u32 m0, s22, 131072
  v_mul_f32 v39, v39, v35
  v_mfma_f32_16x16x32_bf16 v[136:139], v[192:195], v[228:231], v[136:139]
  ds_read_b64_tr_b16 v[182:183], v22 offset:4608
  ds_read_b64_tr_b16 v[184:185], v22 offset:8192
  v_mfma_f32_16x16x32_bf16 v[124:127], v[204:207], v[224:227], v[124:127]
  ds_read_b64_tr_b16 v[186:187], v22 offset:8704
  v_cvt_pk_bf16_f32 v46, v36, v37
  v_cvt_pk_bf16_f32 v47, v38, v39
  v_mfma_f32_16x16x32_bf16 v[124:127], v[200:203], v[208:211], v[124:127]
  ds_read_b64_tr_b16 v[188:189], v22 offset:8
  s_add_u32 s24, s20, 2654336
  v_mfma_f32_16x16x32_bf16 v[124:127], v[196:199], a[240:243], v[124:127]
  ds_write_b128 v4, v[44:47] offset:256
  v_mfma_f32_16x16x32_bf16 v[140:143], v[196:199], a[244:247], v[140:143]
  ds_read_b64_tr_b16 v[190:191], v22 offset:520
  buffer_store_dwordx4 v[44:47], v4, s[12:15], s31 offen offset:256 sc1
  v_mfma_f32_16x16x32_bf16 v[140:143], v[200:203], v[212:215], v[140:143]
  buffer_load_dwordx4 v240, s[40:43], s24 offen offset:0  lds
  v_mfma_f32_16x16x32_bf16 v[140:143], v[204:207], v[228:231], v[140:143]
  ds_read_b64_tr_b16 v[192:193], v22 offset:4104
  v_mov_b32 v244, -1
  s_waitcnt lgkmcnt(4)
  v_mfma_f32_16x16x32_bf16 v[144:147], v[184:187], a[32:35], 0
  ds_read_b64_tr_b16 v[194:195], v22 offset:4616
  v_mov_b32 v245, -1
  v_mfma_f32_16x16x32_bf16 v[144:147], v[180:183], a[16:19], v[144:147]
  ds_read_b64_tr_b16 v[196:197], v22 offset:8200
  v_mov_b32 v246, -1
  v_mfma_f32_16x16x32_bf16 v[144:147], v[176:179], a[0:3], v[144:147]
  ds_read_b64_tr_b16 v[198:199], v22 offset:8712
  v_mov_b32 v247, -1
  s_lshl_b32 s26, s16, 12
  s_add_u32 s26, s26, s10
  v_mfma_f32_16x16x32_bf16 v[160:163], v[176:179], a[4:7], 0
  buffer_load_dwordx4 v241, s[40:43], s24 offen offset:1024  lds
  s_add_u32 s26, s26, 57344
  s_lshl_b32 s25, s18, 1
  v_mfma_f32_16x16x32_bf16 v[160:163], v[180:183], a[20:23], v[160:163]
  buffer_load_dwordx4 v242, s[40:43], s24 offen offset:2048  lds
  s_add_u32 s25, s25, s19
  s_mul_i32 s25, s25, 9
  v_mfma_f32_16x16x32_bf16 v[160:163], v[184:187], a[36:39], v[160:163]
  s_lshl_b32 s25, s25, 3
  s_add_u32 s25, s25, s17
  v_xor_b32 v4, 512, v4
  v_mul_f32 v24, v80, v80
  v_mfma_f32_16x16x32_bf16 v[48:51], v[184:187], a[40:43], 0
  ds_read_b64_tr_b16 v[200:201], v22 offset:12288
  s_lshl_b32 s25, s25, 2
  s_add_u32 s25, s25, s16
  v_mul_f32 v25, v81, v81
  v_mul_f32 v26, v82, v82
  v_mfma_f32_16x16x32_bf16 v[48:51], v[180:183], a[24:27], v[48:51]
  ds_read_b64_tr_b16 v[202:203], v22 offset:12800
  s_add_u32 m0, s22, 143360
  s_lshl_b32 s25, s25, 11
  v_mul_f32 v27, v83, v83
  v_mfma_f32_16x16x32_bf16 v[48:51], v[176:179], a[8:11], v[48:51]
  s_add_u32 s25, s25, 27262976
  s_add_u32 s27, s17, 6
  v_fma_f32 v24, v24, v16, v12
  v_fma_f32 v25, v25, v16, v12
  v_mfma_f32_16x16x32_bf16 v[64:67], v[176:179], a[12:15], 0
  ds_read_b64_tr_b16 v[204:205], v22 offset:16384
  s_and_b32 s27, s27, 6
  s_lshl_b32 s27, s27, 16
  v_fma_f32 v26, v26, v16, v12
  v_mfma_f32_16x16x32_bf16 v[64:67], v[180:183], a[28:31], v[64:67]
  buffer_load_dwordx4 v240, s[44:47], s24 offen offset:0  lds
  s_add_u32 s100, s25, s27
  s_add_u32 s101, s100, 65536
  v_mfma_f32_16x16x32_bf16 v[64:67], v[184:187], a[44:47], v[64:67]
  ds_read_b64_tr_b16 v[206:207], v22 offset:16896
  s_xor_b32 s27, s17, 1
  s_lshl_b32 s27, s27, 16
  v_fma_f32 v27, v27, v16, v12
  s_waitcnt lgkmcnt(4)
  v_mfma_f32_16x16x32_bf16 v[148:151], v[196:199], a[32:35], 0
  s_add_u32 s25, s25, s27
  v_mul_f32 v24, v24, v80
  v_mul_f32 v25, v25, v81
  v_mfma_f32_16x16x32_bf16 v[148:151], v[192:195], a[16:19], v[148:151]
  ds_read_b64_tr_b16 v[176:177], v22 offset:20480
  v_mul_f32 v26, v26, v82
  v_mfma_f32_16x16x32_bf16 v[148:151], v[188:191], a[0:3], v[148:151]
  ds_read_b64_tr_b16 v[178:179], v22 offset:20992
  v_exp_f32 v24, v24
  v_mfma_f32_16x16x32_bf16 v[164:167], v[188:191], a[4:7], 0
  buffer_load_dwordx4 v241, s[44:47], s24 offen offset:1024  lds
  v_mfma_f32_16x16x32_bf16 v[164:167], v[192:195], a[20:23], v[164:167]
  ds_read_b64_tr_b16 v[180:181], v22 offset:12296
  v_mul_f32 v27, v27, v83
  v_mfma_f32_16x16x32_bf16 v[164:167], v[196:199], a[36:39], v[164:167]
  buffer_load_dwordx4 v242, s[44:47], s24 offen offset:2048  lds
  v_mfma_f32_16x16x32_bf16 v[52:55], v[196:199], a[40:43], 0
  ds_read_b64_tr_b16 v[182:183], v22 offset:12808
  v_mul_f32 v28, v80, v88
  v_mfma_f32_16x16x32_bf16 v[52:55], v[192:195], a[24:27], v[52:55]
  buffer_store_dwordx4 v[244:247], v1, s[12:15], s26 offen offset:0 sc1
  v_mfma_f32_16x16x32_bf16 v[52:55], v[188:191], a[8:11], v[52:55]
  ds_read_b64_tr_b16 v[184:185], v22 offset:16392
  v_mul_f32 v29, v81, v89
  v_mfma_f32_16x16x32_bf16 v[68:71], v[188:191], a[12:15], 0
  ds_read_b64_tr_b16 v[186:187], v22 offset:16904
  v_mul_f32 v30, v82, v90
  v_mfma_f32_16x16x32_bf16 v[68:71], v[192:195], a[28:31], v[68:71]
  v_exp_f32 v25, v25
  v_mul_f32 v31, v83, v91
  v_mfma_f32_16x16x32_bf16 v[68:71], v[196:199], a[44:47], v[68:71]
  ds_read_b64_tr_b16 v[188:189], v22 offset:20488
  v_fma_f32 v24, v24, v20, v20
  s_waitcnt lgkmcnt(5)
  v_mfma_f32_16x16x32_bf16 v[152:155], v[176:179], a[32:35], 0
  buffer_store_dwordx4 v[244:247], v1, s[12:15], s26 offen offset:1024 sc1
  v_mfma_f32_16x16x32_bf16 v[152:155], v[204:207], a[16:19], v[152:155]
  ds_read_b64_tr_b16 v[190:191], v22 offset:21000
  v_fma_f32 v25, v25, v20, v20
  v_mfma_f32_16x16x32_bf16 v[152:155], v[200:203], a[0:3], v[152:155]
  v_exp_f32 v26, v26
  v_mfma_f32_16x16x32_bf16 v[168:171], v[200:203], a[4:7], 0
  v_exp_f32 v27, v27
  v_mfma_f32_16x16x32_bf16 v[168:171], v[204:207], a[20:23], v[168:171]
  v_rcp_f32 v24, v24
  v_mfma_f32_16x16x32_bf16 v[168:171], v[176:179], a[36:39], v[168:171]
  v_rcp_f32 v25, v25
  v_mfma_f32_16x16x32_bf16 v[56:59], v[176:179], a[40:43], 0
  v_fma_f32 v26, v26, v20, v20
  v_fma_f32 v27, v27, v20, v20
  v_mul_f32 v28, v28, v24
  v_mfma_f32_16x16x32_bf16 v[56:59], v[204:207], a[24:27], v[56:59]
  v_rcp_f32 v26, v26
  v_mfma_f32_16x16x32_bf16 v[56:59], v[200:203], a[8:11], v[56:59]
  v_rcp_f32 v27, v27
  v_mfma_f32_16x16x32_bf16 v[72:75], v[200:203], a[12:15], 0
  s_waitcnt vmcnt(16) lgkmcnt(0)
  s_barrier
  v_add_u32 v22, 24576, v22
  ds_read_b64_tr_b16 v[192:193], v22 offset:0
  v_mfma_f32_16x16x32_bf16 v[72:75], v[204:207], a[28:31], v[72:75]
  ds_read_b64_tr_b16 v[194:195], v22 offset:512
  s_add_u32 m0, s22, 57344
  v_mul_f32 v29, v29, v25
  v_mfma_f32_16x16x32_bf16 v[72:75], v[176:179], a[44:47], v[72:75]
  v_mul_f32 v30, v30, v26
  v_mul_f32 v31, v31, v27
  v_mfma_f32_16x16x32_bf16 v[156:159], v[188:191], a[32:35], 0
  ds_read_b64_tr_b16 v[196:197], v22 offset:4096
  v_cvt_pk_bf16_f32 v40, v28, v29
  v_mfma_f32_16x16x32_bf16 v[156:159], v[184:187], a[16:19], v[156:159]
  ds_read_b64_tr_b16 v[198:199], v22 offset:4608
  s_add_u32 s24, s20, 3539072
  v_cvt_pk_bf16_f32 v41, v30, v31
  v_mfma_f32_16x16x32_bf16 v[156:159], v[180:183], a[0:3], v[156:159]
  ds_read_b64_tr_b16 v[200:201], v22 offset:8192
  v_mul_f32 v32, v84, v84
  v_mul_f32 v33, v85, v85
  v_mfma_f32_16x16x32_bf16 v[172:175], v[180:183], a[4:7], 0
  ds_read_b64_tr_b16 v[202:203], v22 offset:8704
  v_mul_f32 v34, v86, v86
  v_mfma_f32_16x16x32_bf16 v[172:175], v[184:187], a[20:23], v[172:175]
  buffer_load_dwordx4 v240, s[40:43], s24 offen offset:0  lds
  v_mfma_f32_16x16x32_bf16 v[172:175], v[188:191], a[36:39], v[172:175]
  v_mul_f32 v35, v87, v87
  v_fma_f32 v32, v32, v16, v12
  v_mfma_f32_16x16x32_bf16 v[60:63], v[188:191], a[40:43], 0
  v_fma_f32 v33, v33, v16, v12
  v_fma_f32 v34, v34, v16, v12
  v_mfma_f32_16x16x32_bf16 v[60:63], v[184:187], a[24:27], v[60:63]
  ds_read_b64_tr_b16 v[204:205], v22 offset:8
  v_fma_f32 v35, v35, v16, v12
  v_mfma_f32_16x16x32_bf16 v[60:63], v[180:183], a[8:11], v[60:63]
  buffer_load_dwordx4 v241, s[40:43], s24 offen offset:1024  lds
  v_mfma_f32_16x16x32_bf16 v[76:79], v[180:183], a[12:15], 0
  ds_read_b64_tr_b16 v[206:207], v22 offset:520
  v_mul_f32 v32, v32, v84
  v_mfma_f32_16x16x32_bf16 v[76:79], v[184:187], a[28:31], v[76:79]
  v_mul_f32 v33, v33, v85
  v_exp_f32 v32, v32
  v_mfma_f32_16x16x32_bf16 v[76:79], v[188:191], a[44:47], v[76:79]
  ds_read_b64_tr_b16 v[176:177], v22 offset:4104
  v_mul_f32 v34, v34, v86
  s_waitcnt lgkmcnt(3)
  v_mfma_f32_16x16x32_bf16 v[144:147], v[200:203], a[80:83], v[144:147]
  ds_read_b64_tr_b16 v[178:179], v22 offset:4616
  v_mul_f32 v35, v35, v87
  v_mfma_f32_16x16x32_bf16 v[144:147], v[196:199], a[64:67], v[144:147]
  ds_read_b64_tr_b16 v[180:181], v22 offset:8200
  v_mul_f32 v36, v84, v92
  v_mfma_f32_16x16x32_bf16 v[144:147], v[192:195], a[48:51], v[144:147]
  ds_read_b64_tr_b16 v[182:183], v22 offset:8712
  v_mul_f32 v37, v85, v93
  v_mfma_f32_16x16x32_bf16 v[160:163], v[192:195], a[52:55], v[160:163]
  buffer_load_dwordx4 v242, s[40:43], s24 offen offset:2048  lds
  s_add_u32 m0, s22, 69632
  v_mfma_f32_16x16x32_bf16 v[160:163], v[196:199], a[68:71], v[160:163]
  v_exp_f32 v33, v33
  v_mfma_f32_16x16x32_bf16 v[160:163], v[200:203], a[84:87], v[160:163]
  v_exp_f32 v34, v34
  v_mfma_f32_16x16x32_bf16 v[48:51], v[200:203], a[88:91], v[48:51]
  ds_read_b64_tr_b16 v[184:185], v22 offset:12288
  v_exp_f32 v35, v35
  v_mfma_f32_16x16x32_bf16 v[48:51], v[196:199], a[72:75], v[48:51]
  ds_read_b64_tr_b16 v[186:187], v22 offset:12800
  v_mul_f32 v38, v86, v94
  v_mfma_f32_16x16x32_bf16 v[48:51], v[192:195], a[56:59], v[48:51]
  buffer_load_dwordx4 v240, s[44:47], s24 offen offset:0  lds
  v_mfma_f32_16x16x32_bf16 v[64:67], v[192:195], a[60:63], v[64:67]
  ds_read_b64_tr_b16 v[188:189], v22 offset:16384
  v_mul_f32 v39, v87, v95
  v_mfma_f32_16x16x32_bf16 v[64:67], v[196:199], a[76:79], v[64:67]
  buffer_load_dwordx4 v241, s[44:47], s24 offen offset:1024  lds
  v_mfma_f32_16x16x32_bf16 v[64:67], v[200:203], a[92:95], v[64:67]
  ds_read_b64_tr_b16 v[190:191], v22 offset:16896
  v_fma_f32 v32, v32, v20, v20
  s_waitcnt lgkmcnt(4)
  v_mfma_f32_16x16x32_bf16 v[148:151], v[180:183], a[80:83], v[148:151]
  v_rcp_f32 v32, v32
  v_mfma_f32_16x16x32_bf16 v[148:151], v[176:179], a[64:67], v[148:151]
  ds_read_b64_tr_b16 v[192:193], v22 offset:20480
  v_fma_f32 v33, v33, v20, v20
  v_mfma_f32_16x16x32_bf16 v[148:151], v[204:207], a[48:51], v[148:151]
  ds_read_b64_tr_b16 v[194:195], v22 offset:20992
  v_rcp_f32 v33, v33
  v_mfma_f32_16x16x32_bf16 v[164:167], v[204:207], a[52:55], v[164:167]
  buffer_load_dwordx4 v242, s[44:47], s24 offen offset:2048  lds
  v_mfma_f32_16x16x32_bf16 v[164:167], v[176:179], a[68:71], v[164:167]
  ds_read_b64_tr_b16 v[196:197], v22 offset:12296
  v_fma_f32 v34, v34, v20, v20
  v_mfma_f32_16x16x32_bf16 v[164:167], v[180:183], a[84:87], v[164:167]
  buffer_store_dwordx4 v[244:247], v1, s[12:15], s26 offen offset:2048 sc1
  v_mfma_f32_16x16x32_bf16 v[52:55], v[180:183], a[88:91], v[52:55]
  ds_read_b64_tr_b16 v[198:199], v22 offset:12808
  v_fma_f32 v35, v35, v20, v20
  v_mfma_f32_16x16x32_bf16 v[52:55], v[176:179], a[72:75], v[52:55]
  v_rcp_f32 v34, v34
  v_mfma_f32_16x16x32_bf16 v[52:55], v[204:207], a[56:59], v[52:55]
  ds_read_b64_tr_b16 v[200:201], v22 offset:16392
  v_mul_f32 v36, v36, v32
  v_mfma_f32_16x16x32_bf16 v[68:71], v[204:207], a[60:63], v[68:71]
  ds_read_b64_tr_b16 v[202:203], v22 offset:16904
  v_mul_f32 v37, v37, v33
  v_mfma_f32_16x16x32_bf16 v[68:71], v[176:179], a[76:79], v[68:71]
  buffer_store_dwordx4 v[244:247], v1, s[12:15], s26 offen offset:3072 sc1
  v_mfma_f32_16x16x32_bf16 v[68:71], v[180:183], a[92:95], v[68:71]
  ds_read_b64_tr_b16 v[204:205], v22 offset:20488
  v_rcp_f32 v35, v35
  s_waitcnt lgkmcnt(5)
  v_mfma_f32_16x16x32_bf16 v[152:155], v[192:195], a[80:83], v[152:155]
  v_mul_f32 v38, v38, v34
  v_mul_f32 v39, v39, v35
  v_mfma_f32_16x16x32_bf16 v[152:155], v[188:191], a[64:67], v[152:155]
  ds_read_b64_tr_b16 v[206:207], v22 offset:21000
  v_cvt_pk_bf16_f32 v42, v36, v37
  v_mfma_f32_16x16x32_bf16 v[152:155], v[184:187], a[48:51], v[152:155]
  v_cvt_pk_bf16_f32 v43, v38, v39
  v_mul_f32 v24, v96, v96
  v_mfma_f32_16x16x32_bf16 v[168:171], v[184:187], a[52:55], v[168:171]
  ds_write_b128 v4, v[40:43] offset:0
  v_mfma_f32_16x16x32_bf16 v[168:171], v[188:191], a[68:71], v[168:171]
  buffer_store_dwordx4 v[40:43], v4, s[12:15], s31 offen offset:0 sc1
  v_mfma_f32_16x16x32_bf16 v[168:171], v[192:195], a[84:87], v[168:171]
  v_mul_f32 v25, v97, v97
  v_mul_f32 v26, v98, v98
  v_mfma_f32_16x16x32_bf16 v[56:59], v[192:195], a[88:91], v[56:59]
  v_mul_f32 v27, v99, v99
  v_fma_f32 v24, v24, v17, v13
  v_fma_f32 v25, v25, v17, v13
  v_mfma_f32_16x16x32_bf16 v[56:59], v[188:191], a[72:75], v[56:59]
  v_fma_f32 v26, v26, v17, v13
  v_fma_f32 v27, v27, v17, v13
  v_mfma_f32_16x16x32_bf16 v[56:59], v[184:187], a[56:59], v[56:59]
  v_mul_f32 v24, v24, v96
  v_mul_f32 v25, v25, v97
  v_mfma_f32_16x16x32_bf16 v[72:75], v[184:187], a[60:63], v[72:75]
  s_waitcnt vmcnt(18) lgkmcnt(1)
  s_barrier
  v_add_u32 v22, 24576, v22
  ds_read_b64_tr_b16 v[176:177], v22 offset:0
  v_mfma_f32_16x16x32_bf16 v[72:75], v[188:191], a[76:79], v[72:75]
  ds_read_b64_tr_b16 v[178:179], v22 offset:512
  s_add_u32 m0, s22, 81920
  v_mul_f32 v26, v26, v98
  v_mfma_f32_16x16x32_bf16 v[72:75], v[192:195], a[92:95], v[72:75]
  v_exp_f32 v24, v24
  v_mfma_f32_16x16x32_bf16 v[156:159], v[204:207], a[80:83], v[156:159]
  ds_read_b64_tr_b16 v[180:181], v22 offset:4096
  v_mul_f32 v27, v27, v99
  v_mfma_f32_16x16x32_bf16 v[156:159], v[200:203], a[64:67], v[156:159]
  ds_read_b64_tr_b16 v[182:183], v22 offset:4608
  s_add_u32 s24, s20, 4423808
  v_mul_f32 v28, v96, v104
  v_mfma_f32_16x16x32_bf16 v[156:159], v[196:199], a[48:51], v[156:159]
  ds_read_b64_tr_b16 v[184:185], v22 offset:8192
  v_exp_f32 v25, v25
  v_mfma_f32_16x16x32_bf16 v[172:175], v[196:199], a[52:55], v[172:175]
  ds_read_b64_tr_b16 v[186:187], v22 offset:8704
  v_mul_f32 v29, v97, v105
  v_mfma_f32_16x16x32_bf16 v[172:175], v[200:203], a[68:71], v[172:175]
  buffer_load_dwordx4 v240, s[40:43], s24 offen offset:0  lds
  v_mfma_f32_16x16x32_bf16 v[172:175], v[204:207], a[84:87], v[172:175]
  v_exp_f32 v26, v26
  v_mfma_f32_16x16x32_bf16 v[60:63], v[204:207], a[88:91], v[60:63]
  v_exp_f32 v27, v27
  v_mfma_f32_16x16x32_bf16 v[60:63], v[200:203], a[72:75], v[60:63]
  ds_read_b64_tr_b16 v[188:189], v22 offset:8
  v_mul_f32 v30, v98, v106
  v_mfma_f32_16x16x32_bf16 v[60:63], v[196:199], a[56:59], v[60:63]
  buffer_load_dwordx4 v241, s[40:43], s24 offen offset:1024  lds
  v_mfma_f32_16x16x32_bf16 v[76:79], v[196:199], a[60:63], v[76:79]
  ds_read_b64_tr_b16 v[190:191], v22 offset:520
  v_mul_f32 v31, v99, v107
  v_mfma_f32_16x16x32_bf16 v[76:79], v[200:203], a[76:79], v[76:79]
  v_fma_f32 v24, v24, v21, v21
  v_fma_f32 v25, v25, v21, v21
  v_fma_f32 v26, v26, v21, v21
  v_mfma_f32_16x16x32_bf16 v[76:79], v[204:207], a[92:95], v[76:79]
  ds_read_b64_tr_b16 v[192:193], v22 offset:4104
  v_fma_f32 v27, v27, v21, v21
  s_waitcnt lgkmcnt(3)
  v_mfma_f32_16x16x32_bf16 v[144:147], v[184:187], a[128:131], v[144:147]
  ds_read_b64_tr_b16 v[194:195], v22 offset:4616
  v_mul_f32 v32, v100, v100
  v_mfma_f32_16x16x32_bf16 v[144:147], v[180:183], a[112:115], v[144:147]
  ds_read_b64_tr_b16 v[196:197], v22 offset:8200
  v_mul_f32 v33, v101, v101
  v_mfma_f32_16x16x32_bf16 v[144:147], v[176:179], a[96:99], v[144:147]
  ds_read_b64_tr_b16 v[198:199], v22 offset:8712
  v_mul_f32 v34, v102, v102
  v_mfma_f32_16x16x32_bf16 v[160:163], v[176:179], a[100:103], v[160:163]
  buffer_load_dwordx4 v242, s[40:43], s24 offen offset:2048  lds
  s_add_u32 m0, s22, 94208
  v_mfma_f32_16x16x32_bf16 v[160:163], v[180:183], a[116:119], v[160:163]
  v_rcp_f32 v24, v24
  v_mfma_f32_16x16x32_bf16 v[160:163], v[184:187], a[132:135], v[160:163]
  v_rcp_f32 v25, v25
  v_mfma_f32_16x16x32_bf16 v[48:51], v[184:187], a[136:139], v[48:51]
  ds_read_b64_tr_b16 v[200:201], v22 offset:12288
  v_rcp_f32 v26, v26
  v_mfma_f32_16x16x32_bf16 v[48:51], v[180:183], a[120:123], v[48:51]
  ds_read_b64_tr_b16 v[202:203], v22 offset:12800
  v_mul_f32 v28, v28, v24
  v_mfma_f32_16x16x32_bf16 v[48:51], v[176:179], a[104:107], v[48:51]
  buffer_load_dwordx4 v240, s[44:47], s24 offen offset:0  lds
  v_mfma_f32_16x16x32_bf16 v[64:67], v[176:179], a[108:111], v[64:67]
  ds_read_b64_tr_b16 v[204:205], v22 offset:16384
  v_mul_f32 v29, v29, v25
  v_mfma_f32_16x16x32_bf16 v[64:67], v[180:183], a[124:127], v[64:67]
  buffer_load_dwordx4 v241, s[44:47], s24 offen offset:1024  lds
  v_mfma_f32_16x16x32_bf16 v[64:67], v[184:187], a[140:143], v[64:67]
  ds_read_b64_tr_b16 v[206:207], v22 offset:16896
  v_mul_f32 v30, v30, v26
  s_waitcnt lgkmcnt(4)
  v_mfma_f32_16x16x32_bf16 v[148:151], v[196:199], a[128:131], v[148:151]
  v_rcp_f32 v27, v27
  v_mfma_f32_16x16x32_bf16 v[148:151], v[192:195], a[112:115], v[148:151]
  ds_read_b64_tr_b16 v[176:177], v22 offset:20480
  v_mul_f32 v31, v31, v27
  v_mfma_f32_16x16x32_bf16 v[148:151], v[188:191], a[96:99], v[148:151]
  ds_read_b64_tr_b16 v[178:179], v22 offset:20992
  v_cvt_pk_bf16_f32 v44, v28, v29
  v_cvt_pk_bf16_f32 v45, v30, v31
  v_mfma_f32_16x16x32_bf16 v[164:167], v[188:191], a[100:103], v[164:167]
  buffer_load_dwordx4 v242, s[44:47], s24 offen offset:2048  lds
  v_mfma_f32_16x16x32_bf16 v[164:167], v[192:195], a[116:119], v[164:167]
  ds_read_b64_tr_b16 v[180:181], v22 offset:12296
  v_mul_f32 v35, v103, v103
  v_mfma_f32_16x16x32_bf16 v[164:167], v[196:199], a[132:135], v[164:167]
  buffer_store_dwordx4 v[244:247], v1, s[12:15], s25 offen offset:0 sc1
  v_mfma_f32_16x16x32_bf16 v[52:55], v[196:199], a[136:139], v[52:55]
  ds_read_b64_tr_b16 v[182:183], v22 offset:12808
  v_fma_f32 v32, v32, v17, v13
  v_mfma_f32_16x16x32_bf16 v[52:55], v[192:195], a[120:123], v[52:55]
  v_fma_f32 v33, v33, v17, v13
  v_fma_f32 v34, v34, v17, v13
  v_mfma_f32_16x16x32_bf16 v[52:55], v[188:191], a[104:107], v[52:55]
  ds_read_b64_tr_b16 v[184:185], v22 offset:16392
  v_fma_f32 v35, v35, v17, v13
  v_mfma_f32_16x16x32_bf16 v[68:71], v[188:191], a[108:111], v[68:71]
  ds_read_b64_tr_b16 v[186:187], v22 offset:16904
  v_mul_f32 v32, v32, v100
  v_mfma_f32_16x16x32_bf16 v[68:71], v[192:195], a[124:127], v[68:71]
  v_mul_f32 v33, v33, v101
  v_exp_f32 v32, v32
  v_mfma_f32_16x16x32_bf16 v[68:71], v[196:199], a[140:143], v[68:71]
  ds_read_b64_tr_b16 v[188:189], v22 offset:20488
L_pad3:
  s_cbranch_execz L_pad4
  v_mul_f32 v34, v34, v102
  s_waitcnt lgkmcnt(5)
  v_mfma_f32_16x16x32_bf16 v[152:155], v[176:179], a[128:131], v[152:155]
  v_exp_f32 v33, v33
  v_mfma_f32_16x16x32_bf16 v[152:155], v[204:207], a[112:115], v[152:155]
  ds_read_b64_tr_b16 v[190:191], v22 offset:21000
  v_mul_f32 v35, v35, v103
  v_mfma_f32_16x16x32_bf16 v[152:155], v[200:203], a[96:99], v[152:155]
  v_exp_f32 v34, v34
  v_mfma_f32_16x16x32_bf16 v[168:171], v[200:203], a[100:103], v[168:171]
  v_exp_f32 v35, v35
  v_mfma_f32_16x16x32_bf16 v[168:171], v[204:207], a[116:119], v[168:171]
  v_mul_f32 v36, v100, v108
  v_mul_f32 v37, v101, v109
  v_mfma_f32_16x16x32_bf16 v[168:171], v[176:179], a[132:135], v[168:171]
  v_mul_f32 v38, v102, v110
  v_mul_f32 v39, v103, v111
  v_mfma_f32_16x16x32_bf16 v[56:59], v[176:179], a[136:139], v[56:59]
  v_fma_f32 v32, v32, v21, v21
  v_fma_f32 v33, v33, v21, v21
  v_fma_f32 v34, v34, v21, v21
  v_mfma_f32_16x16x32_bf16 v[56:59], v[204:207], a[120:123], v[56:59]
  v_rcp_f32 v32, v32
  v_mfma_f32_16x16x32_bf16 v[56:59], v[200:203], a[104:107], v[56:59]
  v_rcp_f32 v33, v33
  v_mfma_f32_16x16x32_bf16 v[72:75], v[200:203], a[108:111], v[72:75]
  s_waitcnt vmcnt(18) lgkmcnt(0)
  s_barrier
  v_add_u32 v22, 24576, v22
  ds_read_b64_tr_b16 v[192:193], v22 offset:0
  v_mfma_f32_16x16x32_bf16 v[72:75], v[204:207], a[124:127], v[72:75]
  ds_read_b64_tr_b16 v[194:195], v22 offset:512
  s_add_u32 m0, s22, 106496
  v_fma_f32 v35, v35, v21, v21
  v_mfma_f32_16x16x32_bf16 v[72:75], v[176:179], a[140:143], v[72:75]
  v_rcp_f32 v34, v34
  v_mfma_f32_16x16x32_bf16 v[156:159], v[188:191], a[128:131], v[156:159]
  ds_read_b64_tr_b16 v[196:197], v22 offset:4096
  v_mul_f32 v36, v36, v32
  v_mfma_f32_16x16x32_bf16 v[156:159], v[184:187], a[112:115], v[156:159]
  ds_read_b64_tr_b16 v[198:199], v22 offset:4608
  s_add_u32 s24, s20, 256
  v_mul_f32 v37, v37, v33
  v_mfma_f32_16x16x32_bf16 v[156:159], v[180:183], a[96:99], v[156:159]
  ds_read_b64_tr_b16 v[200:201], v22 offset:8192
  v_rcp_f32 v35, v35
  v_mfma_f32_16x16x32_bf16 v[172:175], v[180:183], a[100:103], v[172:175]
  ds_read_b64_tr_b16 v[202:203], v22 offset:8704
  v_mul_f32 v38, v38, v34
  v_mfma_f32_16x16x32_bf16 v[172:175], v[184:187], a[116:119], v[172:175]
  buffer_load_dwordx4 v240, s[40:43], s24 offen offset:0  lds
  v_mfma_f32_16x16x32_bf16 v[172:175], v[188:191], a[132:135], v[172:175]
  v_mul_f32 v39, v39, v35
  v_cvt_pk_bf16_f32 v46, v36, v37
  v_mfma_f32_16x16x32_bf16 v[60:63], v[188:191], a[136:139], v[60:63]
  v_cvt_pk_bf16_f32 v47, v38, v39
  v_mfma_f32_16x16x32_bf16 v[60:63], v[184:187], a[120:123], v[60:63]
  ds_read_b64_tr_b16 v[204:205], v22 offset:8
  v_mfma_f32_16x16x32_bf16 v[60:63], v[180:183], a[104:107], v[60:63]
  buffer_load_dwordx4 v241, s[40:43], s24 offen offset:1024  lds
  v_mfma_f32_16x16x32_bf16 v[76:79], v[180:183], a[108:111], v[76:79]
  ds_read_b64_tr_b16 v[206:207], v22 offset:520
  v_mfma_f32_16x16x32_bf16 v[76:79], v[184:187], a[124:127], v[76:79]
  ds_write_b128 v4, v[44:47] offset:256
  v_mfma_f32_16x16x32_bf16 v[76:79], v[188:191], a[140:143], v[76:79]
  ds_read_b64_tr_b16 v[176:177], v22 offset:4104
  buffer_store_dwordx4 v[44:47], v4, s[12:15], s31 offen offset:256 sc1
  s_waitcnt lgkmcnt(4)
  v_mfma_f32_16x16x32_bf16 v[144:147], v[200:203], a[176:179], v[144:147]
  ds_read_b64_tr_b16 v[178:179], v22 offset:4616
  v_xor_b32 v4, 512, v4
  v_mfma_f32_16x16x32_bf16 v[144:147], v[196:199], a[160:163], v[144:147]
  ds_read_b64_tr_b16 v[180:181], v22 offset:8200
  s_lshl_b32 s23, s55, 13
  v_subrev_u32 v4, s23, v4
  s_add_u32 s31, s10, 32768
  v_mfma_f32_16x16x32_bf16 v[144:147], v[192:195], a[144:147], v[144:147]
  ds_read_b64_tr_b16 v[182:183], v22 offset:8712
  v_mul_f32 v24, v112, v112
  v_mfma_f32_16x16x32_bf16 v[160:163], v[192:195], a[148:151], v[160:163]
  buffer_load_dwordx4 v242, s[40:43], s24 offen offset:2048  lds
  s_add_u32 m0, s22, 118784
  v_mfma_f32_16x16x32_bf16 v[160:163], v[196:199], a[164:167], v[160:163]
  v_mul_f32 v25, v113, v113
  v_mul_f32 v26, v114, v114
  v_mfma_f32_16x16x32_bf16 v[160:163], v[200:203], a[180:183], v[160:163]
  v_mul_f32 v27, v115, v115
  v_fma_f32 v24, v24, v14, v10
  v_mfma_f32_16x16x32_bf16 v[48:51], v[200:203], a[184:187], v[48:51]
  ds_read_b64_tr_b16 v[184:185], v22 offset:12288
  v_fma_f32 v25, v25, v14, v10
  v_fma_f32 v26, v26, v14, v10
  v_mfma_f32_16x16x32_bf16 v[48:51], v[196:199], a[168:171], v[48:51]
  ds_read_b64_tr_b16 v[186:187], v22 offset:12800
  v_fma_f32 v27, v27, v14, v10
  v_mfma_f32_16x16x32_bf16 v[48:51], v[192:195], a[152:155], v[48:51]
  buffer_load_dwordx4 v240, s[44:47], s24 offen offset:0  lds
  v_mfma_f32_16x16x32_bf16 v[64:67], v[192:195], a[156:159], v[64:67]
  ds_read_b64_tr_b16 v[188:189], v22 offset:16384
  v_mul_f32 v24, v24, v112
  v_mfma_f32_16x16x32_bf16 v[64:67], v[196:199], a[172:175], v[64:67]
  buffer_load_dwordx4 v241, s[44:47], s24 offen offset:1024  lds
  v_mfma_f32_16x16x32_bf16 v[64:67], v[200:203], a[188:191], v[64:67]
  ds_read_b64_tr_b16 v[190:191], v22 offset:16896
  v_mul_f32 v25, v25, v113
  s_waitcnt lgkmcnt(4)
  v_mfma_f32_16x16x32_bf16 v[148:151], v[180:183], a[176:179], v[148:151]
  v_exp_f32 v24, v24
  v_mfma_f32_16x16x32_bf16 v[148:151], v[176:179], a[160:163], v[148:151]
  ds_read_b64_tr_b16 v[192:193], v22 offset:20480
  v_mul_f32 v26, v26, v114
  v_mfma_f32_16x16x32_bf16 v[148:151], v[204:207], a[144:147], v[148:151]
  ds_read_b64_tr_b16 v[194:195], v22 offset:20992
  v_exp_f32 v25, v25
  v_mfma_f32_16x16x32_bf16 v[164:167], v[204:207], a[148:151], v[164:167]
  buffer_load_dwordx4 v242, s[44:47], s24 offen offset:2048  lds
  v_mfma_f32_16x16x32_bf16 v[164:167], v[176:179], a[164:167], v[164:167]
  ds_read_b64_tr_b16 v[196:197], v22 offset:12296
  v_mul_f32 v27, v27, v115
  v_mfma_f32_16x16x32_bf16 v[164:167], v[180:183], a[180:183], v[164:167]
  buffer_store_dwordx4 v[244:247], v1, s[12:15], s100 offen offset:0 sc1
  v_mfma_f32_16x16x32_bf16 v[52:55], v[180:183], a[184:187], v[52:55]
  ds_read_b64_tr_b16 v[198:199], v22 offset:12808
  v_mul_f32 v28, v112, v120
  v_mfma_f32_16x16x32_bf16 v[52:55], v[176:179], a[168:171], v[52:55]
  v_exp_f32 v26, v26
  v_mfma_f32_16x16x32_bf16 v[52:55], v[204:207], a[152:155], v[52:55]
  ds_read_b64_tr_b16 v[200:201], v22 offset:16392
  v_mul_f32 v29, v113, v121
  v_mfma_f32_16x16x32_bf16 v[68:71], v[204:207], a[156:159], v[68:71]
  ds_read_b64_tr_b16 v[202:203], v22 offset:16904
  v_mul_f32 v30, v114, v122
  v_mfma_f32_16x16x32_bf16 v[68:71], v[176:179], a[172:175], v[68:71]
  buffer_store_dwordx4 v[244:247], v1, s[12:15], s25 offen offset:1024 sc1
  v_mfma_f32_16x16x32_bf16 v[68:71], v[180:183], a[188:191], v[68:71]
  ds_read_b64_tr_b16 v[204:205], v22 offset:20488
  v_exp_f32 v27, v27
  s_waitcnt lgkmcnt(5)
  v_mfma_f32_16x16x32_bf16 v[152:155], v[192:195], a[176:179], v[152:155]
  v_mul_f32 v31, v115, v123
  v_fma_f32 v24, v24, v18, v18
  v_mfma_f32_16x16x32_bf16 v[152:155], v[188:191], a[160:163], v[152:155]
  ds_read_b64_tr_b16 v[206:207], v22 offset:21000
  v_fma_f32 v25, v25, v18, v18
  v_mfma_f32_16x16x32_bf16 v[152:155], v[184:187], a[144:147], v[152:155]
  v_rcp_f32 v24, v24
  v_mfma_f32_16x16x32_bf16 v[168:171], v[184:187], a[148:151], v[168:171]
  v_rcp_f32 v25, v25
  v_mfma_f32_16x16x32_bf16 v[168:171], v[188:191], a[164:167], v[168:171]
  v_fma_f32 v26, v26, v18, v18
  v_fma_f32 v27, v27, v18, v18
  v_mfma_f32_16x16x32_bf16 v[168:171], v[192:195], a[180:183], v[168:171]
  v_rcp_f32 v26, v26
  v_mfma_f32_16x16x32_bf16 v[56:59], v[192:195], a[184:187], v[56:59]
  v_rcp_f32 v27, v27
  v_mul_f32 v28, v28, v24
  v_mfma_f32_16x16x32_bf16 v[56:59], v[188:191], a[168:171], v[56:59]
  v_mul_f32 v29, v29, v25
  v_mul_f32 v30, v30, v26
  v_mfma_f32_16x16x32_bf16 v[56:59], v[184:187], a[152:155], v[56:59]
  v_mul_f32 v31, v31, v27
  v_cvt_pk_bf16_f32 v40, v28, v29
  v_mfma_f32_16x16x32_bf16 v[72:75], v[184:187], a[156:159], v[72:75]
  s_waitcnt vmcnt(19) lgkmcnt(0)
  s_barrier
  v_add_u32 v22, 4294893568, v22
  ds_read_b64_tr_b16 v[176:177], v22 offset:0
  v_mfma_f32_16x16x32_bf16 v[72:75], v[188:191], a[172:175], v[72:75]
  ds_read_b64_tr_b16 v[178:179], v22 offset:512
  s_add_u32 m0, s22, 131072
  v_cvt_pk_bf16_f32 v41, v30, v31
  v_mfma_f32_16x16x32_bf16 v[72:75], v[192:195], a[188:191], v[72:75]
  v_mul_f32 v32, v116, v116
  v_mul_f32 v33, v117, v117
  v_mfma_f32_16x16x32_bf16 v[156:159], v[204:207], a[176:179], v[156:159]
  ds_read_b64_tr_b16 v[180:181], v22 offset:4096
  v_mul_f32 v34, v118, v118
  v_mfma_f32_16x16x32_bf16 v[156:159], v[200:203], a[160:163], v[156:159]
  ds_read_b64_tr_b16 v[182:183], v22 offset:4608
  s_add_u32 s24, s20, 884992
  v_mul_f32 v35, v119, v119
  v_mfma_f32_16x16x32_bf16 v[156:159], v[196:199], a[144:147], v[156:159]
  ds_read_b64_tr_b16 v[184:185], v22 offset:8192
  v_fma_f32 v32, v32, v14, v10
  v_fma_f32 v33, v33, v14, v10
  v_mfma_f32_16x16x32_bf16 v[172:175], v[196:199], a[148:151], v[172:175]
  ds_read_b64_tr_b16 v[186:187], v22 offset:8704
  v_fma_f32 v34, v34, v14, v10
  v_mfma_f32_16x16x32_bf16 v[172:175], v[200:203], a[164:167], v[172:175]
  buffer_load_dwordx4 v240, s[40:43], s24 offen offset:0  lds
  v_mfma_f32_16x16x32_bf16 v[172:175], v[204:207], a[180:183], v[172:175]
  v_fma_f32 v35, v35, v14, v10
  v_mul_f32 v32, v32, v116
  v_mfma_f32_16x16x32_bf16 v[60:63], v[204:207], a[184:187], v[60:63]
  v_exp_f32 v32, v32
  v_mfma_f32_16x16x32_bf16 v[60:63], v[200:203], a[168:171], v[60:63]
  ds_read_b64_tr_b16 v[188:189], v22 offset:8
  v_mul_f32 v33, v33, v117
  v_mfma_f32_16x16x32_bf16 v[60:63], v[196:199], a[152:155], v[60:63]
  buffer_load_dwordx4 v241, s[40:43], s24 offen offset:1024  lds
  v_mfma_f32_16x16x32_bf16 v[76:79], v[196:199], a[156:159], v[76:79]
  ds_read_b64_tr_b16 v[190:191], v22 offset:520
  v_mul_f32 v34, v34, v118
  v_mfma_f32_16x16x32_bf16 v[76:79], v[200:203], a[172:175], v[76:79]
  v_mul_f32 v35, v35, v119
  v_exp_f32 v33, v33
  v_mfma_f32_16x16x32_bf16 v[76:79], v[204:207], a[188:191], v[76:79]
  ds_read_b64_tr_b16 v[192:193], v22 offset:4104
  v_mul_f32 v36, v116, v124
  s_waitcnt lgkmcnt(3)
  v_mfma_f32_16x16x32_bf16 v[144:147], v[184:187], a[224:227], v[144:147]
  ds_read_b64_tr_b16 v[194:195], v22 offset:4616
  v_mul_f32 v37, v117, v125
  v_mfma_f32_16x16x32_bf16 v[144:147], v[180:183], a[208:211], v[144:147]
  ds_read_b64_tr_b16 v[196:197], v22 offset:8200
  v_mul_f32 v38, v118, v126
  v_mfma_f32_16x16x32_bf16 v[144:147], v[176:179], a[192:195], v[144:147]
  ds_read_b64_tr_b16 v[198:199], v22 offset:8712
  v_mul_f32 v39, v119, v127
  v_mfma_f32_16x16x32_bf16 v[160:163], v[176:179], a[196:199], v[160:163]
  buffer_load_dwordx4 v242, s[40:43], s24 offen offset:2048  lds
  s_add_u32 m0, s22, 143360
  v_mfma_f32_16x16x32_bf16 v[160:163], v[180:183], a[212:215], v[160:163]
  v_exp_f32 v34, v34
  v_mfma_f32_16x16x32_bf16 v[160:163], v[184:187], a[228:231], v[160:163]
  v_exp_f32 v35, v35
  v_mfma_f32_16x16x32_bf16 v[48:51], v[184:187], a[232:235], v[48:51]
  ds_read_b64_tr_b16 v[200:201], v22 offset:12288
  v_fma_f32 v32, v32, v18, v18
  v_fma_f32 v33, v33, v18, v18
  v_mfma_f32_16x16x32_bf16 v[48:51], v[180:183], a[216:219], v[48:51]
  ds_read_b64_tr_b16 v[202:203], v22 offset:12800
  v_fma_f32 v34, v34, v18, v18
  v_mfma_f32_16x16x32_bf16 v[48:51], v[176:179], a[200:203], v[48:51]
  buffer_load_dwordx4 v240, s[44:47], s24 offen offset:0  lds
  v_mfma_f32_16x16x32_bf16 v[64:67], v[176:179], a[204:207], v[64:67]
  ds_read_b64_tr_b16 v[204:205], v22 offset:16384
  v_fma_f32 v35, v35, v18, v18
  v_mfma_f32_16x16x32_bf16 v[64:67], v[180:183], a[220:223], v[64:67]
  buffer_load_dwordx4 v241, s[44:47], s24 offen offset:1024  lds
  v_mfma_f32_16x16x32_bf16 v[64:67], v[184:187], a[236:239], v[64:67]
  ds_read_b64_tr_b16 v[206:207], v22 offset:16896
  v_mul_f32 v24, v128, v128
  s_waitcnt lgkmcnt(4)
  v_mfma_f32_16x16x32_bf16 v[148:151], v[196:199], a[224:227], v[148:151]
  v_rcp_f32 v32, v32
  v_mfma_f32_16x16x32_bf16 v[148:151], v[192:195], a[208:211], v[148:151]
  ds_read_b64_tr_b16 v[176:177], v22 offset:20480
  v_mul_f32 v36, v36, v32
  v_mfma_f32_16x16x32_bf16 v[148:151], v[188:191], a[192:195], v[148:151]
  ds_read_b64_tr_b16 v[178:179], v22 offset:20992
  v_rcp_f32 v33, v33
  v_mfma_f32_16x16x32_bf16 v[164:167], v[188:191], a[196:199], v[164:167]
  buffer_load_dwordx4 v242, s[44:47], s24 offen offset:2048  lds
  v_mfma_f32_16x16x32_bf16 v[164:167], v[192:195], a[212:215], v[164:167]
  ds_read_b64_tr_b16 v[180:181], v22 offset:12296
  v_mul_f32 v37, v37, v33
  v_mfma_f32_16x16x32_bf16 v[164:167], v[196:199], a[228:231], v[164:167]
  buffer_store_dwordx4 v[244:247], v1, s[12:15], s101 offen offset:0 sc1
  v_mfma_f32_16x16x32_bf16 v[52:55], v[196:199], a[232:235], v[52:55]
  ds_read_b64_tr_b16 v[182:183], v22 offset:12808
  v_cvt_pk_bf16_f32 v42, v36, v37
  v_mfma_f32_16x16x32_bf16 v[52:55], v[192:195], a[216:219], v[52:55]
  v_rcp_f32 v34, v34
  v_mfma_f32_16x16x32_bf16 v[52:55], v[188:191], a[200:203], v[52:55]
  ds_read_b64_tr_b16 v[184:185], v22 offset:16392
  v_mul_f32 v38, v38, v34
  v_mfma_f32_16x16x32_bf16 v[68:71], v[188:191], a[204:207], v[68:71]
  ds_read_b64_tr_b16 v[186:187], v22 offset:16904
  v_mul_f32 v25, v129, v129
  v_mfma_f32_16x16x32_bf16 v[68:71], v[192:195], a[220:223], v[68:71]
  buffer_store_dwordx4 v[244:247], v1, s[12:15], s100 offen offset:1024 sc1
  v_mfma_f32_16x16x32_bf16 v[68:71], v[196:199], a[236:239], v[68:71]
  ds_read_b64_tr_b16 v[188:189], v22 offset:20488
  v_rcp_f32 v35, v35
  s_waitcnt lgkmcnt(5)
  v_mfma_f32_16x16x32_bf16 v[152:155], v[176:179], a[224:227], v[152:155]
  v_mul_f32 v39, v39, v35
  v_mul_f32 v26, v130, v130
  v_mfma_f32_16x16x32_bf16 v[152:155], v[204:207], a[208:211], v[152:155]
  ds_read_b64_tr_b16 v[190:191], v22 offset:21000
  v_cvt_pk_bf16_f32 v43, v38, v39
  v_mfma_f32_16x16x32_bf16 v[152:155], v[200:203], a[192:195], v[152:155]
  ds_write_b128 v4, v[40:43] offset:32768
  v_mfma_f32_16x16x32_bf16 v[168:171], v[200:203], a[196:199], v[168:171]
  buffer_store_dwordx4 v[40:43], v4, s[12:15], s31 offen offset:0 sc1
  v_mfma_f32_16x16x32_bf16 v[168:171], v[204:207], a[212:215], v[168:171]
  v_mul_f32 v27, v131, v131
  v_fma_f32 v24, v24, v15, v11
  v_mfma_f32_16x16x32_bf16 v[168:171], v[176:179], a[228:231], v[168:171]
  v_fma_f32 v25, v25, v15, v11
  v_fma_f32 v26, v26, v15, v11
  v_mfma_f32_16x16x32_bf16 v[56:59], v[176:179], a[232:235], v[56:59]
  v_fma_f32 v27, v27, v15, v11
  v_mul_f32 v24, v24, v128
  v_mul_f32 v25, v25, v129
  v_mfma_f32_16x16x32_bf16 v[56:59], v[204:207], a[216:219], v[56:59]
  v_exp_f32 v24, v24
  v_mfma_f32_16x16x32_bf16 v[56:59], v[200:203], a[200:203], v[56:59]
  v_exp_f32 v25, v25
  v_mfma_f32_16x16x32_bf16 v[72:75], v[200:203], a[204:207], v[72:75]
  s_waitcnt vmcnt(19) lgkmcnt(1)
  s_barrier
  v_add_u32 v22, 24576, v22
  ds_read_b64_tr_b16 v[192:193], v22 offset:0
  v_mfma_f32_16x16x32_bf16 v[72:75], v[204:207], a[220:223], v[72:75]
  ds_read_b64_tr_b16 v[194:195], v22 offset:512
  s_add_u32 m0, s22, 57344
  v_mul_f32 v26, v26, v130
  v_mfma_f32_16x16x32_bf16 v[72:75], v[176:179], a[236:239], v[72:75]
  v_exp_f32 v26, v26
  v_mfma_f32_16x16x32_bf16 v[156:159], v[188:191], a[224:227], v[156:159]
  ds_read_b64_tr_b16 v[196:197], v22 offset:4096
  v_mul_f32 v27, v27, v131
  v_mfma_f32_16x16x32_bf16 v[156:159], v[184:187], a[208:211], v[156:159]
  ds_read_b64_tr_b16 v[198:199], v22 offset:4608
  s_add_u32 s24, s20, 1769728
  v_mul_f32 v28, v128, v136
  v_mfma_f32_16x16x32_bf16 v[156:159], v[180:183], a[192:195], v[156:159]
  ds_read_b64_tr_b16 v[200:201], v22 offset:8192
  v_exp_f32 v27, v27
  v_mfma_f32_16x16x32_bf16 v[172:175], v[180:183], a[196:199], v[172:175]
  ds_read_b64_tr_b16 v[202:203], v22 offset:8704
  v_mul_f32 v29, v129, v137
  v_mfma_f32_16x16x32_bf16 v[172:175], v[184:187], a[212:215], v[172:175]
  buffer_load_dwordx4 v240, s[40:43], s24 offen offset:0  lds
  v_mfma_f32_16x16x32_bf16 v[172:175], v[188:191], a[228:231], v[172:175]
  v_mul_f32 v30, v130, v138
  v_mul_f32 v31, v131, v139
  v_mfma_f32_16x16x32_bf16 v[60:63], v[188:191], a[232:235], v[60:63]
  v_fma_f32 v24, v24, v19, v19
  v_fma_f32 v25, v25, v19, v19
  v_mfma_f32_16x16x32_bf16 v[60:63], v[184:187], a[216:219], v[60:63]
  ds_read_b64_tr_b16 v[204:205], v22 offset:8
  v_fma_f32 v26, v26, v19, v19
  v_mfma_f32_16x16x32_bf16 v[60:63], v[180:183], a[200:203], v[60:63]
  buffer_load_dwordx4 v241, s[40:43], s24 offen offset:1024  lds
  v_mfma_f32_16x16x32_bf16 v[76:79], v[180:183], a[204:207], v[76:79]
  ds_read_b64_tr_b16 v[206:207], v22 offset:520
  v_fma_f32 v27, v27, v19, v19
  v_mfma_f32_16x16x32_bf16 v[76:79], v[184:187], a[220:223], v[76:79]
  v_rcp_f32 v24, v24
  v_mul_f32 v32, v132, v132
  v_mfma_f32_16x16x32_bf16 v[76:79], v[188:191], a[236:239], v[76:79]
  ds_read_b64_tr_b16 v[176:177], v22 offset:4104
  v_mul_f32 v28, v28, v24
  s_waitcnt lgkmcnt(3)
  v_mfma_f32_16x16x32_bf16 v[144:147], v[200:203], v[224:227], v[144:147]
  ds_read_b64_tr_b16 v[178:179], v22 offset:4616
  v_mul_f32 v33, v133, v133
  v_mfma_f32_16x16x32_bf16 v[144:147], v[196:199], v[208:211], v[144:147]
  ds_read_b64_tr_b16 v[180:181], v22 offset:8200
  v_mul_f32 v34, v134, v134
  v_mfma_f32_16x16x32_bf16 v[144:147], v[192:195], a[240:243], v[144:147]
  ds_read_b64_tr_b16 v[182:183], v22 offset:8712
  v_mul_f32 v35, v135, v135
  v_mfma_f32_16x16x32_bf16 v[160:163], v[192:195], a[244:247], v[160:163]
  buffer_load_dwordx4 v242, s[40:43], s24 offen offset:2048  lds
  s_add_u32 m0, s22, 69632
  v_mfma_f32_16x16x32_bf16 v[160:163], v[196:199], v[212:215], v[160:163]
  v_rcp_f32 v25, v25
  v_mfma_f32_16x16x32_bf16 v[160:163], v[200:203], v[228:231], v[160:163]
  v_rcp_f32 v26, v26
  v_mfma_f32_16x16x32_bf16 v[48:51], v[200:203], v[232:235], v[48:51]
  ds_read_b64_tr_b16 v[184:185], v22 offset:12288
  v_rcp_f32 v27, v27
  v_mfma_f32_16x16x32_bf16 v[48:51], v[196:199], v[216:219], v[48:51]
  ds_read_b64_tr_b16 v[186:187], v22 offset:12800
  v_mul_f32 v29, v29, v25
  v_mfma_f32_16x16x32_bf16 v[48:51], v[192:195], a[248:251], v[48:51]
  buffer_load_dwordx4 v240, s[44:47], s24 offen offset:0  lds
  v_mfma_f32_16x16x32_bf16 v[64:67], v[192:195], a[252:255], v[64:67]
  ds_read_b64_tr_b16 v[188:189], v22 offset:16384
  v_mul_f32 v30, v30, v26
  v_mfma_f32_16x16x32_bf16 v[64:67], v[196:199], v[220:223], v[64:67]
  buffer_load_dwordx4 v241, s[44:47], s24 offen offset:1024  lds
  v_mfma_f32_16x16x32_bf16 v[64:67], v[200:203], v[236:239], v[64:67]
  ds_read_b64_tr_b16 v[190:191], v22 offset:16896
  v_mul_f32 v31, v31, v27
  s_waitcnt lgkmcnt(4)
  v_mfma_f32_16x16x32_bf16 v[148:151], v[180:183], v[224:227], v[148:151]
  v_cvt_pk_bf16_f32 v44, v28, v29
  v_cvt_pk_bf16_f32 v45, v30, v31
  v_mfma_f32_16x16x32_bf16 v[148:151], v[176:179], v[208:211], v[148:151]
  ds_read_b64_tr_b16 v[192:193], v22 offset:20480
  v_fma_f32 v32, v32, v15, v11
  v_mfma_f32_16x16x32_bf16 v[148:151], v[204:207], a[240:243], v[148:151]
  ds_read_b64_tr_b16 v[194:195], v22 offset:20992
  v_fma_f32 v33, v33, v15, v11
  v_fma_f32 v34, v34, v15, v11
  v_mfma_f32_16x16x32_bf16 v[164:167], v[204:207], a[244:247], v[164:167]
  buffer_load_dwordx4 v242, s[44:47], s24 offen offset:2048  lds
  v_mfma_f32_16x16x32_bf16 v[164:167], v[176:179], v[212:215], v[164:167]
  ds_read_b64_tr_b16 v[196:197], v22 offset:12296
  v_fma_f32 v35, v35, v15, v11
  v_mfma_f32_16x16x32_bf16 v[164:167], v[180:183], v[228:231], v[164:167]
  v_mul_f32 v32, v32, v132
  v_mul_f32 v33, v33, v133
  v_mfma_f32_16x16x32_bf16 v[52:55], v[180:183], v[232:235], v[52:55]
  ds_read_b64_tr_b16 v[198:199], v22 offset:12808
  v_mul_f32 v34, v34, v134
  v_mfma_f32_16x16x32_bf16 v[52:55], v[176:179], v[216:219], v[52:55]
  v_exp_f32 v32, v32
  v_mfma_f32_16x16x32_bf16 v[52:55], v[204:207], a[248:251], v[52:55]
  ds_read_b64_tr_b16 v[200:201], v22 offset:16392
  v_mul_f32 v35, v35, v135
  v_mfma_f32_16x16x32_bf16 v[68:71], v[204:207], a[252:255], v[68:71]
  ds_read_b64_tr_b16 v[202:203], v22 offset:16904
  v_mul_f32 v36, v132, v140
  v_mfma_f32_16x16x32_bf16 v[68:71], v[176:179], v[220:223], v[68:71]
  buffer_store_dwordx4 v[244:247], v1, s[12:15], s101 offen offset:1024 sc1
  v_mfma_f32_16x16x32_bf16 v[68:71], v[180:183], v[236:239], v[68:71]
  ds_read_b64_tr_b16 v[204:205], v22 offset:20488
  v_exp_f32 v33, v33
  s_waitcnt lgkmcnt(5)
  v_mfma_f32_16x16x32_bf16 v[152:155], v[192:195], v[224:227], v[152:155]
  v_exp_f32 v34, v34
  v_mfma_f32_16x16x32_bf16 v[152:155], v[188:191], v[208:211], v[152:155]
  ds_read_b64_tr_b16 v[206:207], v22 offset:21000
  v_mul_f32 v37, v133, v141
  v_mfma_f32_16x16x32_bf16 v[152:155], v[184:187], a[240:243], v[152:155]
  v_exp_f32 v35, v35
  v_mfma_f32_16x16x32_bf16 v[168:171], v[184:187], a[244:247], v[168:171]
  v_mul_f32 v38, v134, v142
  v_mul_f32 v39, v135, v143
  v_mfma_f32_16x16x32_bf16 v[168:171], v[188:191], v[212:215], v[168:171]
  v_fma_f32 v32, v32, v19, v19
  v_fma_f32 v33, v33, v19, v19
  v_mfma_f32_16x16x32_bf16 v[168:171], v[192:195], v[228:231], v[168:171]
  v_rcp_f32 v32, v32
  v_mfma_f32_16x16x32_bf16 v[56:59], v[192:195], v[232:235], v[56:59]
  v_fma_f32 v34, v34, v19, v19
  v_rcp_f32 v33, v33
  v_mfma_f32_16x16x32_bf16 v[56:59], v[188:191], v[216:219], v[56:59]
  v_rcp_f32 v34, v34
  v_mfma_f32_16x16x32_bf16 v[56:59], v[184:187], a[248:251], v[56:59]
  v_fma_f32 v35, v35, v19, v19
  v_mul_f32 v36, v36, v32
  v_mfma_f32_16x16x32_bf16 v[72:75], v[184:187], a[252:255], v[72:75]
  s_waitcnt vmcnt(18) lgkmcnt(0)
  s_barrier
  v_add_u32 v22, 24576, v22
  ds_read_b64_tr_b16 v[176:177], v22 offset:0
  v_mfma_f32_16x16x32_bf16 v[72:75], v[188:191], v[220:223], v[72:75]
  ds_read_b64_tr_b16 v[178:179], v22 offset:512
  s_add_u32 m0, s22, 81920
  v_mul_f32 v37, v37, v33
  v_mfma_f32_16x16x32_bf16 v[72:75], v[192:195], v[236:239], v[72:75]
  v_rcp_f32 v35, v35
  v_mfma_f32_16x16x32_bf16 v[156:159], v[204:207], v[224:227], v[156:159]
  ds_read_b64_tr_b16 v[180:181], v22 offset:4096
  v_mul_f32 v38, v38, v34
  v_mfma_f32_16x16x32_bf16 v[156:159], v[200:203], v[208:211], v[156:159]
  ds_read_b64_tr_b16 v[182:183], v22 offset:4608
  s_add_u32 s24, s20, 2654464
  v_mul_f32 v39, v39, v35
  v_mfma_f32_16x16x32_bf16 v[156:159], v[196:199], a[240:243], v[156:159]
  ds_read_b64_tr_b16 v[184:185], v22 offset:8192
  v_cvt_pk_bf16_f32 v46, v36, v37
  v_cvt_pk_bf16_f32 v47, v38, v39
  v_mfma_f32_16x16x32_bf16 v[172:175], v[196:199], a[244:247], v[172:175]
  ds_read_b64_tr_b16 v[186:187], v22 offset:8704
  v_mfma_f32_16x16x32_bf16 v[172:175], v[200:203], v[212:215], v[172:175]
  buffer_load_dwordx4 v240, s[40:43], s24 offen offset:0  lds
  v_mfma_f32_16x16x32_bf16 v[172:175], v[204:207], v[228:231], v[172:175]
  ds_write_b128 v4, v[44:47] offset:33024
  v_mfma_f32_16x16x32_bf16 v[60:63], v[204:207], v[232:235], v[60:63]
  buffer_store_dwordx4 v[44:47], v4, s[12:15], s31 offen offset:256 sc1
  v_mfma_f32_16x16x32_bf16 v[60:63], v[200:203], v[216:219], v[60:63]
  ds_read_b64_tr_b16 v[188:189], v22 offset:8
  v_mfma_f32_16x16x32_bf16 v[60:63], v[196:199], a[248:251], v[60:63]
  buffer_load_dwordx4 v241, s[40:43], s24 offen offset:1024  lds
  v_mfma_f32_16x16x32_bf16 v[76:79], v[196:199], a[252:255], v[76:79]
  ds_read_b64_tr_b16 v[190:191], v22 offset:520
  v_mfma_f32_16x16x32_bf16 v[76:79], v[200:203], v[220:223], v[76:79]
  v_mfma_f32_16x16x32_bf16 v[76:79], v[204:207], v[236:239], v[76:79]
  ds_read_b64_tr_b16 v[192:193], v22 offset:4104
  s_and_b32 s23, s17, 1
  s_xor_b32 s27, s23, s55
  s_waitcnt lgkmcnt(4)
  v_mfma_f32_16x16x32_bf16 v[80:83], v[184:187], a[32:35], 0
  ds_read_b64_tr_b16 v[194:195], v22 offset:4616
  s_lshl_b32 s23, s23, 9
  v_xor_b32 v243, s23, v243
  v_mfma_f32_16x16x32_bf16 v[80:83], v[180:183], a[16:19], v[80:83]
  ds_read_b64_tr_b16 v[196:197], v22 offset:8200
  v_xor_b32 v244, 512, v243
  v_mfma_f32_16x16x32_bf16 v[80:83], v[176:179], a[0:3], v[80:83]
  ds_read_b64_tr_b16 v[198:199], v22 offset:8712
  v_add_u32 v2, 0x10000, v243
  v_mfma_f32_16x16x32_bf16 v[96:99], v[176:179], a[4:7], 0
  buffer_load_dwordx4 v242, s[40:43], s24 offen offset:2048  lds
  s_add_u32 m0, s22, 94208
  v_mfma_f32_16x16x32_bf16 v[96:99], v[180:183], a[20:23], v[96:99]
  v_add_u32 v3, 0x10000, v244
  v_mfma_f32_16x16x32_bf16 v[96:99], v[184:187], a[36:39], v[96:99]
  v_mfma_f32_16x16x32_bf16 v[112:115], v[184:187], a[40:43], 0
  ds_read_b64_tr_b16 v[200:201], v22 offset:12288
  v_mfma_f32_16x16x32_bf16 v[112:115], v[180:183], a[24:27], v[112:115]
  ds_read_b64_tr_b16 v[202:203], v22 offset:12800
  v_mfma_f32_16x16x32_bf16 v[112:115], v[176:179], a[8:11], v[112:115]
  buffer_load_dwordx4 v240, s[44:47], s24 offen offset:0  lds
  v_mfma_f32_16x16x32_bf16 v[128:131], v[176:179], a[12:15], 0
  ds_read_b64_tr_b16 v[204:205], v22 offset:16384
  s_lshl_b32 s23, s55, 13
  v_add_u32 v4, s23, v4
  s_add_u32 s31, s10, 16384
  v_mfma_f32_16x16x32_bf16 v[128:131], v[180:183], a[28:31], v[128:131]
  buffer_load_dwordx4 v241, s[44:47], s24 offen offset:1024  lds
  v_mfma_f32_16x16x32_bf16 v[128:131], v[184:187], a[44:47], v[128:131]
  ds_read_b64_tr_b16 v[206:207], v22 offset:16896
  v_mul_f32 v24, v144, v144
  s_waitcnt lgkmcnt(4)
  v_mfma_f32_16x16x32_bf16 v[84:87], v[196:199], a[32:35], 0
  v_mul_f32 v25, v145, v145
  v_mul_f32 v26, v146, v146
  v_mfma_f32_16x16x32_bf16 v[84:87], v[192:195], a[16:19], v[84:87]
  ds_read_b64_tr_b16 v[176:177], v22 offset:20480
  v_mul_f32 v27, v147, v147
  v_mfma_f32_16x16x32_bf16 v[84:87], v[188:191], a[0:3], v[84:87]
  ds_read_b64_tr_b16 v[178:179], v22 offset:20992
  v_fma_f32 v24, v24, v14, v10
  v_mfma_f32_16x16x32_bf16 v[100:103], v[188:191], a[4:7], 0
  buffer_load_dwordx4 v242, s[44:47], s24 offen offset:2048  lds
  v_mfma_f32_16x16x32_bf16 v[100:103], v[192:195], a[20:23], v[100:103]
  ds_read_b64_tr_b16 v[180:181], v22 offset:12296
  v_fma_f32 v25, v25, v14, v10
  v_fma_f32 v26, v26, v14, v10
  v_mfma_f32_16x16x32_bf16 v[100:103], v[196:199], a[36:39], v[100:103]
  v_fma_f32 v27, v27, v14, v10
  v_mul_f32 v24, v24, v144
  v_mfma_f32_16x16x32_bf16 v[116:119], v[196:199], a[40:43], 0
  ds_read_b64_tr_b16 v[182:183], v22 offset:12808
  v_mul_f32 v25, v25, v145
  v_mfma_f32_16x16x32_bf16 v[116:119], v[192:195], a[24:27], v[116:119]
  v_exp_f32 v24, v24
  v_mfma_f32_16x16x32_bf16 v[116:119], v[188:191], a[8:11], v[116:119]
  ds_read_b64_tr_b16 v[184:185], v22 offset:16392
  v_mul_f32 v26, v26, v146
  v_mfma_f32_16x16x32_bf16 v[132:135], v[188:191], a[12:15], 0
  ds_read_b64_tr_b16 v[186:187], v22 offset:16904
  v_mul_f32 v27, v27, v147
  v_mfma_f32_16x16x32_bf16 v[132:135], v[192:195], a[28:31], v[132:135]
  v_exp_f32 v25, v25
  v_mfma_f32_16x16x32_bf16 v[132:135], v[196:199], a[44:47], v[132:135]
  ds_read_b64_tr_b16 v[188:189], v22 offset:20488
  v_exp_f32 v26, v26
  s_waitcnt lgkmcnt(5)
  v_mfma_f32_16x16x32_bf16 v[88:91], v[176:179], a[32:35], 0
  v_exp_f32 v27, v27
  v_mfma_f32_16x16x32_bf16 v[88:91], v[204:207], a[16:19], v[88:91]
  ds_read_b64_tr_b16 v[190:191], v22 offset:21000
  v_mul_f32 v28, v144, v152
  v_mfma_f32_16x16x32_bf16 v[88:91], v[200:203], a[0:3], v[88:91]
  v_mul_f32 v29, v145, v153
  v_mul_f32 v30, v146, v154
  v_mfma_f32_16x16x32_bf16 v[104:107], v[200:203], a[4:7], 0
  v_mul_f32 v31, v147, v155
  v_fma_f32 v24, v24, v18, v18
  v_mfma_f32_16x16x32_bf16 v[104:107], v[204:207], a[20:23], v[104:107]
  v_rcp_f32 v24, v24
  v_mfma_f32_16x16x32_bf16 v[104:107], v[176:179], a[36:39], v[104:107]
  v_fma_f32 v25, v25, v18, v18
  v_fma_f32 v26, v26, v18, v18
  v_mfma_f32_16x16x32_bf16 v[120:123], v[176:179], a[40:43], 0
  v_rcp_f32 v25, v25
  v_mfma_f32_16x16x32_bf16 v[120:123], v[204:207], a[24:27], v[120:123]
  v_fma_f32 v27, v27, v18, v18
  v_rcp_f32 v26, v26
  v_mfma_f32_16x16x32_bf16 v[120:123], v[200:203], a[8:11], v[120:123]
  v_rcp_f32 v27, v27
  v_mfma_f32_16x16x32_bf16 v[136:139], v[200:203], a[12:15], 0
  s_waitcnt vmcnt(17) lgkmcnt(0)
  s_barrier
  v_add_u32 v22, 24576, v22
  ds_read_b64_tr_b16 v[192:193], v22 offset:0
  v_mfma_f32_16x16x32_bf16 v[136:139], v[204:207], a[28:31], v[136:139]
  ds_read_b64_tr_b16 v[194:195], v22 offset:512
  s_add_u32 m0, s22, 106496
  v_mul_f32 v28, v28, v24
  v_mfma_f32_16x16x32_bf16 v[136:139], v[176:179], a[44:47], v[136:139]
  v_mul_f32 v29, v29, v25
  v_mul_f32 v30, v30, v26
  v_mfma_f32_16x16x32_bf16 v[92:95], v[188:191], a[32:35], 0
  ds_read_b64_tr_b16 v[196:197], v22 offset:4096
  v_mul_f32 v31, v31, v27
  v_mfma_f32_16x16x32_bf16 v[92:95], v[184:187], a[16:19], v[92:95]
  ds_read_b64_tr_b16 v[198:199], v22 offset:4608
  s_add_u32 s24, s20, 3539200
  v_cvt_pk_bf16_f32 v40, v28, v29
  v_mfma_f32_16x16x32_bf16 v[92:95], v[180:183], a[0:3], v[92:95]
  ds_read_b64_tr_b16 v[200:201], v22 offset:8192
  v_cvt_pk_bf16_f32 v41, v30, v31
  v_mfma_f32_16x16x32_bf16 v[108:111], v[180:183], a[4:7], 0
  ds_read_b64_tr_b16 v[202:203], v22 offset:8704
L_pad4:
  s_cbranch_execz L_pad5
  v_mul_f32 v32, v148, v148
  v_mul_f32 v33, v149, v149
  v_mfma_f32_16x16x32_bf16 v[108:111], v[184:187], a[20:23], v[108:111]
  buffer_load_dwordx4 v240, s[40:43], s24 offen offset:0  lds
  v_mfma_f32_16x16x32_bf16 v[108:111], v[188:191], a[36:39], v[108:111]
  v_mul_f32 v34, v150, v150
  v_mul_f32 v35, v151, v151
  v_mfma_f32_16x16x32_bf16 v[124:127], v[188:191], a[40:43], 0
  v_fma_f32 v32, v32, v14, v10
  v_fma_f32 v33, v33, v14, v10
  v_mfma_f32_16x16x32_bf16 v[124:127], v[184:187], a[24:27], v[124:127]
  ds_read_b64_tr_b16 v[204:205], v22 offset:8
  v_fma_f32 v34, v34, v14, v10
  v_mfma_f32_16x16x32_bf16 v[124:127], v[180:183], a[8:11], v[124:127]
  buffer_load_dwordx4 v241, s[40:43], s24 offen offset:1024  lds
  v_mfma_f32_16x16x32_bf16 v[140:143], v[180:183], a[12:15], 0
  ds_read_b64_tr_b16 v[206:207], v22 offset:520
  v_fma_f32 v35, v35, v14, v10
  v_mfma_f32_16x16x32_bf16 v[140:143], v[184:187], a[28:31], v[140:143]
  v_mul_f32 v32, v32, v148
  v_mul_f32 v33, v33, v149
  v_mfma_f32_16x16x32_bf16 v[140:143], v[188:191], a[44:47], v[140:143]
  ds_read_b64_tr_b16 v[176:177], v22 offset:4104
  v_exp_f32 v32, v32
  s_waitcnt lgkmcnt(3)
  v_mfma_f32_16x16x32_bf16 v[80:83], v[200:203], a[80:83], v[80:83]
  ds_read_b64_tr_b16 v[178:179], v22 offset:4616
  v_mul_f32 v34, v34, v150
  v_mfma_f32_16x16x32_bf16 v[80:83], v[196:199], a[64:67], v[80:83]
  ds_read_b64_tr_b16 v[180:181], v22 offset:8200
  v_mul_f32 v35, v35, v151
  v_mfma_f32_16x16x32_bf16 v[80:83], v[192:195], a[48:51], v[80:83]
  ds_read_b64_tr_b16 v[182:183], v22 offset:8712
  v_mul_f32 v36, v148, v156
  v_mfma_f32_16x16x32_bf16 v[96:99], v[192:195], a[52:55], v[96:99]
  buffer_load_dwordx4 v242, s[40:43], s24 offen offset:2048  lds
  s_add_u32 m0, s22, 118784
  v_mfma_f32_16x16x32_bf16 v[96:99], v[196:199], a[68:71], v[96:99]
  v_exp_f32 v33, v33
  v_mfma_f32_16x16x32_bf16 v[96:99], v[200:203], a[84:87], v[96:99]
  v_exp_f32 v34, v34
  v_mfma_f32_16x16x32_bf16 v[112:115], v[200:203], a[88:91], v[112:115]
  ds_read_b64_tr_b16 v[184:185], v22 offset:12288
  v_mul_f32 v37, v149, v157
  v_mfma_f32_16x16x32_bf16 v[112:115], v[196:199], a[72:75], v[112:115]
  ds_read_b64_tr_b16 v[186:187], v22 offset:12800
  v_exp_f32 v35, v35
  v_mfma_f32_16x16x32_bf16 v[112:115], v[192:195], a[56:59], v[112:115]
  buffer_load_dwordx4 v240, s[44:47], s24 offen offset:0  lds
  v_mfma_f32_16x16x32_bf16 v[128:131], v[192:195], a[60:63], v[128:131]
  ds_read_b64_tr_b16 v[188:189], v22 offset:16384
  v_mul_f32 v38, v150, v158
  v_mfma_f32_16x16x32_bf16 v[128:131], v[196:199], a[76:79], v[128:131]
  buffer_load_dwordx4 v241, s[44:47], s24 offen offset:1024  lds
  v_mfma_f32_16x16x32_bf16 v[128:131], v[200:203], a[92:95], v[128:131]
  ds_read_b64_tr_b16 v[190:191], v22 offset:16896
  v_mul_f32 v39, v151, v159
  s_waitcnt lgkmcnt(4)
  v_mfma_f32_16x16x32_bf16 v[84:87], v[180:183], a[80:83], v[84:87]
  v_fma_f32 v32, v32, v18, v18
  v_fma_f32 v33, v33, v18, v18
  v_mfma_f32_16x16x32_bf16 v[84:87], v[176:179], a[64:67], v[84:87]
  ds_read_b64_tr_b16 v[192:193], v22 offset:20480
  v_fma_f32 v34, v34, v18, v18
  v_mfma_f32_16x16x32_bf16 v[84:87], v[204:207], a[48:51], v[84:87]
  ds_read_b64_tr_b16 v[194:195], v22 offset:20992
  v_fma_f32 v35, v35, v18, v18
  v_mfma_f32_16x16x32_bf16 v[100:103], v[204:207], a[52:55], v[100:103]
  buffer_load_dwordx4 v242, s[44:47], s24 offen offset:2048  lds
  v_mfma_f32_16x16x32_bf16 v[100:103], v[176:179], a[68:71], v[100:103]
  ds_read_b64_tr_b16 v[196:197], v22 offset:12296
  v_rcp_f32 v32, v32
  v_mfma_f32_16x16x32_bf16 v[100:103], v[180:183], a[84:87], v[100:103]
  v_rcp_f32 v33, v33
  v_mfma_f32_16x16x32_bf16 v[116:119], v[180:183], a[88:91], v[116:119]
  ds_read_b64_tr_b16 v[198:199], v22 offset:12808
  v_mul_f32 v36, v36, v32
  v_mfma_f32_16x16x32_bf16 v[116:119], v[176:179], a[72:75], v[116:119]
  v_rcp_f32 v34, v34
  v_mfma_f32_16x16x32_bf16 v[116:119], v[204:207], a[56:59], v[116:119]
  ds_read_b64_tr_b16 v[200:201], v22 offset:16392
  v_mul_f32 v37, v37, v33
  v_mfma_f32_16x16x32_bf16 v[132:135], v[204:207], a[60:63], v[132:135]
  ds_read_b64_tr_b16 v[202:203], v22 offset:16904
  v_mul_f32 v38, v38, v34
  v_mfma_f32_16x16x32_bf16 v[132:135], v[176:179], a[76:79], v[132:135]
  v_rcp_f32 v35, v35
  v_mfma_f32_16x16x32_bf16 v[132:135], v[180:183], a[92:95], v[132:135]
  ds_read_b64_tr_b16 v[204:205], v22 offset:20488
  v_mul_f32 v39, v39, v35
  v_cvt_pk_bf16_f32 v42, v36, v37
  s_waitcnt lgkmcnt(5)
  v_mfma_f32_16x16x32_bf16 v[88:91], v[192:195], a[80:83], v[88:91]
  v_cvt_pk_bf16_f32 v43, v38, v39
  v_mul_f32 v24, v160, v160
  v_mfma_f32_16x16x32_bf16 v[88:91], v[188:191], a[64:67], v[88:91]
  ds_read_b64_tr_b16 v[206:207], v22 offset:21000
  v_mul_f32 v25, v161, v161
  v_mfma_f32_16x16x32_bf16 v[88:91], v[184:187], a[48:51], v[88:91]
  ds_write_b128 v4, v[40:43] offset:16384
  v_mfma_f32_16x16x32_bf16 v[104:107], v[184:187], a[52:55], v[104:107]
  buffer_store_dwordx4 v[40:43], v4, s[12:15], s31 offen offset:0 sc1
  v_mfma_f32_16x16x32_bf16 v[104:107], v[188:191], a[68:71], v[104:107]
  v_mul_f32 v26, v162, v162
  v_mul_f32 v27, v163, v163
  v_mfma_f32_16x16x32_bf16 v[104:107], v[192:195], a[84:87], v[104:107]
  v_fma_f32 v24, v24, v15, v11
  v_fma_f32 v25, v25, v15, v11
  v_mfma_f32_16x16x32_bf16 v[120:123], v[192:195], a[88:91], v[120:123]
  v_fma_f32 v26, v26, v15, v11
  v_fma_f32 v27, v27, v15, v11
  v_mfma_f32_16x16x32_bf16 v[120:123], v[188:191], a[72:75], v[120:123]
  v_mul_f32 v24, v24, v160
  v_mul_f32 v25, v25, v161
  v_mul_f32 v26, v26, v162
  v_mfma_f32_16x16x32_bf16 v[120:123], v[184:187], a[56:59], v[120:123]
  v_exp_f32 v24, v24
  v_mfma_f32_16x16x32_bf16 v[136:139], v[184:187], a[60:63], v[136:139]
  s_waitcnt vmcnt(15) lgkmcnt(1)
  s_barrier
  v_add_u32 v22, 4294893568, v22
  ds_read_b64_tr_b16 v[176:177], v22 offset:0
  v_mfma_f32_16x16x32_bf16 v[136:139], v[188:191], a[76:79], v[136:139]
  ds_read_b64_tr_b16 v[178:179], v22 offset:512
  s_add_u32 m0, s22, 131072
  v_mul_f32 v27, v27, v163
  v_mfma_f32_16x16x32_bf16 v[136:139], v[192:195], a[92:95], v[136:139]
  v_exp_f32 v25, v25
  v_mfma_f32_16x16x32_bf16 v[92:95], v[204:207], a[80:83], v[92:95]
  ds_read_b64_tr_b16 v[180:181], v22 offset:4096
  v_mul_f32 v28, v160, v168
  v_mfma_f32_16x16x32_bf16 v[92:95], v[200:203], a[64:67], v[92:95]
  ds_read_b64_tr_b16 v[182:183], v22 offset:4608
  s_add_u32 s24, s20, 4423936
  v_mul_f32 v29, v161, v169
  v_mfma_f32_16x16x32_bf16 v[92:95], v[196:199], a[48:51], v[92:95]
  ds_read_b64_tr_b16 v[184:185], v22 offset:8192
  v_mul_f32 v30, v162, v170
  v_mfma_f32_16x16x32_bf16 v[108:111], v[196:199], a[52:55], v[108:111]
  ds_read_b64_tr_b16 v[186:187], v22 offset:8704
  v_exp_f32 v26, v26
  v_mfma_f32_16x16x32_bf16 v[108:111], v[200:203], a[68:71], v[108:111]
  buffer_load_dwordx4 v240, s[40:43], s24 offen offset:0  lds
  v_mfma_f32_16x16x32_bf16 v[108:111], v[204:207], a[84:87], v[108:111]
  v_exp_f32 v27, v27
  v_mfma_f32_16x16x32_bf16 v[124:127], v[204:207], a[88:91], v[124:127]
  v_mul_f32 v31, v163, v171
  v_fma_f32 v24, v24, v19, v19
  v_mfma_f32_16x16x32_bf16 v[124:127], v[200:203], a[72:75], v[124:127]
  ds_read_b64_tr_b16 v[188:189], v22 offset:8
  v_fma_f32 v25, v25, v19, v19
  v_mfma_f32_16x16x32_bf16 v[124:127], v[196:199], a[56:59], v[124:127]
  buffer_load_dwordx4 v241, s[40:43], s24 offen offset:1024  lds
  v_mfma_f32_16x16x32_bf16 v[140:143], v[196:199], a[60:63], v[140:143]
  ds_read_b64_tr_b16 v[190:191], v22 offset:520
  v_fma_f32 v26, v26, v19, v19
  v_mfma_f32_16x16x32_bf16 v[140:143], v[200:203], a[76:79], v[140:143]
  v_rcp_f32 v24, v24
  v_mfma_f32_16x16x32_bf16 v[140:143], v[204:207], a[92:95], v[140:143]
  ds_read_b64_tr_b16 v[192:193], v22 offset:4104
  v_rcp_f32 v25, v25
  s_waitcnt lgkmcnt(3)
  v_mfma_f32_16x16x32_bf16 v[80:83], v[184:187], a[128:131], v[80:83]
  ds_read_b64_tr_b16 v[194:195], v22 offset:4616
  v_fma_f32 v27, v27, v19, v19
  v_mfma_f32_16x16x32_bf16 v[80:83], v[180:183], a[112:115], v[80:83]
  ds_read_b64_tr_b16 v[196:197], v22 offset:8200
  v_mul_f32 v28, v28, v24
  v_mfma_f32_16x16x32_bf16 v[80:83], v[176:179], a[96:99], v[80:83]
  ds_read_b64_tr_b16 v[198:199], v22 offset:8712
  v_mul_f32 v29, v29, v25
  v_mfma_f32_16x16x32_bf16 v[96:99], v[176:179], a[100:103], v[96:99]
  buffer_load_dwordx4 v242, s[40:43], s24 offen offset:2048  lds
  s_add_u32 m0, s22, 143360
  v_mfma_f32_16x16x32_bf16 v[96:99], v[180:183], a[116:119], v[96:99]
  v_rcp_f32 v26, v26
  v_mfma_f32_16x16x32_bf16 v[96:99], v[184:187], a[132:135], v[96:99]
  v_rcp_f32 v27, v27
  v_mfma_f32_16x16x32_bf16 v[112:115], v[184:187], a[136:139], v[112:115]
  ds_read_b64_tr_b16 v[200:201], v22 offset:12288
  v_mul_f32 v30, v30, v26
  v_mfma_f32_16x16x32_bf16 v[112:115], v[180:183], a[120:123], v[112:115]
  ds_read_b64_tr_b16 v[202:203], v22 offset:12800
  v_mul_f32 v31, v31, v27
  v_cvt_pk_bf16_f32 v44, v28, v29
  v_mfma_f32_16x16x32_bf16 v[112:115], v[176:179], a[104:107], v[112:115]
  buffer_load_dwordx4 v240, s[44:47], s24 offen offset:0  lds
  v_mfma_f32_16x16x32_bf16 v[128:131], v[176:179], a[108:111], v[128:131]
  ds_read_b64_tr_b16 v[204:205], v22 offset:16384
  v_cvt_pk_bf16_f32 v45, v30, v31
  v_mfma_f32_16x16x32_bf16 v[128:131], v[180:183], a[124:127], v[128:131]
  buffer_load_dwordx4 v241, s[44:47], s24 offen offset:1024  lds
  v_mfma_f32_16x16x32_bf16 v[128:131], v[184:187], a[140:143], v[128:131]
  ds_read_b64_tr_b16 v[206:207], v22 offset:16896
  v_mul_f32 v32, v164, v164
  s_waitcnt lgkmcnt(4)
  v_mfma_f32_16x16x32_bf16 v[84:87], v[196:199], a[128:131], v[84:87]
  v_mul_f32 v33, v165, v165
  v_mul_f32 v34, v166, v166
  v_mfma_f32_16x16x32_bf16 v[84:87], v[192:195], a[112:115], v[84:87]
  ds_read_b64_tr_b16 v[176:177], v22 offset:20480
  v_mul_f32 v35, v167, v167
  v_mfma_f32_16x16x32_bf16 v[84:87], v[188:191], a[96:99], v[84:87]
  ds_read_b64_tr_b16 v[178:179], v22 offset:20992
  v_fma_f32 v32, v32, v15, v11
  v_mfma_f32_16x16x32_bf16 v[100:103], v[188:191], a[100:103], v[100:103]
  buffer_load_dwordx4 v242, s[44:47], s24 offen offset:2048  lds
  v_mfma_f32_16x16x32_bf16 v[100:103], v[192:195], a[116:119], v[100:103]
  ds_read_b64_tr_b16 v[180:181], v22 offset:12296
  v_fma_f32 v33, v33, v15, v11
  v_fma_f32 v34, v34, v15, v11
  v_mfma_f32_16x16x32_bf16 v[100:103], v[196:199], a[132:135], v[100:103]
  v_fma_f32 v35, v35, v15, v11
  v_mul_f32 v32, v32, v164
  v_mfma_f32_16x16x32_bf16 v[116:119], v[196:199], a[136:139], v[116:119]
  ds_read_b64_tr_b16 v[182:183], v22 offset:12808
  v_mul_f32 v33, v33, v165
  v_mfma_f32_16x16x32_bf16 v[116:119], v[192:195], a[120:123], v[116:119]
  v_exp_f32 v32, v32
  v_mfma_f32_16x16x32_bf16 v[116:119], v[188:191], a[104:107], v[116:119]
  ds_read_b64_tr_b16 v[184:185], v22 offset:16392
  v_mul_f32 v34, v34, v166
  v_mfma_f32_16x16x32_bf16 v[132:135], v[188:191], a[108:111], v[132:135]
  ds_read_b64_tr_b16 v[186:187], v22 offset:16904
  v_mul_f32 v35, v35, v167
  v_mfma_f32_16x16x32_bf16 v[132:135], v[192:195], a[124:127], v[132:135]
  v_exp_f32 v33, v33
  v_mfma_f32_16x16x32_bf16 v[132:135], v[196:199], a[140:143], v[132:135]
  ds_read_b64_tr_b16 v[188:189], v22 offset:20488
  v_exp_f32 v34, v34
  s_waitcnt lgkmcnt(5)
  v_mfma_f32_16x16x32_bf16 v[88:91], v[176:179], a[128:131], v[88:91]
  s_waitcnt vmcnt(18)
  s_add_u32 s23, s52, 0
  s_mov_b64 exec, 1
  buffer_store_dwordx2 v[252:253], off, s[12:15], s23 sc1
  s_mov_b64 exec, -1
  v_mfma_f32_16x16x32_bf16 v[88:91], v[204:207], a[112:115], v[88:91]
  ds_read_b64_tr_b16 v[190:191], v22 offset:21000
  v_mul_f32 v36, v164, v172
  v_mfma_f32_16x16x32_bf16 v[88:91], v[200:203], a[96:99], v[88:91]
  v_exp_f32 v35, v35
  v_mfma_f32_16x16x32_bf16 v[104:107], v[200:203], a[100:103], v[104:107]
  v_mul_f32 v37, v165, v173
  v_mul_f32 v38, v166, v174
  v_mfma_f32_16x16x32_bf16 v[104:107], v[204:207], a[116:119], v[104:107]
  v_mul_f32 v39, v167, v175
  v_fma_f32 v32, v32, v19, v19
  v_mfma_f32_16x16x32_bf16 v[104:107], v[176:179], a[132:135], v[104:107]
  v_rcp_f32 v32, v32
  v_mfma_f32_16x16x32_bf16 v[120:123], v[176:179], a[136:139], v[120:123]
  v_fma_f32 v33, v33, v19, v19
  v_fma_f32 v34, v34, v19, v19
  v_mfma_f32_16x16x32_bf16 v[120:123], v[204:207], a[120:123], v[120:123]
  v_fma_f32 v35, v35, v19, v19
  v_rcp_f32 v33, v33
  v_mfma_f32_16x16x32_bf16 v[120:123], v[200:203], a[104:107], v[120:123]
  v_rcp_f32 v34, v34
  v_mfma_f32_16x16x32_bf16 v[136:139], v[200:203], a[108:111], v[136:139]
  s_waitcnt vmcnt(14) lgkmcnt(0)
  s_barrier
  v_add_u32 v22, 24576, v22
  ds_read_b64_tr_b16 v[192:193], v22 offset:0
  v_mfma_f32_16x16x32_bf16 v[136:139], v[204:207], a[124:127], v[136:139]
  ds_read_b64_tr_b16 v[194:195], v22 offset:512
  s_add_u32 m0, s22, 57344
  v_mul_f32 v36, v36, v32
  v_mfma_f32_16x16x32_bf16 v[136:139], v[176:179], a[140:143], v[136:139]
  v_rcp_f32 v35, v35
  v_mfma_f32_16x16x32_bf16 v[92:95], v[188:191], a[128:131], v[92:95]
  ds_read_b64_tr_b16 v[196:197], v22 offset:4096
  v_mul_f32 v37, v37, v33
  v_mfma_f32_16x16x32_bf16 v[92:95], v[184:187], a[112:115], v[92:95]
  ds_read_b64_tr_b16 v[198:199], v22 offset:4608
  s_add_u32 s24, s20, 384
  v_mul_f32 v38, v38, v34
  v_mfma_f32_16x16x32_bf16 v[92:95], v[180:183], a[96:99], v[92:95]
  ds_read_b64_tr_b16 v[200:201], v22 offset:8192
  v_mul_f32 v39, v39, v35
  v_mfma_f32_16x16x32_bf16 v[108:111], v[180:183], a[100:103], v[108:111]
  ds_read_b64_tr_b16 v[202:203], v22 offset:8704
  v_cvt_pk_bf16_f32 v46, v36, v37
  v_cvt_pk_bf16_f32 v47, v38, v39
  v_mfma_f32_16x16x32_bf16 v[108:111], v[184:187], a[116:119], v[108:111]
  buffer_load_dwordx4 v240, s[40:43], s24 offen offset:0  lds
  v_mfma_f32_16x16x32_bf16 v[108:111], v[188:191], a[132:135], v[108:111]
  ds_write_b128 v4, v[44:47] offset:16640
  v_mfma_f32_16x16x32_bf16 v[124:127], v[188:191], a[136:139], v[124:127]
  buffer_store_dwordx4 v[44:47], v4, s[12:15], s31 offen offset:256 sc1
  v_mfma_f32_16x16x32_bf16 v[124:127], v[184:187], a[120:123], v[124:127]
  ds_read_b64_tr_b16 v[204:205], v22 offset:8
  v_xor_b32 v4, 512, v4
  v_mfma_f32_16x16x32_bf16 v[124:127], v[180:183], a[104:107], v[124:127]
  buffer_load_dwordx4 v241, s[40:43], s24 offen offset:1024  lds
  v_mfma_f32_16x16x32_bf16 v[140:143], v[180:183], a[108:111], v[140:143]
  ds_read_b64_tr_b16 v[206:207], v22 offset:520
  v_mul_f32 v24, v48, v48
  v_mfma_f32_16x16x32_bf16 v[140:143], v[184:187], a[124:127], v[140:143]
  v_mul_f32 v25, v49, v49
  v_mul_f32 v26, v50, v50
  v_mfma_f32_16x16x32_bf16 v[140:143], v[188:191], a[140:143], v[140:143]
  ds_read_b64_tr_b16 v[176:177], v22 offset:4104
  v_mul_f32 v27, v51, v51
  v_fma_f32 v24, v24, v16, v12
  s_waitcnt lgkmcnt(4)
  v_mfma_f32_16x16x32_bf16 v[80:83], v[200:203], a[176:179], v[80:83]
  ds_read_b64_tr_b16 v[178:179], v22 offset:4616
  v_fma_f32 v25, v25, v16, v12
  v_mfma_f32_16x16x32_bf16 v[80:83], v[196:199], a[160:163], v[80:83]
  ds_read_b64_tr_b16 v[180:181], v22 offset:8200
  v_fma_f32 v26, v26, v16, v12
  v_mfma_f32_16x16x32_bf16 v[80:83], v[192:195], a[144:147], v[80:83]
  ds_read_b64_tr_b16 v[182:183], v22 offset:8712
  v_fma_f32 v27, v27, v16, v12
  v_mfma_f32_16x16x32_bf16 v[96:99], v[192:195], a[148:151], v[96:99]
  buffer_load_dwordx4 v242, s[40:43], s24 offen offset:2048  lds
  s_add_u32 m0, s22, 69632
  v_mfma_f32_16x16x32_bf16 v[96:99], v[196:199], a[164:167], v[96:99]
  v_mul_f32 v24, v24, v48
  v_mul_f32 v25, v25, v49
  v_mfma_f32_16x16x32_bf16 v[96:99], v[200:203], a[180:183], v[96:99]
  v_exp_f32 v24, v24
  v_mfma_f32_16x16x32_bf16 v[112:115], v[200:203], a[184:187], v[112:115]
  ds_read_b64_tr_b16 v[184:185], v22 offset:12288
  v_mul_f32 v26, v26, v50
  v_mfma_f32_16x16x32_bf16 v[112:115], v[196:199], a[168:171], v[112:115]
  ds_read_b64_tr_b16 v[186:187], v22 offset:12800
  v_exp_f32 v25, v25
  v_mfma_f32_16x16x32_bf16 v[112:115], v[192:195], a[152:155], v[112:115]
  buffer_load_dwordx4 v240, s[44:47], s24 offen offset:0  lds
  v_mfma_f32_16x16x32_bf16 v[128:131], v[192:195], a[156:159], v[128:131]
  ds_read_b64_tr_b16 v[188:189], v22 offset:16384
  v_mul_f32 v27, v27, v51
  v_mfma_f32_16x16x32_bf16 v[128:131], v[196:199], a[172:175], v[128:131]
  buffer_load_dwordx4 v241, s[44:47], s24 offen offset:1024  lds
  v_mfma_f32_16x16x32_bf16 v[128:131], v[200:203], a[188:191], v[128:131]
  ds_read_b64_tr_b16 v[190:191], v22 offset:16896
  v_mul_f32 v28, v48, v56
  s_waitcnt lgkmcnt(4)
  v_mfma_f32_16x16x32_bf16 v[84:87], v[180:183], a[176:179], v[84:87]
  v_exp_f32 v26, v26
  v_mfma_f32_16x16x32_bf16 v[84:87], v[176:179], a[160:163], v[84:87]
  ds_read_b64_tr_b16 v[192:193], v22 offset:20480
  v_mul_f32 v29, v49, v57
  v_mfma_f32_16x16x32_bf16 v[84:87], v[204:207], a[144:147], v[84:87]
  ds_read_b64_tr_b16 v[194:195], v22 offset:20992
  v_mul_f32 v30, v50, v58
  v_mfma_f32_16x16x32_bf16 v[100:103], v[204:207], a[148:151], v[100:103]
  buffer_load_dwordx4 v242, s[44:47], s24 offen offset:2048  lds
  v_mfma_f32_16x16x32_bf16 v[100:103], v[176:179], a[164:167], v[100:103]
  ds_read_b64_tr_b16 v[196:197], v22 offset:12296
  v_exp_f32 v27, v27
  v_mfma_f32_16x16x32_bf16 v[100:103], v[180:183], a[180:183], v[100:103]
  v_mul_f32 v31, v51, v59
  v_fma_f32 v24, v24, v20, v20
  v_mfma_f32_16x16x32_bf16 v[116:119], v[180:183], a[184:187], v[116:119]
  ds_read_b64_tr_b16 v[198:199], v22 offset:12808
  v_fma_f32 v25, v25, v20, v20
  v_mfma_f32_16x16x32_bf16 v[116:119], v[176:179], a[168:171], v[116:119]
  v_rcp_f32 v24, v24
  v_mfma_f32_16x16x32_bf16 v[116:119], v[204:207], a[152:155], v[116:119]
  ds_read_b64_tr_b16 v[200:201], v22 offset:16392
  v_fma_f32 v26, v26, v20, v20
  v_mfma_f32_16x16x32_bf16 v[132:135], v[204:207], a[156:159], v[132:135]
  ds_read_b64_tr_b16 v[202:203], v22 offset:16904
  v_fma_f32 v27, v27, v20, v20
  v_mfma_f32_16x16x32_bf16 v[132:135], v[176:179], a[172:175], v[132:135]
  v_rcp_f32 v25, v25
  v_mfma_f32_16x16x32_bf16 v[132:135], v[180:183], a[188:191], v[132:135]
  ds_read_b64_tr_b16 v[204:205], v22 offset:20488
  v_rcp_f32 v26, v26
  s_waitcnt lgkmcnt(5)
  v_mfma_f32_16x16x32_bf16 v[88:91], v[192:195], a[176:179], v[88:91]
  v_rcp_f32 v27, v27
  v_mfma_f32_16x16x32_bf16 v[88:91], v[188:191], a[160:163], v[88:91]
  ds_read_b64_tr_b16 v[206:207], v22 offset:21000
  v_mul_f32 v28, v28, v24
  v_mfma_f32_16x16x32_bf16 v[88:91], v[184:187], a[144:147], v[88:91]
  v_mul_f32 v29, v29, v25
  v_mul_f32 v30, v30, v26
  v_mfma_f32_16x16x32_bf16 v[104:107], v[184:187], a[148:151], v[104:107]
  v_mul_f32 v31, v31, v27
  v_cvt_pk_bf16_f32 v40, v28, v29
  v_mfma_f32_16x16x32_bf16 v[104:107], v[188:191], a[164:167], v[104:107]
  v_cvt_pk_bf16_f32 v41, v30, v31
  v_mul_f32 v32, v52, v52
  v_mfma_f32_16x16x32_bf16 v[104:107], v[192:195], a[180:183], v[104:107]
  v_mul_f32 v33, v53, v53
  v_mul_f32 v34, v54, v54
  v_mfma_f32_16x16x32_bf16 v[120:123], v[192:195], a[184:187], v[120:123]
  v_mul_f32 v35, v55, v55
  v_fma_f32 v32, v32, v16, v12
  v_mfma_f32_16x16x32_bf16 v[120:123], v[188:191], a[168:171], v[120:123]
  v_fma_f32 v33, v33, v16, v12
  v_fma_f32 v34, v34, v16, v12
  v_fma_f32 v35, v35, v16, v12
  v_mfma_f32_16x16x32_bf16 v[120:123], v[184:187], a[152:155], v[120:123]
  v_mul_f32 v32, v32, v52
  v_mul_f32 v33, v33, v53
  v_mfma_f32_16x16x32_bf16 v[136:139], v[184:187], a[156:159], v[136:139]
  s_waitcnt vmcnt(15) lgkmcnt(0)
  s_barrier
  v_add_u32 v22, 24576, v22
  ds_read_b64_tr_b16 v[176:177], v22 offset:0
  v_mfma_f32_16x16x32_bf16 v[136:139], v[188:191], a[172:175], v[136:139]
  ds_read_b64_tr_b16 v[178:179], v22 offset:512
  s_add_u32 m0, s22, 81920
  v_mul_f32 v34, v34, v54
  v_mfma_f32_16x16x32_bf16 v[136:139], v[192:195], a[188:191], v[136:139]
  v_exp_f32 v32, v32
  v_mfma_f32_16x16x32_bf16 v[92:95], v[204:207], a[176:179], v[92:95]
  ds_read_b64_tr_b16 v[180:181], v22 offset:4096
  v_mul_f32 v35, v35, v55
  v_mfma_f32_16x16x32_bf16 v[92:95], v[200:203], a[160:163], v[92:95]
  ds_read_b64_tr_b16 v[182:183], v22 offset:4608
  s_add_u32 s24, s20, 885120
  v_mul_f32 v36, v52, v60
  v_mfma_f32_16x16x32_bf16 v[92:95], v[196:199], a[144:147], v[92:95]
  ds_read_b64_tr_b16 v[184:185], v22 offset:8192
  v_mul_f32 v37, v53, v61
  v_mfma_f32_16x16x32_bf16 v[108:111], v[196:199], a[148:151], v[108:111]
  ds_read_b64_tr_b16 v[186:187], v22 offset:8704
  v_exp_f32 v33, v33
  v_mfma_f32_16x16x32_bf16 v[108:111], v[200:203], a[164:167], v[108:111]
  buffer_load_dwordx4 v240, s[40:43], s24 offen offset:0  lds
  v_mfma_f32_16x16x32_bf16 v[108:111], v[204:207], a[180:183], v[108:111]
  v_exp_f32 v34, v34
  v_mfma_f32_16x16x32_bf16 v[124:127], v[204:207], a[184:187], v[124:127]
  v_exp_f32 v35, v35
  v_mfma_f32_16x16x32_bf16 v[124:127], v[200:203], a[168:171], v[124:127]
  ds_read_b64_tr_b16 v[188:189], v22 offset:8
  v_mul_f32 v38, v54, v62
  v_mfma_f32_16x16x32_bf16 v[124:127], v[196:199], a[152:155], v[124:127]
  buffer_load_dwordx4 v241, s[40:43], s24 offen offset:1024  lds
  v_mfma_f32_16x16x32_bf16 v[140:143], v[196:199], a[156:159], v[140:143]
  ds_read_b64_tr_b16 v[190:191], v22 offset:520
  v_mul_f32 v39, v55, v63
  v_mfma_f32_16x16x32_bf16 v[140:143], v[200:203], a[172:175], v[140:143]
  v_fma_f32 v32, v32, v20, v20
  v_fma_f32 v33, v33, v20, v20
  v_mfma_f32_16x16x32_bf16 v[140:143], v[204:207], a[188:191], v[140:143]
  ds_read_b64_tr_b16 v[192:193], v22 offset:4104
  v_rcp_f32 v32, v32
  s_waitcnt lgkmcnt(3)
  v_mfma_f32_16x16x32_bf16 v[80:83], v[184:187], a[224:227], v[80:83]
  ds_read_b64_tr_b16 v[194:195], v22 offset:4616
  v_fma_f32 v34, v34, v20, v20
  v_mfma_f32_16x16x32_bf16 v[80:83], v[180:183], a[208:211], v[80:83]
  ds_read_b64_tr_b16 v[196:197], v22 offset:8200
  v_fma_f32 v35, v35, v20, v20
  v_mfma_f32_16x16x32_bf16 v[80:83], v[176:179], a[192:195], v[80:83]
  ds_read_b64_tr_b16 v[198:199], v22 offset:8712
  v_mul_f32 v36, v36, v32
  v_mfma_f32_16x16x32_bf16 v[96:99], v[176:179], a[196:199], v[96:99]
  buffer_load_dwordx4 v242, s[40:43], s24 offen offset:2048  lds
  s_add_u32 m0, s22, 94208
  v_mfma_f32_16x16x32_bf16 v[96:99], v[180:183], a[212:215], v[96:99]
  v_rcp_f32 v33, v33
  v_mfma_f32_16x16x32_bf16 v[96:99], v[184:187], a[228:231], v[96:99]
  v_rcp_f32 v34, v34
  v_mfma_f32_16x16x32_bf16 v[112:115], v[184:187], a[232:235], v[112:115]
  ds_read_b64_tr_b16 v[200:201], v22 offset:12288
  v_mul_f32 v37, v37, v33
  v_mfma_f32_16x16x32_bf16 v[112:115], v[180:183], a[216:219], v[112:115]
  ds_read_b64_tr_b16 v[202:203], v22 offset:12800
  v_rcp_f32 v35, v35
  v_mfma_f32_16x16x32_bf16 v[112:115], v[176:179], a[200:203], v[112:115]
  buffer_load_dwordx4 v240, s[44:47], s24 offen offset:0  lds
  v_mfma_f32_16x16x32_bf16 v[128:131], v[176:179], a[204:207], v[128:131]
  ds_read_b64_tr_b16 v[204:205], v22 offset:16384
  v_mul_f32 v38, v38, v34
  v_mfma_f32_16x16x32_bf16 v[128:131], v[180:183], a[220:223], v[128:131]
  buffer_load_dwordx4 v241, s[44:47], s24 offen offset:1024  lds
  v_mfma_f32_16x16x32_bf16 v[128:131], v[184:187], a[236:239], v[128:131]
  ds_read_b64_tr_b16 v[206:207], v22 offset:16896
  v_mul_f32 v39, v39, v35
  s_waitcnt lgkmcnt(4)
  v_mfma_f32_16x16x32_bf16 v[84:87], v[196:199], a[224:227], v[84:87]
  v_cvt_pk_bf16_f32 v42, v36, v37
  v_cvt_pk_bf16_f32 v43, v38, v39
  v_mfma_f32_16x16x32_bf16 v[84:87], v[192:195], a[208:211], v[84:87]
  ds_read_b64_tr_b16 v[176:177], v22 offset:20480
  v_mul_f32 v24, v64, v64
  v_mfma_f32_16x16x32_bf16 v[84:87], v[188:191], a[192:195], v[84:87]
  ds_read_b64_tr_b16 v[178:179], v22 offset:20992
  v_mul_f32 v25, v65, v65
  v_mfma_f32_16x16x32_bf16 v[100:103], v[188:191], a[196:199], v[100:103]
  buffer_load_dwordx4 v242, s[44:47], s24 offen offset:2048  lds
  v_mfma_f32_16x16x32_bf16 v[100:103], v[192:195], a[212:215], v[100:103]
  ds_read_b64_tr_b16 v[180:181], v22 offset:12296
  ds_write_b128 v4, v[40:43] offset:16384
  v_mfma_f32_16x16x32_bf16 v[100:103], v[196:199], a[228:231], v[100:103]
  buffer_store_dwordx4 v[40:43], v4, s[12:15], s31 offen offset:0 sc1
  v_mfma_f32_16x16x32_bf16 v[116:119], v[196:199], a[232:235], v[116:119]
  ds_read_b64_tr_b16 v[182:183], v22 offset:12808
  v_mul_f32 v26, v66, v66
  v_mfma_f32_16x16x32_bf16 v[116:119], v[192:195], a[216:219], v[116:119]
  v_mul_f32 v27, v67, v67
  v_fma_f32 v24, v24, v17, v13
  v_mfma_f32_16x16x32_bf16 v[116:119], v[188:191], a[200:203], v[116:119]
  ds_read_b64_tr_b16 v[184:185], v22 offset:16392
  v_fma_f32 v25, v25, v17, v13
  v_mfma_f32_16x16x32_bf16 v[132:135], v[188:191], a[204:207], v[132:135]
  ds_read_b64_tr_b16 v[186:187], v22 offset:16904
  v_fma_f32 v26, v26, v17, v13
  v_mfma_f32_16x16x32_bf16 v[132:135], v[192:195], a[220:223], v[132:135]
  v_fma_f32 v27, v27, v17, v13
  v_mul_f32 v24, v24, v64
  v_mfma_f32_16x16x32_bf16 v[132:135], v[196:199], a[236:239], v[132:135]
  ds_read_b64_tr_b16 v[188:189], v22 offset:20488
  v_exp_f32 v24, v24
  s_waitcnt lgkmcnt(6)
  v_mfma_f32_16x16x32_bf16 v[88:91], v[176:179], a[224:227], v[88:91]
  v_mul_f32 v25, v25, v65
  v_mul_f32 v26, v26, v66
  v_mfma_f32_16x16x32_bf16 v[88:91], v[204:207], a[208:211], v[88:91]
  ds_read_b64_tr_b16 v[190:191], v22 offset:21000
  v_mul_f32 v27, v27, v67
  v_mfma_f32_16x16x32_bf16 v[88:91], v[200:203], a[192:195], v[88:91]
  v_exp_f32 v25, v25
  v_mfma_f32_16x16x32_bf16 v[104:107], v[200:203], a[196:199], v[104:107]
  v_exp_f32 v26, v26
  v_mfma_f32_16x16x32_bf16 v[104:107], v[204:207], a[212:215], v[104:107]
  v_exp_f32 v27, v27
  v_mfma_f32_16x16x32_bf16 v[104:107], v[176:179], a[228:231], v[104:107]
  v_mul_f32 v28, v64, v72
  v_mul_f32 v29, v65, v73
  v_mfma_f32_16x16x32_bf16 v[120:123], v[176:179], a[232:235], v[120:123]
  v_mul_f32 v30, v66, v74
  v_mul_f32 v31, v67, v75
  v_mfma_f32_16x16x32_bf16 v[120:123], v[204:207], a[216:219], v[120:123]
  v_fma_f32 v24, v24, v21, v21
  v_fma_f32 v25, v25, v21, v21
  v_fma_f32 v26, v26, v21, v21
  v_mfma_f32_16x16x32_bf16 v[120:123], v[200:203], a[200:203], v[120:123]
  v_rcp_f32 v24, v24
  v_mfma_f32_16x16x32_bf16 v[136:139], v[200:203], a[204:207], v[136:139]
  s_waitcnt vmcnt(15) lgkmcnt(0)
  s_barrier
  v_add_u32 v22, 24576, v22
  ds_read_b64_tr_b16 v[192:193], v22 offset:0
  v_mfma_f32_16x16x32_bf16 v[136:139], v[204:207], a[220:223], v[136:139]
  ds_read_b64_tr_b16 v[194:195], v22 offset:512
  s_add_u32 m0, s22, 106496
  v_fma_f32 v27, v27, v21, v21
  v_mfma_f32_16x16x32_bf16 v[136:139], v[176:179], a[236:239], v[136:139]
  v_rcp_f32 v25, v25
  v_mfma_f32_16x16x32_bf16 v[92:95], v[188:191], a[224:227], v[92:95]
  ds_read_b64_tr_b16 v[196:197], v22 offset:4096
  v_mul_f32 v28, v28, v24
  v_mfma_f32_16x16x32_bf16 v[92:95], v[184:187], a[208:211], v[92:95]
  ds_read_b64_tr_b16 v[198:199], v22 offset:4608
  s_add_u32 s24, s20, 1769856
  v_mul_f32 v29, v29, v25
  v_mfma_f32_16x16x32_bf16 v[92:95], v[180:183], a[192:195], v[92:95]
  ds_read_b64_tr_b16 v[200:201], v22 offset:8192
  v_cvt_pk_bf16_f32 v44, v28, v29
  v_mfma_f32_16x16x32_bf16 v[108:111], v[180:183], a[196:199], v[108:111]
  ds_read_b64_tr_b16 v[202:203], v22 offset:8704
  v_rcp_f32 v26, v26
  v_mfma_f32_16x16x32_bf16 v[108:111], v[184:187], a[212:215], v[108:111]
  buffer_load_dwordx4 v240, s[40:43], s24 offen offset:0  lds
  v_mfma_f32_16x16x32_bf16 v[108:111], v[188:191], a[228:231], v[108:111]
  v_rcp_f32 v27, v27
  v_mfma_f32_16x16x32_bf16 v[124:127], v[188:191], a[232:235], v[124:127]
  v_mul_f32 v30, v30, v26
  v_mul_f32 v31, v31, v27
  v_mfma_f32_16x16x32_bf16 v[124:127], v[184:187], a[216:219], v[124:127]
  ds_read_b64_tr_b16 v[204:205], v22 offset:8
  v_cvt_pk_bf16_f32 v45, v30, v31
  v_mfma_f32_16x16x32_bf16 v[124:127], v[180:183], a[200:203], v[124:127]
  buffer_load_dwordx4 v241, s[40:43], s24 offen offset:1024  lds
  v_mfma_f32_16x16x32_bf16 v[140:143], v[180:183], a[204:207], v[140:143]
  ds_read_b64_tr_b16 v[206:207], v22 offset:520
  v_mul_f32 v32, v68, v68
  v_mfma_f32_16x16x32_bf16 v[140:143], v[184:187], a[220:223], v[140:143]
  v_mul_f32 v33, v69, v69
  v_mul_f32 v34, v70, v70
  v_mfma_f32_16x16x32_bf16 v[140:143], v[188:191], a[236:239], v[140:143]
  ds_read_b64_tr_b16 v[176:177], v22 offset:4104
  v_mul_f32 v35, v71, v71
  v_fma_f32 v32, v32, v17, v13
  s_waitcnt lgkmcnt(3)
  v_mfma_f32_16x16x32_bf16 v[80:83], v[200:203], v[224:227], v[80:83]
  ds_read_b64_tr_b16 v[178:179], v22 offset:4616
  v_fma_f32 v33, v33, v17, v13
  v_mfma_f32_16x16x32_bf16 v[80:83], v[196:199], v[208:211], v[80:83]
  ds_read_b64_tr_b16 v[180:181], v22 offset:8200
  v_fma_f32 v34, v34, v17, v13
  v_mfma_f32_16x16x32_bf16 v[80:83], v[192:195], a[240:243], v[80:83]
  ds_read_b64_tr_b16 v[182:183], v22 offset:8712
  v_fma_f32 v35, v35, v17, v13
  v_mfma_f32_16x16x32_bf16 v[96:99], v[192:195], a[244:247], v[96:99]
  buffer_load_dwordx4 v242, s[40:43], s24 offen offset:2048  lds
  s_add_u32 m0, s22, 118784
  v_mfma_f32_16x16x32_bf16 v[96:99], v[196:199], v[212:215], v[96:99]
  v_mul_f32 v32, v32, v68
  v_mul_f32 v33, v33, v69
  v_mfma_f32_16x16x32_bf16 v[96:99], v[200:203], v[228:231], v[96:99]
L_pad5:
  s_cbranch_execz L_pad6
  v_exp_f32 v32, v32
  v_mfma_f32_16x16x32_bf16 v[112:115], v[200:203], v[232:235], v[112:115]
  ds_read_b64_tr_b16 v[184:185], v22 offset:12288
  v_mul_f32 v34, v34, v70
  v_mfma_f32_16x16x32_bf16 v[112:115], v[196:199], v[216:219], v[112:115]
  ds_read_b64_tr_b16 v[186:187], v22 offset:12800
  v_exp_f32 v33, v33
  v_mfma_f32_16x16x32_bf16 v[112:115], v[192:195], a[248:251], v[112:115]
  buffer_load_dwordx4 v240, s[44:47], s24 offen offset:0  lds
  v_mfma_f32_16x16x32_bf16 v[128:131], v[192:195], a[252:255], v[128:131]
  ds_read_b64_tr_b16 v[188:189], v22 offset:16384
  v_mul_f32 v35, v35, v71
  v_mfma_f32_16x16x32_bf16 v[128:131], v[196:199], v[220:223], v[128:131]
  buffer_load_dwordx4 v241, s[44:47], s24 offen offset:1024  lds
  v_mfma_f32_16x16x32_bf16 v[128:131], v[200:203], v[236:239], v[128:131]
  ds_read_b64_tr_b16 v[190:191], v22 offset:16896
  v_mul_f32 v36, v68, v76
  s_waitcnt lgkmcnt(4)
  v_mfma_f32_16x16x32_bf16 v[84:87], v[180:183], v[224:227], v[84:87]
  v_exp_f32 v34, v34
  v_mfma_f32_16x16x32_bf16 v[84:87], v[176:179], v[208:211], v[84:87]
  ds_read_b64_tr_b16 v[192:193], v22 offset:20480
  v_mul_f32 v37, v69, v77
  v_mfma_f32_16x16x32_bf16 v[84:87], v[204:207], a[240:243], v[84:87]
  ds_read_b64_tr_b16 v[194:195], v22 offset:20992
  v_mul_f32 v38, v70, v78
  v_mfma_f32_16x16x32_bf16 v[100:103], v[204:207], a[244:247], v[100:103]
  buffer_load_dwordx4 v242, s[44:47], s24 offen offset:2048  lds
  v_mfma_f32_16x16x32_bf16 v[100:103], v[176:179], v[212:215], v[100:103]
  ds_read_b64_tr_b16 v[196:197], v22 offset:12296
  v_exp_f32 v35, v35
  v_mfma_f32_16x16x32_bf16 v[100:103], v[180:183], v[228:231], v[100:103]
  v_mul_f32 v39, v71, v79
  v_fma_f32 v32, v32, v21, v21
  v_mfma_f32_16x16x32_bf16 v[116:119], v[180:183], v[232:235], v[116:119]
  ds_read_b64_tr_b16 v[198:199], v22 offset:12808
  v_fma_f32 v33, v33, v21, v21
  v_mfma_f32_16x16x32_bf16 v[116:119], v[176:179], v[216:219], v[116:119]
  v_rcp_f32 v32, v32
  v_mfma_f32_16x16x32_bf16 v[116:119], v[204:207], a[248:251], v[116:119]
  ds_read_b64_tr_b16 v[200:201], v22 offset:16392
  v_fma_f32 v34, v34, v21, v21
  v_mfma_f32_16x16x32_bf16 v[132:135], v[204:207], a[252:255], v[132:135]
  ds_read_b64_tr_b16 v[202:203], v22 offset:16904
  v_fma_f32 v35, v35, v21, v21
  v_mfma_f32_16x16x32_bf16 v[132:135], v[176:179], v[220:223], v[132:135]
  v_rcp_f32 v33, v33
  v_mfma_f32_16x16x32_bf16 v[132:135], v[180:183], v[236:239], v[132:135]
  ds_read_b64_tr_b16 v[204:205], v22 offset:20488
  v_rcp_f32 v34, v34
  s_waitcnt lgkmcnt(5)
  v_mfma_f32_16x16x32_bf16 v[88:91], v[192:195], v[224:227], v[88:91]
  s_add_u32 s26, s53, 0
  s_mov_b64 exec, s[98:99]
  buffer_load_dwordx2 v[248:249], v250, s[12:15], s26 offen sc1
  s_mov_b64 exec, -1
  v_mfma_f32_16x16x32_bf16 v[88:91], v[188:191], v[208:211], v[88:91]
  ds_read_b64_tr_b16 v[206:207], v22 offset:21000
  v_mul_f32 v36, v36, v32
  v_mfma_f32_16x16x32_bf16 v[88:91], v[184:187], a[240:243], v[88:91]
  v_rcp_f32 v35, v35
  v_mfma_f32_16x16x32_bf16 v[104:107], v[184:187], a[244:247], v[104:107]
  v_mul_f32 v37, v37, v33
  v_mul_f32 v38, v38, v34
  v_mfma_f32_16x16x32_bf16 v[104:107], v[188:191], v[212:215], v[104:107]
  v_mul_f32 v39, v39, v35
  v_cvt_pk_bf16_f32 v46, v36, v37
  v_mfma_f32_16x16x32_bf16 v[104:107], v[192:195], v[228:231], v[104:107]
  v_cvt_pk_bf16_f32 v47, v38, v39
  v_mfma_f32_16x16x32_bf16 v[120:123], v[192:195], v[232:235], v[120:123]
  ds_write_b128 v4, v[44:47] offset:16640
  v_mfma_f32_16x16x32_bf16 v[120:123], v[188:191], v[216:219], v[120:123]
  buffer_store_dwordx4 v[44:47], v4, s[12:15], s31 offen offset:256 sc1
  v_mfma_f32_16x16x32_bf16 v[120:123], v[184:187], a[248:251], v[120:123]
  v_mfma_f32_16x16x32_bf16 v[136:139], v[184:187], a[252:255], v[136:139]
  s_waitcnt vmcnt(15) lgkmcnt(1)
  s_barrier
  v_add_u32 v22, 4294893568, v22
  ds_read_b64_tr_b16 v[176:177], v22 offset:0
  v_mfma_f32_16x16x32_bf16 v[136:139], v[188:191], v[220:223], v[136:139]
  ds_read_b64_tr_b16 v[178:179], v22 offset:512
  s_add_u32 m0, s22, 131072
  v_mfma_f32_16x16x32_bf16 v[136:139], v[192:195], v[236:239], v[136:139]
  v_mfma_f32_16x16x32_bf16 v[92:95], v[204:207], v[224:227], v[92:95]
  ds_read_b64_tr_b16 v[180:181], v22 offset:4096
  v_mfma_f32_16x16x32_bf16 v[92:95], v[200:203], v[208:211], v[92:95]
  ds_read_b64_tr_b16 v[182:183], v22 offset:4608
  s_add_u32 s24, s20, 2654592
  v_mfma_f32_16x16x32_bf16 v[92:95], v[196:199], a[240:243], v[92:95]
  ds_read_b64_tr_b16 v[184:185], v22 offset:8192
  v_mfma_f32_16x16x32_bf16 v[108:111], v[196:199], a[244:247], v[108:111]
  ds_read_b64_tr_b16 v[186:187], v22 offset:8704
  v_mfma_f32_16x16x32_bf16 v[108:111], v[200:203], v[212:215], v[108:111]
  buffer_load_dwordx4 v240, s[40:43], s24 offen offset:0  lds
  v_mfma_f32_16x16x32_bf16 v[108:111], v[204:207], v[228:231], v[108:111]
  v_mfma_f32_16x16x32_bf16 v[124:127], v[204:207], v[232:235], v[124:127]
  v_mfma_f32_16x16x32_bf16 v[124:127], v[200:203], v[216:219], v[124:127]
  ds_read_b64_tr_b16 v[188:189], v22 offset:8
  v_mfma_f32_16x16x32_bf16 v[124:127], v[196:199], a[248:251], v[124:127]
  buffer_load_dwordx4 v241, s[40:43], s24 offen offset:1024  lds
  v_mfma_f32_16x16x32_bf16 v[140:143], v[196:199], a[252:255], v[140:143]
  ds_read_b64_tr_b16 v[190:191], v22 offset:520
  v_mfma_f32_16x16x32_bf16 v[140:143], v[200:203], v[220:223], v[140:143]
  v_mfma_f32_16x16x32_bf16 v[140:143], v[204:207], v[236:239], v[140:143]
  ds_read_b64_tr_b16 v[192:193], v22 offset:4104
  s_waitcnt lgkmcnt(3)
  v_mfma_f32_16x16x32_bf16 v[144:147], v[184:187], a[32:35], 0
  ds_read_b64_tr_b16 v[194:195], v22 offset:4616
  v_mfma_f32_16x16x32_bf16 v[144:147], v[180:183], a[16:19], v[144:147]
  ds_read_b64_tr_b16 v[196:197], v22 offset:8200
  v_mfma_f32_16x16x32_bf16 v[144:147], v[176:179], a[0:3], v[144:147]
  ds_read_b64_tr_b16 v[198:199], v22 offset:8712
  v_mfma_f32_16x16x32_bf16 v[160:163], v[176:179], a[4:7], 0
  buffer_load_dwordx4 v242, s[40:43], s24 offen offset:2048  lds
  s_add_u32 m0, s22, 143360
  v_mfma_f32_16x16x32_bf16 v[160:163], v[180:183], a[20:23], v[160:163]
  v_mfma_f32_16x16x32_bf16 v[160:163], v[184:187], a[36:39], v[160:163]
  v_mfma_f32_16x16x32_bf16 v[48:51], v[184:187], a[40:43], 0
  ds_read_b64_tr_b16 v[200:201], v22 offset:12288
  v_mfma_f32_16x16x32_bf16 v[48:51], v[180:183], a[24:27], v[48:51]
  ds_read_b64_tr_b16 v[202:203], v22 offset:12800
  v_mfma_f32_16x16x32_bf16 v[48:51], v[176:179], a[8:11], v[48:51]
  buffer_load_dwordx4 v240, s[44:47], s24 offen offset:0  lds
  s_add_u32 s31, s10, 40960
  v_mfma_f32_16x16x32_bf16 v[64:67], v[176:179], a[12:15], 0
  ds_read_b64_tr_b16 v[204:205], v22 offset:16384
  v_xor_b32 v4, 512, v4
  v_mfma_f32_16x16x32_bf16 v[64:67], v[180:183], a[28:31], v[64:67]
  buffer_load_dwordx4 v241, s[44:47], s24 offen offset:1024  lds
  v_mfma_f32_16x16x32_bf16 v[64:67], v[184:187], a[44:47], v[64:67]
  ds_read_b64_tr_b16 v[206:207], v22 offset:16896
  v_mul_f32 v24, v80, v80
  v_mul_f32 v25, v81, v81
  s_waitcnt lgkmcnt(4)
  v_mfma_f32_16x16x32_bf16 v[148:151], v[196:199], a[32:35], 0
  v_mul_f32 v26, v82, v82
  v_mul_f32 v27, v83, v83
  v_mfma_f32_16x16x32_bf16 v[148:151], v[192:195], a[16:19], v[148:151]
  ds_read_b64_tr_b16 v[176:177], v22 offset:20480
  v_fma_f32 v24, v24, v14, v10
  v_mfma_f32_16x16x32_bf16 v[148:151], v[188:191], a[0:3], v[148:151]
  ds_read_b64_tr_b16 v[178:179], v22 offset:20992
  v_fma_f32 v25, v25, v14, v10
  v_mfma_f32_16x16x32_bf16 v[164:167], v[188:191], a[4:7], 0
  buffer_load_dwordx4 v242, s[44:47], s24 offen offset:2048  lds
  v_mfma_f32_16x16x32_bf16 v[164:167], v[192:195], a[20:23], v[164:167]
  ds_read_b64_tr_b16 v[180:181], v22 offset:12296
  v_fma_f32 v26, v26, v14, v10
  v_fma_f32 v27, v27, v14, v10
  v_mfma_f32_16x16x32_bf16 v[164:167], v[196:199], a[36:39], v[164:167]
  v_mul_f32 v24, v24, v80
  v_mul_f32 v25, v25, v81
  v_mfma_f32_16x16x32_bf16 v[52:55], v[196:199], a[40:43], 0
  ds_read_b64_tr_b16 v[182:183], v22 offset:12808
  v_mul_f32 v26, v26, v82
  v_mfma_f32_16x16x32_bf16 v[52:55], v[192:195], a[24:27], v[52:55]
  v_mul_f32 v27, v27, v83
  v_exp_f32 v24, v24
  v_mfma_f32_16x16x32_bf16 v[52:55], v[188:191], a[8:11], v[52:55]
  ds_read_b64_tr_b16 v[184:185], v22 offset:16392
  v_mul_f32 v28, v80, v88
  v_mfma_f32_16x16x32_bf16 v[68:71], v[188:191], a[12:15], 0
  ds_read_b64_tr_b16 v[186:187], v22 offset:16904
  v_mul_f32 v29, v81, v89
  v_mfma_f32_16x16x32_bf16 v[68:71], v[192:195], a[28:31], v[68:71]
  v_exp_f32 v25, v25
  v_mfma_f32_16x16x32_bf16 v[68:71], v[196:199], a[44:47], v[68:71]
  ds_read_b64_tr_b16 v[188:189], v22 offset:20488
  v_exp_f32 v26, v26
  s_waitcnt lgkmcnt(5)
  v_mfma_f32_16x16x32_bf16 v[152:155], v[176:179], a[32:35], 0
  v_exp_f32 v27, v27
  v_mfma_f32_16x16x32_bf16 v[152:155], v[204:207], a[16:19], v[152:155]
  ds_read_b64_tr_b16 v[190:191], v22 offset:21000
  v_mul_f32 v30, v82, v90
  v_mfma_f32_16x16x32_bf16 v[152:155], v[200:203], a[0:3], v[152:155]
  v_mul_f32 v31, v83, v91
  v_fma_f32 v24, v24, v18, v18
  v_mfma_f32_16x16x32_bf16 v[168:171], v[200:203], a[4:7], 0
  v_fma_f32 v25, v25, v18, v18
  v_rcp_f32 v24, v24
  v_mfma_f32_16x16x32_bf16 v[168:171], v[204:207], a[20:23], v[168:171]
  v_rcp_f32 v25, v25
  v_mfma_f32_16x16x32_bf16 v[168:171], v[176:179], a[36:39], v[168:171]
  v_fma_f32 v26, v26, v18, v18
  v_fma_f32 v27, v27, v18, v18
  v_mfma_f32_16x16x32_bf16 v[56:59], v[176:179], a[40:43], 0
  v_rcp_f32 v26, v26
  v_mfma_f32_16x16x32_bf16 v[56:59], v[204:207], a[24:27], v[56:59]
  v_rcp_f32 v27, v27
  v_mul_f32 v28, v28, v24
  v_mfma_f32_16x16x32_bf16 v[56:59], v[200:203], a[8:11], v[56:59]
  v_mul_f32 v29, v29, v25
  v_mul_f32 v30, v30, v26
  v_mfma_f32_16x16x32_bf16 v[72:75], v[200:203], a[12:15], 0
  s_waitcnt vmcnt(15) lgkmcnt(0)
  s_barrier
  v_add_u32 v22, 24576, v22
  ds_read_b64_tr_b16 v[192:193], v22 offset:0
  v_mfma_f32_16x16x32_bf16 v[72:75], v[204:207], a[28:31], v[72:75]
  ds_read_b64_tr_b16 v[194:195], v22 offset:512
  s_add_u32 m0, s22, 57344
  v_mul_f32 v31, v31, v27
  v_mfma_f32_16x16x32_bf16 v[72:75], v[176:179], a[44:47], v[72:75]
  v_cvt_pk_bf16_f32 v40, v28, v29
  v_cvt_pk_bf16_f32 v41, v30, v31
  v_mul_f32 v32, v84, v84
  v_mfma_f32_16x16x32_bf16 v[156:159], v[188:191], a[32:35], 0
  ds_read_b64_tr_b16 v[196:197], v22 offset:4096
  v_mul_f32 v33, v85, v85
  v_mfma_f32_16x16x32_bf16 v[156:159], v[184:187], a[16:19], v[156:159]
  ds_read_b64_tr_b16 v[198:199], v22 offset:4608
  s_add_u32 s24, s20, 3539328
  v_mul_f32 v34, v86, v86
  v_mfma_f32_16x16x32_bf16 v[156:159], v[180:183], a[0:3], v[156:159]
  ds_read_b64_tr_b16 v[200:201], v22 offset:8192
  v_mul_f32 v35, v87, v87
  v_mfma_f32_16x16x32_bf16 v[172:175], v[180:183], a[4:7], 0
  ds_read_b64_tr_b16 v[202:203], v22 offset:8704
  v_fma_f32 v32, v32, v14, v10
  v_fma_f32 v33, v33, v14, v10
  v_mfma_f32_16x16x32_bf16 v[172:175], v[184:187], a[20:23], v[172:175]
  buffer_load_dwordx4 v240, s[40:43], s24 offen offset:0  lds
  v_mfma_f32_16x16x32_bf16 v[172:175], v[188:191], a[36:39], v[172:175]
  v_fma_f32 v34, v34, v14, v10
  v_fma_f32 v35, v35, v14, v10
  v_mfma_f32_16x16x32_bf16 v[60:63], v[188:191], a[40:43], 0
  v_mul_f32 v32, v32, v84
  v_mul_f32 v33, v33, v85
  v_mfma_f32_16x16x32_bf16 v[60:63], v[184:187], a[24:27], v[60:63]
  ds_read_b64_tr_b16 v[204:205], v22 offset:8
  v_exp_f32 v32, v32
  v_mfma_f32_16x16x32_bf16 v[60:63], v[180:183], a[8:11], v[60:63]
  buffer_load_dwordx4 v241, s[40:43], s24 offen offset:1024  lds
  v_mfma_f32_16x16x32_bf16 v[76:79], v[180:183], a[12:15], 0
  ds_read_b64_tr_b16 v[206:207], v22 offset:520
  v_mul_f32 v34, v34, v86
  v_mfma_f32_16x16x32_bf16 v[76:79], v[184:187], a[28:31], v[76:79]
  v_exp_f32 v33, v33
  v_mfma_f32_16x16x32_bf16 v[76:79], v[188:191], a[44:47], v[76:79]
  ds_read_b64_tr_b16 v[176:177], v22 offset:4104
  v_exp_f32 v34, v34
  s_waitcnt lgkmcnt(3)
  v_mfma_f32_16x16x32_bf16 v[144:147], v[200:203], a[80:83], v[144:147]
  ds_read_b64_tr_b16 v[178:179], v22 offset:4616
  v_mul_f32 v35, v35, v87
  v_mfma_f32_16x16x32_bf16 v[144:147], v[196:199], a[64:67], v[144:147]
  ds_read_b64_tr_b16 v[180:181], v22 offset:8200
  v_mul_f32 v36, v84, v92
  v_mfma_f32_16x16x32_bf16 v[144:147], v[192:195], a[48:51], v[144:147]
  ds_read_b64_tr_b16 v[182:183], v22 offset:8712
  v_mul_f32 v37, v85, v93
  v_mfma_f32_16x16x32_bf16 v[160:163], v[192:195], a[52:55], v[160:163]
  buffer_load_dwordx4 v242, s[40:43], s24 offen offset:2048  lds
  s_add_u32 m0, s22, 69632
  v_mfma_f32_16x16x32_bf16 v[160:163], v[196:199], a[68:71], v[160:163]
  s_waitcnt vmcnt(10)
  v_cmp_eq_u64 vcc, s[56:57], v[248:249]
  s_nop 1
  s_orn2_b64 vcc, vcc, s[98:99]
  s_cmp_eq_u64 vcc, -1
  s_cbranch_scc0 L_lp52s
L_ok51:
  v_mul_f32 v38, v86, v94
  v_mfma_f32_16x16x32_bf16 v[160:163], v[200:203], a[84:87], v[160:163]
  v_exp_f32 v35, v35
  v_mfma_f32_16x16x32_bf16 v[48:51], v[200:203], a[88:91], v[48:51]
  ds_read_b64_tr_b16 v[184:185], v22 offset:12288
  v_mul_f32 v39, v87, v95
  v_mfma_f32_16x16x32_bf16 v[48:51], v[196:199], a[72:75], v[48:51]
  ds_read_b64_tr_b16 v[186:187], v22 offset:12800
  v_fma_f32 v32, v32, v18, v18
  v_fma_f32 v33, v33, v18, v18
  v_mfma_f32_16x16x32_bf16 v[48:51], v[192:195], a[56:59], v[48:51]
  buffer_load_dwordx4 v240, s[44:47], s24 offen offset:0  lds
  v_mfma_f32_16x16x32_bf16 v[64:67], v[192:195], a[60:63], v[64:67]
  ds_read_b64_tr_b16 v[188:189], v22 offset:16384
  v_fma_f32 v34, v34, v18, v18
  v_mfma_f32_16x16x32_bf16 v[64:67], v[196:199], a[76:79], v[64:67]
  buffer_load_dwordx4 v241, s[44:47], s24 offen offset:1024  lds
  v_mfma_f32_16x16x32_bf16 v[64:67], v[200:203], a[92:95], v[64:67]
  ds_read_b64_tr_b16 v[190:191], v22 offset:16896
  v_rcp_f32 v32, v32
  s_waitcnt lgkmcnt(4)
  v_mfma_f32_16x16x32_bf16 v[148:151], v[180:183], a[80:83], v[148:151]
  s_add_u32 s25, s11, 0
  buffer_load_dwordx4 a[0:3], v243, s[12:15], s25 offen offset:0 sc1
  v_mfma_f32_16x16x32_bf16 v[148:151], v[176:179], a[64:67], v[148:151]
  ds_read_b64_tr_b16 v[192:193], v22 offset:20480
  v_fma_f32 v35, v35, v18, v18
  v_mfma_f32_16x16x32_bf16 v[148:151], v[204:207], a[48:51], v[148:151]
  ds_read_b64_tr_b16 v[194:195], v22 offset:20992
  v_mul_f32 v36, v36, v32
  v_mfma_f32_16x16x32_bf16 v[164:167], v[204:207], a[52:55], v[164:167]
  buffer_load_dwordx4 v242, s[44:47], s24 offen offset:2048  lds
  v_mfma_f32_16x16x32_bf16 v[164:167], v[176:179], a[68:71], v[164:167]
  ds_read_b64_tr_b16 v[196:197], v22 offset:12296
  v_rcp_f32 v33, v33
  v_mfma_f32_16x16x32_bf16 v[164:167], v[180:183], a[84:87], v[164:167]
  v_rcp_f32 v34, v34
  v_mfma_f32_16x16x32_bf16 v[52:55], v[180:183], a[88:91], v[52:55]
  ds_read_b64_tr_b16 v[198:199], v22 offset:12808
  v_mul_f32 v37, v37, v33
  v_mfma_f32_16x16x32_bf16 v[52:55], v[176:179], a[72:75], v[52:55]
  v_rcp_f32 v35, v35
  v_mul_f32 v38, v38, v34
  v_mfma_f32_16x16x32_bf16 v[52:55], v[204:207], a[56:59], v[52:55]
  ds_read_b64_tr_b16 v[200:201], v22 offset:16392
  v_mul_f32 v39, v39, v35
  v_mfma_f32_16x16x32_bf16 v[68:71], v[204:207], a[60:63], v[68:71]
  ds_read_b64_tr_b16 v[202:203], v22 offset:16904
  v_cvt_pk_bf16_f32 v42, v36, v37
  v_mfma_f32_16x16x32_bf16 v[68:71], v[176:179], a[76:79], v[68:71]
  buffer_load_dwordx4 a[4:7], v243, s[12:15], s25 offen offset:256 sc1
  v_mfma_f32_16x16x32_bf16 v[68:71], v[180:183], a[92:95], v[68:71]
  ds_read_b64_tr_b16 v[204:205], v22 offset:20488
  v_cvt_pk_bf16_f32 v43, v38, v39
  v_mul_f32 v24, v96, v96
  s_waitcnt lgkmcnt(5)
  v_mfma_f32_16x16x32_bf16 v[152:155], v[192:195], a[80:83], v[152:155]
  ds_write_b128 v4, v[40:43] offset:40960
  v_mfma_f32_16x16x32_bf16 v[152:155], v[188:191], a[64:67], v[152:155]
  ds_read_b64_tr_b16 v[206:207], v22 offset:21000
  v_mul_f32 v25, v97, v97
  v_mfma_f32_16x16x32_bf16 v[152:155], v[184:187], a[48:51], v[152:155]
  buffer_store_dwordx4 v[40:43], v4, s[12:15], s31 offen offset:0 sc1
  v_mfma_f32_16x16x32_bf16 v[168:171], v[184:187], a[52:55], v[168:171]
  v_mul_f32 v26, v98, v98
  v_mul_f32 v27, v99, v99
  v_fma_f32 v24, v24, v15, v11
  v_mfma_f32_16x16x32_bf16 v[168:171], v[188:191], a[68:71], v[168:171]
  v_fma_f32 v25, v25, v15, v11
  v_fma_f32 v26, v26, v15, v11
  v_mfma_f32_16x16x32_bf16 v[168:171], v[192:195], a[84:87], v[168:171]
  v_fma_f32 v27, v27, v15, v11
  v_mul_f32 v24, v24, v96
  v_mfma_f32_16x16x32_bf16 v[56:59], v[192:195], a[88:91], v[56:59]
  v_exp_f32 v24, v24
  v_mfma_f32_16x16x32_bf16 v[56:59], v[188:191], a[72:75], v[56:59]
  v_mul_f32 v25, v25, v97
  v_mul_f32 v26, v26, v98
  v_mul_f32 v27, v27, v99
  v_mfma_f32_16x16x32_bf16 v[56:59], v[184:187], a[56:59], v[56:59]
  s_waitcnt vmcnt(15)
  s_add_u32 s23, s52, 256
  s_mov_b64 exec, 1
  buffer_store_dwordx2 v[252:253], off, s[12:15], s23 sc1
  s_mov_b64 exec, -1
  v_mfma_f32_16x16x32_bf16 v[72:75], v[184:187], a[60:63], v[72:75]
  s_waitcnt lgkmcnt(0)
  s_barrier
  v_add_u32 v22, 24576, v22
  ds_read_b64_tr_b16 v[176:177], v22 offset:0
  v_mfma_f32_16x16x32_bf16 v[72:75], v[188:191], a[76:79], v[72:75]
  ds_read_b64_tr_b16 v[178:179], v22 offset:512
  s_add_u32 m0, s22, 81920
  v_mul_f32 v28, v96, v104
  v_mfma_f32_16x16x32_bf16 v[72:75], v[192:195], a[92:95], v[72:75]
  buffer_load_dwordx4 a[8:11], v244, s[12:15], s25 offen offset:0 sc1
  v_mfma_f32_16x16x32_bf16 v[156:159], v[204:207], a[80:83], v[156:159]
  ds_read_b64_tr_b16 v[180:181], v22 offset:4096
  v_exp_f32 v25, v25
  v_mfma_f32_16x16x32_bf16 v[156:159], v[200:203], a[64:67], v[156:159]
  ds_read_b64_tr_b16 v[182:183], v22 offset:4608
  s_add_u32 s24, s20, 4424064
  v_mul_f32 v29, v97, v105
  v_mfma_f32_16x16x32_bf16 v[156:159], v[196:199], a[48:51], v[156:159]
  ds_read_b64_tr_b16 v[184:185], v22 offset:8192
  v_mul_f32 v30, v98, v106
  v_mfma_f32_16x16x32_bf16 v[172:175], v[196:199], a[52:55], v[172:175]
  ds_read_b64_tr_b16 v[186:187], v22 offset:8704
  v_exp_f32 v26, v26
  v_mfma_f32_16x16x32_bf16 v[172:175], v[200:203], a[68:71], v[172:175]
  buffer_load_dwordx4 v240, s[40:43], s24 offen offset:0  lds
  v_mfma_f32_16x16x32_bf16 v[172:175], v[204:207], a[84:87], v[172:175]
  v_exp_f32 v27, v27
  v_mfma_f32_16x16x32_bf16 v[60:63], v[204:207], a[88:91], v[60:63]
  v_mul_f32 v31, v99, v107
  v_fma_f32 v24, v24, v19, v19
  v_mfma_f32_16x16x32_bf16 v[60:63], v[200:203], a[72:75], v[60:63]
  ds_read_b64_tr_b16 v[188:189], v22 offset:8
  v_rcp_f32 v24, v24
  v_mfma_f32_16x16x32_bf16 v[60:63], v[196:199], a[56:59], v[60:63]
  buffer_load_dwordx4 v241, s[40:43], s24 offen offset:1024  lds
  v_mfma_f32_16x16x32_bf16 v[76:79], v[196:199], a[60:63], v[76:79]
  ds_read_b64_tr_b16 v[190:191], v22 offset:520
  v_fma_f32 v25, v25, v19, v19
  v_mfma_f32_16x16x32_bf16 v[76:79], v[200:203], a[76:79], v[76:79]
  buffer_load_dwordx4 a[12:15], v244, s[12:15], s25 offen offset:256 sc1
  v_mfma_f32_16x16x32_bf16 v[76:79], v[204:207], a[92:95], v[76:79]
  ds_read_b64_tr_b16 v[192:193], v22 offset:4104
  v_rcp_f32 v25, v25
  s_waitcnt lgkmcnt(3)
  v_mfma_f32_16x16x32_bf16 v[144:147], v[184:187], a[128:131], v[144:147]
  ds_read_b64_tr_b16 v[194:195], v22 offset:4616
  v_fma_f32 v26, v26, v19, v19
  v_mfma_f32_16x16x32_bf16 v[144:147], v[180:183], a[112:115], v[144:147]
  ds_read_b64_tr_b16 v[196:197], v22 offset:8200
  v_fma_f32 v27, v27, v19, v19
  v_mfma_f32_16x16x32_bf16 v[144:147], v[176:179], a[96:99], v[144:147]
  ds_read_b64_tr_b16 v[198:199], v22 offset:8712
  v_mul_f32 v28, v28, v24
  v_mfma_f32_16x16x32_bf16 v[160:163], v[176:179], a[100:103], v[160:163]
  buffer_load_dwordx4 v242, s[40:43], s24 offen offset:2048  lds
  s_add_u32 m0, s22, 94208
  v_mfma_f32_16x16x32_bf16 v[160:163], v[180:183], a[116:119], v[160:163]
  v_rcp_f32 v26, v26
  v_mul_f32 v29, v29, v25
  v_mfma_f32_16x16x32_bf16 v[160:163], v[184:187], a[132:135], v[160:163]
  v_rcp_f32 v27, v27
  v_mfma_f32_16x16x32_bf16 v[48:51], v[184:187], a[136:139], v[48:51]
  ds_read_b64_tr_b16 v[200:201], v22 offset:12288
  v_mul_f32 v30, v30, v26
  v_mfma_f32_16x16x32_bf16 v[48:51], v[180:183], a[120:123], v[48:51]
  ds_read_b64_tr_b16 v[202:203], v22 offset:12800
  v_mul_f32 v31, v31, v27
  v_cvt_pk_bf16_f32 v44, v28, v29
  v_mfma_f32_16x16x32_bf16 v[48:51], v[176:179], a[104:107], v[48:51]
  buffer_load_dwordx4 v240, s[44:47], s24 offen offset:0  lds
  v_mfma_f32_16x16x32_bf16 v[64:67], v[176:179], a[108:111], v[64:67]
  ds_read_b64_tr_b16 v[204:205], v22 offset:16384
  v_cvt_pk_bf16_f32 v45, v30, v31
  v_mfma_f32_16x16x32_bf16 v[64:67], v[180:183], a[124:127], v[64:67]
  buffer_load_dwordx4 v241, s[44:47], s24 offen offset:1024  lds
  v_mfma_f32_16x16x32_bf16 v[64:67], v[184:187], a[140:143], v[64:67]
  ds_read_b64_tr_b16 v[206:207], v22 offset:16896
  v_mul_f32 v32, v100, v100
  v_mul_f32 v33, v101, v101
  s_waitcnt lgkmcnt(4)
  v_mfma_f32_16x16x32_bf16 v[148:151], v[196:199], a[128:131], v[148:151]
  s_add_u32 s25, s11, 8192
  buffer_load_dwordx4 a[16:19], v243, s[12:15], s25 offen offset:0 sc1
  v_mfma_f32_16x16x32_bf16 v[148:151], v[192:195], a[112:115], v[148:151]
  ds_read_b64_tr_b16 v[176:177], v22 offset:20480
  v_mul_f32 v34, v102, v102
  v_mfma_f32_16x16x32_bf16 v[148:151], v[188:191], a[96:99], v[148:151]
  ds_read_b64_tr_b16 v[178:179], v22 offset:20992
  v_mul_f32 v35, v103, v103
  v_mfma_f32_16x16x32_bf16 v[164:167], v[188:191], a[100:103], v[164:167]
  buffer_load_dwordx4 v242, s[44:47], s24 offen offset:2048  lds
  v_mfma_f32_16x16x32_bf16 v[164:167], v[192:195], a[116:119], v[164:167]
  ds_read_b64_tr_b16 v[180:181], v22 offset:12296
  v_fma_f32 v32, v32, v15, v11
  v_fma_f32 v33, v33, v15, v11
  v_mfma_f32_16x16x32_bf16 v[164:167], v[196:199], a[132:135], v[164:167]
  v_fma_f32 v34, v34, v15, v11
  v_fma_f32 v35, v35, v15, v11
  v_mfma_f32_16x16x32_bf16 v[52:55], v[196:199], a[136:139], v[52:55]
  ds_read_b64_tr_b16 v[182:183], v22 offset:12808
  v_mul_f32 v32, v32, v100
  v_mfma_f32_16x16x32_bf16 v[52:55], v[192:195], a[120:123], v[52:55]
  buffer_load_dwordx4 a[20:23], v243, s[12:15], s25 offen offset:256 sc1
  v_mfma_f32_16x16x32_bf16 v[52:55], v[188:191], a[104:107], v[52:55]
  ds_read_b64_tr_b16 v[184:185], v22 offset:16392
  v_exp_f32 v32, v32
  v_mfma_f32_16x16x32_bf16 v[68:71], v[188:191], a[108:111], v[68:71]
  ds_read_b64_tr_b16 v[186:187], v22 offset:16904
  v_mul_f32 v33, v33, v101
  v_mfma_f32_16x16x32_bf16 v[68:71], v[192:195], a[124:127], v[68:71]
  v_exp_f32 v33, v33
  v_mfma_f32_16x16x32_bf16 v[68:71], v[196:199], a[140:143], v[68:71]
  ds_read_b64_tr_b16 v[188:189], v22 offset:20488
  v_mul_f32 v34, v34, v102
  v_mul_f32 v35, v35, v103
  s_waitcnt lgkmcnt(5)
  v_mfma_f32_16x16x32_bf16 v[152:155], v[176:179], a[128:131], v[152:155]
  v_exp_f32 v34, v34
  v_mfma_f32_16x16x32_bf16 v[152:155], v[204:207], a[112:115], v[152:155]
  ds_read_b64_tr_b16 v[190:191], v22 offset:21000
  v_mul_f32 v36, v100, v108
  v_mfma_f32_16x16x32_bf16 v[152:155], v[200:203], a[96:99], v[152:155]
  v_exp_f32 v35, v35
  v_mfma_f32_16x16x32_bf16 v[168:171], v[200:203], a[100:103], v[168:171]
  v_mul_f32 v37, v101, v109
  v_mul_f32 v38, v102, v110
  v_mul_f32 v39, v103, v111
  v_mfma_f32_16x16x32_bf16 v[168:171], v[204:207], a[116:119], v[168:171]
  v_fma_f32 v32, v32, v19, v19
  v_fma_f32 v33, v33, v19, v19
  v_mfma_f32_16x16x32_bf16 v[168:171], v[176:179], a[132:135], v[168:171]
  v_rcp_f32 v32, v32
  v_mfma_f32_16x16x32_bf16 v[56:59], v[176:179], a[136:139], v[56:59]
  v_rcp_f32 v33, v33
  v_mfma_f32_16x16x32_bf16 v[56:59], v[204:207], a[120:123], v[56:59]
  buffer_load_dwordx4 a[24:27], v244, s[12:15], s25 offen offset:0 sc1
  v_mfma_f32_16x16x32_bf16 v[56:59], v[200:203], a[104:107], v[56:59]
  v_fma_f32 v34, v34, v19, v19
  v_fma_f32 v35, v35, v19, v19
  v_mul_f32 v36, v36, v32
  v_mfma_f32_16x16x32_bf16 v[72:75], v[200:203], a[108:111], v[72:75]
  s_waitcnt vmcnt(21) lgkmcnt(0)
  s_barrier
  v_add_u32 v22, 24576, v22
  ds_read_b64_tr_b16 v[192:193], v22 offset:0
  v_mfma_f32_16x16x32_bf16 v[72:75], v[204:207], a[124:127], v[72:75]
  ds_read_b64_tr_b16 v[194:195], v22 offset:512
  s_add_u32 m0, s28, 106496
  v_mul_f32 v37, v37, v33
  v_mfma_f32_16x16x32_bf16 v[72:75], v[176:179], a[140:143], v[72:75]
  s_add_u32 s4, s4, s36
  v_rcp_f32 v34, v34
  v_cvt_pk_bf16_f32 v46, v36, v37
  v_mfma_f32_16x16x32_bf16 v[156:159], v[188:191], a[128:131], v[156:159]
  ds_read_b64_tr_b16 v[196:197], v22 offset:4096
  s_add_u32 s5, s5, s36
  v_mul_f32 v38, v38, v34
  v_mfma_f32_16x16x32_bf16 v[156:159], v[184:187], a[112:115], v[156:159]
  ds_read_b64_tr_b16 v[198:199], v22 offset:4608
  v_mul_f32 v24, v112, v112
  v_mfma_f32_16x16x32_bf16 v[156:159], v[180:183], a[96:99], v[156:159]
  ds_read_b64_tr_b16 v[200:201], v22 offset:8192
  s_add_u32 s6, s6, s36
  v_mul_f32 v25, v113, v113
  v_mfma_f32_16x16x32_bf16 v[172:175], v[180:183], a[100:103], v[172:175]
  ds_read_b64_tr_b16 v[202:203], v22 offset:8704
  s_add_u32 s7, s7, s36
  v_rcp_f32 v35, v35
  v_mfma_f32_16x16x32_bf16 v[172:175], v[184:187], a[116:119], v[172:175]
  v_mul_f32 v39, v39, v35
  v_mul_f32 v26, v114, v114
  v_mfma_f32_16x16x32_bf16 v[172:175], v[188:191], a[132:135], v[172:175]
  s_add_u32 s24, s4, 0
  v_cvt_pk_bf16_f32 v47, v38, v39
  v_mul_f32 v27, v115, v115
  v_mfma_f32_16x16x32_bf16 v[60:63], v[188:191], a[136:139], v[60:63]
  buffer_load_dwordx4 v5, s[48:51], s24 offen  lds
  v_mfma_f32_16x16x32_bf16 v[60:63], v[184:187], a[120:123], v[60:63]
  ds_read_b64_tr_b16 v[204:205], v22 offset:8
  s_add_u32 m0, s28, 110592
  ds_write_b128 v4, v[44:47] offset:41216
  v_mfma_f32_16x16x32_bf16 v[60:63], v[180:183], a[104:107], v[60:63]
  buffer_load_dwordx4 a[28:31], v244, s[12:15], s25 offen offset:256 sc1
  v_mfma_f32_16x16x32_bf16 v[76:79], v[180:183], a[108:111], v[76:79]
  ds_read_b64_tr_b16 v[206:207], v22 offset:520
  s_add_u32 s24, s4, 36864
  v_fma_f32 v24, v24, v16, v12
  v_mfma_f32_16x16x32_bf16 v[76:79], v[184:187], a[124:127], v[76:79]
  buffer_load_dwordx4 v5, s[48:51], s24 offen  lds
  v_mfma_f32_16x16x32_bf16 v[76:79], v[188:191], a[140:143], v[76:79]
  ds_read_b64_tr_b16 v[176:177], v22 offset:4104
  buffer_store_dwordx4 v[44:47], v4, s[12:15], s31 offen offset:256 sc1
  s_waitcnt lgkmcnt(4)
  v_mfma_f32_16x16x32_bf16 v[144:147], v[200:203], a[176:179], v[144:147]
  ds_read_b64_tr_b16 v[178:179], v22 offset:4616
  s_add_u32 m0, s28, 114688
  v_xor_b32 v4, 512, v4
  v_mfma_f32_16x16x32_bf16 v[144:147], v[196:199], a[160:163], v[144:147]
  ds_read_b64_tr_b16 v[180:181], v22 offset:8200
  s_add_u32 s24, s3, 0
  v_fma_f32 v25, v25, v16, v12
  v_mfma_f32_16x16x32_bf16 v[144:147], v[192:195], a[144:147], v[144:147]
  ds_read_b64_tr_b16 v[182:183], v22 offset:8712
  v_fma_f32 v26, v26, v16, v12
  v_mfma_f32_16x16x32_bf16 v[160:163], v[192:195], a[148:151], v[160:163]
  buffer_load_dwordx4 v6, s[48:51], s24 offen  lds
  v_mfma_f32_16x16x32_bf16 v[160:163], v[196:199], a[164:167], v[160:163]
  s_add_u32 m0, s28, 118784
  ds_read_b128 a[80:83], v243 offset:0
  v_fma_f32 v27, v27, v16, v12
  v_mul_f32 v24, v24, v112
  v_mfma_f32_16x16x32_bf16 v[160:163], v[200:203], a[180:183], v[160:163]
  s_add_u32 s24, s5, 0
  v_exp_f32 v24, v24
  v_mfma_f32_16x16x32_bf16 v[48:51], v[200:203], a[184:187], v[48:51]
  ds_read_b64_tr_b16 v[184:185], v22 offset:12288
  ds_read_b128 a[84:87], v243 offset:256
  v_mfma_f32_16x16x32_bf16 v[48:51], v[196:199], a[168:171], v[48:51]
  ds_read_b64_tr_b16 v[186:187], v22 offset:12800
  v_mul_f32 v25, v25, v113
  v_mul_f32 v26, v26, v114
  v_mfma_f32_16x16x32_bf16 v[48:51], v[192:195], a[152:155], v[48:51]
  buffer_load_dwordx4 v5, s[48:51], s24 offen  lds
  s_add_u32 m0, s28, 122880
  v_mfma_f32_16x16x32_bf16 v[64:67], v[192:195], a[156:159], v[64:67]
  ds_read_b64_tr_b16 v[188:189], v22 offset:16384
  v_mul_f32 v27, v27, v115
  v_mfma_f32_16x16x32_bf16 v[64:67], v[196:199], a[172:175], v[64:67]
  s_add_u32 s24, s5, 36864
  s_add_u32 s25, s11, 32768
  buffer_load_dwordx4 a[32:35], v243, s[12:15], s25 offen offset:0 sc1
  v_mfma_f32_16x16x32_bf16 v[64:67], v[200:203], a[188:191], v[64:67]
  ds_read_b64_tr_b16 v[190:191], v22 offset:16896
  ds_read_b128 a[88:91], v244 offset:0
  v_mul_f32 v28, v112, v120
  s_waitcnt lgkmcnt(7)
  v_mfma_f32_16x16x32_bf16 v[148:151], v[180:183], a[176:179], v[148:151]
  buffer_load_dwordx4 v5, s[48:51], s24 offen  lds
  s_add_u32 m0, s28, 126976
  v_mfma_f32_16x16x32_bf16 v[148:151], v[176:179], a[160:163], v[148:151]
  ds_read_b64_tr_b16 v[192:193], v22 offset:20480
  v_mul_f32 v29, v113, v121
  v_mfma_f32_16x16x32_bf16 v[148:151], v[204:207], a[144:147], v[148:151]
  ds_read_b64_tr_b16 v[194:195], v22 offset:20992
  s_add_u32 s24, s58, 0
  v_mul_f32 v30, v114, v122
  v_mfma_f32_16x16x32_bf16 v[164:167], v[204:207], a[148:151], v[164:167]
  buffer_load_dwordx4 v6, s[48:51], s24 offen  lds
L_pad6:
  s_cbranch_execz L_pad7
  v_mfma_f32_16x16x32_bf16 v[164:167], v[176:179], a[164:167], v[164:167]
  ds_read_b64_tr_b16 v[196:197], v22 offset:12296
  ds_read_b128 a[92:95], v244 offset:256
  v_mul_f32 v31, v115, v123
  v_mfma_f32_16x16x32_bf16 v[164:167], v[180:183], a[180:183], v[164:167]
  buffer_load_dwordx4 a[36:39], v243, s[12:15], s25 offen offset:256 sc1
  v_mfma_f32_16x16x32_bf16 v[52:55], v[180:183], a[184:187], v[52:55]
  ds_read_b64_tr_b16 v[198:199], v22 offset:12808
  v_fma_f32 v24, v24, v20, v20
  v_mfma_f32_16x16x32_bf16 v[52:55], v[176:179], a[168:171], v[52:55]
  s_add_u32 s26, s53, 256
  s_mov_b64 exec, s[98:99]
  buffer_load_dwordx2 v[248:249], v250, s[12:15], s26 offen sc1
  s_mov_b64 exec, -1
  v_mfma_f32_16x16x32_bf16 v[52:55], v[204:207], a[152:155], v[52:55]
  ds_read_b64_tr_b16 v[200:201], v22 offset:16392
  v_exp_f32 v25, v25
  v_mfma_f32_16x16x32_bf16 v[68:71], v[204:207], a[156:159], v[68:71]
  ds_read_b64_tr_b16 v[202:203], v22 offset:16904
  v_fma_f32 v25, v25, v20, v20
  v_mfma_f32_16x16x32_bf16 v[68:71], v[176:179], a[172:175], v[68:71]
  ds_read_b128 a[96:99], v243 offset:8192
  v_mul_f32 v32, v116, v116
  v_mfma_f32_16x16x32_bf16 v[68:71], v[180:183], a[188:191], v[68:71]
  ds_read_b64_tr_b16 v[204:205], v22 offset:20488
  v_exp_f32 v26, v26
  s_waitcnt lgkmcnt(7)
  v_mfma_f32_16x16x32_bf16 v[152:155], v[192:195], a[176:179], v[152:155]
  v_exp_f32 v27, v27
  v_mfma_f32_16x16x32_bf16 v[152:155], v[188:191], a[160:163], v[152:155]
  ds_read_b64_tr_b16 v[206:207], v22 offset:21000
  v_fma_f32 v26, v26, v20, v20
  v_mfma_f32_16x16x32_bf16 v[152:155], v[184:187], a[144:147], v[152:155]
  ds_read_b128 a[100:103], v243 offset:8448
  v_fma_f32 v27, v27, v20, v20
  v_mfma_f32_16x16x32_bf16 v[168:171], v[184:187], a[148:151], v[168:171]
  v_rcp_f32 v24, v24
  v_mul_f32 v33, v117, v117
  v_mfma_f32_16x16x32_bf16 v[168:171], v[188:191], a[164:167], v[168:171]
  buffer_load_dwordx4 a[40:43], v244, s[12:15], s25 offen offset:0 sc1
  v_mfma_f32_16x16x32_bf16 v[168:171], v[192:195], a[180:183], v[168:171]
  v_rcp_f32 v25, v25
  v_mfma_f32_16x16x32_bf16 v[56:59], v[192:195], a[184:187], v[56:59]
  v_rcp_f32 v26, v26
  v_mfma_f32_16x16x32_bf16 v[56:59], v[188:191], a[168:171], v[56:59]
  ds_read_b128 a[104:107], v244 offset:8192
  v_rcp_f32 v27, v27
  v_mfma_f32_16x16x32_bf16 v[56:59], v[184:187], a[152:155], v[56:59]
  v_mul_f32 v28, v28, v24
  v_mul_f32 v29, v29, v25
  v_mfma_f32_16x16x32_bf16 v[72:75], v[184:187], a[156:159], v[72:75]
  s_waitcnt vmcnt(26) lgkmcnt(2)
  s_barrier
  v_add_u32 v22, 4294893568, v22
  ds_read_b64_tr_b16 v[176:177], v22 offset:0
  v_mfma_f32_16x16x32_bf16 v[72:75], v[188:191], a[172:175], v[72:75]
  ds_read_b64_tr_b16 v[178:179], v22 offset:512
  s_add_u32 m0, s28, 131072
  v_mul_f32 v30, v30, v26
  v_mfma_f32_16x16x32_bf16 v[72:75], v[192:195], a[188:191], v[72:75]
  s_add_u32 s24, s6, 0
  v_mul_f32 v31, v31, v27
  v_cvt_pk_bf16_f32 v40, v28, v29
  v_mul_f32 v34, v118, v118
  v_mfma_f32_16x16x32_bf16 v[156:159], v[204:207], a[176:179], v[156:159]
  ds_read_b64_tr_b16 v[180:181], v22 offset:4096
  ds_read_b128 a[108:111], v244 offset:8448
  v_mfma_f32_16x16x32_bf16 v[156:159], v[200:203], a[160:163], v[156:159]
  ds_read_b64_tr_b16 v[182:183], v22 offset:4608
  v_cvt_pk_bf16_f32 v41, v30, v31
  v_mfma_f32_16x16x32_bf16 v[156:159], v[196:199], a[144:147], v[156:159]
  ds_read_b64_tr_b16 v[184:185], v22 offset:8192
  v_mul_f32 v35, v119, v119
  v_mfma_f32_16x16x32_bf16 v[172:175], v[196:199], a[148:151], v[172:175]
  ds_read_b64_tr_b16 v[186:187], v22 offset:8704
  v_fma_f32 v32, v32, v16, v12
  v_fma_f32 v33, v33, v16, v12
  v_mfma_f32_16x16x32_bf16 v[172:175], v[200:203], a[164:167], v[172:175]
  buffer_load_dwordx4 v5, s[48:51], s24 offen  lds
  s_add_u32 m0, s28, 135168
  s_add_u32 s24, s7, 0
  v_mfma_f32_16x16x32_bf16 v[172:175], v[204:207], a[180:183], v[172:175]
  buffer_load_dwordx4 a[44:47], v244, s[12:15], s25 offen offset:256 sc1
  v_mfma_f32_16x16x32_bf16 v[60:63], v[204:207], a[184:187], v[60:63]
  buffer_load_dwordx4 v5, s[48:51], s24 offen  lds
  v_mfma_f32_16x16x32_bf16 v[60:63], v[200:203], a[168:171], v[60:63]
  ds_read_b64_tr_b16 v[188:189], v22 offset:8
  v_fma_f32 v34, v34, v16, v12
  v_fma_f32 v35, v35, v16, v12
  v_mfma_f32_16x16x32_bf16 v[60:63], v[196:199], a[152:155], v[60:63]
  s_add_u32 m0, s28, 139264
  ds_read_b128 a[112:115], v243 offset:32768
  v_mul_f32 v32, v32, v116
  v_mfma_f32_16x16x32_bf16 v[76:79], v[196:199], a[156:159], v[76:79]
  ds_read_b64_tr_b16 v[190:191], v22 offset:520
  v_mul_f32 v33, v33, v117
  v_mfma_f32_16x16x32_bf16 v[76:79], v[200:203], a[172:175], v[76:79]
  s_mov_b32 s24, s8
  ds_read_b128 a[116:119], v243 offset:33024
  v_mul_f32 v34, v34, v118
  v_mfma_f32_16x16x32_bf16 v[76:79], v[204:207], a[188:191], v[76:79]
  ds_read_b64_tr_b16 v[192:193], v22 offset:4104
  v_exp_f32 v32, v32
  s_waitcnt lgkmcnt(5)
  v_mfma_f32_16x16x32_bf16 v[144:147], v[184:187], a[224:227], v[144:147]
  ds_read_b64_tr_b16 v[194:195], v22 offset:4616
  v_mul_f32 v35, v35, v119
  v_mfma_f32_16x16x32_bf16 v[144:147], v[180:183], a[208:211], v[144:147]
  ds_read_b64_tr_b16 v[196:197], v22 offset:8200
  v_mul_f32 v36, v116, v124
  v_mfma_f32_16x16x32_bf16 v[144:147], v[176:179], a[192:195], v[144:147]
  ds_read_b64_tr_b16 v[198:199], v22 offset:8712
  v_mul_f32 v37, v117, v125
  v_mfma_f32_16x16x32_bf16 v[160:163], v[176:179], a[196:199], v[160:163]
  buffer_load_dwordx4 v6, s[48:51], s24 offen  lds
  s_add_u32 m0, s28, 143360
  s_add_u32 s24, s4, 73728
  v_mfma_f32_16x16x32_bf16 v[160:163], v[180:183], a[212:215], v[160:163]
  ds_read_b128 a[120:123], v244 offset:32768
  v_exp_f32 v33, v33
  v_mfma_f32_16x16x32_bf16 v[160:163], v[184:187], a[228:231], v[160:163]
  buffer_load_dwordx4 v5, s[48:51], s24 offen  lds
  v_mfma_f32_16x16x32_bf16 v[48:51], v[184:187], a[232:235], v[48:51]
  ds_read_b64_tr_b16 v[200:201], v22 offset:12288
  s_add_u32 m0, s28, 147456
  v_mul_f32 v38, v118, v126
  v_mfma_f32_16x16x32_bf16 v[48:51], v[180:183], a[216:219], v[48:51]
  ds_read_b64_tr_b16 v[202:203], v22 offset:12800
  v_exp_f32 v34, v34
  v_mfma_f32_16x16x32_bf16 v[48:51], v[176:179], a[200:203], v[48:51]
  s_add_u32 s24, s4, 110592
  s_waitcnt vmcnt(6)
  v_cmp_eq_u64 vcc, s[56:57], v[248:249]
  s_nop 1
  s_orn2_b64 vcc, vcc, s[98:99]
  s_cmp_eq_u64 vcc, -1
  s_cbranch_scc0 L_lp54s
L_ok53:
  v_mfma_f32_16x16x32_bf16 v[64:67], v[176:179], a[204:207], v[64:67]
  ds_read_b64_tr_b16 v[204:205], v22 offset:16384
  v_mul_f32 v39, v119, v127
  v_mfma_f32_16x16x32_bf16 v[64:67], v[180:183], a[220:223], v[64:67]
  buffer_load_dwordx4 v5, s[48:51], s24 offen  lds
  v_mfma_f32_16x16x32_bf16 v[64:67], v[184:187], a[236:239], v[64:67]
  ds_read_b64_tr_b16 v[206:207], v22 offset:16896
  v_exp_f32 v35, v35
  s_waitcnt lgkmcnt(5)
  v_mfma_f32_16x16x32_bf16 v[148:151], v[196:199], a[224:227], v[148:151]
  s_add_u32 m0, s28, 151552
  ds_read_b128 a[124:127], v244 offset:33024
  v_fma_f32 v32, v32, v20, v20
  v_mfma_f32_16x16x32_bf16 v[148:151], v[192:195], a[208:211], v[148:151]
  ds_read_b64_tr_b16 v[176:177], v22 offset:20480
  s_add_u32 s24, s3, 73728
  v_fma_f32 v33, v33, v20, v20
  v_mfma_f32_16x16x32_bf16 v[148:151], v[188:191], a[192:195], v[148:151]
  ds_read_b64_tr_b16 v[178:179], v22 offset:20992
  v_fma_f32 v34, v34, v20, v20
  v_mfma_f32_16x16x32_bf16 v[164:167], v[188:191], a[196:199], v[164:167]
  buffer_load_dwordx4 v6, s[48:51], s24 offen  lds
  v_mfma_f32_16x16x32_bf16 v[164:167], v[192:195], a[212:215], v[164:167]
  ds_read_b64_tr_b16 v[180:181], v22 offset:12296
  v_rcp_f32 v32, v32
  v_mfma_f32_16x16x32_bf16 v[164:167], v[196:199], a[228:231], v[164:167]
  ds_read_b128 a[128:131], v243 offset:16384
  v_fma_f32 v35, v35, v20, v20
  v_mfma_f32_16x16x32_bf16 v[52:55], v[196:199], a[232:235], v[52:55]
  ds_read_b64_tr_b16 v[182:183], v22 offset:12808
  v_mul_f32 v36, v36, v32
  v_mfma_f32_16x16x32_bf16 v[52:55], v[192:195], a[216:219], v[52:55]
  ds_read_b128 a[132:135], v243 offset:16640
  v_rcp_f32 v33, v33
  v_mfma_f32_16x16x32_bf16 v[52:55], v[188:191], a[200:203], v[52:55]
  ds_read_b64_tr_b16 v[184:185], v22 offset:16392
  v_mul_f32 v37, v37, v33
  v_mfma_f32_16x16x32_bf16 v[68:71], v[188:191], a[204:207], v[68:71]
  ds_read_b64_tr_b16 v[186:187], v22 offset:16904
  v_cvt_pk_bf16_f32 v42, v36, v37
  v_mfma_f32_16x16x32_bf16 v[68:71], v[192:195], a[220:223], v[68:71]
  s_add_u32 s25, s11, 16384
  buffer_load_dwordx4 a[48:51], v243, s[12:15], s25 offen offset:0 sc1
  v_mfma_f32_16x16x32_bf16 v[68:71], v[196:199], a[236:239], v[68:71]
  ds_read_b64_tr_b16 v[188:189], v22 offset:20488
  v_rcp_f32 v34, v34
  s_waitcnt lgkmcnt(7)
  v_mfma_f32_16x16x32_bf16 v[152:155], v[176:179], a[224:227], v[152:155]
  ds_read_b128 a[136:139], v244 offset:16384
  v_mul_f32 v38, v38, v34
  v_mfma_f32_16x16x32_bf16 v[152:155], v[204:207], a[208:211], v[152:155]
  ds_read_b64_tr_b16 v[190:191], v22 offset:21000
  v_mul_f32 v24, v128, v128
  v_mfma_f32_16x16x32_bf16 v[152:155], v[200:203], a[192:195], v[152:155]
  v_rcp_f32 v35, v35
  v_mfma_f32_16x16x32_bf16 v[168:171], v[200:203], a[196:199], v[168:171]
  ds_read_b128 a[140:143], v244 offset:16640
  v_mul_f32 v39, v39, v35
  v_mul_f32 v25, v129, v129
  v_mfma_f32_16x16x32_bf16 v[168:171], v[204:207], a[212:215], v[168:171]
  v_cvt_pk_bf16_f32 v43, v38, v39
  v_mul_f32 v26, v130, v130
  v_mfma_f32_16x16x32_bf16 v[168:171], v[176:179], a[228:231], v[168:171]
  ds_write_b128 v4, v[40:43] offset:40960
  v_mfma_f32_16x16x32_bf16 v[56:59], v[176:179], a[232:235], v[56:59]
  buffer_store_dwordx4 v[40:43], v4, s[12:15], s31 offen offset:0 sc1
  v_mfma_f32_16x16x32_bf16 v[56:59], v[204:207], a[216:219], v[56:59]
  v_mul_f32 v27, v131, v131
  v_fma_f32 v24, v24, v17, v13
  v_fma_f32 v25, v25, v17, v13
  v_mfma_f32_16x16x32_bf16 v[56:59], v[200:203], a[200:203], v[56:59]
  v_fma_f32 v26, v26, v17, v13
  v_fma_f32 v27, v27, v17, v13
  v_mfma_f32_16x16x32_bf16 v[72:75], v[200:203], a[204:207], v[72:75]
  s_waitcnt lgkmcnt(2)
  s_barrier
  v_add_u32 v22, 24576, v22
  ds_read_b64_tr_b16 v[192:193], v22 offset:0
  v_mfma_f32_16x16x32_bf16 v[72:75], v[204:207], a[220:223], v[72:75]
  ds_read_b64_tr_b16 v[194:195], v22 offset:512
  v_mul_f32 v24, v24, v128
  v_mfma_f32_16x16x32_bf16 v[72:75], v[176:179], a[236:239], v[72:75]
  buffer_load_dwordx4 a[52:55], v243, s[12:15], s25 offen offset:256 sc1
  v_mfma_f32_16x16x32_bf16 v[156:159], v[188:191], a[224:227], v[156:159]
  ds_read_b64_tr_b16 v[196:197], v22 offset:4096
  v_exp_f32 v24, v24
  v_mfma_f32_16x16x32_bf16 v[156:159], v[184:187], a[208:211], v[156:159]
  ds_read_b64_tr_b16 v[198:199], v22 offset:4608
  v_mul_f32 v25, v25, v129
  v_mfma_f32_16x16x32_bf16 v[156:159], v[180:183], a[192:195], v[156:159]
  ds_read_b64_tr_b16 v[200:201], v22 offset:8192
  v_mul_f32 v26, v26, v130
  v_mfma_f32_16x16x32_bf16 v[172:175], v[180:183], a[196:199], v[172:175]
  ds_read_b64_tr_b16 v[202:203], v22 offset:8704
  v_exp_f32 v25, v25
  v_mfma_f32_16x16x32_bf16 v[172:175], v[184:187], a[212:215], v[172:175]
  v_exp_f32 v26, v26
  v_mfma_f32_16x16x32_bf16 v[172:175], v[188:191], a[228:231], v[172:175]
  v_mul_f32 v27, v27, v131
  v_mul_f32 v28, v128, v136
  v_mfma_f32_16x16x32_bf16 v[60:63], v[188:191], a[232:235], v[60:63]
  v_exp_f32 v27, v27
  v_mfma_f32_16x16x32_bf16 v[60:63], v[184:187], a[216:219], v[60:63]
  ds_read_b64_tr_b16 v[204:205], v22 offset:8
  v_mul_f32 v29, v129, v137
  v_mul_f32 v30, v130, v138
  v_mfma_f32_16x16x32_bf16 v[60:63], v[180:183], a[200:203], v[60:63]
  v_mul_f32 v31, v131, v139
  v_fma_f32 v24, v24, v21, v21
  v_mfma_f32_16x16x32_bf16 v[76:79], v[180:183], a[204:207], v[76:79]
  ds_read_b64_tr_b16 v[206:207], v22 offset:520
  v_fma_f32 v25, v25, v21, v21
  v_mfma_f32_16x16x32_bf16 v[76:79], v[184:187], a[220:223], v[76:79]
  buffer_load_dwordx4 a[56:59], v244, s[12:15], s25 offen offset:0 sc1
  v_mfma_f32_16x16x32_bf16 v[76:79], v[188:191], a[236:239], v[76:79]
  ds_read_b64_tr_b16 v[176:177], v22 offset:4104
  v_rcp_f32 v24, v24
  s_waitcnt lgkmcnt(3)
  v_mfma_f32_16x16x32_bf16 v[144:147], v[200:203], v[224:227], v[144:147]
  ds_read_b64_tr_b16 v[178:179], v22 offset:4616
  v_fma_f32 v26, v26, v21, v21
  v_mfma_f32_16x16x32_bf16 v[144:147], v[196:199], v[208:211], v[144:147]
  ds_read_b64_tr_b16 v[180:181], v22 offset:8200
  v_fma_f32 v27, v27, v21, v21
  v_mfma_f32_16x16x32_bf16 v[144:147], v[192:195], a[240:243], v[144:147]
  ds_read_b64_tr_b16 v[182:183], v22 offset:8712
  v_mul_f32 v28, v28, v24
  v_mfma_f32_16x16x32_bf16 v[160:163], v[192:195], a[244:247], v[160:163]
  ds_read_b128 a[144:147], v243 offset:24576
  v_rcp_f32 v25, v25
  v_mfma_f32_16x16x32_bf16 v[160:163], v[196:199], v[212:215], v[160:163]
  v_rcp_f32 v26, v26
  v_mfma_f32_16x16x32_bf16 v[160:163], v[200:203], v[228:231], v[160:163]
  v_rcp_f32 v27, v27
  v_mfma_f32_16x16x32_bf16 v[48:51], v[200:203], v[232:235], v[48:51]
  ds_read_b64_tr_b16 v[184:185], v22 offset:12288
  v_mul_f32 v29, v29, v25
  v_mfma_f32_16x16x32_bf16 v[48:51], v[196:199], v[216:219], v[48:51]
  ds_read_b64_tr_b16 v[186:187], v22 offset:12800
  v_mul_f32 v30, v30, v26
  v_mul_f32 v31, v31, v27
  v_mfma_f32_16x16x32_bf16 v[48:51], v[192:195], a[248:251], v[48:51]
  ds_read_b128 a[148:151], v243 offset:24832
  v_cvt_pk_bf16_f32 v44, v28, v29
  v_mfma_f32_16x16x32_bf16 v[64:67], v[192:195], a[252:255], v[64:67]
  ds_read_b64_tr_b16 v[188:189], v22 offset:16384
  v_cvt_pk_bf16_f32 v45, v30, v31
  v_mfma_f32_16x16x32_bf16 v[64:67], v[196:199], v[220:223], v[64:67]
  buffer_load_dwordx4 a[60:63], v244, s[12:15], s25 offen offset:256 sc1
  v_mfma_f32_16x16x32_bf16 v[64:67], v[200:203], v[236:239], v[64:67]
  ds_read_b64_tr_b16 v[190:191], v22 offset:16896
  v_mul_f32 v32, v132, v132
  v_mul_f32 v33, v133, v133
  s_waitcnt lgkmcnt(6)
  v_mfma_f32_16x16x32_bf16 v[148:151], v[180:183], v[224:227], v[148:151]
  ds_read_b128 a[152:155], v244 offset:24576
  v_mul_f32 v34, v134, v134
  v_mfma_f32_16x16x32_bf16 v[148:151], v[176:179], v[208:211], v[148:151]
  ds_read_b64_tr_b16 v[192:193], v22 offset:20480
  v_mul_f32 v35, v135, v135
  v_mfma_f32_16x16x32_bf16 v[148:151], v[204:207], a[240:243], v[148:151]
  ds_read_b64_tr_b16 v[194:195], v22 offset:20992
  v_fma_f32 v32, v32, v17, v13
  v_mfma_f32_16x16x32_bf16 v[164:167], v[204:207], a[244:247], v[164:167]
  v_fma_f32 v33, v33, v17, v13
  v_fma_f32 v34, v34, v17, v13
  v_fma_f32 v35, v35, v17, v13
  v_mfma_f32_16x16x32_bf16 v[164:167], v[176:179], v[212:215], v[164:167]
  ds_read_b64_tr_b16 v[196:197], v22 offset:12296
  v_mul_f32 v32, v32, v132
  v_mfma_f32_16x16x32_bf16 v[164:167], v[180:183], v[228:231], v[164:167]
  ds_read_b128 a[156:159], v244 offset:24832
  v_mul_f32 v33, v33, v133
  v_mfma_f32_16x16x32_bf16 v[52:55], v[180:183], v[232:235], v[52:55]
  ds_read_b64_tr_b16 v[198:199], v22 offset:12808
  v_mul_f32 v34, v34, v134
  v_mfma_f32_16x16x32_bf16 v[52:55], v[176:179], v[216:219], v[52:55]
  v_mul_f32 v35, v35, v135
  v_exp_f32 v32, v32
  v_mfma_f32_16x16x32_bf16 v[52:55], v[204:207], a[248:251], v[52:55]
  ds_read_b64_tr_b16 v[200:201], v22 offset:16392
  v_mul_f32 v36, v132, v140
  v_mfma_f32_16x16x32_bf16 v[68:71], v[204:207], a[252:255], v[68:71]
  ds_read_b64_tr_b16 v[202:203], v22 offset:16904
  v_mul_f32 v37, v133, v141
  v_mfma_f32_16x16x32_bf16 v[68:71], v[176:179], v[220:223], v[68:71]
  s_add_u32 s25, s11, 24576
  buffer_load_dwordx4 a[64:67], v243, s[12:15], s25 offen offset:0 sc1
  v_mfma_f32_16x16x32_bf16 v[68:71], v[180:183], v[236:239], v[68:71]
  ds_read_b64_tr_b16 v[204:205], v22 offset:20488
  v_exp_f32 v33, v33
  s_waitcnt lgkmcnt(6)
  v_mfma_f32_16x16x32_bf16 v[152:155], v[192:195], v[224:227], v[152:155]
  v_exp_f32 v34, v34
  v_mfma_f32_16x16x32_bf16 v[152:155], v[188:191], v[208:211], v[152:155]
  ds_read_b64_tr_b16 v[206:207], v22 offset:21000
  v_mul_f32 v38, v134, v142
  v_mfma_f32_16x16x32_bf16 v[152:155], v[184:187], a[240:243], v[152:155]
  v_exp_f32 v35, v35
  v_mfma_f32_16x16x32_bf16 v[168:171], v[184:187], a[244:247], v[168:171]
  v_mul_f32 v39, v135, v143
  v_fma_f32 v32, v32, v21, v21
  v_fma_f32 v33, v33, v21, v21
  v_mfma_f32_16x16x32_bf16 v[168:171], v[188:191], v[212:215], v[168:171]
  v_rcp_f32 v32, v32
  v_mfma_f32_16x16x32_bf16 v[168:171], v[192:195], v[228:231], v[168:171]
  v_rcp_f32 v33, v33
  v_mfma_f32_16x16x32_bf16 v[56:59], v[192:195], v[232:235], v[56:59]
  v_fma_f32 v34, v34, v21, v21
  v_fma_f32 v35, v35, v21, v21
  v_mfma_f32_16x16x32_bf16 v[56:59], v[188:191], v[216:219], v[56:59]
  v_rcp_f32 v34, v34
  v_mul_f32 v36, v36, v32
  v_mfma_f32_16x16x32_bf16 v[56:59], v[184:187], a[248:251], v[56:59]
  v_rcp_f32 v35, v35
  v_mfma_f32_16x16x32_bf16 v[72:75], v[184:187], a[252:255], v[72:75]
  s_waitcnt lgkmcnt(0)
  s_barrier
  v_add_u32 v22, 24576, v22
  v_add_u32 v23, 4294942720, v23
  v_mfma_f32_16x16x32_bf16 v[72:75], v[188:191], v[220:223], v[72:75]
  ds_read_b64_tr_b16 v[176:177], v22 offset:0
  s_add_u32 m0, s28, 81920
  buffer_load_dwordx4 a[68:71], v243, s[12:15], s25 offen offset:256 sc1
  v_mfma_f32_16x16x32_bf16 v[72:75], v[192:195], v[236:239], v[72:75]
  ds_read_b64_tr_b16 v[178:179], v22 offset:512
  s_add_u32 s24, s5, 73728
  v_mul_f32 v37, v37, v33
  v_mul_f32 v38, v38, v34
  v_mfma_f32_16x16x32_bf16 v[156:159], v[204:207], v[224:227], v[156:159]
  ds_read_b64_tr_b16 v[180:181], v22 offset:4096
  v_mul_f32 v39, v39, v35
  v_mfma_f32_16x16x32_bf16 v[156:159], v[200:203], v[208:211], v[156:159]
  ds_read_b64_tr_b16 v[182:183], v22 offset:4608
  v_cvt_pk_bf16_f32 v46, v36, v37
  v_mfma_f32_16x16x32_bf16 v[156:159], v[196:199], a[240:243], v[156:159]
  ds_read_b64_tr_b16 v[184:185], v22 offset:8
  v_cvt_pk_bf16_f32 v47, v38, v39
  v_mfma_f32_16x16x32_bf16 v[172:175], v[196:199], a[244:247], v[172:175]
  ds_read_b64_tr_b16 v[186:187], v22 offset:520
  ds_write_b128 v4, v[44:47] offset:41216
  v_mfma_f32_16x16x32_bf16 v[172:175], v[200:203], v[212:215], v[172:175]
  ds_read_b64_tr_b16 v[188:189], v22 offset:4104
  v_mfma_f32_16x16x32_bf16 v[172:175], v[204:207], v[228:231], v[172:175]
  buffer_load_dwordx4 v5, s[48:51], s24 offen  lds
  s_add_u32 m0, s28, 86016
  s_add_u32 s24, s5, 110592
  v_mfma_f32_16x16x32_bf16 v[60:63], v[204:207], v[232:235], v[60:63]
  ds_read_b64_tr_b16 v[190:191], v22 offset:4616
  v_mfma_f32_16x16x32_bf16 v[60:63], v[200:203], v[216:219], v[60:63]
  ds_read_b64_tr_b16 v[192:193], v22 offset:12288
  buffer_store_dwordx4 v[44:47], v4, s[12:15], s31 offen offset:256 sc1
  v_mfma_f32_16x16x32_bf16 v[60:63], v[196:199], a[248:251], v[60:63]
  ds_read_b64_tr_b16 v[194:195], v22 offset:12800
  v_mfma_f32_16x16x32_bf16 v[76:79], v[196:199], a[252:255], v[76:79]
  buffer_load_dwordx4 v5, s[48:51], s24 offen  lds
  s_add_u32 m0, s28, 90112
  v_mfma_f32_16x16x32_bf16 v[76:79], v[200:203], v[220:223], v[76:79]
  ds_read_b64_tr_b16 v[196:197], v22 offset:16384
  s_add_u32 s24, s58, 73728
  buffer_load_dwordx4 a[72:75], v244, s[12:15], s25 offen offset:0 sc1
  v_mfma_f32_16x16x32_bf16 v[76:79], v[204:207], v[236:239], v[76:79]
  ds_read_b64_tr_b16 v[198:199], v22 offset:16896
  s_waitcnt lgkmcnt(9)
  v_mfma_f32_16x16x32_bf16 v[80:83], v[180:183], a[96:99], 0
  ds_read_b64_tr_b16 v[200:201], v22 offset:12296
  v_mfma_f32_16x16x32_bf16 v[80:83], v[176:179], a[80:83], v[80:83]
  buffer_load_dwordx4 v6, s[48:51], s24 offen  lds
  s_add_u32 m0, s28, 94208
  v_mfma_f32_16x16x32_bf16 v[88:91], v[176:179], a[84:87], 0
  ds_read_b64_tr_b16 v[202:203], v22 offset:12808
  v_mfma_f32_16x16x32_bf16 v[88:91], v[180:183], a[100:103], v[88:91]
  ds_read_b64_tr_b16 v[204:205], v22 offset:16392
  s_add_u32 s24, s4, 147456
  v_mfma_f32_16x16x32_bf16 v[96:99], v[180:183], a[104:107], 0
  ds_read_b64_tr_b16 v[206:207], v22 offset:16904
  v_mfma_f32_16x16x32_bf16 v[96:99], v[176:179], a[88:91], v[96:99]
  buffer_load_dwordx4 v5, s[48:51], s24 offen  lds
  v_mfma_f32_16x16x32_bf16 v[104:107], v[176:179], a[92:95], 0
  ds_read_b64_tr_b16 v[176:177], v23 offset:8192
  s_add_u32 m0, s28, 98304
  v_mfma_f32_16x16x32_bf16 v[104:107], v[180:183], a[108:111], v[104:107]
  ds_read_b64_tr_b16 v[178:179], v23 offset:8448
  s_waitcnt lgkmcnt(10)
  v_mfma_f32_16x16x32_bf16 v[84:87], v[188:191], a[96:99], 0
  ds_read_b64_tr_b16 v[180:181], v23 offset:10240
  s_add_u32 s24, s4, 184320
  v_xor_b32 v4, 512, v4
  s_add_u32 s31, s10, 57344
  v_mul_f32 v24, v144, v144
  v_mfma_f32_16x16x32_bf16 v[84:87], v[184:187], a[80:83], v[84:87]
  ds_read_b64_tr_b16 v[182:183], v23 offset:10496
  v_mul_f32 v25, v145, v145
  v_mul_f32 v26, v146, v146
  v_mul_f32 v27, v147, v147
  v_mfma_f32_16x16x32_bf16 v[92:95], v[184:187], a[84:87], 0
  buffer_load_dwordx4 v5, s[48:51], s24 offen  lds
  v_mfma_f32_16x16x32_bf16 v[92:95], v[188:191], a[100:103], v[92:95]
  buffer_load_dwordx4 a[76:79], v244, s[12:15], s25 offen offset:256 sc1
  v_mfma_f32_16x16x32_bf16 v[100:103], v[188:191], a[104:107], 0
  s_add_u32 m0, s28, 102400
  v_fma_f32 v24, v24, v14, v10
  v_fma_f32 v25, v25, v14, v10
  v_fma_f32 v26, v26, v14, v10
  v_fma_f32 v27, v27, v14, v10
  v_mul_f32 v28, v144, v152
  v_mul_f32 v29, v145, v153
  v_mul_f32 v30, v146, v154
  v_mfma_f32_16x16x32_bf16 v[100:103], v[184:187], a[88:91], v[100:103]
  s_add_u32 s24, s3, 147456
  v_mul_f32 v24, v24, v144
  v_mul_f32 v25, v25, v145
  v_mul_f32 v26, v26, v146
  v_mul_f32 v27, v27, v147
  v_mul_f32 v31, v147, v155
  v_mul_f32 v32, v148, v148
  v_mfma_f32_16x16x32_bf16 v[108:111], v[184:187], a[92:95], 0
  ds_read_b64_tr_b16 v[184:185], v23 offset:20480
  v_exp_f32 v24, v24
  v_exp_f32 v25, v25
  v_mul_f32 v33, v149, v149
  v_mfma_f32_16x16x32_bf16 v[108:111], v[188:191], a[108:111], v[108:111]
  ds_read_b64_tr_b16 v[186:187], v23 offset:20736
  v_exp_f32 v26, v26
  v_exp_f32 v27, v27
  s_waitcnt lgkmcnt(10)
  v_mfma_f32_16x16x32_bf16 v[80:83], v[196:199], a[16:19], v[80:83]
  ds_read_b64_tr_b16 v[188:189], v23 offset:22528
  v_fma_f32 v24, v24, v18, v18
  v_fma_f32 v25, v25, v18, v18
  v_fma_f32 v26, v26, v18, v18
  v_fma_f32 v27, v27, v18, v18
  v_mfma_f32_16x16x32_bf16 v[80:83], v[192:195], a[0:3], v[80:83]
  ds_read_b64_tr_b16 v[190:191], v23 offset:22784
  v_rcp_f32 v24, v24
  v_rcp_f32 v25, v25
  v_mfma_f32_16x16x32_bf16 v[88:91], v[192:195], a[4:7], v[88:91]
  buffer_load_dwordx4 v6, s[48:51], s24 offen  lds
  s_add_u32 m0, s28, 0
  s_add_u32 s24, s4, 221184
  v_mfma_f32_16x16x32_bf16 v[88:91], v[196:199], a[20:23], v[88:91]
  v_rcp_f32 v26, v26
  v_rcp_f32 v27, v27
  v_mul_f32 v28, v28, v24
  v_mul_f32 v29, v29, v25
  v_mfma_f32_16x16x32_bf16 v[96:99], v[196:199], a[24:27], v[96:99]
  buffer_load_dwordx4 v5, s[48:51], s24 offen  lds
  v_mfma_f32_16x16x32_bf16 v[96:99], v[192:195], a[8:11], v[96:99]
  v_mul_f32 v30, v30, v26
  v_mul_f32 v31, v31, v27
  v_cvt_pk_bf16_f32 v40, v28, v29
  v_mul_f32 v34, v150, v150
  v_mul_f32 v35, v151, v151
  v_fma_f32 v32, v32, v14, v10
  v_fma_f32 v33, v33, v14, v10
  v_mfma_f32_16x16x32_bf16 v[104:107], v[192:195], a[12:15], v[104:107]
  ds_read_b64_tr_b16 v[192:193], v23 offset:8200
  s_add_u32 m0, s28, 4096
  v_cvt_pk_bf16_f32 v41, v30, v31
  v_fma_f32 v34, v34, v14, v10
  v_fma_f32 v35, v35, v14, v10
  v_mul_f32 v32, v32, v148
  v_mul_f32 v33, v33, v149
  v_mfma_f32_16x16x32_bf16 v[104:107], v[196:199], a[28:31], v[104:107]
  ds_read_b64_tr_b16 v[194:195], v23 offset:8456
  v_mul_f32 v34, v34, v150
  v_mul_f32 v35, v35, v151
  v_exp_f32 v32, v32
  s_waitcnt lgkmcnt(10)
  v_mfma_f32_16x16x32_bf16 v[84:87], v[204:207], a[16:19], v[84:87]
  ds_read_b64_tr_b16 v[196:197], v23 offset:10248
  s_add_u32 s24, s4, 258048
  v_exp_f32 v33, v33
  v_exp_f32 v34, v34
  v_mfma_f32_16x16x32_bf16 v[84:87], v[200:203], a[0:3], v[84:87]
  ds_read_b64_tr_b16 v[198:199], v23 offset:10504
  v_exp_f32 v35, v35
  v_mul_f32 v36, v148, v156
  v_mul_f32 v37, v149, v157
  v_mfma_f32_16x16x32_bf16 v[92:95], v[200:203], a[4:7], v[92:95]
  buffer_load_dwordx4 v5, s[48:51], s24 offen  lds
  v_mfma_f32_16x16x32_bf16 v[92:95], v[204:207], a[20:23], v[92:95]
  v_mul_f32 v38, v150, v158
  v_mul_f32 v39, v151, v159
  v_fma_f32 v32, v32, v18, v18
  v_fma_f32 v33, v33, v18, v18
  v_fma_f32 v34, v34, v18, v18
  v_fma_f32 v35, v35, v18, v18
  v_mfma_f32_16x16x32_bf16 v[100:103], v[204:207], a[24:27], v[100:103]
  v_rcp_f32 v32, v32
  v_rcp_f32 v33, v33
  v_rcp_f32 v34, v34
  v_mfma_f32_16x16x32_bf16 v[100:103], v[200:203], a[8:11], v[100:103]
  v_rcp_f32 v35, v35
  v_mul_f32 v36, v36, v32
  v_mul_f32 v37, v37, v33
  v_mul_f32 v38, v38, v34
  v_mfma_f32_16x16x32_bf16 v[108:111], v[200:203], a[12:15], v[108:111]
  ds_read_b64_tr_b16 v[200:201], v23 offset:20488
  v_mul_f32 v39, v39, v35
  v_cvt_pk_bf16_f32 v42, v36, v37
  v_mul_f32 v24, v160, v160
  v_mul_f32 v25, v161, v161
  v_mfma_f32_16x16x32_bf16 v[108:111], v[204:207], a[28:31], v[108:111]
  ds_read_b64_tr_b16 v[202:203], v23 offset:20744
  v_cvt_pk_bf16_f32 v43, v38, v39
  v_mul_f32 v26, v162, v162
  v_mul_f32 v27, v163, v163
  v_fma_f32 v24, v24, v15, v11
  s_waitcnt lgkmcnt(6)
  v_mfma_f32_16x16x32_bf16 v[112:115], v[188:191], a[16:19], 0
  ds_read_b64_tr_b16 v[204:205], v23 offset:22536
  ds_read_b64_tr_b16 v[206:207], v23 offset:22792
  ds_write_b128 v4, v[40:43] offset:57344
  v_mfma_f32_16x16x32_bf16 v[112:115], v[184:187], a[0:3], v[112:115]
  buffer_store_dwordx4 v[40:43], v4, s[12:15], s31 offen offset:0 sc1
  v_fma_f32 v25, v25, v15, v11
  v_fma_f32 v26, v26, v15, v11
  v_fma_f32 v27, v27, v15, v11
  v_mfma_f32_16x16x32_bf16 v[112:115], v[180:183], a[96:99], v[112:115]
  v_mul_f32 v24, v24, v160
  v_mul_f32 v25, v25, v161
  v_mul_f32 v26, v26, v162
  v_mul_f32 v27, v27, v163
  v_mul_f32 v28, v160, v168
  v_mfma_f32_16x16x32_bf16 v[112:115], v[176:179], a[80:83], v[112:115]
  v_exp_f32 v24, v24
  v_exp_f32 v25, v25
  v_mul_f32 v29, v161, v169
  v_mfma_f32_16x16x32_bf16 v[120:123], v[176:179], a[84:87], 0
  v_exp_f32 v26, v26
  v_exp_f32 v27, v27
  v_mfma_f32_16x16x32_bf16 v[120:123], v[180:183], a[100:103], v[120:123]
  s_waitcnt vmcnt(19) lgkmcnt(1)
  s_barrier
  v_add_u32 v22, 24576, v22
  v_add_u32 v23, 24576, v23
  s_waitcnt vmcnt(10)
  s_add_u32 s23, s52, 512
  s_mov_b64 exec, 1
  buffer_store_dwordx2 v[252:253], off, s[12:15], s23 sc1
  s_mov_b64 exec, -1
  v_mfma_f32_16x16x32_bf16 v[120:123], v[184:187], a[4:7], v[120:123]
  ds_read_b64_tr_b16 v[176:177], v22 offset:0
  s_add_u32 m0, s28, 8192
  v_mul_f32 v30, v162, v170
  v_mul_f32 v31, v163, v171
  v_fma_f32 v24, v24, v19, v19
  v_fma_f32 v25, v25, v19, v19
  v_fma_f32 v26, v26, v19, v19
  v_mfma_f32_16x16x32_bf16 v[120:123], v[188:191], a[20:23], v[120:123]
  ds_read_b64_tr_b16 v[178:179], v22 offset:512
  s_add_u32 s24, s3, 221184
  v_fma_f32 v27, v27, v19, v19
  v_rcp_f32 v24, v24
  v_rcp_f32 v25, v25
  v_mfma_f32_16x16x32_bf16 v[116:119], v[204:207], a[16:19], 0
  ds_read_b64_tr_b16 v[180:181], v22 offset:4096
  ds_read_b64_tr_b16 v[182:183], v22 offset:4608
  v_rcp_f32 v26, v26
  v_mul_f32 v28, v28, v24
  v_mfma_f32_16x16x32_bf16 v[116:119], v[200:203], a[0:3], v[116:119]
  ds_read_b64_tr_b16 v[184:185], v22 offset:8
  buffer_load_dwordx4 v6, s[48:51], s24 offen  lds
  v_mfma_f32_16x16x32_bf16 v[116:119], v[196:199], a[96:99], v[116:119]
  ds_read_b64_tr_b16 v[186:187], v22 offset:520
  s_add_u32 m0, s28, 12288
  v_rcp_f32 v27, v27
L_pad7:
  s_cbranch_execz L_pad8
  v_mul_f32 v29, v29, v25
  v_mul_f32 v30, v30, v26
  v_mul_f32 v32, v164, v164
  v_mfma_f32_16x16x32_bf16 v[116:119], v[192:195], a[80:83], v[116:119]
  ds_read_b64_tr_b16 v[188:189], v22 offset:4104
  s_add_u32 s24, s5, 147456
  v_mul_f32 v31, v31, v27
  v_cvt_pk_bf16_f32 v44, v28, v29
  v_mul_f32 v33, v165, v165
  v_mul_f32 v34, v166, v166
  v_mul_f32 v35, v167, v167
  v_mfma_f32_16x16x32_bf16 v[124:127], v[192:195], a[84:87], 0
  ds_read_b64_tr_b16 v[190:191], v22 offset:4616
  buffer_load_dwordx4 v5, s[48:51], s24 offen  lds
  v_mfma_f32_16x16x32_bf16 v[124:127], v[196:199], a[100:103], v[124:127]
  ds_read_b64_tr_b16 v[192:193], v22 offset:12288
  v_cvt_pk_bf16_f32 v45, v30, v31
  v_fma_f32 v32, v32, v15, v11
  v_fma_f32 v33, v33, v15, v11
  v_fma_f32 v34, v34, v15, v11
  v_fma_f32 v35, v35, v15, v11
  v_mfma_f32_16x16x32_bf16 v[124:127], v[200:203], a[4:7], v[124:127]
  ds_read_b64_tr_b16 v[194:195], v22 offset:12800
  s_add_u32 m0, s28, 16384
  v_mul_f32 v32, v32, v164
  v_mul_f32 v33, v33, v165
  v_mul_f32 v34, v34, v166
  v_mul_f32 v35, v35, v167
  v_mul_f32 v36, v164, v172
  v_mfma_f32_16x16x32_bf16 v[124:127], v[204:207], a[20:23], v[124:127]
  ds_read_b64_tr_b16 v[196:197], v22 offset:16384
  s_add_u32 s24, s5, 184320
  ds_read_b128 a[160:163], v243 offset:40960
  v_exp_f32 v32, v32
  v_exp_f32 v33, v33
  s_waitcnt lgkmcnt(8)
  v_mfma_f32_16x16x32_bf16 v[80:83], v[180:183], a[32:35], v[80:83]
  ds_read_b64_tr_b16 v[198:199], v22 offset:16896
  v_exp_f32 v34, v34
  v_exp_f32 v35, v35
  v_mfma_f32_16x16x32_bf16 v[80:83], v[176:179], a[112:115], v[80:83]
  ds_read_b64_tr_b16 v[200:201], v22 offset:12296
  v_mul_f32 v37, v165, v173
  v_mul_f32 v38, v166, v174
  v_mul_f32 v39, v167, v175
  v_mfma_f32_16x16x32_bf16 v[88:91], v[176:179], a[116:119], v[88:91]
  ds_read_b64_tr_b16 v[202:203], v22 offset:12808
  ds_read_b128 a[164:167], v243 offset:41216
  v_fma_f32 v32, v32, v19, v19
  v_fma_f32 v33, v33, v19, v19
  v_fma_f32 v34, v34, v19, v19
  v_mfma_f32_16x16x32_bf16 v[88:91], v[180:183], a[36:39], v[88:91]
  ds_read_b64_tr_b16 v[204:205], v22 offset:16392
  v_fma_f32 v35, v35, v19, v19
  v_rcp_f32 v32, v32
  v_mul_f32 v24, v48, v48
  v_mfma_f32_16x16x32_bf16 v[96:99], v[180:183], a[40:43], v[96:99]
  ds_read_b64_tr_b16 v[206:207], v22 offset:16904
  v_rcp_f32 v33, v33
  v_rcp_f32 v34, v34
  v_mfma_f32_16x16x32_bf16 v[96:99], v[176:179], a[120:123], v[96:99]
  buffer_load_dwordx4 v5, s[48:51], s24 offen  lds
  s_add_u32 m0, s28, 20480
  s_add_u32 s24, s58, 147456
  v_mfma_f32_16x16x32_bf16 v[104:107], v[176:179], a[124:127], v[104:107]
  ds_read_b64_tr_b16 v[176:177], v23 offset:8192
  v_rcp_f32 v35, v35
  v_mul_f32 v36, v36, v32
  v_mul_f32 v37, v37, v33
  v_mul_f32 v38, v38, v34
  v_mfma_f32_16x16x32_bf16 v[104:107], v[180:183], a[44:47], v[104:107]
  ds_read_b64_tr_b16 v[178:179], v23 offset:8448
  v_mul_f32 v39, v39, v35
  v_cvt_pk_bf16_f32 v46, v36, v37
  v_mul_f32 v25, v49, v49
  v_mul_f32 v26, v50, v50
  s_waitcnt lgkmcnt(12)
  v_mfma_f32_16x16x32_bf16 v[84:87], v[188:191], a[32:35], v[84:87]
  ds_read_b64_tr_b16 v[180:181], v23 offset:10240
  v_cvt_pk_bf16_f32 v47, v38, v39
  v_mul_f32 v27, v51, v51
  v_fma_f32 v24, v24, v16, v12
  v_fma_f32 v25, v25, v16, v12
  v_mfma_f32_16x16x32_bf16 v[84:87], v[184:187], a[112:115], v[84:87]
  ds_read_b64_tr_b16 v[182:183], v23 offset:10496
  ds_write_b128 v4, v[44:47] offset:57600
  v_fma_f32 v26, v26, v16, v12
  v_fma_f32 v27, v27, v16, v12
  v_mfma_f32_16x16x32_bf16 v[92:95], v[184:187], a[116:119], v[92:95]
  buffer_load_dwordx4 v6, s[48:51], s24 offen  lds
  s_add_u32 m0, s28, 106496
  s_add_u32 s4, s4, s37
  v_mfma_f32_16x16x32_bf16 v[92:95], v[188:191], a[36:39], v[92:95]
  s_add_u32 s5, s5, s37
  s_add_u32 s6, s6, s37
  ds_read_b128 a[168:171], v244 offset:40960
  buffer_store_dwordx4 v[44:47], v4, s[12:15], s31 offen offset:256 sc1
  v_xor_b32 v4, 512, v4
  v_mul_f32 v24, v24, v48
  v_mul_f32 v25, v25, v49
  v_mfma_f32_16x16x32_bf16 v[100:103], v[188:191], a[40:43], v[100:103]
  s_add_u32 s7, s7, s37
  ds_read_b128 a[172:175], v244 offset:41216
  v_mul_f32 v26, v26, v50
  v_mul_f32 v27, v27, v51
  v_exp_f32 v24, v24
  v_mfma_f32_16x16x32_bf16 v[100:103], v[184:187], a[120:123], v[100:103]
  s_add_u32 s24, s5, 0
  ds_read_b128 a[176:179], v243 offset:49152
  v_exp_f32 v25, v25
  v_exp_f32 v26, v26
  v_mfma_f32_16x16x32_bf16 v[108:111], v[184:187], a[124:127], v[108:111]
  ds_read_b64_tr_b16 v[184:185], v23 offset:20480
  v_exp_f32 v27, v27
  v_mul_f32 v28, v48, v56
  v_mul_f32 v29, v49, v57
  v_mfma_f32_16x16x32_bf16 v[108:111], v[188:191], a[44:47], v[108:111]
  ds_read_b64_tr_b16 v[186:187], v23 offset:20736
  v_mul_f32 v30, v50, v58
  v_mul_f32 v31, v51, v59
  v_fma_f32 v24, v24, v20, v20
  v_fma_f32 v25, v25, v20, v20
  s_waitcnt lgkmcnt(15)
  v_mfma_f32_16x16x32_bf16 v[80:83], v[196:199], a[144:147], v[80:83]
  ds_read_b64_tr_b16 v[188:189], v23 offset:22528
  v_fma_f32 v26, v26, v20, v20
  v_fma_f32 v27, v27, v20, v20
  v_rcp_f32 v24, v24
  v_mfma_f32_16x16x32_bf16 v[80:83], v[192:195], a[128:131], v[80:83]
  ds_read_b64_tr_b16 v[190:191], v23 offset:22784
  v_rcp_f32 v25, v25
  v_rcp_f32 v26, v26
  v_mfma_f32_16x16x32_bf16 v[88:91], v[192:195], a[132:135], v[88:91]
  buffer_load_dwordx4 v5, s[48:51], s24 offen  lds
  s_add_u32 m0, s28, 110592
  s_add_u32 s24, s5, 36864
  v_mfma_f32_16x16x32_bf16 v[88:91], v[196:199], a[148:151], v[88:91]
  buffer_load_dwordx4 v5, s[48:51], s24 offen  lds
  v_mfma_f32_16x16x32_bf16 v[96:99], v[196:199], a[152:155], v[96:99]
  s_add_u32 m0, s28, 114688
  ds_read_b128 a[180:183], v243 offset:49408
  v_rcp_f32 v27, v27
  v_mul_f32 v28, v28, v24
  v_mul_f32 v29, v29, v25
  v_mul_f32 v30, v30, v26
  v_mul_f32 v32, v52, v52
  v_mfma_f32_16x16x32_bf16 v[96:99], v[192:195], a[136:139], v[96:99]
  s_add_u32 s24, s7, 0
  ds_read_b128 a[184:187], v244 offset:49152
  v_mul_f32 v31, v31, v27
  v_cvt_pk_bf16_f32 v40, v28, v29
  v_mul_f32 v33, v53, v53
  v_mul_f32 v34, v54, v54
  v_mul_f32 v35, v55, v55
  v_mfma_f32_16x16x32_bf16 v[104:107], v[192:195], a[140:143], v[104:107]
  ds_read_b64_tr_b16 v[192:193], v23 offset:8200
  v_cvt_pk_bf16_f32 v41, v30, v31
  v_fma_f32 v32, v32, v16, v12
  v_fma_f32 v33, v33, v16, v12
  v_fma_f32 v34, v34, v16, v12
  v_fma_f32 v35, v35, v16, v12
  v_mfma_f32_16x16x32_bf16 v[104:107], v[196:199], a[156:159], v[104:107]
  ds_read_b64_tr_b16 v[194:195], v23 offset:8456
  v_mul_f32 v32, v32, v52
  v_mul_f32 v33, v33, v53
  v_mul_f32 v34, v34, v54
  v_mul_f32 v35, v35, v55
  s_waitcnt lgkmcnt(15)
  v_mfma_f32_16x16x32_bf16 v[84:87], v[204:207], a[144:147], v[84:87]
  ds_read_b64_tr_b16 v[196:197], v23 offset:10248
  ds_read_b128 a[188:191], v244 offset:49408
  v_exp_f32 v32, v32
  v_mul_f32 v36, v52, v60
  v_mfma_f32_16x16x32_bf16 v[84:87], v[200:203], a[128:131], v[84:87]
  ds_read_b64_tr_b16 v[198:199], v23 offset:10504
  v_exp_f32 v33, v33
  v_exp_f32 v34, v34
  v_mfma_f32_16x16x32_bf16 v[92:95], v[200:203], a[132:135], v[92:95]
  buffer_load_dwordx4 v5, s[48:51], s24 offen  lds
  s_add_u32 m0, s28, 118784
  s_add_u32 s24, s5, 73728
  v_mfma_f32_16x16x32_bf16 v[92:95], v[204:207], a[148:151], v[92:95]
  buffer_load_dwordx4 v5, s[48:51], s24 offen  lds
  v_mfma_f32_16x16x32_bf16 v[100:103], v[204:207], a[152:155], v[100:103]
  v_exp_f32 v35, v35
  v_mul_f32 v37, v53, v61
  v_mul_f32 v38, v54, v62
  v_mul_f32 v39, v55, v63
  v_fma_f32 v32, v32, v20, v20
  v_fma_f32 v33, v33, v20, v20
  v_mfma_f32_16x16x32_bf16 v[100:103], v[200:203], a[136:139], v[100:103]
  v_fma_f32 v34, v34, v20, v20
  v_fma_f32 v35, v35, v20, v20
  v_rcp_f32 v32, v32
  v_rcp_f32 v33, v33
  v_mfma_f32_16x16x32_bf16 v[108:111], v[200:203], a[140:143], v[108:111]
  ds_read_b64_tr_b16 v[200:201], v23 offset:20488
  v_rcp_f32 v34, v34
  v_rcp_f32 v35, v35
  v_mul_f32 v36, v36, v32
  v_mfma_f32_16x16x32_bf16 v[108:111], v[204:207], a[156:159], v[108:111]
  ds_read_b64_tr_b16 v[202:203], v23 offset:20744
  v_mul_f32 v37, v37, v33
  v_mul_f32 v38, v38, v34
  v_mul_f32 v39, v39, v35
  v_mul_f32 v24, v64, v64
  s_waitcnt lgkmcnt(9)
  v_mfma_f32_16x16x32_bf16 v[112:115], v[188:191], a[144:147], v[112:115]
  ds_read_b64_tr_b16 v[204:205], v23 offset:22536
  ds_read_b64_tr_b16 v[206:207], v23 offset:22792
  v_cvt_pk_bf16_f32 v42, v36, v37
  v_cvt_pk_bf16_f32 v43, v38, v39
  v_mul_f32 v25, v65, v65
  v_mfma_f32_16x16x32_bf16 v[112:115], v[184:187], a[128:131], v[112:115]
  s_add_u32 s26, s53, 512
  s_mov_b64 exec, s[98:99]
  buffer_load_dwordx2 v[248:249], v250, s[12:15], s26 offen sc1
  s_mov_b64 exec, -1
  v_mfma_f32_16x16x32_bf16 v[112:115], v[180:183], a[32:35], v[112:115]
  ds_write_b128 v4, v[40:43] offset:57344
  v_mul_f32 v26, v66, v66
  v_mul_f32 v27, v67, v67
  v_fma_f32 v24, v24, v17, v13
  v_fma_f32 v25, v25, v17, v13
  v_mfma_f32_16x16x32_bf16 v[112:115], v[176:179], a[112:115], v[112:115]
  buffer_store_dwordx4 v[40:43], v4, s[12:15], s31 offen offset:0 sc1
  v_fma_f32 v26, v26, v17, v13
  v_fma_f32 v27, v27, v17, v13
  v_mul_f32 v24, v24, v64
  v_mul_f32 v25, v25, v65
  v_mfma_f32_16x16x32_bf16 v[120:123], v[176:179], a[116:119], v[120:123]
  v_mul_f32 v26, v26, v66
  v_mul_f32 v27, v27, v67
  v_exp_f32 v24, v24
  v_mul_f32 v28, v64, v72
  v_mfma_f32_16x16x32_bf16 v[120:123], v[180:183], a[36:39], v[120:123]
  s_waitcnt vmcnt(15) lgkmcnt(1)
  s_barrier
  v_add_u32 v22, 4294918144, v22
  v_add_u32 v23, 4294918144, v23
  v_exp_f32 v25, v25
  v_mul_f32 v29, v65, v73
  v_mfma_f32_16x16x32_bf16 v[120:123], v[184:187], a[132:135], v[120:123]
  ds_read_b64_tr_b16 v[176:177], v22 offset:0
  s_add_u32 m0, s28, 122880
  v_exp_f32 v26, v26
  v_exp_f32 v27, v27
  v_mfma_f32_16x16x32_bf16 v[120:123], v[188:191], a[148:151], v[120:123]
  ds_read_b64_tr_b16 v[178:179], v22 offset:512
  s_add_u32 s24, s5, 110592
  v_mul_f32 v30, v66, v74
  v_mul_f32 v31, v67, v75
  v_fma_f32 v24, v24, v21, v21
  v_fma_f32 v25, v25, v21, v21
  v_mfma_f32_16x16x32_bf16 v[116:119], v[204:207], a[144:147], v[116:119]
  ds_read_b64_tr_b16 v[180:181], v22 offset:4096
  ds_read_b64_tr_b16 v[182:183], v22 offset:4608
  v_fma_f32 v26, v26, v21, v21
  v_rcp_f32 v24, v24
  v_mfma_f32_16x16x32_bf16 v[116:119], v[200:203], a[128:131], v[116:119]
  ds_read_b64_tr_b16 v[184:185], v22 offset:8
  buffer_load_dwordx4 v5, s[48:51], s24 offen  lds
  v_mfma_f32_16x16x32_bf16 v[116:119], v[196:199], a[32:35], v[116:119]
  ds_read_b64_tr_b16 v[186:187], v22 offset:520
  s_add_u32 m0, s28, 126976
  v_fma_f32 v27, v27, v21, v21
  v_rcp_f32 v25, v25
  v_rcp_f32 v26, v26
  v_mfma_f32_16x16x32_bf16 v[116:119], v[192:195], a[112:115], v[116:119]
  ds_read_b64_tr_b16 v[188:189], v22 offset:4104
  v_rcp_f32 v27, v27
  v_mul_f32 v28, v28, v24
  v_mul_f32 v29, v29, v25
  v_mfma_f32_16x16x32_bf16 v[124:127], v[192:195], a[116:119], v[124:127]
  ds_read_b64_tr_b16 v[190:191], v22 offset:4616
  s_add_u32 s24, s4, 0
  v_mul_f32 v30, v30, v26
  v_mul_f32 v31, v31, v27
  v_cvt_pk_bf16_f32 v44, v28, v29
  v_mul_f32 v32, v68, v68
  v_mfma_f32_16x16x32_bf16 v[124:127], v[196:199], a[36:39], v[124:127]
  ds_read_b64_tr_b16 v[192:193], v22 offset:12288
  v_cvt_pk_bf16_f32 v45, v30, v31
  v_mul_f32 v33, v69, v69
  v_mul_f32 v34, v70, v70
  v_mul_f32 v35, v71, v71
  v_mfma_f32_16x16x32_bf16 v[124:127], v[200:203], a[132:135], v[124:127]
  ds_read_b64_tr_b16 v[194:195], v22 offset:12800
  buffer_load_dwordx4 v5, s[48:51], s24 offen  lds
  v_mfma_f32_16x16x32_bf16 v[124:127], v[204:207], a[148:151], v[124:127]
  ds_read_b64_tr_b16 v[196:197], v22 offset:16384
  s_add_u32 m0, s28, 131072
  v_fma_f32 v32, v32, v17, v13
  v_fma_f32 v33, v33, v17, v13
  v_fma_f32 v34, v34, v17, v13
  v_fma_f32 v35, v35, v17, v13
  v_mul_f32 v36, v68, v76
  s_waitcnt lgkmcnt(7)
  v_mfma_f32_16x16x32_bf16 v[80:83], v[180:183], a[64:67], v[80:83]
  ds_read_b64_tr_b16 v[198:199], v22 offset:16896
  v_mul_f32 v32, v32, v68
  v_mul_f32 v33, v33, v69
  v_mul_f32 v34, v34, v70
  v_mul_f32 v35, v35, v71
  v_mfma_f32_16x16x32_bf16 v[80:83], v[176:179], a[48:51], v[80:83]
  ds_read_b64_tr_b16 v[200:201], v22 offset:12296
  s_sub_u32 s4, s4, s37
  v_exp_f32 v32, v32
  v_exp_f32 v33, v33
  v_mfma_f32_16x16x32_bf16 v[88:91], v[176:179], a[52:55], v[88:91]
  ds_read_b64_tr_b16 v[202:203], v22 offset:12808
  v_exp_f32 v34, v34
  v_exp_f32 v35, v35
  v_mfma_f32_16x16x32_bf16 v[88:91], v[180:183], a[68:71], v[88:91]
  ds_read_b64_tr_b16 v[204:205], v22 offset:16392
  s_sub_u32 s5, s5, s37
  v_mul_f32 v37, v69, v77
  v_mul_f32 v38, v70, v78
  v_mul_f32 v39, v71, v79
  v_fma_f32 v32, v32, v21, v21
  v_mfma_f32_16x16x32_bf16 v[96:99], v[180:183], a[72:75], v[96:99]
  ds_read_b64_tr_b16 v[206:207], v22 offset:16904
  s_sub_u32 s6, s6, s37
  v_fma_f32 v33, v33, v21, v21
  v_fma_f32 v34, v34, v21, v21
  v_fma_f32 v35, v35, v21, v21
  v_mfma_f32_16x16x32_bf16 v[96:99], v[176:179], a[56:59], v[96:99]
  v_rcp_f32 v32, v32
  v_rcp_f32 v33, v33
  v_rcp_f32 v34, v34
  v_mfma_f32_16x16x32_bf16 v[104:107], v[176:179], a[60:63], v[104:107]
  ds_read_b64_tr_b16 v[176:177], v23 offset:8192
  s_sub_u32 s7, s7, s37
  v_rcp_f32 v35, v35
  v_mul_f32 v36, v36, v32
  v_mul_f32 v37, v37, v33
  v_mfma_f32_16x16x32_bf16 v[104:107], v[180:183], a[76:79], v[104:107]
  ds_read_b64_tr_b16 v[178:179], v23 offset:8448
  v_mul_f32 v38, v38, v34
  v_mul_f32 v39, v39, v35
  v_cvt_pk_bf16_f32 v46, v36, v37
  s_waitcnt lgkmcnt(10)
  v_mfma_f32_16x16x32_bf16 v[84:87], v[188:191], a[64:67], v[84:87]
  ds_read_b64_tr_b16 v[180:181], v23 offset:10240
  s_add_u32 s24, s5, 221184
  v_cvt_pk_bf16_f32 v47, v38, v39
  v_mfma_f32_16x16x32_bf16 v[84:87], v[184:187], a[48:51], v[84:87]
  ds_read_b64_tr_b16 v[182:183], v23 offset:10496
  ds_write_b128 v4, v[44:47] offset:57600
  v_mfma_f32_16x16x32_bf16 v[92:95], v[184:187], a[52:55], v[92:95]
  buffer_load_dwordx4 v5, s[48:51], s24 offen  lds
  v_mfma_f32_16x16x32_bf16 v[92:95], v[188:191], a[68:71], v[92:95]
  s_add_u32 m0, s28, 135168
  buffer_store_dwordx4 v[44:47], v4, s[12:15], s31 offen offset:256 sc1
  v_mfma_f32_16x16x32_bf16 v[100:103], v[188:191], a[72:75], v[100:103]
  s_add_u32 s24, s5, 258048
  v_mfma_f32_16x16x32_bf16 v[100:103], v[184:187], a[56:59], v[100:103]
  s_waitcnt vmcnt(5)
  v_cmp_eq_u64 vcc, s[56:57], v[248:249]
  s_nop 1
  s_orn2_b64 vcc, vcc, s[98:99]
  s_cmp_eq_u64 vcc, -1
  s_cbranch_scc0 L_lp56s
L_ok55:
  v_mfma_f32_16x16x32_bf16 v[108:111], v[184:187], a[60:63], v[108:111]
  ds_read_b64_tr_b16 v[184:185], v23 offset:20480
  v_mfma_f32_16x16x32_bf16 v[108:111], v[188:191], a[76:79], v[108:111]
  ds_read_b64_tr_b16 v[186:187], v23 offset:20736
  s_waitcnt lgkmcnt(11)
  v_mfma_f32_16x16x32_bf16 v[80:83], v[196:199], a[176:179], v[80:83]
  ds_read_b64_tr_b16 v[188:189], v23 offset:22528
  v_mfma_f32_16x16x32_bf16 v[80:83], v[192:195], a[160:163], v[80:83]
  ds_read_b64_tr_b16 v[190:191], v23 offset:22784
  v_mfma_f32_16x16x32_bf16 v[88:91], v[192:195], a[164:167], v[88:91]
  buffer_load_dwordx4 v5, s[48:51], s24 offen  lds
  s_add_u32 m0, s28, 139264
  s_add_u32 s24, s58, 221184
  v_mfma_f32_16x16x32_bf16 v[88:91], v[196:199], a[180:183], v[88:91]
  buffer_load_dwordx4 v6, s[48:51], s24 offen  lds
  v_mfma_f32_16x16x32_bf16 v[96:99], v[196:199], a[184:187], v[96:99]
  s_add_u32 s25, s11, 40960
  buffer_load_dwordx4 a[192:195], v243, s[12:15], s25 offen offset:0 sc1
  v_mfma_f32_16x16x32_bf16 v[96:99], v[192:195], a[168:171], v[96:99]
  buffer_load_dwordx4 a[196:199], v243, s[12:15], s25 offen offset:256 sc1
  v_mfma_f32_16x16x32_bf16 v[104:107], v[192:195], a[172:175], v[104:107]
  ds_read_b64_tr_b16 v[192:193], v23 offset:8200
  v_mfma_f32_16x16x32_bf16 v[104:107], v[196:199], a[188:191], v[104:107]
  ds_read_b64_tr_b16 v[194:195], v23 offset:8456
  s_waitcnt lgkmcnt(11)
  v_mfma_f32_16x16x32_bf16 v[84:87], v[204:207], a[176:179], v[84:87]
  ds_read_b64_tr_b16 v[196:197], v23 offset:10248
  v_mfma_f32_16x16x32_bf16 v[84:87], v[200:203], a[160:163], v[84:87]
  ds_read_b64_tr_b16 v[198:199], v23 offset:10504
  v_mfma_f32_16x16x32_bf16 v[92:95], v[200:203], a[164:167], v[92:95]
  buffer_load_dwordx4 a[200:203], v244, s[12:15], s25 offen offset:0 sc1
  v_mfma_f32_16x16x32_bf16 v[92:95], v[204:207], a[180:183], v[92:95]
  buffer_load_dwordx4 a[204:207], v244, s[12:15], s25 offen offset:256 sc1
  v_mfma_f32_16x16x32_bf16 v[100:103], v[204:207], a[184:187], v[100:103]
  s_add_u32 s25, s11, 49152
  buffer_load_dwordx4 a[208:211], v243, s[12:15], s25 offen offset:0 sc1
  v_mfma_f32_16x16x32_bf16 v[100:103], v[200:203], a[168:171], v[100:103]
  buffer_load_dwordx4 a[212:215], v243, s[12:15], s25 offen offset:256 sc1
  v_mfma_f32_16x16x32_bf16 v[108:111], v[200:203], a[172:175], v[108:111]
  ds_read_b64_tr_b16 v[200:201], v23 offset:20488
  v_mfma_f32_16x16x32_bf16 v[108:111], v[204:207], a[188:191], v[108:111]
  ds_read_b64_tr_b16 v[202:203], v23 offset:20744
  s_waitcnt lgkmcnt(6)
  v_mfma_f32_16x16x32_bf16 v[112:115], v[188:191], a[176:179], v[112:115]
  ds_read_b64_tr_b16 v[204:205], v23 offset:22536
  ds_read_b64_tr_b16 v[206:207], v23 offset:22792
  v_mfma_f32_16x16x32_bf16 v[112:115], v[184:187], a[160:163], v[112:115]
  buffer_load_dwordx4 a[216:219], v244, s[12:15], s25 offen offset:0 sc1
  v_mfma_f32_16x16x32_bf16 v[112:115], v[180:183], a[64:67], v[112:115]
  buffer_load_dwordx4 a[220:223], v244, s[12:15], s25 offen offset:256 sc1
  v_mfma_f32_16x16x32_bf16 v[112:115], v[176:179], a[48:51], v[112:115]
  v_mfma_f32_16x16x32_bf16 v[120:123], v[176:179], a[52:55], v[120:123]
  v_mfma_f32_16x16x32_bf16 v[120:123], v[180:183], a[68:71], v[120:123]
  s_waitcnt lgkmcnt(0)
  s_barrier
  v_add_u32 v22, 4294885376, v22
  v_add_u32 v23, 4294885376, v23
  ds_read_b128 a[224:227], v243 offset:57344
  s_lshl_b32 s23, s18, 1
  v_mfma_f32_16x16x32_bf16 v[120:123], v[184:187], a[164:167], v[120:123]
  ds_read_b64_tr_b16 v[176:177], v22 offset:0
  s_add_u32 m0, s28, 81920
  s_add_u32 s23, s23, s19
  v_mfma_f32_16x16x32_bf16 v[120:123], v[188:191], a[180:183], v[120:123]
  ds_read_b64_tr_b16 v[178:179], v22 offset:512
  s_add_u32 s4, s4, s37
  ds_read_b128 a[240:243], v2 offset:0
  s_mul_i32 s20, s23, 589824
  v_mfma_f32_16x16x32_bf16 v[116:119], v[204:207], a[176:179], v[116:119]
  ds_read_b64_tr_b16 v[180:181], v22 offset:4096
  ds_read_b64_tr_b16 v[182:183], v22 offset:4608
  s_add_u32 s5, s5, s37
  s_add_u32 s20, s20, 27262976
  v_mfma_f32_16x16x32_bf16 v[116:119], v[200:203], a[160:163], v[116:119]
  ds_read_b64_tr_b16 v[184:185], v22 offset:8
  ds_read_b128 a[228:231], v243 offset:57600
  s_mul_i32 s21, s23, 18432
  s_add_u32 s21, s21, 48476160
  v_mfma_f32_16x16x32_bf16 v[116:119], v[196:199], a[64:67], v[116:119]
  ds_read_b64_tr_b16 v[186:187], v22 offset:520
  s_add_u32 s6, s6, s37
  s_lshl_b32 s23, s16, 11
  v_mfma_f32_16x16x32_bf16 v[116:119], v[192:195], a[48:51], v[116:119]
  ds_read_b64_tr_b16 v[188:189], v22 offset:4104
  s_add_u32 s7, s7, s37
  ds_read_b128 a[244:247], v2 offset:256
  s_add_u32 s40, s20, s23
  v_mfma_f32_16x16x32_bf16 v[124:127], v[192:195], a[52:55], v[124:127]
  ds_read_b64_tr_b16 v[190:191], v22 offset:4616
  s_lshl_b32 s23, s16, 9
  s_add_u32 s41, s21, s23
  v_mfma_f32_16x16x32_bf16 v[124:127], v[196:199], a[68:71], v[124:127]
  ds_read_b64_tr_b16 v[192:193], v22 offset:12288
  s_add_u32 s24, s4, 36864
  ds_read_b128 a[232:235], v244 offset:57344
  s_lshl_b32 s23, s17, 13
  v_mfma_f32_16x16x32_bf16 v[124:127], v[200:203], a[164:167], v[124:127]
  ds_read_b64_tr_b16 v[194:195], v22 offset:12800
  buffer_load_dwordx4 v5, s[48:51], s24 offen  lds
  s_add_u32 s42, s40, s23
  s_add_u32 s20, s20, s23
  v_mfma_f32_16x16x32_bf16 v[124:127], v[204:207], a[180:183], v[124:127]
  ds_read_b64_tr_b16 v[196:197], v22 offset:16384
  s_add_u32 m0, s28, 86016
  ds_read_b128 a[248:251], v3 offset:0
  s_lshl_b32 s23, s17, 6
  s_waitcnt lgkmcnt(11)
  v_mfma_f32_16x16x32_bf16 v[80:83], v[180:183], a[240:243], v[80:83]
  ds_read_b64_tr_b16 v[198:199], v22 offset:16896
  s_add_u32 s44, s41, s23
  s_add_u32 s21, s21, s23
  v_mfma_f32_16x16x32_bf16 v[80:83], v[176:179], a[224:227], v[80:83]
  ds_read_b64_tr_b16 v[200:201], v22 offset:12296
  s_add_u32 s24, s6, 0
  ds_read_b128 a[236:239], v244 offset:57600
  s_lshl_b32 s23, s54, 1
  s_waitcnt lgkmcnt(12)
  v_mfma_f32_16x16x32_bf16 v[88:91], v[176:179], a[228:231], v[88:91]
  ds_read_b64_tr_b16 v[202:203], v22 offset:12808
  s_add_u32 s23, s23, s27
  s_lshl_b32 s45, s23, 11
  s_waitcnt lgkmcnt(10)
  v_mfma_f32_16x16x32_bf16 v[88:91], v[180:183], a[244:247], v[88:91]
  ds_read_b64_tr_b16 v[204:205], v22 offset:16392
  ds_read_b128 a[252:255], v3 offset:256
  s_add_u32 s20, s20, s45
  s_add_u32 s20, s20, 524288
  s_waitcnt lgkmcnt(6)
  v_mfma_f32_16x16x32_bf16 v[96:99], v[180:183], a[248:251], v[96:99]
  ds_read_b64_tr_b16 v[206:207], v22 offset:16904
  s_lshl_b32 s45, s23, 9
  s_add_u32 s21, s21, s45
  v_mfma_f32_16x16x32_bf16 v[96:99], v[176:179], a[232:235], v[96:99]
  buffer_load_dwordx4 v5, s[48:51], s24 offen  lds
  s_add_u32 m0, s28, 90112
  s_add_u32 s24, s4, 73728
  s_waitcnt lgkmcnt(4)
  v_mfma_f32_16x16x32_bf16 v[104:107], v[176:179], a[236:239], v[104:107]
  ds_read_b64_tr_b16 v[176:177], v23 offset:8192
  s_add_u32 s21, s21, 16384
  s_waitcnt lgkmcnt(2)
  v_mfma_f32_16x16x32_bf16 v[104:107], v[180:183], a[252:255], v[104:107]
  ds_read_b64_tr_b16 v[178:179], v23 offset:8448
  v_mfma_f32_16x16x32_bf16 v[84:87], v[188:191], a[240:243], v[84:87]
  ds_read_b64_tr_b16 v[180:181], v23 offset:10240
  v_mfma_f32_16x16x32_bf16 v[84:87], v[184:187], a[224:227], v[84:87]
  ds_read_b64_tr_b16 v[182:183], v23 offset:10496
  v_mfma_f32_16x16x32_bf16 v[92:95], v[184:187], a[228:231], v[92:95]
  buffer_load_dwordx4 v5, s[48:51], s24 offen  lds
  s_add_u32 m0, s28, 94208
  s_add_u32 s24, s4, 110592
  v_mfma_f32_16x16x32_bf16 v[92:95], v[188:191], a[244:247], v[92:95]
  buffer_load_dwordx4 v5, s[48:51], s24 offen  lds
  v_mfma_f32_16x16x32_bf16 v[100:103], v[188:191], a[248:251], v[100:103]
  s_add_u32 m0, s28, 98304
  v_mfma_f32_16x16x32_bf16 v[100:103], v[184:187], a[232:235], v[100:103]
  v_mfma_f32_16x16x32_bf16 v[108:111], v[184:187], a[236:239], v[108:111]
  ds_read_b64_tr_b16 v[184:185], v23 offset:20480
  s_add_u32 s24, s4, 147456
  v_mfma_f32_16x16x32_bf16 v[108:111], v[188:191], a[252:255], v[108:111]
  ds_read_b64_tr_b16 v[186:187], v23 offset:20736
  s_waitcnt vmcnt(7)
  v_mfma_f32_16x16x32_bf16 v[80:83], v[196:199], a[208:211], v[80:83]
  ds_read_b64_tr_b16 v[188:189], v23 offset:22528
  v_mfma_f32_16x16x32_bf16 v[80:83], v[192:195], a[192:195], v[80:83]
  ds_read_b64_tr_b16 v[190:191], v23 offset:22784
  v_mfma_f32_16x16x32_bf16 v[88:91], v[192:195], a[196:199], v[88:91]
  buffer_load_dwordx4 v5, s[48:51], s24 offen  lds
  s_add_u32 m0, s28, 102400
  s_add_u32 s24, s4, 184320
  s_waitcnt vmcnt(7)
  v_mfma_f32_16x16x32_bf16 v[88:91], v[196:199], a[212:215], v[88:91]
  buffer_load_dwordx4 v5, s[48:51], s24 offen  lds
  s_waitcnt vmcnt(7)
  v_mfma_f32_16x16x32_bf16 v[96:99], v[196:199], a[216:219], v[96:99]
  s_add_u32 s25, s11, 57344
  buffer_load_dwordx4 v[208:211], v243, s[12:15], s25 offen offset:0 sc1
  v_mfma_f32_16x16x32_bf16 v[96:99], v[192:195], a[200:203], v[96:99]
  buffer_load_dwordx4 v[212:215], v243, s[12:15], s25 offen offset:256 sc1
  v_mfma_f32_16x16x32_bf16 v[104:107], v[192:195], a[204:207], v[104:107]
  ds_read_b64_tr_b16 v[192:193], v23 offset:8200
  s_waitcnt vmcnt(8)
  v_mfma_f32_16x16x32_bf16 v[104:107], v[196:199], a[220:223], v[104:107]
  ds_read_b64_tr_b16 v[194:195], v23 offset:8456
  s_waitcnt lgkmcnt(10)
  v_mfma_f32_16x16x32_bf16 v[84:87], v[204:207], a[208:211], v[84:87]
  ds_read_b64_tr_b16 v[196:197], v23 offset:10248
  v_mfma_f32_16x16x32_bf16 v[84:87], v[200:203], a[192:195], v[84:87]
  ds_read_b64_tr_b16 v[198:199], v23 offset:10504
  v_mfma_f32_16x16x32_bf16 v[92:95], v[200:203], a[196:199], v[92:95]
  buffer_load_dwordx4 v[216:219], v244, s[12:15], s25 offen offset:0 sc1
  v_mfma_f32_16x16x32_bf16 v[92:95], v[204:207], a[212:215], v[92:95]
  buffer_load_dwordx4 v[220:223], v244, s[12:15], s25 offen offset:256 sc1
  v_mfma_f32_16x16x32_bf16 v[100:103], v[204:207], a[216:219], v[100:103]
  s_add_u32 s25, s11, 65536
  buffer_load_dwordx4 v[224:227], v243, s[12:15], s25 offen offset:0 sc1
  v_mfma_f32_16x16x32_bf16 v[100:103], v[200:203], a[200:203], v[100:103]
  v_mfma_f32_16x16x32_bf16 v[108:111], v[200:203], a[204:207], v[108:111]
  ds_read_b64_tr_b16 v[200:201], v23 offset:20488
  v_mfma_f32_16x16x32_bf16 v[108:111], v[204:207], a[220:223], v[108:111]
  ds_read_b64_tr_b16 v[202:203], v23 offset:20744
  s_waitcnt lgkmcnt(6)
  v_mfma_f32_16x16x32_bf16 v[112:115], v[188:191], a[208:211], v[112:115]
  ds_read_b64_tr_b16 v[204:205], v23 offset:22536
  ds_read_b64_tr_b16 v[206:207], v23 offset:22792
  v_mfma_f32_16x16x32_bf16 v[112:115], v[184:187], a[192:195], v[112:115]
  buffer_load_dwordx4 v[228:231], v243, s[12:15], s25 offen offset:256 sc1
  v_mfma_f32_16x16x32_bf16 v[112:115], v[180:183], a[240:243], v[112:115]
  buffer_load_dwordx4 v[232:235], v244, s[12:15], s25 offen offset:0 sc1
  v_mfma_f32_16x16x32_bf16 v[112:115], v[176:179], a[224:227], v[112:115]
  v_mfma_f32_16x16x32_bf16 v[120:123], v[176:179], a[228:231], v[120:123]
  buffer_load_dwordx4 v[236:239], v244, s[12:15], s25 offen offset:256 sc1
  v_mfma_f32_16x16x32_bf16 v[120:123], v[180:183], a[244:247], v[120:123]
  s_waitcnt lgkmcnt(0)
  s_barrier
  v_add_u32 v22, 106496, v22
  ds_read_b64_tr_b16 v[176:177], v22 offset:0
  v_mfma_f32_16x16x32_bf16 v[120:123], v[184:187], a[196:199], v[120:123]
  ds_read_b64_tr_b16 v[178:179], v22 offset:512
  s_add_u32 m0, s28, 0
  v_mfma_f32_16x16x32_bf16 v[120:123], v[188:191], a[212:215], v[120:123]
  ds_read_b64_tr_b16 v[180:181], v22 offset:4096
  s_add_u32 s24, s5, 147456
  v_mfma_f32_16x16x32_bf16 v[116:119], v[204:207], a[208:211], v[116:119]
  ds_read_b64_tr_b16 v[182:183], v22 offset:4608
  ds_read_b64_tr_b16 v[184:185], v22 offset:8192
  v_mfma_f32_16x16x32_bf16 v[116:119], v[200:203], a[192:195], v[116:119]
  ds_read_b64_tr_b16 v[186:187], v22 offset:8704
  v_mfma_f32_16x16x32_bf16 v[116:119], v[196:199], a[240:243], v[116:119]
  buffer_load_dwordx4 v5, s[48:51], s24 offen  lds
  s_add_u32 m0, s28, 4096
  v_mfma_f32_16x16x32_bf16 v[116:119], v[192:195], a[224:227], v[116:119]
  ds_read_b64_tr_b16 v[188:189], v22 offset:8
  s_add_u32 s24, s5, 184320
  v_mfma_f32_16x16x32_bf16 v[124:127], v[192:195], a[228:231], v[124:127]
  v_mfma_f32_16x16x32_bf16 v[124:127], v[196:199], a[244:247], v[124:127]
  ds_read_b64_tr_b16 v[190:191], v22 offset:520
  v_mfma_f32_16x16x32_bf16 v[124:127], v[200:203], a[196:199], v[124:127]
  buffer_load_dwordx4 v5, s[48:51], s24 offen  lds
  s_add_u32 m0, s28, 8192
  v_mfma_f32_16x16x32_bf16 v[124:127], v[204:207], a[212:215], v[124:127]
  ds_read_b64_tr_b16 v[192:193], v22 offset:4104
  s_add_u32 s24, s4, 221184
  s_waitcnt lgkmcnt(3)
  v_mfma_f32_16x16x32_bf16 v[144:147], v[184:187], a[32:35], 0
  ds_read_b64_tr_b16 v[194:195], v22 offset:4616
L_pad8:
  s_cbranch_execz L_pad9
  v_mfma_f32_16x16x32_bf16 v[144:147], v[180:183], a[16:19], v[144:147]
  ds_read_b64_tr_b16 v[196:197], v22 offset:8200
  v_mfma_f32_16x16x32_bf16 v[144:147], v[176:179], a[0:3], v[144:147]
  ds_read_b64_tr_b16 v[198:199], v22 offset:8712
  v_mfma_f32_16x16x32_bf16 v[152:155], v[176:179], a[4:7], 0
  buffer_load_dwordx4 v5, s[48:51], s24 offen  lds
  s_add_u32 m0, s28, 12288
  v_mfma_f32_16x16x32_bf16 v[152:155], v[180:183], a[20:23], v[152:155]
  s_add_u32 s24, s4, 258048
  v_mfma_f32_16x16x32_bf16 v[152:155], v[184:187], a[36:39], v[152:155]
  buffer_load_dwordx4 v5, s[48:51], s24 offen  lds
  v_mfma_f32_16x16x32_bf16 v[160:163], v[184:187], a[40:43], 0
  ds_read_b64_tr_b16 v[200:201], v22 offset:12288
  s_add_u32 m0, s28, 16384
  v_mfma_f32_16x16x32_bf16 v[160:163], v[180:183], a[24:27], v[160:163]
  ds_read_b64_tr_b16 v[202:203], v22 offset:12800
  v_mfma_f32_16x16x32_bf16 v[160:163], v[176:179], a[8:11], v[160:163]
  s_add_u32 s24, s5, 221184
  v_mfma_f32_16x16x32_bf16 v[168:171], v[176:179], a[12:15], 0
  ds_read_b64_tr_b16 v[204:205], v22 offset:16384
  v_mfma_f32_16x16x32_bf16 v[168:171], v[180:183], a[28:31], v[168:171]
  buffer_load_dwordx4 v5, s[48:51], s24 offen  lds
  v_mfma_f32_16x16x32_bf16 v[168:171], v[184:187], a[44:47], v[168:171]
  ds_read_b64_tr_b16 v[206:207], v22 offset:16896
  s_add_u32 m0, s28, 20480
  s_waitcnt lgkmcnt(4)
  v_mfma_f32_16x16x32_bf16 v[148:151], v[196:199], a[32:35], 0
  s_add_u32 s24, s5, 258048
  v_mfma_f32_16x16x32_bf16 v[148:151], v[192:195], a[16:19], v[148:151]
  ds_read_b64_tr_b16 v[176:177], v22 offset:20480
  v_mfma_f32_16x16x32_bf16 v[148:151], v[188:191], a[0:3], v[148:151]
  ds_read_b64_tr_b16 v[178:179], v22 offset:20992
  v_mfma_f32_16x16x32_bf16 v[156:159], v[188:191], a[4:7], 0
  buffer_load_dwordx4 v5, s[48:51], s24 offen  lds
  s_add_u32 m0, s28, 24576
  v_mfma_f32_16x16x32_bf16 v[156:159], v[192:195], a[20:23], v[156:159]
  ds_read_b64_tr_b16 v[180:181], v22 offset:12296
  s_add_u32 s4, s4, s38
  v_mfma_f32_16x16x32_bf16 v[156:159], v[196:199], a[36:39], v[156:159]
  v_mfma_f32_16x16x32_bf16 v[164:167], v[196:199], a[40:43], 0
  ds_read_b64_tr_b16 v[182:183], v22 offset:12808
  s_add_u32 s5, s5, s38
  v_mfma_f32_16x16x32_bf16 v[164:167], v[192:195], a[24:27], v[164:167]
  s_add_u32 s6, s6, s38
  v_mfma_f32_16x16x32_bf16 v[164:167], v[188:191], a[8:11], v[164:167]
  ds_read_b64_tr_b16 v[184:185], v22 offset:16392
  s_add_u32 s7, s7, s38
  v_mfma_f32_16x16x32_bf16 v[172:175], v[188:191], a[12:15], 0
  ds_read_b64_tr_b16 v[186:187], v22 offset:16904
  v_mfma_f32_16x16x32_bf16 v[172:175], v[192:195], a[28:31], v[172:175]
  s_add_u32 s24, s5, 0
  v_mfma_f32_16x16x32_bf16 v[172:175], v[196:199], a[44:47], v[172:175]
  ds_read_b64_tr_b16 v[188:189], v22 offset:20488
  s_waitcnt lgkmcnt(5)
  v_mfma_f32_16x16x32_bf16 v[144:147], v[176:179], a[80:83], v[144:147]
  buffer_load_dwordx4 v5, s[48:51], s24 offen  lds
  v_mfma_f32_16x16x32_bf16 v[144:147], v[204:207], a[64:67], v[144:147]
  ds_read_b64_tr_b16 v[190:191], v22 offset:21000
  v_mfma_f32_16x16x32_bf16 v[144:147], v[200:203], a[48:51], v[144:147]
  v_mfma_f32_16x16x32_bf16 v[152:155], v[200:203], a[52:55], v[152:155]
  v_mfma_f32_16x16x32_bf16 v[152:155], v[204:207], a[68:71], v[152:155]
  v_mfma_f32_16x16x32_bf16 v[152:155], v[176:179], a[84:87], v[152:155]
  v_mfma_f32_16x16x32_bf16 v[160:163], v[176:179], a[88:91], v[160:163]
  v_mfma_f32_16x16x32_bf16 v[160:163], v[204:207], a[72:75], v[160:163]
  s_waitcnt vmcnt(7)
  v_max3_u32 v24, v208, v209, v210
  v_max3_u32 v25, v211, v212, v213
  v_mfma_f32_16x16x32_bf16 v[160:163], v[200:203], a[56:59], v[160:163]
  v_max3_u32 v24, v24, v214, v215
  v_max3_u32 v25, v25, v216, v217
  v_mfma_f32_16x16x32_bf16 v[168:171], v[200:203], a[60:63], v[168:171]
  s_waitcnt lgkmcnt(0)
  s_barrier
  v_add_u32 v22, 24576, v22
  v_add_u32 v23, 131072, v23
  v_mfma_f32_16x16x32_bf16 v[168:171], v[204:207], a[76:79], v[168:171]
  ds_read_b64_tr_b16 v[192:193], v22 offset:0
  s_add_u32 m0, s28, 28672
  v_max3_u32 v24, v24, v218, v219
  v_max3_u32 v25, v25, v220, v221
  v_mfma_f32_16x16x32_bf16 v[168:171], v[176:179], a[92:95], v[168:171]
  ds_read_b64_tr_b16 v[194:195], v22 offset:512
  s_add_u32 s24, s5, 36864
  v_max3_u32 v24, v24, v222, v223
  v_mfma_f32_16x16x32_bf16 v[148:151], v[188:191], a[80:83], v[148:151]
  ds_read_b64_tr_b16 v[196:197], v22 offset:4096
  v_max3_u32 v25, v25, v224, v225
  v_mfma_f32_16x16x32_bf16 v[148:151], v[184:187], a[64:67], v[148:151]
  ds_read_b64_tr_b16 v[198:199], v22 offset:4608
  v_max3_u32 v24, v24, v226, v227
  v_mfma_f32_16x16x32_bf16 v[148:151], v[180:183], a[48:51], v[148:151]
  ds_read_b64_tr_b16 v[200:201], v22 offset:8
  v_max3_u32 v25, v25, v228, v229
  v_max3_u32 v24, v24, v230, v231
  v_mfma_f32_16x16x32_bf16 v[156:159], v[180:183], a[52:55], v[156:159]
  ds_read_b64_tr_b16 v[202:203], v22 offset:520
  v_max3_u32 v25, v25, v232, v233
  v_mfma_f32_16x16x32_bf16 v[156:159], v[184:187], a[68:71], v[156:159]
  ds_read_b64_tr_b16 v[204:205], v22 offset:4104
  v_max3_u32 v24, v24, v234, v235
  v_mfma_f32_16x16x32_bf16 v[156:159], v[188:191], a[84:87], v[156:159]
  buffer_load_dwordx4 v5, s[48:51], s24 offen  lds
  s_add_u32 m0, s28, 32768
  s_add_u32 s24, s7, 0
  v_mfma_f32_16x16x32_bf16 v[164:167], v[188:191], a[88:91], v[164:167]
  ds_read_b64_tr_b16 v[206:207], v22 offset:4616
  v_max3_u32 v25, v25, v236, v237
  v_max3_u32 v24, v24, v238, v239
  v_mfma_f32_16x16x32_bf16 v[164:167], v[184:187], a[72:75], v[164:167]
  ds_read_b64_tr_b16 v[176:177], v23 offset:8192
  v_max_u32 v24, v24, v25
  v_mfma_f32_16x16x32_bf16 v[164:167], v[180:183], a[56:59], v[164:167]
  ds_read_b64_tr_b16 v[178:179], v23 offset:8448
  v_cmp_eq_u32 vcc, -1, v24
  v_mfma_f32_16x16x32_bf16 v[172:175], v[180:183], a[60:63], v[172:175]
  buffer_load_dwordx4 v5, s[48:51], s24 offen  lds
  s_add_u32 m0, s28, 36864
  s_add_u32 s24, s5, 73728
  buffer_load_dwordx4 v5, s[48:51], s24 offen  lds
  v_mfma_f32_16x16x32_bf16 v[172:175], v[184:187], a[76:79], v[172:175]
  ds_read_b64_tr_b16 v[180:181], v23 offset:10240
  s_add_u32 m0, s28, 40960
  v_mfma_f32_16x16x32_bf16 v[172:175], v[188:191], a[92:95], v[172:175]
  ds_read_b64_tr_b16 v[182:183], v23 offset:10496
  s_add_u32 s24, s5, 110592
  s_cmp_eq_u64 vcc, 0
  s_cbranch_scc0 L_lp58s
L_ok57:
  s_waitcnt lgkmcnt(8)
  v_mfma_f32_16x16x32_bf16 v[80:83], v[196:199], v[224:227], v[80:83]
  ds_read_b64_tr_b16 v[184:185], v23 offset:8200
  buffer_load_dwordx4 v5, s[48:51], s24 offen  lds
  v_mfma_f32_16x16x32_bf16 v[80:83], v[192:195], v[208:211], v[80:83]
  v_mfma_f32_16x16x32_bf16 v[88:91], v[192:195], v[212:215], v[88:91]
  ds_read_b64_tr_b16 v[186:187], v23 offset:8456
  v_mfma_f32_16x16x32_bf16 v[88:91], v[196:199], v[228:231], v[88:91]
  ds_read_b64_tr_b16 v[188:189], v23 offset:10248
  v_mfma_f32_16x16x32_bf16 v[96:99], v[196:199], v[232:235], v[96:99]
  ds_read_b64_tr_b16 v[190:191], v23 offset:10504
  v_mfma_f32_16x16x32_bf16 v[96:99], v[192:195], v[216:219], v[96:99]
  v_mfma_f32_16x16x32_bf16 v[104:107], v[192:195], v[220:223], v[104:107]
  v_mfma_f32_16x16x32_bf16 v[104:107], v[196:199], v[236:239], v[104:107]
  s_waitcnt lgkmcnt(8)
  v_mfma_f32_16x16x32_bf16 v[84:87], v[204:207], v[224:227], v[84:87]
  v_mfma_f32_16x16x32_bf16 v[84:87], v[200:203], v[208:211], v[84:87]
  s_waitcnt lgkmcnt(0)
  s_barrier
  v_add_u32 v22, 4294918144, v22
  ds_read_b64_tr_b16 v[192:193], v22 offset:0
  v_mfma_f32_16x16x32_bf16 v[92:95], v[200:203], v[212:215], v[92:95]
  ds_read_b64_tr_b16 v[194:195], v22 offset:512
  s_add_u32 m0, s28, 45056
  v_mfma_f32_16x16x32_bf16 v[92:95], v[204:207], v[228:231], v[92:95]
  s_add_u32 s24, s4, 0
  v_mfma_f32_16x16x32_bf16 v[100:103], v[204:207], v[232:235], v[100:103]
  ds_read_b64_tr_b16 v[196:197], v22 offset:4096
  v_mfma_f32_16x16x32_bf16 v[100:103], v[200:203], v[216:219], v[100:103]
  ds_read_b64_tr_b16 v[198:199], v22 offset:4608
  v_mfma_f32_16x16x32_bf16 v[108:111], v[200:203], v[220:223], v[108:111]
  ds_read_b64_tr_b16 v[200:201], v22 offset:8192
  v_mfma_f32_16x16x32_bf16 v[108:111], v[204:207], v[236:239], v[108:111]
  ds_read_b64_tr_b16 v[202:203], v22 offset:8704
  v_mfma_f32_16x16x32_bf16 v[112:115], v[180:183], v[224:227], v[112:115]
  buffer_load_dwordx4 v5, s[48:51], s24 offen  lds
  s_add_u32 m0, s28, 49152
  s_add_u32 s24, s4, 36864
  v_mfma_f32_16x16x32_bf16 v[112:115], v[176:179], v[208:211], v[112:115]
  v_mfma_f32_16x16x32_bf16 v[120:123], v[176:179], v[212:215], v[120:123]
  buffer_load_dwordx4 v5, s[48:51], s24 offen  lds
  v_mfma_f32_16x16x32_bf16 v[120:123], v[180:183], v[228:231], v[120:123]
  ds_read_b64_tr_b16 v[204:205], v22 offset:8
  s_add_u32 m0, s28, 53248
  v_mfma_f32_16x16x32_bf16 v[116:119], v[188:191], v[224:227], v[116:119]
  v_mfma_f32_16x16x32_bf16 v[116:119], v[184:187], v[208:211], v[116:119]
  ds_read_b64_tr_b16 v[206:207], v22 offset:520
  s_add_u32 s24, s6, 0
  v_mfma_f32_16x16x32_bf16 v[124:127], v[184:187], v[212:215], v[124:127]
  buffer_load_dwordx4 v5, s[48:51], s24 offen  lds
  v_mfma_f32_16x16x32_bf16 v[124:127], v[188:191], v[228:231], v[124:127]
  ds_read_b64_tr_b16 v[176:177], v22 offset:4104
  s_waitcnt lgkmcnt(3)
  v_mfma_f32_16x16x32_bf16 v[144:147], v[200:203], a[128:131], v[144:147]
  ds_read_b64_tr_b16 v[178:179], v22 offset:4616
  s_add_u32 m0, s28, 57344
  v_mfma_f32_16x16x32_bf16 v[144:147], v[196:199], a[112:115], v[144:147]
  ds_read_b64_tr_b16 v[180:181], v22 offset:8200
  v_mfma_f32_16x16x32_bf16 v[144:147], v[192:195], a[96:99], v[144:147]
  ds_read_b64_tr_b16 v[182:183], v22 offset:8712
  s_add_u32 s24, s4, 73728
  v_mfma_f32_16x16x32_bf16 v[152:155], v[192:195], a[100:103], v[152:155]
  buffer_load_dwordx4 v5, s[48:51], s24 offen  lds
  v_mfma_f32_16x16x32_bf16 v[152:155], v[196:199], a[116:119], v[152:155]
  v_mfma_f32_16x16x32_bf16 v[152:155], v[200:203], a[132:135], v[152:155]
  s_add_u32 m0, s28, 61440
  v_mfma_f32_16x16x32_bf16 v[160:163], v[200:203], a[136:139], v[160:163]
  ds_read_b64_tr_b16 v[184:185], v22 offset:12288
  s_add_u32 s24, s4, 110592
  v_mfma_f32_16x16x32_bf16 v[160:163], v[196:199], a[120:123], v[160:163]
  ds_read_b64_tr_b16 v[186:187], v22 offset:12800
  v_mfma_f32_16x16x32_bf16 v[160:163], v[192:195], a[104:107], v[160:163]
  buffer_load_dwordx4 v5, s[48:51], s24 offen  lds
  s_xor_b32 s31, s17, 1
  s_add_u32 s31, s31, 2
  v_mfma_f32_16x16x32_bf16 v[168:171], v[192:195], a[108:111], v[168:171]
  ds_read_b64_tr_b16 v[188:189], v22 offset:16384
  s_and_b32 s31, s31, 7
  s_lshl_b32 s31, s31, 16
  v_mfma_f32_16x16x32_bf16 v[168:171], v[196:199], a[124:127], v[168:171]
  s_add_u32 m0, s28, 65536
  s_add_u32 s31, s31, s42
  v_cvt_pk_bf16_f32 v24, v80, v81
  v_cvt_pk_bf16_f32 v25, v82, v83
  v_mfma_f32_16x16x32_bf16 v[168:171], v[200:203], a[140:143], v[168:171]
  ds_read_b64_tr_b16 v[190:191], v22 offset:16896
  s_add_u32 s24, s4, 147456
  v_cvt_pk_bf16_f32 v26, v84, v85
  s_waitcnt lgkmcnt(4)
  v_mfma_f32_16x16x32_bf16 v[148:151], v[180:183], a[128:131], v[148:151]
  v_cvt_pk_bf16_f32 v27, v86, v87
  v_mfma_f32_16x16x32_bf16 v[148:151], v[176:179], a[112:115], v[148:151]
  ds_read_b64_tr_b16 v[192:193], v22 offset:20480
  v_mfma_f32_16x16x32_bf16 v[148:151], v[204:207], a[96:99], v[148:151]
  ds_read_b64_tr_b16 v[194:195], v22 offset:20992
  v_mfma_f32_16x16x32_bf16 v[156:159], v[204:207], a[100:103], v[156:159]
  buffer_load_dwordx4 v5, s[48:51], s24 offen  lds
  s_add_u32 m0, s28, 69632
  v_mfma_f32_16x16x32_bf16 v[156:159], v[176:179], a[116:119], v[156:159]
  ds_read_b64_tr_b16 v[196:197], v22 offset:12296
  s_add_u32 s24, s4, 184320
  buffer_store_dwordx4 v[24:27], v1, s[12:15], s31 offen offset:0 sc1
  v_mfma_f32_16x16x32_bf16 v[156:159], v[180:183], a[132:135], v[156:159]
  v_cvt_pk_bf16_f32 v28, v88, v89
  v_cvt_pk_bf16_f32 v29, v90, v91
  v_mfma_f32_16x16x32_bf16 v[164:167], v[180:183], a[136:139], v[164:167]
  ds_read_b64_tr_b16 v[198:199], v22 offset:12808
  v_cvt_pk_bf16_f32 v30, v92, v93
  v_mfma_f32_16x16x32_bf16 v[164:167], v[176:179], a[120:123], v[164:167]
  buffer_load_dwordx4 v5, s[48:51], s24 offen  lds
  s_add_u32 m0, s28, 106496
  v_mfma_f32_16x16x32_bf16 v[164:167], v[204:207], a[104:107], v[164:167]
  ds_read_b64_tr_b16 v[200:201], v22 offset:16392
  v_cvt_pk_bf16_f32 v31, v94, v95
  v_mfma_f32_16x16x32_bf16 v[172:175], v[204:207], a[108:111], v[172:175]
  ds_read_b64_tr_b16 v[202:203], v22 offset:16904
  s_add_u32 s24, s5, 147456
  v_mfma_f32_16x16x32_bf16 v[172:175], v[176:179], a[124:127], v[172:175]
  buffer_load_dwordx4 v5, s[48:51], s24 offen  lds
  v_mfma_f32_16x16x32_bf16 v[172:175], v[180:183], a[140:143], v[172:175]
  ds_read_b64_tr_b16 v[204:205], v22 offset:20488
  buffer_store_dwordx4 v[28:31], v1, s[12:15], s31 offen offset:1024 sc1
  s_mov_b32 s31, s17
  s_add_u32 s31, s31, 2
  s_waitcnt lgkmcnt(5)
  v_mfma_f32_16x16x32_bf16 v[144:147], v[192:195], a[176:179], v[144:147]
  s_and_b32 s31, s31, 7
  s_lshl_b32 s31, s31, 16
  v_mfma_f32_16x16x32_bf16 v[144:147], v[188:191], a[160:163], v[144:147]
  ds_read_b64_tr_b16 v[206:207], v22 offset:21000
  s_add_u32 s31, s31, s42
  v_cvt_pk_bf16_f32 v32, v96, v97
  v_mfma_f32_16x16x32_bf16 v[144:147], v[184:187], a[144:147], v[144:147]
  v_cvt_pk_bf16_f32 v33, v98, v99
  v_cvt_pk_bf16_f32 v34, v100, v101
  v_mfma_f32_16x16x32_bf16 v[152:155], v[184:187], a[148:151], v[152:155]
  v_cvt_pk_bf16_f32 v35, v102, v103
  v_mfma_f32_16x16x32_bf16 v[152:155], v[188:191], a[164:167], v[152:155]
  buffer_store_dwordx4 v[32:35], v1, s[12:15], s31 offen offset:0 sc1
  v_mfma_f32_16x16x32_bf16 v[152:155], v[192:195], a[180:183], v[152:155]
  v_cvt_pk_bf16_f32 v36, v104, v105
  v_cvt_pk_bf16_f32 v37, v106, v107
  v_mfma_f32_16x16x32_bf16 v[160:163], v[192:195], a[184:187], v[160:163]
  v_cvt_pk_bf16_f32 v38, v108, v109
  v_cvt_pk_bf16_f32 v39, v110, v111
  v_mfma_f32_16x16x32_bf16 v[160:163], v[188:191], a[168:171], v[160:163]
  buffer_store_dwordx4 v[36:39], v1, s[12:15], s31 offen offset:1024 sc1
  s_mov_b32 s31, s20
  v_cvt_pk_bf16_f32 v24, v112, v113
  v_mfma_f32_16x16x32_bf16 v[160:163], v[184:187], a[152:155], v[160:163]
  v_cvt_pk_bf16_f32 v25, v114, v115
  v_cvt_pk_bf16_f32 v26, v116, v117
  v_mfma_f32_16x16x32_bf16 v[168:171], v[184:187], a[156:159], v[168:171]
  s_waitcnt vmcnt(17) lgkmcnt(0)
  s_barrier
  v_add_u32 v22, 4294885376, v22
  ds_read_b64_tr_b16 v[176:177], v22 offset:0
  v_mfma_f32_16x16x32_bf16 v[168:171], v[188:191], a[172:175], v[168:171]
  ds_read_b64_tr_b16 v[178:179], v22 offset:512
  s_add_u32 m0, s28, 110592
  v_cvt_pk_bf16_f32 v27, v118, v119
  v_mfma_f32_16x16x32_bf16 v[168:171], v[192:195], a[188:191], v[168:171]
  s_add_u32 s24, s5, 184320
  buffer_store_dwordx4 v[24:27], v1, s[12:15], s31 offen offset:0 sc1
  v_mfma_f32_16x16x32_bf16 v[148:151], v[204:207], a[176:179], v[148:151]
  ds_read_b64_tr_b16 v[180:181], v22 offset:4096
  v_cvt_pk_bf16_f32 v28, v120, v121
  v_mfma_f32_16x16x32_bf16 v[148:151], v[200:203], a[160:163], v[148:151]
  ds_read_b64_tr_b16 v[182:183], v22 offset:4608
  v_cvt_pk_bf16_f32 v29, v122, v123
  v_mfma_f32_16x16x32_bf16 v[148:151], v[196:199], a[144:147], v[148:151]
  ds_read_b64_tr_b16 v[184:185], v22 offset:8192
  v_cvt_pk_bf16_f32 v30, v124, v125
  v_mfma_f32_16x16x32_bf16 v[156:159], v[196:199], a[148:151], v[156:159]
  ds_read_b64_tr_b16 v[186:187], v22 offset:8704
  v_cvt_pk_bf16_f32 v31, v126, v127
  v_mfma_f32_16x16x32_bf16 v[156:159], v[200:203], a[164:167], v[156:159]
  buffer_load_dwordx4 v5, s[48:51], s24 offen  lds
  s_add_u32 m0, s28, 114688
  s_add_u32 s24, s4, 221184
  v_mfma_f32_16x16x32_bf16 v[156:159], v[204:207], a[180:183], v[156:159]
  buffer_load_dwordx4 v5, s[48:51], s24 offen  lds
  v_mfma_f32_16x16x32_bf16 v[164:167], v[204:207], a[184:187], v[164:167]
  s_add_u32 m0, s28, 118784
  buffer_store_dwordx4 v[28:31], v1, s[12:15], s31 offen offset:1024 sc1
  v_mfma_f32_16x16x32_bf16 v[164:167], v[200:203], a[168:171], v[164:167]
  ds_read_b64_tr_b16 v[188:189], v22 offset:8
  s_add_u32 s24, s4, 258048
  v_mfma_f32_16x16x32_bf16 v[164:167], v[196:199], a[152:155], v[164:167]
  buffer_load_dwordx4 v5, s[48:51], s24 offen  lds
  v_mfma_f32_16x16x32_bf16 v[172:175], v[196:199], a[156:159], v[172:175]
  ds_read_b64_tr_b16 v[190:191], v22 offset:520
  v_mfma_f32_16x16x32_bf16 v[172:175], v[200:203], a[172:175], v[172:175]
  s_add_u32 m0, s28, 122880
  v_mfma_f32_16x16x32_bf16 v[172:175], v[204:207], a[188:191], v[172:175]
  ds_read_b64_tr_b16 v[192:193], v22 offset:4104
  s_add_u32 s24, s5, 221184
  s_waitcnt lgkmcnt(3)
  v_mfma_f32_16x16x32_bf16 v[144:147], v[184:187], a[224:227], v[144:147]
  ds_read_b64_tr_b16 v[194:195], v22 offset:4616
  v_mfma_f32_16x16x32_bf16 v[144:147], v[180:183], a[208:211], v[144:147]
  ds_read_b64_tr_b16 v[196:197], v22 offset:8200
  v_mfma_f32_16x16x32_bf16 v[144:147], v[176:179], a[192:195], v[144:147]
  ds_read_b64_tr_b16 v[198:199], v22 offset:8712
  v_mfma_f32_16x16x32_bf16 v[152:155], v[176:179], a[196:199], v[152:155]
  buffer_load_dwordx4 v5, s[48:51], s24 offen  lds
  s_add_u32 m0, s28, 126976
  s_add_u32 s24, s5, 258048
  v_mfma_f32_16x16x32_bf16 v[152:155], v[180:183], a[212:215], v[152:155]
  v_mfma_f32_16x16x32_bf16 v[152:155], v[184:187], a[228:231], v[152:155]
  buffer_load_dwordx4 v5, s[48:51], s24 offen  lds
  v_mfma_f32_16x16x32_bf16 v[160:163], v[184:187], a[232:235], v[160:163]
  ds_read_b64_tr_b16 v[200:201], v22 offset:12288
  s_add_u32 m0, s28, 131072
  v_mfma_f32_16x16x32_bf16 v[160:163], v[180:183], a[216:219], v[160:163]
  ds_read_b64_tr_b16 v[202:203], v22 offset:12800
  s_add_u32 s4, s4, s39
  v_mfma_f32_16x16x32_bf16 v[160:163], v[176:179], a[200:203], v[160:163]
  v_mfma_f32_16x16x32_bf16 v[168:171], v[176:179], a[204:207], v[168:171]
  ds_read_b64_tr_b16 v[204:205], v22 offset:16384
  s_add_u32 s5, s5, s39
  v_mfma_f32_16x16x32_bf16 v[168:171], v[180:183], a[220:223], v[168:171]
  s_add_u32 s6, s6, s39
  v_mfma_f32_16x16x32_bf16 v[168:171], v[184:187], a[236:239], v[168:171]
  ds_read_b64_tr_b16 v[206:207], v22 offset:16896
  s_waitcnt lgkmcnt(4)
  v_mfma_f32_16x16x32_bf16 v[148:151], v[196:199], a[224:227], v[148:151]
  s_add_u32 s7, s7, s39
  v_mfma_f32_16x16x32_bf16 v[148:151], v[192:195], a[208:211], v[148:151]
  ds_read_b64_tr_b16 v[176:177], v22 offset:20480
  s_add_u32 s24, s5, 0
  v_mfma_f32_16x16x32_bf16 v[148:151], v[188:191], a[192:195], v[148:151]
  ds_read_b64_tr_b16 v[178:179], v22 offset:20992
  v_mfma_f32_16x16x32_bf16 v[156:159], v[188:191], a[196:199], v[156:159]
  buffer_load_dwordx4 v5, s[48:51], s24 offen  lds
  v_mfma_f32_16x16x32_bf16 v[156:159], v[192:195], a[212:215], v[156:159]
  ds_read_b64_tr_b16 v[180:181], v22 offset:12296
  s_add_u32 m0, s28, 135168
  v_mfma_f32_16x16x32_bf16 v[156:159], v[196:199], a[228:231], v[156:159]
  s_add_u32 s24, s5, 36864
  v_mfma_f32_16x16x32_bf16 v[164:167], v[196:199], a[232:235], v[164:167]
  ds_read_b64_tr_b16 v[182:183], v22 offset:12808
  v_mfma_f32_16x16x32_bf16 v[164:167], v[192:195], a[216:219], v[164:167]
  buffer_load_dwordx4 v5, s[48:51], s24 offen  lds
  v_mfma_f32_16x16x32_bf16 v[164:167], v[188:191], a[200:203], v[164:167]
  ds_read_b64_tr_b16 v[184:185], v22 offset:16392
  s_add_u32 m0, s28, 139264
  v_mfma_f32_16x16x32_bf16 v[172:175], v[188:191], a[204:207], v[172:175]
  ds_read_b64_tr_b16 v[186:187], v22 offset:16904
  s_add_u32 s24, s7, 0
  v_mfma_f32_16x16x32_bf16 v[172:175], v[192:195], a[220:223], v[172:175]
  v_mfma_f32_16x16x32_bf16 v[172:175], v[196:199], a[236:239], v[172:175]
  ds_read_b64_tr_b16 v[188:189], v22 offset:20488
  buffer_load_dwordx4 v5, s[48:51], s24 offen  lds
  s_waitcnt lgkmcnt(5)
  v_mfma_f32_16x16x32_bf16 v[144:147], v[176:179], v[224:227], v[144:147]
  v_mfma_f32_16x16x32_bf16 v[144:147], v[204:207], v[208:211], v[144:147]
  ds_read_b64_tr_b16 v[190:191], v22 offset:21000
  v_mfma_f32_16x16x32_bf16 v[144:147], v[200:203], a[240:243], v[144:147]
  v_mfma_f32_16x16x32_bf16 v[152:155], v[200:203], a[244:247], v[152:155]
  v_mfma_f32_16x16x32_bf16 v[152:155], v[204:207], v[212:215], v[152:155]
  v_mfma_f32_16x16x32_bf16 v[152:155], v[176:179], v[228:231], v[152:155]
  v_mfma_f32_16x16x32_bf16 v[160:163], v[176:179], v[232:235], v[160:163]
  v_mfma_f32_16x16x32_bf16 v[160:163], v[204:207], v[216:219], v[160:163]
  v_mfma_f32_16x16x32_bf16 v[160:163], v[200:203], a[248:251], v[160:163]
  v_mfma_f32_16x16x32_bf16 v[168:171], v[200:203], a[252:255], v[168:171]
  s_waitcnt vmcnt(21) lgkmcnt(0)
  s_barrier
  v_add_u32 v22, 24576, v22
  ds_read_b64_tr_b16 v[192:193], v22 offset:0
  v_mfma_f32_16x16x32_bf16 v[168:171], v[204:207], v[220:223], v[168:171]
  ds_read_b64_tr_b16 v[194:195], v22 offset:512
  s_add_u32 m0, s28, 143360
  v_mfma_f32_16x16x32_bf16 v[168:171], v[176:179], v[236:239], v[168:171]
  s_add_u32 s24, s5, 73728
  v_mfma_f32_16x16x32_bf16 v[148:151], v[188:191], v[224:227], v[148:151]
  ds_read_b64_tr_b16 v[196:197], v22 offset:4096
  v_mfma_f32_16x16x32_bf16 v[148:151], v[184:187], v[208:211], v[148:151]
  ds_read_b64_tr_b16 v[198:199], v22 offset:4608
  v_mfma_f32_16x16x32_bf16 v[148:151], v[180:183], a[240:243], v[148:151]
  ds_read_b64_tr_b16 v[200:201], v22 offset:8192
  v_mfma_f32_16x16x32_bf16 v[156:159], v[180:183], a[244:247], v[156:159]
  ds_read_b64_tr_b16 v[202:203], v22 offset:8704
  v_mfma_f32_16x16x32_bf16 v[156:159], v[184:187], v[212:215], v[156:159]
  buffer_load_dwordx4 v5, s[48:51], s24 offen  lds
  s_add_u32 m0, s28, 147456
  s_add_u32 s24, s5, 110592
  v_mfma_f32_16x16x32_bf16 v[156:159], v[188:191], v[228:231], v[156:159]
  v_mfma_f32_16x16x32_bf16 v[164:167], v[188:191], v[232:235], v[164:167]
  buffer_load_dwordx4 v5, s[48:51], s24 offen  lds
  v_mfma_f32_16x16x32_bf16 v[164:167], v[184:187], v[216:219], v[164:167]
  ds_read_b64_tr_b16 v[204:205], v22 offset:8
  s_add_u32 m0, s28, 151552
  v_mfma_f32_16x16x32_bf16 v[164:167], v[180:183], a[248:251], v[164:167]
  v_mfma_f32_16x16x32_bf16 v[172:175], v[180:183], a[252:255], v[172:175]
  ds_read_b64_tr_b16 v[206:207], v22 offset:520
  s_add_u32 s24, s4, 0
  v_mfma_f32_16x16x32_bf16 v[172:175], v[184:187], v[220:223], v[172:175]
  buffer_load_dwordx4 v5, s[48:51], s24 offen  lds
  v_mfma_f32_16x16x32_bf16 v[172:175], v[188:191], v[236:239], v[172:175]
  ds_read_b64_tr_b16 v[176:177], v22 offset:4104
  s_waitcnt lgkmcnt(3)
  v_mfma_f32_16x16x32_bf16 v[48:51], v[200:203], a[32:35], 0
  ds_read_b64_tr_b16 v[178:179], v22 offset:4616
  s_add_u32 m0, s28, 81920
  v_mfma_f32_16x16x32_bf16 v[48:51], v[196:199], a[16:19], v[48:51]
  ds_read_b64_tr_b16 v[180:181], v22 offset:8200
  v_mfma_f32_16x16x32_bf16 v[48:51], v[192:195], a[0:3], v[48:51]
  ds_read_b64_tr_b16 v[182:183], v22 offset:8712
  s_add_u32 s24, s4, 36864
  v_mfma_f32_16x16x32_bf16 v[56:59], v[192:195], a[4:7], 0
  buffer_load_dwordx4 v5, s[48:51], s24 offen  lds
  v_mfma_f32_16x16x32_bf16 v[56:59], v[196:199], a[20:23], v[56:59]
  v_mfma_f32_16x16x32_bf16 v[56:59], v[200:203], a[36:39], v[56:59]
  s_add_u32 m0, s28, 86016
  v_mfma_f32_16x16x32_bf16 v[64:67], v[200:203], a[40:43], 0
  ds_read_b64_tr_b16 v[184:185], v22 offset:12288
  s_add_u32 s24, s6, 0
  v_mfma_f32_16x16x32_bf16 v[64:67], v[196:199], a[24:27], v[64:67]
  ds_read_b64_tr_b16 v[186:187], v22 offset:12800
  v_mfma_f32_16x16x32_bf16 v[64:67], v[192:195], a[8:11], v[64:67]
  buffer_load_dwordx4 v5, s[48:51], s24 offen  lds
  v_mfma_f32_16x16x32_bf16 v[72:75], v[192:195], a[12:15], 0
  ds_read_b64_tr_b16 v[188:189], v22 offset:16384
  s_xor_b32 s31, s17, 1
  s_add_u32 s31, s31, 4
  v_mfma_f32_16x16x32_bf16 v[72:75], v[196:199], a[28:31], v[72:75]
  s_add_u32 m0, s28, 90112
  s_and_b32 s31, s31, 7
  v_mfma_f32_16x16x32_bf16 v[72:75], v[200:203], a[44:47], v[72:75]
  ds_read_b64_tr_b16 v[190:191], v22 offset:16896
  s_add_u32 s24, s4, 73728
  s_lshl_b32 s31, s31, 16
  s_waitcnt lgkmcnt(4)
  v_mfma_f32_16x16x32_bf16 v[52:55], v[180:183], a[32:35], 0
  s_add_u32 s31, s31, s42
  v_cvt_pk_bf16_f32 v32, v144, v145
  v_cvt_pk_bf16_f32 v33, v146, v147
  v_mfma_f32_16x16x32_bf16 v[52:55], v[176:179], a[16:19], v[52:55]
  ds_read_b64_tr_b16 v[192:193], v22 offset:20480
  v_cvt_pk_bf16_f32 v34, v148, v149
  v_mfma_f32_16x16x32_bf16 v[52:55], v[204:207], a[0:3], v[52:55]
  ds_read_b64_tr_b16 v[194:195], v22 offset:20992
  v_cvt_pk_bf16_f32 v35, v150, v151
  v_mfma_f32_16x16x32_bf16 v[60:63], v[204:207], a[4:7], 0
  buffer_load_dwordx4 v5, s[48:51], s24 offen  lds
  s_add_u32 m0, s28, 94208
  v_mfma_f32_16x16x32_bf16 v[60:63], v[176:179], a[20:23], v[60:63]
  ds_read_b64_tr_b16 v[196:197], v22 offset:12296
  s_add_u32 s24, s4, 110592
  v_mfma_f32_16x16x32_bf16 v[60:63], v[180:183], a[36:39], v[60:63]
  buffer_store_dwordx4 v[32:35], v1, s[12:15], s31 offen offset:0 sc1
  v_mfma_f32_16x16x32_bf16 v[68:71], v[180:183], a[40:43], 0
  ds_read_b64_tr_b16 v[198:199], v22 offset:12808
  v_cvt_pk_bf16_f32 v36, v152, v153
  v_mfma_f32_16x16x32_bf16 v[68:71], v[176:179], a[24:27], v[68:71]
  buffer_load_dwordx4 v5, s[48:51], s24 offen  lds
  s_add_u32 m0, s28, 98304
  v_mfma_f32_16x16x32_bf16 v[68:71], v[204:207], a[8:11], v[68:71]
  ds_read_b64_tr_b16 v[200:201], v22 offset:16392
  v_cvt_pk_bf16_f32 v37, v154, v155
  v_mfma_f32_16x16x32_bf16 v[76:79], v[204:207], a[12:15], 0
  ds_read_b64_tr_b16 v[202:203], v22 offset:16904
  s_add_u32 s24, s4, 147456
  v_cvt_pk_bf16_f32 v38, v156, v157
  v_mfma_f32_16x16x32_bf16 v[76:79], v[176:179], a[28:31], v[76:79]
  buffer_load_dwordx4 v5, s[48:51], s24 offen  lds
  v_mfma_f32_16x16x32_bf16 v[76:79], v[180:183], a[44:47], v[76:79]
  ds_read_b64_tr_b16 v[204:205], v22 offset:20488
  v_cvt_pk_bf16_f32 v39, v158, v159
  s_waitcnt lgkmcnt(5)
  v_mfma_f32_16x16x32_bf16 v[48:51], v[192:195], a[80:83], v[48:51]
  buffer_store_dwordx4 v[36:39], v1, s[12:15], s31 offen offset:1024 sc1
  s_mov_b32 s31, s17
  s_add_u32 s31, s31, 4
  v_mfma_f32_16x16x32_bf16 v[48:51], v[188:191], a[64:67], v[48:51]
  ds_read_b64_tr_b16 v[206:207], v22 offset:21000
  s_and_b32 s31, s31, 7
  s_lshl_b32 s31, s31, 16
  v_mfma_f32_16x16x32_bf16 v[48:51], v[184:187], a[48:51], v[48:51]
  s_add_u32 s31, s31, s42
  v_cvt_pk_bf16_f32 v24, v160, v161
  v_cvt_pk_bf16_f32 v25, v162, v163
  v_mfma_f32_16x16x32_bf16 v[56:59], v[184:187], a[52:55], v[56:59]
  v_cvt_pk_bf16_f32 v26, v164, v165
  v_cvt_pk_bf16_f32 v27, v166, v167
  v_mfma_f32_16x16x32_bf16 v[56:59], v[188:191], a[68:71], v[56:59]
  buffer_store_dwordx4 v[24:27], v1, s[12:15], s31 offen offset:0 sc1
  v_mfma_f32_16x16x32_bf16 v[56:59], v[192:195], a[84:87], v[56:59]
  v_cvt_pk_bf16_f32 v28, v168, v169
  v_cvt_pk_bf16_f32 v29, v170, v171
  v_mfma_f32_16x16x32_bf16 v[64:67], v[192:195], a[88:91], v[64:67]
  v_cvt_pk_bf16_f32 v30, v172, v173
  v_cvt_pk_bf16_f32 v31, v174, v175
  v_mfma_f32_16x16x32_bf16 v[64:67], v[188:191], a[72:75], v[64:67]
  buffer_store_dwordx4 v[28:31], v1, s[12:15], s31 offen offset:1024 sc1
  v_mfma_f32_16x16x32_bf16 v[64:67], v[184:187], a[56:59], v[64:67]
  v_mfma_f32_16x16x32_bf16 v[72:75], v[184:187], a[60:63], v[72:75]
  s_waitcnt vmcnt(26) lgkmcnt(0)
  s_barrier
  v_add_u32 v22, 24576, v22
  ds_read_b64_tr_b16 v[176:177], v22 offset:0
  v_mfma_f32_16x16x32_bf16 v[72:75], v[188:191], a[76:79], v[72:75]
  ds_read_b64_tr_b16 v[178:179], v22 offset:512
  s_add_u32 m0, s28, 102400
  v_mfma_f32_16x16x32_bf16 v[72:75], v[192:195], a[92:95], v[72:75]
  s_add_u32 s24, s4, 184320
  v_mfma_f32_16x16x32_bf16 v[52:55], v[204:207], a[80:83], v[52:55]
  ds_read_b64_tr_b16 v[180:181], v22 offset:4096
  v_mfma_f32_16x16x32_bf16 v[52:55], v[200:203], a[64:67], v[52:55]
  ds_read_b64_tr_b16 v[182:183], v22 offset:4608
  v_mfma_f32_16x16x32_bf16 v[52:55], v[196:199], a[48:51], v[52:55]
  ds_read_b64_tr_b16 v[184:185], v22 offset:8192
  v_mfma_f32_16x16x32_bf16 v[60:63], v[196:199], a[52:55], v[60:63]
  ds_read_b64_tr_b16 v[186:187], v22 offset:8704
  v_mfma_f32_16x16x32_bf16 v[60:63], v[200:203], a[68:71], v[60:63]
  buffer_load_dwordx4 v5, s[48:51], s24 offen  lds
L_pad9:
  s_cbranch_execz L_pad10
  s_add_u32 m0, s28, 0
  v_mfma_f32_16x16x32_bf16 v[60:63], v[204:207], a[84:87], v[60:63]
  s_add_u32 s24, s5, 147456
  v_mfma_f32_16x16x32_bf16 v[68:71], v[204:207], a[88:91], v[68:71]
  v_mfma_f32_16x16x32_bf16 v[68:71], v[200:203], a[72:75], v[68:71]
  ds_read_b64_tr_b16 v[188:189], v22 offset:8
  v_mfma_f32_16x16x32_bf16 v[68:71], v[196:199], a[56:59], v[68:71]
  buffer_load_dwordx4 v5, s[48:51], s24 offen  lds
  s_add_u32 m0, s28, 4096
  v_mfma_f32_16x16x32_bf16 v[76:79], v[196:199], a[60:63], v[76:79]
  ds_read_b64_tr_b16 v[190:191], v22 offset:520
  v_mfma_f32_16x16x32_bf16 v[76:79], v[200:203], a[76:79], v[76:79]
  s_add_u32 s24, s5, 184320
  v_mfma_f32_16x16x32_bf16 v[76:79], v[204:207], a[92:95], v[76:79]
  ds_read_b64_tr_b16 v[192:193], v22 offset:4104
  s_waitcnt lgkmcnt(3)
  v_mfma_f32_16x16x32_bf16 v[48:51], v[184:187], a[128:131], v[48:51]
  ds_read_b64_tr_b16 v[194:195], v22 offset:4616
  v_mfma_f32_16x16x32_bf16 v[48:51], v[180:183], a[112:115], v[48:51]
  ds_read_b64_tr_b16 v[196:197], v22 offset:8200
  v_mfma_f32_16x16x32_bf16 v[48:51], v[176:179], a[96:99], v[48:51]
  ds_read_b64_tr_b16 v[198:199], v22 offset:8712
  v_mfma_f32_16x16x32_bf16 v[56:59], v[176:179], a[100:103], v[56:59]
  buffer_load_dwordx4 v5, s[48:51], s24 offen  lds
  s_add_u32 m0, s28, 8192
  v_mfma_f32_16x16x32_bf16 v[56:59], v[180:183], a[116:119], v[56:59]
  s_add_u32 s24, s4, 221184
  s_waitcnt vmcnt(27)
  s_xor_b32 s23, s17, 1
  s_add_u32 s23, s23, 2
  s_and_b32 s23, s23, 7
  s_lshl_b32 s23, s23, 11
  s_add_u32 s23, s23, s44
  s_mov_b64 exec, 1
  buffer_store_dwordx2 v[252:253], off, s[12:15], s23 sc1
  s_mov_b64 exec, -1
  v_mfma_f32_16x16x32_bf16 v[56:59], v[184:187], a[132:135], v[56:59]
  s_waitcnt vmcnt(26)
  s_mov_b32 s23, s17
  s_add_u32 s23, s23, 2
  s_and_b32 s23, s23, 7
  s_lshl_b32 s23, s23, 11
  s_add_u32 s23, s23, s44
  s_mov_b64 exec, 1
  buffer_store_dwordx2 v[252:253], off, s[12:15], s23 sc1
  s_mov_b64 exec, -1
  v_mfma_f32_16x16x32_bf16 v[64:67], v[184:187], a[136:139], v[64:67]
  ds_read_b64_tr_b16 v[200:201], v22 offset:12288
  v_mfma_f32_16x16x32_bf16 v[64:67], v[180:183], a[120:123], v[64:67]
  ds_read_b64_tr_b16 v[202:203], v22 offset:12800
  v_mfma_f32_16x16x32_bf16 v[64:67], v[176:179], a[104:107], v[64:67]
  buffer_load_dwordx4 v5, s[48:51], s24 offen  lds
  s_add_u32 m0, s28, 12288
  v_mfma_f32_16x16x32_bf16 v[72:75], v[176:179], a[108:111], v[72:75]
  ds_read_b64_tr_b16 v[204:205], v22 offset:16384
  s_add_u32 s24, s4, 258048
  v_mfma_f32_16x16x32_bf16 v[72:75], v[180:183], a[124:127], v[72:75]
  s_waitcnt vmcnt(24)
  s_mov_b32 s23, s21
  s_mov_b64 exec, 1
  buffer_store_dwordx2 v[252:253], off, s[12:15], s23 sc1
  s_mov_b64 exec, -1
  v_mfma_f32_16x16x32_bf16 v[72:75], v[184:187], a[140:143], v[72:75]
  ds_read_b64_tr_b16 v[206:207], v22 offset:16896
  s_waitcnt lgkmcnt(4)
  v_mfma_f32_16x16x32_bf16 v[52:55], v[196:199], a[128:131], v[52:55]
  buffer_load_dwordx4 v5, s[48:51], s24 offen  lds
  v_mfma_f32_16x16x32_bf16 v[52:55], v[192:195], a[112:115], v[52:55]
  ds_read_b64_tr_b16 v[176:177], v22 offset:20480
  s_add_u32 m0, s28, 16384
  s_lshl_b32 s23, s18, 1
  v_mfma_f32_16x16x32_bf16 v[52:55], v[188:191], a[96:99], v[52:55]
  ds_read_b64_tr_b16 v[178:179], v22 offset:20992
  s_add_u32 s23, s23, s54
  s_mul_i32 s30, s23, 73728
  v_mfma_f32_16x16x32_bf16 v[60:63], v[188:191], a[100:103], v[60:63]
  s_add_u32 s24, s5, 221184
  s_add_u32 s30, s30, 4718592
  v_mfma_f32_16x16x32_bf16 v[60:63], v[192:195], a[116:119], v[60:63]
  ds_read_b64_tr_b16 v[180:181], v22 offset:12296
  s_lshl_b32 s22, s23, 8
  s_add_u32 s22, s22, 9437184
  v_mfma_f32_16x16x32_bf16 v[60:63], v[196:199], a[132:135], v[60:63]
  buffer_load_dwordx4 v5, s[48:51], s24 offen  lds
  s_mul_i32 s10, s23, 2304
  s_xor_b32 s27, s27, 1
  v_mfma_f32_16x16x32_bf16 v[68:71], v[196:199], a[136:139], v[68:71]
  ds_read_b64_tr_b16 v[182:183], v22 offset:12808
  s_add_u32 m0, s28, 20480
  s_lshl_b32 s23, s55, 6
  v_mfma_f32_16x16x32_bf16 v[68:71], v[192:195], a[120:123], v[68:71]
  s_add_u32 s52, s23, s29
  v_and_b32 v16, 15, v9
  v_lshrrev_b32 v17, 4, v9
  v_mfma_f32_16x16x32_bf16 v[68:71], v[188:191], a[104:107], v[68:71]
  ds_read_b64_tr_b16 v[184:185], v22 offset:16392
  s_add_u32 s24, s5, 258048
  v_lshlrev_b32 v18, 10, v17
  v_mfma_f32_16x16x32_bf16 v[76:79], v[188:191], a[108:111], v[76:79]
  ds_read_b64_tr_b16 v[186:187], v22 offset:16904
  v_lshl_add_u32 v18, v16, 4, v18
  v_mfma_f32_16x16x32_bf16 v[76:79], v[192:195], a[124:127], v[76:79]
  buffer_load_dwordx4 v5, s[48:51], s24 offen  lds
  v_mfma_f32_16x16x32_bf16 v[76:79], v[196:199], a[140:143], v[76:79]
  ds_read_b64_tr_b16 v[188:189], v22 offset:20488
  v_lshlrev_b32 v8, 2, v16
  s_lshl_b32 s23, s52, 6
  s_add_u32 s23, s23, s30
  s_waitcnt lgkmcnt(5)
  v_mfma_f32_16x16x32_bf16 v[48:51], v[176:179], a[176:179], v[48:51]
  s_lshl_b32 s25, s27, 9
  s_add_u32 s23, s23, s25
  buffer_load_dwordx4 v[40:43], v18, s[12:15], s23 offen offset:0 sc1
  v_mfma_f32_16x16x32_bf16 v[48:51], v[204:207], a[160:163], v[48:51]
  ds_read_b64_tr_b16 v[190:191], v22 offset:21000
  v_mfma_f32_16x16x32_bf16 v[48:51], v[200:203], a[144:147], v[48:51]
  buffer_load_dwordx4 v[44:47], v18, s[12:15], s23 offen offset:256 sc1
  s_lshl_b32 s25, s27, 7
  s_add_u32 s23, s22, s25
  v_mfma_f32_16x16x32_bf16 v[56:59], v[200:203], a[148:151], v[56:59]
  buffer_load_dword v10, v8, s[12:15], s23 offen offset:0 sc1
  v_mfma_f32_16x16x32_bf16 v[56:59], v[204:207], a[164:167], v[56:59]
  buffer_load_dword v11, v8, s[12:15], s23 offen offset:64 sc1
  v_mfma_f32_16x16x32_bf16 v[56:59], v[176:179], a[180:183], v[56:59]
  v_and_b32 v19, 3, v9
  v_bfe_u32 v20, v9, 2, 2
  v_mfma_f32_16x16x32_bf16 v[64:67], v[176:179], a[184:187], v[64:67]
  v_lshlrev_b32 v8, 2, v19
  s_lshl_b32 s25, s55, 7
  s_add_u32 s23, s22, s25
  v_mfma_f32_16x16x32_bf16 v[64:67], v[204:207], a[168:171], v[64:67]
  s_lshl_b32 s25, s17, 4
  s_add_u32 s23, s23, s25
  buffer_load_dword v12, v8, s[12:15], s23 offen sc1
  v_mfma_f32_16x16x32_bf16 v[64:67], v[200:203], a[152:155], v[64:67]
  v_lshlrev_b32 v18, 10, v20
  v_lshl_add_u32 v18, v19, 4, v18
  v_mfma_f32_16x16x32_bf16 v[72:75], v[200:203], a[156:159], v[72:75]
  s_waitcnt vmcnt(30) lgkmcnt(0)
  s_barrier
  v_add_u32 v22, 57344, v22
  ds_read_b64_tr_b16 v[192:193], v22 offset:0
  v_mfma_f32_16x16x32_bf16 v[72:75], v[204:207], a[172:175], v[72:75]
  ds_read_b64_tr_b16 v[194:195], v22 offset:512
  v_lshl_add_u32 v18, v17, 2, v18
  s_lshl_b32 s23, s9, 6
  s_add_u32 s23, s23, s30
  v_mfma_f32_16x16x32_bf16 v[72:75], v[176:179], a[188:191], v[72:75]
  s_lshl_b32 s25, s55, 9
  s_add_u32 s23, s23, s25
  v_mfma_f32_16x16x32_bf16 v[52:55], v[188:191], a[176:179], v[52:55]
  ds_read_b64_tr_b16 v[196:197], v22 offset:4096
  s_lshl_b32 s25, s17, 6
  s_add_u32 s23, s23, s25
  v_mfma_f32_16x16x32_bf16 v[52:55], v[184:187], a[160:163], v[52:55]
  ds_read_b64_tr_b16 v[198:199], v22 offset:4608
  v_mfma_f32_16x16x32_bf16 v[52:55], v[180:183], a[144:147], v[52:55]
  ds_read_b64_tr_b16 v[200:201], v22 offset:8192
  v_mfma_f32_16x16x32_bf16 v[60:63], v[180:183], a[148:151], v[60:63]
  ds_read_b64_tr_b16 v[202:203], v22 offset:8704
  v_mfma_f32_16x16x32_bf16 v[60:63], v[184:187], a[164:167], v[60:63]
  buffer_load_dword v13, v18, s[12:15], s23 offen sc1
  v_mfma_f32_16x16x32_bf16 v[60:63], v[188:191], a[180:183], v[60:63]
  v_lshlrev_b32 v246, 13, v17
  v_lshl_add_u32 v246, v20, 8, v246
  v_mfma_f32_16x16x32_bf16 v[68:71], v[188:191], a[184:187], v[68:71]
  v_lshl_add_u32 v246, v19, 4, v246
  s_lshr_b32 s25, s17, 2
  s_lshl_b32 s25, s25, 10
  v_mfma_f32_16x16x32_bf16 v[68:71], v[184:187], a[168:171], v[68:71]
  ds_read_b64_tr_b16 v[204:205], v22 offset:8
  s_and_b32 s23, s17, 3
  s_lshl_b32 s23, s23, 6
  v_mfma_f32_16x16x32_bf16 v[68:71], v[180:183], a[152:155], v[68:71]
  s_add_u32 s25, s25, s23
  s_add_u32 s11, s40, s25
  v_mfma_f32_16x16x32_bf16 v[76:79], v[180:183], a[156:159], v[76:79]
  ds_read_b64_tr_b16 v[206:207], v22 offset:520
  s_add_u32 s11, s11, 524288
  s_mov_b32 s23, 73728
  v_mfma_f32_16x16x32_bf16 v[76:79], v[184:187], a[172:175], v[76:79]
  v_mul_lo_u32 v2, v16, s23
  v_mfma_f32_16x16x32_bf16 v[76:79], v[188:191], a[188:191], v[76:79]
  ds_read_b64_tr_b16 v[176:177], v22 offset:4104
  v_lshl_add_u32 v2, v17, 4, v2
  s_waitcnt lgkmcnt(3)
  v_mfma_f32_16x16x32_bf16 v[48:51], v[200:203], a[224:227], v[48:51]
  ds_read_b64_tr_b16 v[178:179], v22 offset:4616
  v_mfma_f32_16x16x32_bf16 v[48:51], v[196:199], a[208:211], v[48:51]
  ds_read_b64_tr_b16 v[180:181], v22 offset:8200
  v_mfma_f32_16x16x32_bf16 v[48:51], v[192:195], a[192:195], v[48:51]
  ds_read_b64_tr_b16 v[182:183], v22 offset:8712
  v_mfma_f32_16x16x32_bf16 v[56:59], v[192:195], a[196:199], v[56:59]
  v_mul_lo_u32 v3, v19, s23
  v_mfma_f32_16x16x32_bf16 v[56:59], v[196:199], a[212:215], v[56:59]
  v_lshl_add_u32 v3, v20, 4, v3
  v_lshl_add_u32 v3, v17, 2, v3
  s_mul_i32 s23, s27, 1152
  s_add_u32 s52, s52, s23
  v_mfma_f32_16x16x32_bf16 v[56:59], v[200:203], a[228:231], v[56:59]
  s_add_u32 s52, s52, s10
  s_mul_i32 s23, s55, 1152
  v_mfma_f32_16x16x32_bf16 v[64:67], v[200:203], a[232:235], v[64:67]
  ds_read_b64_tr_b16 v[184:185], v22 offset:12288
  s_add_u32 s53, s23, s10
  s_add_u32 s53, s53, s9
  v_mfma_f32_16x16x32_bf16 v[64:67], v[196:199], a[216:219], v[64:67]
  ds_read_b64_tr_b16 v[186:187], v22 offset:12800
  s_mul_i32 s23, s17, 294912
  s_add_u32 s53, s53, s23
  v_mfma_f32_16x16x32_bf16 v[64:67], v[192:195], a[200:203], v[64:67]
  s_add_u32 s30, s41, 16384
  s_lshl_b32 s23, s17, 16
  v_mfma_f32_16x16x32_bf16 v[72:75], v[192:195], a[204:207], v[72:75]
  ds_read_b64_tr_b16 v[188:189], v22 offset:16384
  s_add_u32 s40, s40, s23
  s_lshl_b32 s23, s17, 11
  v_mfma_f32_16x16x32_bf16 v[72:75], v[196:199], a[220:223], v[72:75]
  s_add_u32 s41, s41, s23
  s_and_b32 s23, s17, 6
  v_mfma_f32_16x16x32_bf16 v[72:75], v[200:203], a[236:239], v[72:75]
  ds_read_b64_tr_b16 v[190:191], v22 offset:16896
  s_lshl_b32 s25, 0x0303, s23
  s_lshr_b32 s96, s25, 2
  s_waitcnt lgkmcnt(4)
  v_mfma_f32_16x16x32_bf16 v[52:55], v[180:183], a[224:227], v[52:55]
  s_and_b32 s96, s96, 0xff
  s_mov_b32 s97, 0
  v_mfma_f32_16x16x32_bf16 v[52:55], v[176:179], a[208:211], v[52:55]
  ds_read_b64_tr_b16 v[192:193], v22 offset:20480
  s_lshr_b32 s98, s25, 4
  s_and_b32 s98, s98, 0xff
  v_mfma_f32_16x16x32_bf16 v[52:55], v[204:207], a[192:195], v[52:55]
  ds_read_b64_tr_b16 v[194:195], v22 offset:20992
  s_or_b32 s96, s96, s98
  s_lshr_b32 s98, s25, 6
  v_mfma_f32_16x16x32_bf16 v[60:63], v[204:207], a[196:199], v[60:63]
  s_and_b32 s98, s98, 0xff
  s_mov_b32 s99, 0
  v_mfma_f32_16x16x32_bf16 v[60:63], v[176:179], a[212:215], v[60:63]
  ds_read_b64_tr_b16 v[196:197], v22 offset:12296
  s_mov_b32 s100, 0x3f80
  s_mov_b32 s101, 0x3f800000
  v_mfma_f32_16x16x32_bf16 v[60:63], v[180:183], a[228:231], v[60:63]
  s_mov_b64 s[46:47], 0xff
  v_mfma_f32_16x16x32_bf16 v[68:71], v[180:183], a[232:235], v[68:71]
  ds_read_b64_tr_b16 v[198:199], v22 offset:12808
  v_mfma_f32_16x16x32_bf16 v[68:71], v[176:179], a[216:219], v[68:71]
  v_mfma_f32_16x16x32_bf16 v[68:71], v[204:207], a[200:203], v[68:71]
  ds_read_b64_tr_b16 v[200:201], v22 offset:16392
  v_mfma_f32_16x16x32_bf16 v[76:79], v[204:207], a[204:207], v[76:79]
  ds_read_b64_tr_b16 v[202:203], v22 offset:16904
  v_mfma_f32_16x16x32_bf16 v[76:79], v[176:179], a[220:223], v[76:79]
  v_mfma_f32_16x16x32_bf16 v[76:79], v[180:183], a[236:239], v[76:79]
  ds_read_b64_tr_b16 v[204:205], v22 offset:20488
  s_waitcnt lgkmcnt(5)
  v_mfma_f32_16x16x32_bf16 v[48:51], v[192:195], v[224:227], v[48:51]
  v_mfma_f32_16x16x32_bf16 v[48:51], v[188:191], v[208:211], v[48:51]
  ds_read_b64_tr_b16 v[206:207], v22 offset:21000
  v_mfma_f32_16x16x32_bf16 v[48:51], v[184:187], a[240:243], v[48:51]
  v_mfma_f32_16x16x32_bf16 v[56:59], v[184:187], a[244:247], v[56:59]
  v_mfma_f32_16x16x32_bf16 v[56:59], v[188:191], v[212:215], v[56:59]
  v_mfma_f32_16x16x32_bf16 v[56:59], v[192:195], v[228:231], v[56:59]
  v_mfma_f32_16x16x32_bf16 v[64:67], v[192:195], v[232:235], v[64:67]
  v_mfma_f32_16x16x32_bf16 v[64:67], v[188:191], v[216:219], v[64:67]
  v_mfma_f32_16x16x32_bf16 v[64:67], v[184:187], a[248:251], v[64:67]
  v_mfma_f32_16x16x32_bf16 v[72:75], v[184:187], a[252:255], v[72:75]
  s_waitcnt vmcnt(25) lgkmcnt(0)
  s_barrier
  v_add_u32 v22, 24576, v22
  ds_read_b64_tr_b16 v[176:177], v22 offset:0
  v_mfma_f32_16x16x32_bf16 v[72:75], v[188:191], v[220:223], v[72:75]
  ds_read_b64_tr_b16 v[178:179], v22 offset:512
  v_mfma_f32_16x16x32_bf16 v[72:75], v[192:195], v[236:239], v[72:75]
  ds_read_b64_tr_b16 v[180:181], v22 offset:4096
  v_mfma_f32_16x16x32_bf16 v[52:55], v[204:207], v[224:227], v[52:55]
  ds_read_b64_tr_b16 v[182:183], v22 offset:4608
  s_waitcnt vmcnt(18)
  s_xor_b32 s23, s17, 1
  s_add_u32 s23, s23, 4
  s_and_b32 s23, s23, 7
  s_lshl_b32 s23, s23, 11
  s_add_u32 s23, s23, s44
  s_mov_b64 exec, 1
  buffer_store_dwordx2 v[252:253], off, s[12:15], s23 sc1
  s_mov_b64 exec, -1
  v_mfma_f32_16x16x32_bf16 v[52:55], v[200:203], v[208:211], v[52:55]
  ds_read_b64_tr_b16 v[184:185], v22 offset:8192
  v_mfma_f32_16x16x32_bf16 v[52:55], v[196:199], a[240:243], v[52:55]
  ds_read_b64_tr_b16 v[186:187], v22 offset:8704
  v_mfma_f32_16x16x32_bf16 v[60:63], v[196:199], a[244:247], v[60:63]
  ds_read_b64_tr_b16 v[188:189], v22 offset:8
  v_mfma_f32_16x16x32_bf16 v[60:63], v[200:203], v[212:215], v[60:63]
  ds_read_b64_tr_b16 v[190:191], v22 offset:520
  v_mfma_f32_16x16x32_bf16 v[60:63], v[204:207], v[228:231], v[60:63]
  ds_read_b64_tr_b16 v[192:193], v22 offset:4104
  v_mfma_f32_16x16x32_bf16 v[68:71], v[204:207], v[232:235], v[68:71]
  ds_read_b64_tr_b16 v[194:195], v22 offset:4616
  v_mfma_f32_16x16x32_bf16 v[68:71], v[200:203], v[216:219], v[68:71]
  s_waitcnt vmcnt(17)
  s_mov_b32 s23, s17
  s_add_u32 s23, s23, 4
  s_and_b32 s23, s23, 7
  s_lshl_b32 s23, s23, 11
  s_add_u32 s23, s23, s44
  s_mov_b64 exec, 1
  buffer_store_dwordx2 v[252:253], off, s[12:15], s23 sc1
  s_mov_b64 exec, -1
  v_mfma_f32_16x16x32_bf16 v[68:71], v[196:199], a[248:251], v[68:71]
  v_mfma_f32_16x16x32_bf16 v[76:79], v[196:199], a[252:255], v[76:79]
  ds_read_b64_tr_b16 v[196:197], v22 offset:8200
  v_mfma_f32_16x16x32_bf16 v[76:79], v[200:203], v[220:223], v[76:79]
  ds_read_b64_tr_b16 v[198:199], v22 offset:8712
  v_mfma_f32_16x16x32_bf16 v[76:79], v[204:207], v[236:239], v[76:79]
  ds_read_b64_tr_b16 v[200:201], v22 offset:12288
  s_waitcnt lgkmcnt(7)
  v_mfma_f32_16x16x32_bf16 v[80:83], v[184:187], a[32:35], 0
  ds_read_b64_tr_b16 v[202:203], v22 offset:12800
  v_mfma_f32_16x16x32_bf16 v[80:83], v[180:183], a[16:19], v[80:83]
  ds_read_b64_tr_b16 v[204:205], v22 offset:16384
  v_mfma_f32_16x16x32_bf16 v[80:83], v[176:179], a[0:3], v[80:83]
  ds_read_b64_tr_b16 v[206:207], v22 offset:16896
  v_mfma_f32_16x16x32_bf16 v[88:91], v[176:179], a[4:7], 0
  ds_read_b64_tr_b16 v[176:177], v22 offset:20480
  v_mfma_f32_16x16x32_bf16 v[88:91], v[180:183], a[20:23], v[88:91]
  ds_read_b64_tr_b16 v[178:179], v22 offset:20992
  v_mfma_f32_16x16x32_bf16 v[88:91], v[184:187], a[36:39], v[88:91]
  ds_read_b64_tr_b16 v[180:181], v22 offset:12296
  s_waitcnt lgkmcnt(7)
  v_mfma_f32_16x16x32_bf16 v[84:87], v[196:199], a[32:35], 0
  ds_read_b64_tr_b16 v[182:183], v22 offset:12808
  v_mfma_f32_16x16x32_bf16 v[84:87], v[192:195], a[16:19], v[84:87]
  ds_read_b64_tr_b16 v[184:185], v22 offset:16392
  v_mfma_f32_16x16x32_bf16 v[84:87], v[188:191], a[0:3], v[84:87]
  ds_read_b64_tr_b16 v[186:187], v22 offset:16904
  v_mfma_f32_16x16x32_bf16 v[92:95], v[188:191], a[4:7], 0
  ds_read_b64_tr_b16 v[188:189], v22 offset:20488
  v_mfma_f32_16x16x32_bf16 v[92:95], v[192:195], a[20:23], v[92:95]
  ds_read_b64_tr_b16 v[190:191], v22 offset:21000
  v_mfma_f32_16x16x32_bf16 v[92:95], v[196:199], a[36:39], v[92:95]
  s_xor_b32 s31, s17, 1
  s_add_u32 s31, s31, 6
  s_waitcnt lgkmcnt(6)
  v_mfma_f32_16x16x32_bf16 v[80:83], v[176:179], a[80:83], v[80:83]
  s_and_b32 s31, s31, 7
  s_lshl_b32 s31, s31, 16
  v_mfma_f32_16x16x32_bf16 v[80:83], v[204:207], a[64:67], v[80:83]
  s_add_u32 s31, s31, s42
  v_cvt_pk_bf16_f32 v32, v48, v49
  v_cvt_pk_bf16_f32 v33, v50, v51
  v_cvt_pk_bf16_f32 v34, v52, v53
  v_mfma_f32_16x16x32_bf16 v[80:83], v[200:203], a[48:51], v[80:83]
  v_cvt_pk_bf16_f32 v35, v54, v55
  v_mfma_f32_16x16x32_bf16 v[88:91], v[200:203], a[52:55], v[88:91]
  s_waitcnt vmcnt(17) lgkmcnt(0)
  s_barrier
  v_add_u32 v22, 4294918144, v22
  ds_read_b64_tr_b16 v[192:193], v22 offset:0
  v_mfma_f32_16x16x32_bf16 v[88:91], v[204:207], a[68:71], v[88:91]
  ds_read_b64_tr_b16 v[194:195], v22 offset:512
  ds_read_b64_tr_b16 v[196:197], v22 offset:4096
  v_mfma_f32_16x16x32_bf16 v[88:91], v[176:179], a[84:87], v[88:91]
  ds_read_b64_tr_b16 v[198:199], v22 offset:4608
  ds_read_b64_tr_b16 v[200:201], v22 offset:8192
  v_mfma_f32_16x16x32_bf16 v[84:87], v[188:191], a[80:83], v[84:87]
  ds_read_b64_tr_b16 v[202:203], v22 offset:8704
  buffer_store_dwordx4 v[32:35], v1, s[12:15], s31 offen offset:0 sc1
  v_mfma_f32_16x16x32_bf16 v[84:87], v[184:187], a[64:67], v[84:87]
  ds_read_b64_tr_b16 v[204:205], v22 offset:8
  v_cvt_pk_bf16_f32 v36, v56, v57
  v_cvt_pk_bf16_f32 v37, v58, v59
  v_mfma_f32_16x16x32_bf16 v[84:87], v[180:183], a[48:51], v[84:87]
  ds_read_b64_tr_b16 v[206:207], v22 offset:520
  v_cvt_pk_bf16_f32 v38, v60, v61
  v_mfma_f32_16x16x32_bf16 v[92:95], v[180:183], a[52:55], v[92:95]
  ds_read_b64_tr_b16 v[176:177], v22 offset:4104
  v_cvt_pk_bf16_f32 v39, v62, v63
  v_mfma_f32_16x16x32_bf16 v[92:95], v[184:187], a[68:71], v[92:95]
  ds_read_b64_tr_b16 v[178:179], v22 offset:4616
  ds_read_b64_tr_b16 v[180:181], v22 offset:8200
  v_mfma_f32_16x16x32_bf16 v[92:95], v[188:191], a[84:87], v[92:95]
  ds_read_b64_tr_b16 v[182:183], v22 offset:8712
  buffer_store_dwordx4 v[36:39], v1, s[12:15], s31 offen offset:1024 sc1
  s_mov_b32 s31, s17
  s_add_u32 s31, s31, 6
  s_waitcnt lgkmcnt(6)
  v_mfma_f32_16x16x32_bf16 v[80:83], v[200:203], a[128:131], v[80:83]
  ds_read_b64_tr_b16 v[184:185], v22 offset:12288
  s_and_b32 s31, s31, 7
  s_lshl_b32 s31, s31, 16
  v_mfma_f32_16x16x32_bf16 v[80:83], v[196:199], a[112:115], v[80:83]
  ds_read_b64_tr_b16 v[186:187], v22 offset:12800
  s_add_u32 s31, s31, s42
  v_cvt_pk_bf16_f32 v24, v64, v65
  v_cvt_pk_bf16_f32 v25, v66, v67
  v_mfma_f32_16x16x32_bf16 v[80:83], v[192:195], a[96:99], v[80:83]
  ds_read_b64_tr_b16 v[188:189], v22 offset:16384
  v_cvt_pk_bf16_f32 v26, v68, v69
  v_cvt_pk_bf16_f32 v27, v70, v71
  v_mfma_f32_16x16x32_bf16 v[88:91], v[192:195], a[100:103], v[88:91]
  ds_read_b64_tr_b16 v[190:191], v22 offset:16896
  v_mfma_f32_16x16x32_bf16 v[88:91], v[196:199], a[116:119], v[88:91]
  ds_read_b64_tr_b16 v[192:193], v22 offset:20480
  ds_read_b64_tr_b16 v[194:195], v22 offset:20992
  v_mfma_f32_16x16x32_bf16 v[88:91], v[200:203], a[132:135], v[88:91]
  ds_read_b64_tr_b16 v[196:197], v22 offset:12296
  buffer_store_dwordx4 v[24:27], v1, s[12:15], s31 offen offset:0 sc1
  s_waitcnt lgkmcnt(7)
  v_mfma_f32_16x16x32_bf16 v[84:87], v[180:183], a[128:131], v[84:87]
  ds_read_b64_tr_b16 v[198:199], v22 offset:12808
  v_cvt_pk_bf16_f32 v28, v72, v73
  v_mfma_f32_16x16x32_bf16 v[84:87], v[176:179], a[112:115], v[84:87]
  ds_read_b64_tr_b16 v[200:201], v22 offset:16392
  v_cvt_pk_bf16_f32 v29, v74, v75
  v_mfma_f32_16x16x32_bf16 v[84:87], v[204:207], a[96:99], v[84:87]
  ds_read_b64_tr_b16 v[202:203], v22 offset:16904
  v_cvt_pk_bf16_f32 v30, v76, v77
  v_cvt_pk_bf16_f32 v31, v78, v79
  v_mfma_f32_16x16x32_bf16 v[92:95], v[204:207], a[100:103], v[92:95]
  ds_read_b64_tr_b16 v[204:205], v22 offset:20488
  v_mfma_f32_16x16x32_bf16 v[92:95], v[176:179], a[116:119], v[92:95]
  ds_read_b64_tr_b16 v[206:207], v22 offset:21000
  buffer_store_dwordx4 v[28:31], v1, s[12:15], s31 offen offset:1024 sc1
  v_mfma_f32_16x16x32_bf16 v[92:95], v[180:183], a[132:135], v[92:95]
  s_waitcnt lgkmcnt(6)
  v_mfma_f32_16x16x32_bf16 v[80:83], v[192:195], a[176:179], v[80:83]
  s_waitcnt vmcnt(6)
  v_lshlrev_b32 v243, 16, v40
  v_and_b32 v4, 0xffff0000, v40
  v_mfma_f32_16x16x32_bf16 v[80:83], v[188:191], a[160:163], v[80:83]
  v_add_f32 v128, v243, v10
  v_add_f32 v129, v4, v10
  v_mfma_f32_16x16x32_bf16 v[80:83], v[184:187], a[144:147], v[80:83]
  v_lshlrev_b32 v243, 16, v41
  v_and_b32 v4, 0xffff0000, v41
  v_mfma_f32_16x16x32_bf16 v[88:91], v[184:187], a[148:151], v[88:91]
  s_waitcnt lgkmcnt(0)
  s_barrier
  v_add_u32 v22, 4294885376, v22
  ds_read_b64_tr_b16 v[176:177], v22 offset:0
  v_mfma_f32_16x16x32_bf16 v[88:91], v[188:191], a[164:167], v[88:91]
  ds_read_b64_tr_b16 v[178:179], v22 offset:512
  ds_read_b64_tr_b16 v[180:181], v22 offset:4096
  v_mfma_f32_16x16x32_bf16 v[88:91], v[192:195], a[180:183], v[88:91]
  ds_read_b64_tr_b16 v[182:183], v22 offset:4608
  ds_read_b64_tr_b16 v[184:185], v22 offset:8192
  v_mfma_f32_16x16x32_bf16 v[84:87], v[204:207], a[176:179], v[84:87]
  ds_read_b64_tr_b16 v[186:187], v22 offset:8704
  v_add_f32 v130, v243, v10
  v_mfma_f32_16x16x32_bf16 v[84:87], v[200:203], a[160:163], v[84:87]
  ds_read_b64_tr_b16 v[188:189], v22 offset:8
  v_add_f32 v131, v4, v10
  v_lshlrev_b32 v243, 16, v42
  v_mfma_f32_16x16x32_bf16 v[84:87], v[196:199], a[144:147], v[84:87]
  ds_read_b64_tr_b16 v[190:191], v22 offset:520
  v_and_b32 v4, 0xffff0000, v42
  v_mfma_f32_16x16x32_bf16 v[92:95], v[196:199], a[148:151], v[92:95]
  ds_read_b64_tr_b16 v[192:193], v22 offset:4104
  v_add_f32 v132, v243, v10
  v_mfma_f32_16x16x32_bf16 v[92:95], v[200:203], a[164:167], v[92:95]
  ds_read_b64_tr_b16 v[194:195], v22 offset:4616
  ds_read_b64_tr_b16 v[196:197], v22 offset:8200
  v_mfma_f32_16x16x32_bf16 v[92:95], v[204:207], a[180:183], v[92:95]
  ds_read_b64_tr_b16 v[198:199], v22 offset:8712
  v_add_f32 v133, v4, v10
  s_waitcnt lgkmcnt(6)
  v_mfma_f32_16x16x32_bf16 v[80:83], v[184:187], a[224:227], v[80:83]
  ds_read_b64_tr_b16 v[200:201], v22 offset:12288
  v_lshlrev_b32 v243, 16, v43
  v_mfma_f32_16x16x32_bf16 v[80:83], v[180:183], a[208:211], v[80:83]
  ds_read_b64_tr_b16 v[202:203], v22 offset:12800
  v_and_b32 v4, 0xffff0000, v43
  v_mfma_f32_16x16x32_bf16 v[80:83], v[176:179], a[192:195], v[80:83]
  ds_read_b64_tr_b16 v[204:205], v22 offset:16384
  v_add_f32 v134, v243, v10
  v_mfma_f32_16x16x32_bf16 v[88:91], v[176:179], a[196:199], v[88:91]
  ds_read_b64_tr_b16 v[206:207], v22 offset:16896
  v_add_f32 v135, v4, v10
  v_lshlrev_b32 v243, 16, v44
  v_mfma_f32_16x16x32_bf16 v[88:91], v[180:183], a[212:215], v[88:91]
  ds_read_b64_tr_b16 v[176:177], v22 offset:20480
  ds_read_b64_tr_b16 v[178:179], v22 offset:20992
  v_mfma_f32_16x16x32_bf16 v[88:91], v[184:187], a[228:231], v[88:91]
  ds_read_b64_tr_b16 v[180:181], v22 offset:12296
  v_and_b32 v4, 0xffff0000, v44
  s_waitcnt lgkmcnt(7)
  v_mfma_f32_16x16x32_bf16 v[84:87], v[196:199], a[224:227], v[84:87]
  ds_read_b64_tr_b16 v[182:183], v22 offset:12808
  v_add_f32 v136, v243, v11
  v_mfma_f32_16x16x32_bf16 v[84:87], v[192:195], a[208:211], v[84:87]
  ds_read_b64_tr_b16 v[184:185], v22 offset:16392
  v_add_f32 v137, v4, v11
  v_mfma_f32_16x16x32_bf16 v[84:87], v[188:191], a[192:195], v[84:87]
  ds_read_b64_tr_b16 v[186:187], v22 offset:16904
  v_lshlrev_b32 v243, 16, v45
  v_mfma_f32_16x16x32_bf16 v[92:95], v[188:191], a[196:199], v[92:95]
  ds_read_b64_tr_b16 v[188:189], v22 offset:20488
  v_and_b32 v4, 0xffff0000, v45
  v_mfma_f32_16x16x32_bf16 v[92:95], v[192:195], a[212:215], v[92:95]
  ds_read_b64_tr_b16 v[190:191], v22 offset:21000
  v_add_u32 v22, 131072, v22
  v_mfma_f32_16x16x32_bf16 v[92:95], v[196:199], a[228:231], v[92:95]
  ds_read_b64_tr_b16 v[192:193], v22 offset:0
  v_add_f32 v138, v243, v11
  v_add_f32 v139, v4, v11
  s_waitcnt lgkmcnt(7)
  v_mfma_f32_16x16x32_bf16 v[80:83], v[176:179], v[224:227], v[80:83]
  ds_read_b64_tr_b16 v[194:195], v22 offset:512
  v_lshlrev_b32 v243, 16, v46
  v_mfma_f32_16x16x32_bf16 v[80:83], v[204:207], v[208:211], v[80:83]
  ds_read_b64_tr_b16 v[196:197], v22 offset:4096
  v_and_b32 v4, 0xffff0000, v46
  v_mfma_f32_16x16x32_bf16 v[80:83], v[200:203], a[240:243], v[80:83]
  ds_read_b64_tr_b16 v[198:199], v22 offset:4608
  v_add_f32 v140, v243, v11
  v_mfma_f32_16x16x32_bf16 v[88:91], v[200:203], a[244:247], v[88:91]
  ds_read_b64_tr_b16 v[200:201], v22 offset:8192
  v_add_f32 v141, v4, v11
  v_mfma_f32_16x16x32_bf16 v[88:91], v[204:207], v[212:215], v[88:91]
  ds_read_b64_tr_b16 v[202:203], v22 offset:8704
  v_lshlrev_b32 v243, 16, v47
  v_mfma_f32_16x16x32_bf16 v[88:91], v[176:179], v[228:231], v[88:91]
  ds_read_b64_tr_b16 v[204:205], v22 offset:8
  v_and_b32 v4, 0xffff0000, v47
  s_waitcnt lgkmcnt(7)
  v_mfma_f32_16x16x32_bf16 v[84:87], v[188:191], v[224:227], v[84:87]
  ds_read_b64_tr_b16 v[206:207], v22 offset:520
  v_add_f32 v142, v243, v11
  v_mfma_f32_16x16x32_bf16 v[84:87], v[184:187], v[208:211], v[84:87]
  ds_read_b64_tr_b16 v[176:177], v22 offset:4104
  v_add_f32 v143, v4, v11
  v_lshlrev_b32 v243, 16, v13
  v_mfma_f32_16x16x32_bf16 v[84:87], v[180:183], a[240:243], v[84:87]
  ds_read_b64_tr_b16 v[178:179], v22 offset:4616
  v_and_b32 v4, 0xffff0000, v13
  v_mfma_f32_16x16x32_bf16 v[92:95], v[180:183], a[244:247], v[92:95]
  ds_read_b64_tr_b16 v[180:181], v22 offset:8200
  v_add_f32 v14, v243, v12
  v_mfma_f32_16x16x32_bf16 v[92:95], v[184:187], v[212:215], v[92:95]
  ds_read_b64_tr_b16 v[182:183], v22 offset:8712
  v_add_f32 v15, v4, v12
  v_mfma_f32_16x16x32_bf16 v[92:95], v[188:191], v[228:231], v[92:95]
  ds_read_b64_tr_b16 v[184:185], v22 offset:12288
  v_mov_b32 v120, 0
  s_mov_b64 exec, s[96:97]
  buffer_load_dwordx2 v[248:249], v250, s[12:15], s41 offen sc1
  s_mov_b64 exec, -1
  s_waitcnt lgkmcnt(7)
  v_mfma_f32_16x16x32_bf16 v[96:99], v[200:203], a[40:43], 0
  ds_read_b64_tr_b16 v[186:187], v22 offset:12800
  v_mov_b32 v121, 0
  v_mfma_f32_16x16x32_bf16 v[96:99], v[196:199], a[24:27], v[96:99]
  ds_read_b64_tr_b16 v[188:189], v22 offset:16384
  v_mov_b32 v122, 0
  s_mov_b64 exec, s[46:47]
  buffer_load_dwordx2 v[244:245], v250, s[12:15], s30 offen sc1
  s_mov_b64 exec, -1
  v_mfma_f32_16x16x32_bf16 v[96:99], v[192:195], a[8:11], v[96:99]
  ds_read_b64_tr_b16 v[190:191], v22 offset:16896
  v_mov_b32 v123, 0
  v_mfma_f32_16x16x32_bf16 v[104:107], v[192:195], a[12:15], 0
  ds_read_b64_tr_b16 v[192:193], v22 offset:20480
  v_mov_b32 v124, 0
  v_mov_b32 v125, 0
  v_mfma_f32_16x16x32_bf16 v[104:107], v[196:199], a[28:31], v[104:107]
  ds_read_b64_tr_b16 v[194:195], v22 offset:20992
  v_mov_b32 v126, 0
  v_mfma_f32_16x16x32_bf16 v[104:107], v[200:203], a[44:47], v[104:107]
  ds_read_b64_tr_b16 v[196:197], v22 offset:12296
  v_mov_b32 v127, 0
  s_waitcnt lgkmcnt(7)
  v_mfma_f32_16x16x32_bf16 v[100:103], v[180:183], a[40:43], 0
  ds_read_b64_tr_b16 v[198:199], v22 offset:12808
  v_mfma_f32_16x16x32_bf16 v[100:103], v[176:179], a[24:27], v[100:103]
  ds_read_b64_tr_b16 v[200:201], v22 offset:16392
  s_xor_b32 s31, s17, 1
  s_lshl_b32 s31, s31, 16
  v_mfma_f32_16x16x32_bf16 v[100:103], v[204:207], a[8:11], v[100:103]
  ds_read_b64_tr_b16 v[202:203], v22 offset:16904
  s_add_u32 s31, s31, s42
  v_cvt_pk_bf16_f32 v32, v80, v81
  v_cvt_pk_bf16_f32 v33, v82, v83
  v_mfma_f32_16x16x32_bf16 v[108:111], v[204:207], a[12:15], 0
  ds_read_b64_tr_b16 v[204:205], v22 offset:20488
  v_cvt_pk_bf16_f32 v34, v84, v85
  v_cvt_pk_bf16_f32 v35, v86, v87
  v_mfma_f32_16x16x32_bf16 v[108:111], v[176:179], a[28:31], v[108:111]
  ds_read_b64_tr_b16 v[206:207], v22 offset:21000
  v_add_u32 v22, 4294918144, v22
  v_mfma_f32_16x16x32_bf16 v[108:111], v[180:183], a[44:47], v[108:111]
  ds_read_b64_tr_b16 v[176:177], v22 offset:0
  buffer_store_dwordx4 v[32:35], v1, s[12:15], s31 offen offset:0 sc1
  s_waitcnt lgkmcnt(7)
  v_mfma_f32_16x16x32_bf16 v[96:99], v[192:195], a[88:91], v[96:99]
  ds_read_b64_tr_b16 v[178:179], v22 offset:512
  v_cvt_pk_bf16_f32 v36, v88, v89
  v_cvt_pk_bf16_f32 v37, v90, v91
L_pad10:
  s_cbranch_execz L_pad11
  v_mfma_f32_16x16x32_bf16 v[96:99], v[188:191], a[72:75], v[96:99]
  ds_read_b64_tr_b16 v[180:181], v22 offset:4096
  v_cvt_pk_bf16_f32 v38, v92, v93
  v_cvt_pk_bf16_f32 v39, v94, v95
  v_mfma_f32_16x16x32_bf16 v[96:99], v[184:187], a[56:59], v[96:99]
  ds_read_b64_tr_b16 v[182:183], v22 offset:4608
  buffer_store_dwordx4 v[36:39], v1, s[12:15], s31 offen offset:1024 sc1
  v_mfma_f32_16x16x32_bf16 v[104:107], v[184:187], a[60:63], v[104:107]
  ds_read_b64_tr_b16 v[184:185], v22 offset:8192
  v_mfma_f32_16x16x32_bf16 v[104:107], v[188:191], a[76:79], v[104:107]
  ds_read_b64_tr_b16 v[186:187], v22 offset:8704
  v_mfma_f32_16x16x32_bf16 v[104:107], v[192:195], a[92:95], v[104:107]
  ds_read_b64_tr_b16 v[188:189], v22 offset:8
  s_waitcnt lgkmcnt(7)
  v_mfma_f32_16x16x32_bf16 v[100:103], v[204:207], a[88:91], v[100:103]
  ds_read_b64_tr_b16 v[190:191], v22 offset:520
  v_mfma_f32_16x16x32_bf16 v[100:103], v[200:203], a[72:75], v[100:103]
  ds_read_b64_tr_b16 v[192:193], v22 offset:4104
  v_mfma_f32_16x16x32_bf16 v[100:103], v[196:199], a[56:59], v[100:103]
  ds_read_b64_tr_b16 v[194:195], v22 offset:4616
  v_mfma_f32_16x16x32_bf16 v[108:111], v[196:199], a[60:63], v[108:111]
  ds_read_b64_tr_b16 v[196:197], v22 offset:8200
  v_mfma_f32_16x16x32_bf16 v[108:111], v[200:203], a[76:79], v[108:111]
  ds_read_b64_tr_b16 v[198:199], v22 offset:8712
  v_mfma_f32_16x16x32_bf16 v[108:111], v[204:207], a[92:95], v[108:111]
  ds_read_b64_tr_b16 v[200:201], v22 offset:12288
  s_waitcnt lgkmcnt(7)
  v_mfma_f32_16x16x32_bf16 v[96:99], v[184:187], a[136:139], v[96:99]
  ds_read_b64_tr_b16 v[202:203], v22 offset:12800
  v_mfma_f32_16x16x32_bf16 v[96:99], v[180:183], a[120:123], v[96:99]
  ds_read_b64_tr_b16 v[204:205], v22 offset:16384
  v_mfma_f32_16x16x32_bf16 v[96:99], v[176:179], a[104:107], v[96:99]
  ds_read_b64_tr_b16 v[206:207], v22 offset:16896
  v_mfma_f32_16x16x32_bf16 v[104:107], v[176:179], a[108:111], v[104:107]
  ds_read_b64_tr_b16 v[176:177], v22 offset:20480
  v_mfma_f32_16x16x32_bf16 v[104:107], v[180:183], a[124:127], v[104:107]
  ds_read_b64_tr_b16 v[178:179], v22 offset:20992
  v_mfma_f32_16x16x32_bf16 v[104:107], v[184:187], a[140:143], v[104:107]
  ds_read_b64_tr_b16 v[180:181], v22 offset:12296
  s_waitcnt lgkmcnt(7)
  v_mfma_f32_16x16x32_bf16 v[100:103], v[196:199], a[136:139], v[100:103]
  ds_read_b64_tr_b16 v[182:183], v22 offset:12808
  v_mfma_f32_16x16x32_bf16 v[100:103], v[192:195], a[120:123], v[100:103]
  ds_read_b64_tr_b16 v[184:185], v22 offset:16392
  v_mfma_f32_16x16x32_bf16 v[100:103], v[188:191], a[104:107], v[100:103]
  ds_read_b64_tr_b16 v[186:187], v22 offset:16904
  v_mfma_f32_16x16x32_bf16 v[108:111], v[188:191], a[108:111], v[108:111]
  ds_read_b64_tr_b16 v[188:189], v22 offset:20488
  v_mfma_f32_16x16x32_bf16 v[108:111], v[192:195], a[124:127], v[108:111]
  ds_read_b64_tr_b16 v[190:191], v22 offset:21000
  v_add_u32 v22, 4294885376, v22
  v_mfma_f32_16x16x32_bf16 v[108:111], v[196:199], a[140:143], v[108:111]
  ds_read_b64_tr_b16 v[192:193], v22 offset:0
  s_waitcnt lgkmcnt(7)
  v_mfma_f32_16x16x32_bf16 v[96:99], v[176:179], a[184:187], v[96:99]
  ds_read_b64_tr_b16 v[194:195], v22 offset:512
  v_mfma_f32_16x16x32_bf16 v[96:99], v[204:207], a[168:171], v[96:99]
  ds_read_b64_tr_b16 v[196:197], v22 offset:4096
  s_waitcnt vmcnt(3)
  v_cmp_eq_u64 vcc, s[56:57], v[248:249]
  s_nop 1
  s_orn2_b64 vcc, vcc, s[96:97]
  s_cmp_eq_u64 vcc, -1
  s_cbranch_scc0 L_lp60s
L_ok59:
  v_mfma_f32_16x16x32_bf16 v[96:99], v[200:203], a[152:155], v[96:99]
  ds_read_b64_tr_b16 v[198:199], v22 offset:4608
  s_and_b32 s23, s17, 6
  s_add_u32 s23, s23, 6
  v_mfma_f32_16x16x32_bf16 v[104:107], v[200:203], a[156:159], v[104:107]
  ds_read_b64_tr_b16 v[200:201], v22 offset:8192
  s_and_b32 s23, s23, 7
  v_mfma_f32_16x16x32_bf16 v[104:107], v[204:207], a[172:175], v[104:107]
  ds_read_b64_tr_b16 v[202:203], v22 offset:8704
  s_lshl_b32 s23, s23, 13
  s_add_u32 s23, s23, s40
  v_mfma_f32_16x16x32_bf16 v[104:107], v[176:179], a[188:191], v[104:107]
  ds_read_b64_tr_b16 v[204:205], v22 offset:8
  buffer_load_dwordx4 v[144:147], v1, s[12:15], s23 offen offset:0 sc1
  s_waitcnt lgkmcnt(7)
  v_mfma_f32_16x16x32_bf16 v[100:103], v[188:191], a[184:187], v[100:103]
  ds_read_b64_tr_b16 v[206:207], v22 offset:520
  buffer_load_dwordx4 v[148:151], v1, s[12:15], s23 offen offset:1024 sc1
  v_mfma_f32_16x16x32_bf16 v[100:103], v[184:187], a[168:171], v[100:103]
  ds_read_b64_tr_b16 v[176:177], v22 offset:4104
  s_and_b32 s23, s17, 6
  s_add_u32 s23, s23, 7
  v_mfma_f32_16x16x32_bf16 v[100:103], v[180:183], a[152:155], v[100:103]
  ds_read_b64_tr_b16 v[178:179], v22 offset:4616
  s_and_b32 s23, s23, 7
  v_mfma_f32_16x16x32_bf16 v[108:111], v[180:183], a[156:159], v[108:111]
  ds_read_b64_tr_b16 v[180:181], v22 offset:8200
  s_lshl_b32 s23, s23, 13
  s_add_u32 s23, s23, s40
  v_mfma_f32_16x16x32_bf16 v[108:111], v[184:187], a[172:175], v[108:111]
  ds_read_b64_tr_b16 v[182:183], v22 offset:8712
  buffer_load_dwordx4 v[152:155], v1, s[12:15], s23 offen offset:0 sc1
  v_mfma_f32_16x16x32_bf16 v[108:111], v[188:191], a[188:191], v[108:111]
  ds_read_b64_tr_b16 v[184:185], v22 offset:12288
  buffer_load_dwordx4 v[156:159], v1, s[12:15], s23 offen offset:1024 sc1
  s_and_b32 s23, s17, 6
  s_waitcnt lgkmcnt(7)
  v_mfma_f32_16x16x32_bf16 v[96:99], v[200:203], a[232:235], v[96:99]
  ds_read_b64_tr_b16 v[186:187], v22 offset:12800
  s_add_u32 s23, s23, 4
  v_mfma_f32_16x16x32_bf16 v[96:99], v[196:199], a[216:219], v[96:99]
  ds_read_b64_tr_b16 v[188:189], v22 offset:16384
  s_and_b32 s23, s23, 7
  v_mfma_f32_16x16x32_bf16 v[96:99], v[192:195], a[200:203], v[96:99]
  ds_read_b64_tr_b16 v[190:191], v22 offset:16896
  s_lshl_b32 s23, s23, 13
  s_add_u32 s23, s23, s40
  v_mfma_f32_16x16x32_bf16 v[104:107], v[192:195], a[204:207], v[104:107]
  ds_read_b64_tr_b16 v[192:193], v22 offset:20480
  buffer_load_dwordx4 v[160:163], v1, s[12:15], s23 offen offset:0 sc1
  v_mfma_f32_16x16x32_bf16 v[104:107], v[196:199], a[220:223], v[104:107]
  ds_read_b64_tr_b16 v[194:195], v22 offset:20992
  buffer_load_dwordx4 v[164:167], v1, s[12:15], s23 offen offset:1024 sc1
  s_and_b32 s23, s17, 6
  v_mfma_f32_16x16x32_bf16 v[104:107], v[200:203], a[236:239], v[104:107]
  ds_read_b64_tr_b16 v[196:197], v22 offset:12296
  s_add_u32 s23, s23, 5
  s_waitcnt lgkmcnt(7)
  v_mfma_f32_16x16x32_bf16 v[100:103], v[180:183], a[232:235], v[100:103]
  ds_read_b64_tr_b16 v[198:199], v22 offset:12808
  s_and_b32 s23, s23, 7
  v_mfma_f32_16x16x32_bf16 v[100:103], v[176:179], a[216:219], v[100:103]
  ds_read_b64_tr_b16 v[200:201], v22 offset:16392
  s_lshl_b32 s23, s23, 13
  s_add_u32 s23, s23, s40
  v_mfma_f32_16x16x32_bf16 v[100:103], v[204:207], a[200:203], v[100:103]
  ds_read_b64_tr_b16 v[202:203], v22 offset:16904
  v_mfma_f32_16x16x32_bf16 v[108:111], v[204:207], a[204:207], v[108:111]
  ds_read_b64_tr_b16 v[204:205], v22 offset:20488
  v_mfma_f32_16x16x32_bf16 v[108:111], v[176:179], a[220:223], v[108:111]
  ds_read_b64_tr_b16 v[206:207], v22 offset:21000
  v_mfma_f32_16x16x32_bf16 v[108:111], v[180:183], a[236:239], v[108:111]
  buffer_load_dwordx4 v[168:171], v1, s[12:15], s23 offen offset:0 sc1
  s_waitcnt lgkmcnt(6)
  v_mfma_f32_16x16x32_bf16 v[96:99], v[192:195], v[232:235], v[96:99]
  buffer_load_dwordx4 v[172:175], v1, s[12:15], s23 offen offset:1024 sc1
  v_mfma_f32_16x16x32_bf16 v[96:99], v[188:191], v[216:219], v[96:99]
  s_waitcnt vmcnt(10)
  v_cmp_eq_u64 vcc, s[56:57], v[244:245]
  s_nop 1
  s_orn2_b64 vcc, vcc, s[46:47]
  s_cmp_eq_u64 vcc, -1
  s_cbranch_scc0 L_lp62s
L_ok61:
  v_mfma_f32_16x16x32_bf16 v[96:99], v[184:187], a[248:251], v[96:99]
  buffer_load_dwordx4 v[112:115], v246, s[12:15], s11 offen sc1
  s_add_u32 s11, s11, 32768
  v_mfma_f32_16x16x32_bf16 v[104:107], v[184:187], a[252:255], v[104:107]
  buffer_load_dwordx4 v[116:119], v246, s[12:15], s11 offen sc1
  s_add_u32 s11, s11, 32768
  s_and_b32 s23, s17, 6
  s_add_u32 s23, s23, 2
  v_mfma_f32_16x16x32_bf16 v[104:107], v[188:191], v[220:223], v[104:107]
  s_and_b32 s23, s23, 7
  s_lshl_b32 s23, s23, 13
  v_mfma_f32_16x16x32_bf16 v[104:107], v[192:195], v[236:239], v[104:107]
  s_add_u32 s23, s23, s40
  buffer_load_dwordx4 v[56:59], v1, s[12:15], s23 offen offset:0 sc1
  s_waitcnt lgkmcnt(0)
  v_mfma_f32_16x16x32_bf16 v[100:103], v[204:207], v[232:235], v[100:103]
  buffer_load_dwordx4 v[60:63], v1, s[12:15], s23 offen offset:1024 sc1
  s_and_b32 s23, s17, 6
  s_add_u32 s23, s23, 3
  v_mfma_f32_16x16x32_bf16 v[100:103], v[200:203], v[216:219], v[100:103]
  s_and_b32 s23, s23, 7
  s_lshl_b32 s23, s23, 13
  v_mfma_f32_16x16x32_bf16 v[100:103], v[196:199], a[248:251], v[100:103]
  s_add_u32 s23, s23, s40
  buffer_load_dwordx4 v[64:67], v1, s[12:15], s23 offen offset:0 sc1
  v_mfma_f32_16x16x32_bf16 v[108:111], v[196:199], a[252:255], v[108:111]
  buffer_load_dwordx4 v[68:71], v1, s[12:15], s23 offen offset:1024 sc1
  v_mfma_f32_16x16x32_bf16 v[108:111], v[200:203], v[220:223], v[108:111]
  v_mfma_f32_16x16x32_bf16 v[108:111], v[204:207], v[236:239], v[108:111]
  s_xor_b32 s23, s17, 1
  s_lshl_b32 s23, s23, 13
  s_add_u32 s23, s23, s40
  buffer_load_dwordx4 v[48:51], v1, s[12:15], s23 offen offset:0 sc1
  buffer_load_dwordx4 v[52:55], v1, s[12:15], s23 offen offset:1024 sc1
  s_waitcnt vmcnt(14)
  v_dot2c_f32_bf16 v128, s100, v144
  v_dot2c_f32_bf16 v129, s101, v144
  v_dot2c_f32_bf16 v130, s100, v145
  v_dot2c_f32_bf16 v131, s101, v145
  v_dot2c_f32_bf16 v132, s100, v146
  v_dot2c_f32_bf16 v133, s101, v146
  v_dot2c_f32_bf16 v134, s100, v147
  v_dot2c_f32_bf16 v135, s101, v147
  v_dot2c_f32_bf16 v136, s100, v148
  v_dot2c_f32_bf16 v137, s101, v148
  v_dot2c_f32_bf16 v138, s100, v149
  v_dot2c_f32_bf16 v139, s101, v149
  v_dot2c_f32_bf16 v140, s100, v150
  v_dot2c_f32_bf16 v141, s101, v150
  v_dot2c_f32_bf16 v142, s100, v151
  v_dot2c_f32_bf16 v143, s101, v151
  s_waitcnt vmcnt(12)
  v_dot2c_f32_bf16 v128, s100, v152
  v_dot2c_f32_bf16 v129, s101, v152
  v_dot2c_f32_bf16 v130, s100, v153
  v_dot2c_f32_bf16 v131, s101, v153
  v_dot2c_f32_bf16 v132, s100, v154
  v_dot2c_f32_bf16 v133, s101, v154
  v_dot2c_f32_bf16 v134, s100, v155
  v_dot2c_f32_bf16 v135, s101, v155
  v_dot2c_f32_bf16 v136, s100, v156
  v_dot2c_f32_bf16 v137, s101, v156
  v_dot2c_f32_bf16 v138, s100, v157
  v_dot2c_f32_bf16 v139, s101, v157
  v_dot2c_f32_bf16 v140, s100, v158
  v_dot2c_f32_bf16 v141, s101, v158
  v_dot2c_f32_bf16 v142, s100, v159
  v_dot2c_f32_bf16 v143, s101, v159
  s_waitcnt vmcnt(10)
  v_dot2c_f32_bf16 v128, s100, v160
  v_dot2c_f32_bf16 v129, s101, v160
  v_dot2c_f32_bf16 v130, s100, v161
  v_dot2c_f32_bf16 v131, s101, v161
  v_dot2c_f32_bf16 v132, s100, v162
  v_dot2c_f32_bf16 v133, s101, v162
  v_dot2c_f32_bf16 v134, s100, v163
  v_dot2c_f32_bf16 v135, s101, v163
  v_dot2c_f32_bf16 v136, s100, v164
  v_dot2c_f32_bf16 v137, s101, v164
  v_dot2c_f32_bf16 v138, s100, v165
  v_dot2c_f32_bf16 v139, s101, v165
  v_dot2c_f32_bf16 v140, s100, v166
  v_dot2c_f32_bf16 v141, s101, v166
  v_dot2c_f32_bf16 v142, s100, v167
  v_dot2c_f32_bf16 v143, s101, v167
  s_waitcnt vmcnt(8)
  v_dot2c_f32_bf16 v128, s100, v168
  v_dot2c_f32_bf16 v129, s101, v168
  v_dot2c_f32_bf16 v130, s100, v169
  v_dot2c_f32_bf16 v131, s101, v169
  v_dot2c_f32_bf16 v132, s100, v170
  v_dot2c_f32_bf16 v133, s101, v170
  v_dot2c_f32_bf16 v134, s100, v171
  v_dot2c_f32_bf16 v135, s101, v171
  v_dot2c_f32_bf16 v136, s100, v172
  v_dot2c_f32_bf16 v137, s101, v172
  v_dot2c_f32_bf16 v138, s100, v173
  v_dot2c_f32_bf16 v139, s101, v173
  v_dot2c_f32_bf16 v140, s100, v174
  v_dot2c_f32_bf16 v141, s101, v174
  v_dot2c_f32_bf16 v142, s100, v175
  v_dot2c_f32_bf16 v143, s101, v175
  s_waitcnt vmcnt(6)
  v_dot2c_f32_bf16 v120, s100, v112
  v_dot2c_f32_bf16 v121, s101, v112
  v_dot2c_f32_bf16 v122, s100, v113
  v_dot2c_f32_bf16 v123, s101, v113
  v_dot2c_f32_bf16 v124, s100, v114
  v_dot2c_f32_bf16 v125, s101, v114
  v_dot2c_f32_bf16 v126, s100, v115
  v_dot2c_f32_bf16 v127, s101, v115
  v_dot2c_f32_bf16 v120, s100, v116
  v_dot2c_f32_bf16 v121, s101, v116
  v_dot2c_f32_bf16 v122, s100, v117
  v_dot2c_f32_bf16 v123, s101, v117
  v_dot2c_f32_bf16 v124, s100, v118
  v_dot2c_f32_bf16 v125, s101, v118
  v_dot2c_f32_bf16 v126, s100, v119
  v_dot2c_f32_bf16 v127, s101, v119
  v_add_f32 v128, v128, v96
  v_add_f32 v129, v129, v97
  v_add_f32 v130, v130, v98
  v_add_f32 v131, v131, v99
  v_add_f32 v132, v132, v100
  v_add_f32 v133, v133, v101
  v_add_f32 v134, v134, v102
  v_add_f32 v135, v135, v103
  v_add_f32 v136, v136, v104
  v_add_f32 v137, v137, v105
  v_add_f32 v138, v138, v106
  v_add_f32 v139, v139, v107
  v_add_f32 v140, v140, v108
  v_add_f32 v141, v141, v109
  v_add_f32 v142, v142, v110
  v_add_f32 v143, v143, v111
  v_permlane32_swap_b32 v120, v124
  v_permlane32_swap_b32 v121, v125
  v_permlane32_swap_b32 v122, v126
  v_permlane32_swap_b32 v123, v127
  v_add_f32 v120, v120, v124
  v_add_f32 v121, v121, v125
  v_add_f32 v122, v122, v126
  v_add_f32 v123, v123, v127
  s_nop 1
  v_permlane16_swap_b32 v120, v122
  v_permlane16_swap_b32 v121, v123
  s_nop 1
  v_add_f32 v14, v14, v120
  v_add_f32 v15, v15, v121
  v_add_f32 v14, v14, v122
  v_add_f32 v15, v15, v123
  v_cvt_pk_bf16_f32 v13, v14, v15
  buffer_store_dword v13, v3, s[32:35], s53 offen
  s_add_u32 s53, s52, 1179648
  s_waitcnt vmcnt(1)
  v_max3_u32 v24, v48, v49, v50
  v_max3_u32 v25, v51, v52, v53
  v_max3_u32 v24, v24, v54, v55
  v_max3_u32 v25, v25, v56, v57
  v_max3_u32 v24, v24, v58, v59
  v_max3_u32 v25, v25, v60, v61
  v_max3_u32 v24, v24, v62, v63
  v_max3_u32 v25, v25, v64, v65
  v_max3_u32 v24, v24, v66, v67
  v_max3_u32 v25, v25, v68, v69
  v_max3_u32 v24, v24, v70, v71
  v_max_u32 v24, v24, v25
  v_cmp_eq_u32 vcc, -1, v24
  s_nop 1
  s_cmp_eq_u64 vcc, 0
  s_cbranch_scc1 L_ok63
L_lp64s:
  s_mov_b32 s59, 50000
L_lp64:
  s_and_b32 s23, s17, 6
  s_add_u32 s23, s23, 2
  s_and_b32 s23, s23, 7
  s_lshl_b32 s23, s23, 13
  s_add_u32 s23, s23, s40
  buffer_load_dwordx4 v[56:59], v1, s[12:15], s23 offen offset:0 sc1
  buffer_load_dwordx4 v[60:63], v1, s[12:15], s23 offen offset:1024 sc1
  s_and_b32 s23, s17, 6
  s_add_u32 s23, s23, 3
  s_and_b32 s23, s23, 7
  s_lshl_b32 s23, s23, 13
  s_add_u32 s23, s23, s40
  buffer_load_dwordx4 v[64:67], v1, s[12:15], s23 offen offset:0 sc1
  buffer_load_dwordx4 v[68:71], v1, s[12:15], s23 offen offset:1024 sc1
  s_xor_b32 s23, s17, 1
  s_lshl_b32 s23, s23, 13
  s_add_u32 s23, s23, s40
  buffer_load_dwordx4 v[48:51], v1, s[12:15], s23 offen offset:0 sc1
  buffer_load_dwordx4 v[52:55], v1, s[12:15], s23 offen offset:1024 sc1
  s_waitcnt vmcnt(0)
  s_sub_u32 s59, s59, 1
  s_cbranch_scc1 L_ok63
  v_max3_u32 v24, v48, v49, v50
  v_max3_u32 v25, v51, v52, v53
  v_max3_u32 v24, v24, v54, v55
  v_max3_u32 v25, v25, v56, v57
  v_max3_u32 v24, v24, v58, v59
  v_max3_u32 v25, v25, v60, v61
  v_max3_u32 v24, v24, v62, v63
  v_max3_u32 v25, v25, v64, v65
  v_max3_u32 v24, v24, v66, v67
  v_max3_u32 v25, v25, v68, v69
  v_max3_u32 v24, v24, v70, v71
  v_max_u32 v24, v24, v25
  v_cmp_eq_u32 vcc, -1, v24
  s_nop 1
  s_cmp_eq_u64 vcc, 0
  s_cbranch_scc0 L_lp64
L_ok63:
  v_dot2c_f32_bf16 v128, s100, v48
  v_dot2c_f32_bf16 v129, s101, v48
  v_dot2c_f32_bf16 v130, s100, v49
  v_dot2c_f32_bf16 v131, s101, v49
  v_dot2c_f32_bf16 v132, s100, v50
  v_dot2c_f32_bf16 v133, s101, v50
  v_dot2c_f32_bf16 v134, s100, v51
  v_dot2c_f32_bf16 v135, s101, v51
  v_dot2c_f32_bf16 v128, s100, v56
  v_dot2c_f32_bf16 v129, s101, v56
  v_dot2c_f32_bf16 v130, s100, v57
  v_dot2c_f32_bf16 v131, s101, v57
  v_dot2c_f32_bf16 v132, s100, v58
  v_dot2c_f32_bf16 v133, s101, v58
  v_dot2c_f32_bf16 v134, s100, v59
  v_dot2c_f32_bf16 v135, s101, v59
  v_dot2c_f32_bf16 v128, s100, v64
  v_dot2c_f32_bf16 v129, s101, v64
  v_dot2c_f32_bf16 v130, s100, v65
  v_dot2c_f32_bf16 v131, s101, v65
  v_dot2c_f32_bf16 v132, s100, v66
  v_dot2c_f32_bf16 v133, s101, v66
  v_dot2c_f32_bf16 v134, s100, v67
  v_dot2c_f32_bf16 v135, s101, v67
  v_dot2c_f32_bf16 v136, s100, v52
  v_dot2c_f32_bf16 v137, s101, v52
  v_dot2c_f32_bf16 v138, s100, v53
  v_dot2c_f32_bf16 v139, s101, v53
  v_dot2c_f32_bf16 v140, s100, v54
  v_dot2c_f32_bf16 v141, s101, v54
  v_dot2c_f32_bf16 v142, s100, v55
  v_dot2c_f32_bf16 v143, s101, v55
  v_dot2c_f32_bf16 v136, s100, v60
  v_dot2c_f32_bf16 v137, s101, v60
  v_dot2c_f32_bf16 v138, s100, v61
  v_dot2c_f32_bf16 v139, s101, v61
  v_dot2c_f32_bf16 v140, s100, v62
  v_dot2c_f32_bf16 v141, s101, v62
  v_dot2c_f32_bf16 v142, s100, v63
  v_dot2c_f32_bf16 v143, s101, v63
  v_dot2c_f32_bf16 v136, s100, v68
  v_dot2c_f32_bf16 v137, s101, v68
  v_dot2c_f32_bf16 v138, s100, v69
  v_dot2c_f32_bf16 v139, s101, v69
  v_dot2c_f32_bf16 v140, s100, v70
  v_dot2c_f32_bf16 v141, s101, v70
  v_dot2c_f32_bf16 v142, s100, v71
  v_dot2c_f32_bf16 v143, s101, v71
  v_cvt_pk_bf16_f32 v40, v128, v129
  v_cvt_pk_bf16_f32 v41, v130, v131
  v_cvt_pk_bf16_f32 v42, v132, v133
  v_cvt_pk_bf16_f32 v43, v134, v135
  buffer_store_dwordx4 v[40:43], v2, s[32:35], s52 offen
  s_nop 0
  v_cvt_pk_bf16_f32 v44, v136, v137
  v_cvt_pk_bf16_f32 v45, v138, v139
  v_cvt_pk_bf16_f32 v46, v140, v141
  v_cvt_pk_bf16_f32 v47, v142, v143
  buffer_store_dwordx4 v[44:47], v2, s[32:35], s53 offen
L_end:
  s_endpgm
L_lp22s:
  s_mov_b32 s59, 50000
L_lp22:
  s_sleep 8
  buffer_load_dwordx2 v[240:241], v250, s[12:15], s27 offen sc1
  s_waitcnt vmcnt(0)
  s_sub_u32 s59, s59, 1
  s_cbranch_scc1 L_ok21
  v_cmp_eq_u64 vcc, s[56:57], v[240:241]
  s_nop 1
  s_cmp_eq_u64 vcc, -1
  s_cbranch_scc0 L_lp22
  s_branch L_ok21
L_lp30s:
  s_mov_b32 s59, 50000
L_lp30:
  s_sleep 8
  s_mov_b64 exec, s[20:21]
  buffer_load_dwordx2 v[248:249], v250, s[12:15], s23 offen sc1
  s_mov_b64 exec, -1
  s_waitcnt vmcnt(0)
  s_sub_u32 s59, s59, 1
  s_cbranch_scc1 L_ok29
  v_cmp_eq_u64 vcc, s[56:57], v[248:249]
  s_nop 1
  s_orn2_b64 vcc, vcc, s[20:21]
  s_cmp_eq_u64 vcc, -1
  s_cbranch_scc0 L_lp30
  s_branch L_ok29
L_lp34s:
  s_mov_b32 s59, 50000
L_lp34:
  s_sleep 8
  buffer_load_dwordx2 v[248:249], v250, s[12:15], s23 offen sc1
  s_waitcnt vmcnt(0)
  s_sub_u32 s59, s59, 1
  s_cbranch_scc1 L_ok33
  v_cmp_eq_u64 vcc, s[56:57], v[248:249]
  s_nop 1
  s_cmp_eq_u64 vcc, -1
  s_cbranch_scc0 L_lp34
  s_branch L_ok33
L_lp36s:
  s_mov_b32 s59, 50000
L_lp36:
  s_sleep 4
  s_mov_b64 exec, s[100:101]
  buffer_load_dwordx2 v[248:249], v250, s[12:15], s23 offen sc1
  s_mov_b64 exec, -1
  s_waitcnt vmcnt(0)
  s_sub_u32 s59, s59, 1
  s_cbranch_scc1 L_ok35
  v_cmp_eq_u64 vcc, s[56:57], v[248:249]
  s_nop 1
  s_orn2_b64 vcc, vcc, s[100:101]
  s_cmp_eq_u64 vcc, -1
  s_cbranch_scc0 L_lp36
  s_branch L_ok35
L_lp40s:
  s_mov_b32 s59, 50000
L_lp40:
  s_add_u32 m0, s22, 24576
  s_add_u32 s24, s30, 12288
  buffer_load_dwordx4 v1, s[12:15], s24 offen offset:0 sc1 lds
  buffer_load_dwordx4 v1, s[12:15], s24 offen offset:1024 sc1 lds
  buffer_load_dwordx4 v1, s[12:15], s24 offen offset:2048 sc1 lds
  s_add_u32 m0, s22, 36864
  s_add_u32 s24, s30, 86016
  buffer_load_dwordx4 v1, s[12:15], s24 offen offset:0 sc1 lds
  buffer_load_dwordx4 v1, s[12:15], s24 offen offset:1024 sc1 lds
  buffer_load_dwordx4 v1, s[12:15], s24 offen offset:2048 sc1 lds
  s_waitcnt vmcnt(0)
  ds_read_b128 v[112:115], v247 offset:24576
  ds_read_b128 v[116:119], v247 offset:25600
  ds_read_b128 v[120:123], v247 offset:26624
  ds_read_b128 v[124:127], v247 offset:36864
  ds_read_b128 v[128:131], v247 offset:37888
  ds_read_b128 v[132:135], v247 offset:38912
  s_waitcnt lgkmcnt(0)
  s_sub_u32 s59, s59, 1
  s_cbranch_scc1 L_ok39
  v_max3_u32 v136, v112, v113, v114
  v_max3_u32 v137, v115, v116, v117
  v_max3_u32 v136, v136, v118, v119
  v_max3_u32 v137, v137, v120, v121
  v_max3_u32 v136, v136, v122, v123
  v_max3_u32 v137, v137, v124, v125
  v_max3_u32 v136, v136, v126, v127
  v_max3_u32 v137, v137, v128, v129
  v_max3_u32 v136, v136, v130, v131
  v_max3_u32 v137, v137, v132, v133
  v_max3_u32 v136, v136, v134, v135
  v_max_u32 v136, v136, v137
  v_cmp_eq_u32 vcc, -1, v136
  s_nop 1
  s_cmp_eq_u64 vcc, 0
  s_cbranch_scc0 L_lp40
  s_branch L_ok39
L_lp42s:
  s_mov_b32 s59, 50000
L_lp42:
  s_add_u32 m0, s22, 49152
  s_add_u32 s24, s30, 24576
  buffer_load_dwordx4 v1, s[12:15], s24 offen offset:0 sc1 lds
  buffer_load_dwordx4 v1, s[12:15], s24 offen offset:1024 sc1 lds
  buffer_load_dwordx4 v1, s[12:15], s24 offen offset:2048 sc1 lds
  s_add_u32 m0, s22, 61440
  s_add_u32 s24, s30, 98304
  buffer_load_dwordx4 v1, s[12:15], s24 offen offset:0 sc1 lds
  buffer_load_dwordx4 v1, s[12:15], s24 offen offset:1024 sc1 lds
  buffer_load_dwordx4 v1, s[12:15], s24 offen offset:2048 sc1 lds
  s_waitcnt vmcnt(0)
  ds_read_b128 v[112:115], v247 offset:49152
  ds_read_b128 v[116:119], v247 offset:50176
  ds_read_b128 v[120:123], v247 offset:51200
  ds_read_b128 v[124:127], v247 offset:61440
  ds_read_b128 v[128:131], v247 offset:62464
  ds_read_b128 v[132:135], v247 offset:63488
  s_waitcnt lgkmcnt(0)
  s_sub_u32 s59, s59, 1
  s_cbranch_scc1 L_ok41
  v_max3_u32 v136, v112, v113, v114
  v_max3_u32 v137, v115, v116, v117
  v_max3_u32 v136, v136, v118, v119
  v_max3_u32 v137, v137, v120, v121
  v_max3_u32 v136, v136, v122, v123
  v_max3_u32 v137, v137, v124, v125
  v_max3_u32 v136, v136, v126, v127
  v_max3_u32 v137, v137, v128, v129
  v_max3_u32 v136, v136, v130, v131
  v_max3_u32 v137, v137, v132, v133
  v_max3_u32 v136, v136, v134, v135
  v_max_u32 v136, v136, v137
  v_cmp_eq_u32 vcc, -1, v136
  s_nop 1
  s_cmp_eq_u64 vcc, 0
  s_cbranch_scc0 L_lp42
  s_branch L_ok41
L_lp44s:
  s_mov_b32 s59, 50000
L_lp44:
  s_add_u32 m0, s22, 0
  s_add_u32 s24, s30, 36864
  buffer_load_dwordx4 v1, s[12:15], s24 offen offset:0 sc1 lds
  buffer_load_dwordx4 v1, s[12:15], s24 offen offset:1024 sc1 lds
  buffer_load_dwordx4 v1, s[12:15], s24 offen offset:2048 sc1 lds
  s_add_u32 m0, s22, 12288
  s_add_u32 s24, s30, 110592
  buffer_load_dwordx4 v1, s[12:15], s24 offen offset:0 sc1 lds
  buffer_load_dwordx4 v1, s[12:15], s24 offen offset:1024 sc1 lds
  buffer_load_dwordx4 v1, s[12:15], s24 offen offset:2048 sc1 lds
  s_waitcnt vmcnt(0)
  ds_read_b128 v[112:115], v247 offset:0
  ds_read_b128 v[116:119], v247 offset:1024
  ds_read_b128 v[120:123], v247 offset:2048
  ds_read_b128 v[124:127], v247 offset:12288
  ds_read_b128 v[128:131], v247 offset:13312
  ds_read_b128 v[132:135], v247 offset:14336
  s_waitcnt lgkmcnt(0)
  s_sub_u32 s59, s59, 1
  s_cbranch_scc1 L_ok43
  v_max3_u32 v136, v112, v113, v114
  v_max3_u32 v137, v115, v116, v117
  v_max3_u32 v136, v136, v118, v119
  v_max3_u32 v137, v137, v120, v121
  v_max3_u32 v136, v136, v122, v123
  v_max3_u32 v137, v137, v124, v125
  v_max3_u32 v136, v136, v126, v127
  v_max3_u32 v137, v137, v128, v129
  v_max3_u32 v136, v136, v130, v131
  v_max3_u32 v137, v137, v132, v133
  v_max3_u32 v136, v136, v134, v135
  v_max_u32 v136, v136, v137
  v_cmp_eq_u32 vcc, -1, v136
  s_nop 1
  s_cmp_eq_u64 vcc, 0
  s_cbranch_scc0 L_lp44
  s_branch L_ok43
L_lp46s:
  s_mov_b32 s59, 50000
L_lp46:
  s_add_u32 m0, s22, 24576
  s_add_u32 s24, s30, 49152
  buffer_load_dwordx4 v1, s[12:15], s24 offen offset:0 sc1 lds
  buffer_load_dwordx4 v1, s[12:15], s24 offen offset:1024 sc1 lds
  buffer_load_dwordx4 v1, s[12:15], s24 offen offset:2048 sc1 lds
  s_add_u32 m0, s22, 36864
  s_add_u32 s24, s30, 122880
  buffer_load_dwordx4 v1, s[12:15], s24 offen offset:0 sc1 lds
  buffer_load_dwordx4 v1, s[12:15], s24 offen offset:1024 sc1 lds
  buffer_load_dwordx4 v1, s[12:15], s24 offen offset:2048 sc1 lds
  s_waitcnt vmcnt(0)
  ds_read_b128 v[112:115], v247 offset:24576
  ds_read_b128 v[116:119], v247 offset:25600
  ds_read_b128 v[120:123], v247 offset:26624
  ds_read_b128 v[124:127], v247 offset:36864
  ds_read_b128 v[128:131], v247 offset:37888
  ds_read_b128 v[132:135], v247 offset:38912
  s_waitcnt lgkmcnt(0)
  s_sub_u32 s59, s59, 1
  s_cbranch_scc1 L_ok45
  v_max3_u32 v136, v112, v113, v114
  v_max3_u32 v137, v115, v116, v117
  v_max3_u32 v136, v136, v118, v119
  v_max3_u32 v137, v137, v120, v121
  v_max3_u32 v136, v136, v122, v123
  v_max3_u32 v137, v137, v124, v125
  v_max3_u32 v136, v136, v126, v127
  v_max3_u32 v137, v137, v128, v129
  v_max3_u32 v136, v136, v130, v131
  v_max3_u32 v137, v137, v132, v133
  v_max3_u32 v136, v136, v134, v135
  v_max_u32 v136, v136, v137
  v_cmp_eq_u32 vcc, -1, v136
  s_nop 1
  s_cmp_eq_u64 vcc, 0
  s_cbranch_scc0 L_lp46
  s_branch L_ok45
L_lp48s:
  s_mov_b32 s59, 50000
L_lp48:
  s_sleep 2
  s_mov_b64 exec, s[96:97]
  buffer_load_dwordx2 v[248:249], v250, s[12:15], s26 offen sc1
  s_mov_b64 exec, -1
  s_waitcnt vmcnt(0)
  s_sub_u32 s59, s59, 1
  s_cbranch_scc1 L_ok47
  v_cmp_eq_u64 vcc, s[56:57], v[248:249]
  s_nop 1
  s_orn2_b64 vcc, vcc, s[96:97]
  s_cmp_eq_u64 vcc, -1
  s_cbranch_scc0 L_lp48
  s_branch L_ok47
L_lp50s:
  s_mov_b32 s59, 50000
L_lp50:
  s_add_u32 m0, s22, 49152
  s_add_u32 s24, s30, 61440
  buffer_load_dwordx4 v1, s[12:15], s24 offen offset:0 sc1 lds
  buffer_load_dwordx4 v1, s[12:15], s24 offen offset:1024 sc1 lds
  buffer_load_dwordx4 v1, s[12:15], s24 offen offset:2048 sc1 lds
  s_add_u32 m0, s22, 61440
  s_add_u32 s24, s30, 135168
  buffer_load_dwordx4 v1, s[12:15], s24 offen offset:0 sc1 lds
  buffer_load_dwordx4 v1, s[12:15], s24 offen offset:1024 sc1 lds
  buffer_load_dwordx4 v1, s[12:15], s24 offen offset:2048 sc1 lds
  s_waitcnt vmcnt(0)
  ds_read_b128 v[112:115], v247 offset:49152
  ds_read_b128 v[116:119], v247 offset:50176
  ds_read_b128 v[120:123], v247 offset:51200
  ds_read_b128 v[124:127], v247 offset:61440
  ds_read_b128 v[128:131], v247 offset:62464
  ds_read_b128 v[132:135], v247 offset:63488
  s_waitcnt lgkmcnt(0)
  s_sub_u32 s59, s59, 1
  s_cbranch_scc1 L_ok49
  v_max3_u32 v136, v112, v113, v114
  v_max3_u32 v137, v115, v116, v117
  v_max3_u32 v136, v136, v118, v119
  v_max3_u32 v137, v137, v120, v121
  v_max3_u32 v136, v136, v122, v123
  v_max3_u32 v137, v137, v124, v125
  v_max3_u32 v136, v136, v126, v127
  v_max3_u32 v137, v137, v128, v129
  v_max3_u32 v136, v136, v130, v131
  v_max3_u32 v137, v137, v132, v133
  v_max3_u32 v136, v136, v134, v135
  v_max_u32 v136, v136, v137
  v_cmp_eq_u32 vcc, -1, v136
  s_nop 1
  s_cmp_eq_u64 vcc, 0
  s_cbranch_scc0 L_lp50
  s_branch L_ok49
L_lp52s:
  s_mov_b32 s59, 50000
L_lp52:
  s_sleep 1
  s_mov_b64 exec, s[98:99]
  buffer_load_dwordx2 v[248:249], v250, s[12:15], s26 offen sc1
  s_mov_b64 exec, -1
  s_waitcnt vmcnt(0)
  s_sub_u32 s59, s59, 1
  s_cbranch_scc1 L_ok51
  v_cmp_eq_u64 vcc, s[56:57], v[248:249]
  s_nop 1
  s_orn2_b64 vcc, vcc, s[98:99]
  s_cmp_eq_u64 vcc, -1
  s_cbranch_scc0 L_lp52
  s_branch L_ok51
L_lp54s:
  s_mov_b32 s59, 50000
L_lp54:
  s_sleep 1
  s_mov_b64 exec, s[98:99]
  buffer_load_dwordx2 v[248:249], v250, s[12:15], s26 offen sc1
  s_mov_b64 exec, -1
  s_waitcnt vmcnt(0)
  s_sub_u32 s59, s59, 1
  s_cbranch_scc1 L_ok53
  v_cmp_eq_u64 vcc, s[56:57], v[248:249]
  s_nop 1
  s_orn2_b64 vcc, vcc, s[98:99]
  s_cmp_eq_u64 vcc, -1
  s_cbranch_scc0 L_lp54
  s_branch L_ok53
L_lp56s:
  s_mov_b32 s59, 50000
L_lp56:
L_pad11:
  s_cbranch_execz L_pad12
  s_sleep 1
  s_mov_b64 exec, s[98:99]
  buffer_load_dwordx2 v[248:249], v250, s[12:15], s26 offen sc1
  s_mov_b64 exec, -1
  s_waitcnt vmcnt(0)
  s_sub_u32 s59, s59, 1
  s_cbranch_scc1 L_ok55
  v_cmp_eq_u64 vcc, s[56:57], v[248:249]
  s_nop 1
  s_orn2_b64 vcc, vcc, s[98:99]
  s_cmp_eq_u64 vcc, -1
  s_cbranch_scc0 L_lp56
  s_branch L_ok55
L_lp58s:
  s_mov_b32 s59, 50000
L_lp58:
  s_add_u32 s25, s11, 57344
  buffer_load_dwordx4 v[208:211], v243, s[12:15], s25 offen offset:0 sc1
  buffer_load_dwordx4 v[212:215], v243, s[12:15], s25 offen offset:256 sc1
  buffer_load_dwordx4 v[216:219], v244, s[12:15], s25 offen offset:0 sc1
  buffer_load_dwordx4 v[220:223], v244, s[12:15], s25 offen offset:256 sc1
  s_add_u32 s25, s11, 65536
  buffer_load_dwordx4 v[224:227], v243, s[12:15], s25 offen offset:0 sc1
  buffer_load_dwordx4 v[228:231], v243, s[12:15], s25 offen offset:256 sc1
  buffer_load_dwordx4 v[232:235], v244, s[12:15], s25 offen offset:0 sc1
  buffer_load_dwordx4 v[236:239], v244, s[12:15], s25 offen offset:256 sc1
  s_waitcnt vmcnt(0)
  s_sub_u32 s59, s59, 1
  s_cbranch_scc1 L_ok57
  v_max3_u32 v24, v208, v209, v210
  v_max3_u32 v25, v211, v212, v213
  v_max3_u32 v24, v24, v214, v215
  v_max3_u32 v25, v25, v216, v217
  v_max3_u32 v24, v24, v218, v219
  v_max3_u32 v25, v25, v220, v221
  v_max3_u32 v24, v24, v222, v223
  v_max3_u32 v25, v25, v224, v225
  v_max3_u32 v24, v24, v226, v227
  v_max3_u32 v25, v25, v228, v229
  v_max3_u32 v24, v24, v230, v231
  v_max3_u32 v25, v25, v232, v233
  v_max3_u32 v24, v24, v234, v235
  v_max3_u32 v25, v25, v236, v237
  v_max3_u32 v24, v24, v238, v239
  v_max_u32 v24, v24, v25
  v_cmp_eq_u32 vcc, -1, v24
  s_nop 1
  s_cmp_eq_u64 vcc, 0
  s_cbranch_scc0 L_lp58
  s_branch L_ok57
L_lp60s:
  s_mov_b32 s59, 50000
L_lp60:
  s_sleep 1
  s_mov_b64 exec, s[96:97]
  buffer_load_dwordx2 v[248:249], v250, s[12:15], s41 offen sc1
  s_mov_b64 exec, -1
  s_waitcnt vmcnt(0)
  s_sub_u32 s59, s59, 1
  s_cbranch_scc1 L_ok59
  v_cmp_eq_u64 vcc, s[56:57], v[248:249]
  s_nop 1
  s_orn2_b64 vcc, vcc, s[96:97]
  s_cmp_eq_u64 vcc, -1
  s_cbranch_scc0 L_lp60
  s_branch L_ok59
L_lp62s:
  s_mov_b32 s59, 50000
L_lp62:
  s_sleep 1
  s_mov_b64 exec, s[46:47]
  buffer_load_dwordx2 v[244:245], v250, s[12:15], s30 offen sc1
  s_mov_b64 exec, -1
  s_waitcnt vmcnt(0)
  s_sub_u32 s59, s59, 1
  s_cbranch_scc1 L_ok61
  v_cmp_eq_u64 vcc, s[56:57], v[244:245]
  s_nop 1
  s_orn2_b64 vcc, vcc, s[46:47]
  s_cmp_eq_u64 vcc, -1
  s_cbranch_scc0 L_lp62
  s_branch L_ok61
L_pad12:
  s_branch L_pad_end
L_codeend:
.section .rodata,"a"
.p2align 6
.amdhsa_kernel sequential_preLN__spectral_gfnet__geglu_ffn__prompt_kernel
  .amdhsa_next_free_vgpr 512
  .amdhsa_next_free_sgpr 102
  .amdhsa_accum_offset 256
  .amdhsa_group_segment_fixed_size 0
  .amdhsa_kernarg_size 80
  .amdhsa_user_sgpr_count 2
  .amdhsa_user_sgpr_kernarg_segment_ptr 1
  .amdhsa_system_sgpr_workgroup_id_x 1
.end_amdhsa_kernel
```
